```python
import torch

def _softmax(x, axis=-1):
    return torch.softmax(x, dim=axis)
def _gelu(x):
    return torch.nn.functional.gelu(x, approximate="tanh")
def _silu(x):
    return torch.nn.functional.silu(x)
def _sigmoid(x):
    return torch.sigmoid(x)
def _layernorm(x, axis=-1, eps=1e-5):
    m = x.mean(dim=axis, keepdim=True)
    v = x.var(dim=axis, keepdim=True, unbiased=False)
    return (x - m) / torch.sqrt(v + eps)
def _scatter_add(tgt, idx, src, axis=0):
    return tgt.clone().index_add_(axis, idx, src)
def _segment_sum(src, seg, n):
    out = torch.zeros((n,) + src.shape[1:], dtype=src.dtype)
    return out.index_add_(0, seg, src)
def _pad(x, pw):
    flat = tuple(v for pair in reversed(pw) for v in pair)
    return torch.nn.functional.pad(x, flat)

kernel_name = 'standalone__batchnorm__sampling'

def setup_inputs():

    _w = (lambda a: (lambda t: t.to(torch.bfloat16) if t.is_floating_point() else t)(torch.as_tensor(a)))
    B, S, C = 1024, 32, 576
    K = 3
    return {
        "x": _w((lambda *s: torch.randn(*s, dtype=torch.bfloat16) * 0.05)(B, S, C)),
        "w": _w((lambda *s: torch.randn(*s, dtype=torch.bfloat16) * 0.05)(K, C, C) * (1.0 / (K * C) ** 0.5)),
        "mean": _w((lambda *s: torch.randn(*s, dtype=torch.bfloat16) * 0.05)(C) * 0.1),
        "var": _w(torch.abs((lambda *s: torch.randn(*s, dtype=torch.bfloat16) * 0.05)(C)) + 0.5),
        "g": _w((lambda *s: torch.randn(*s, dtype=torch.bfloat16) * 0.05)(C) + 1.0),
        "b": _w((lambda *s: torch.randn(*s, dtype=torch.bfloat16) * 0.05)(C) * 0.1),
    }

def reference(x, w, mean, var, g, b):
    K = 3
    P = K // 2
    S = x.shape[1]
    xp = _pad(x, ((0, 0), (P, P), (0, 0)))
    y = sum(torch.einsum('bsc,cd->bsd', xp[:, k:k + S, :], w[k]) for k in range(K))
    inv_std = 1.0 / torch.sqrt(var + 1e-5)
    y = (y - mean) * (g * inv_std) + b
    return _silu(y)
```

```asm
; @launch grid=(256,1,1) block=(256,1,1) lds=163840
.amdgcn_target "amdgcn-amd-amdhsa--gfx950"
.text
.globl standalone__batchnorm__sampling_kernel
.p2align 12
.p2align 8
.type standalone__batchnorm__sampling_kernel,@function
standalone__batchnorm__sampling_kernel:
s_cmp_lt_u32 s2, 256
s_cbranch_scc1 L_go
s_endpgm
L_go:
s_load_dwordx2 s[8:9], s[0:1], 0
s_load_dwordx2 s[12:13], s[0:1], 8
s_load_dwordx2 s[80:81], s[0:1], 64
s_load_dwordx4 s[76:79], s[0:1], 48
s_load_dwordx8 s[68:75], s[0:1], 16
s_getpc_b64 s[4:5]
L_pc:
s_lshr_b32 s3, s2, 3
s_mul_i32 s3, s3, 2560
v_min_u32 v14, 19, v0
v_lshl_add_u32 v14, v14, 7, s3
v_min_u32 v14, L_codeend-L_pc-4, v14
global_load_dword v254, v14, s[4:5]
v_lshrrev_b32 v1, 6, v0
v_and_b32 v2, 63, v0
v_readfirstlane_b32 s40, v1
s_bfe_u32 s41, s2, 0x10003
s_lshr_b32 s42, s2, 4
s_and_b32 s3, s2, 7
s_lshl3_add_u32 s42, s42, s3
v_lshrrev_b32 v3, 2, v2
v_and_b32 v4, 3, v2
v_lshrrev_b32 v5, 4, v2
v_and_b32 v6, 15, v2
s_lshl2_add_u32 s6, s42, s40
s_mul_i32 s7, s6, 73728
s_mul_i32 s4, s41, 36864
s_add_u32 s44, s7, s4
s_sub_u32 s63, 36864, s4
s_add_u32 s63, s63, s7
s_add_u32 s45, s44, 18432
s_add_u32 s83, s63, 18432
s_mul_i32 s48, s40, 12288
s_add_u32 s48, s48, 114688
s_mul_i32 s43, s40, 4608
s_mul_i32 s3, s41, 640
s_mul_i32 s46, s40, 18432
s_lshl_b32 s4, s41, 6
s_add_u32 s46, s46, s4
s_bitcmp1_b32 s40, 0
s_cselect_b32 s4, 13832, 0
s_cselect_b32 s5, 9216, 0
s_add_u32 s43, s43, s4
s_sub_u32 s46, s46, s5
s_add_u32 s49, s44, s3
s_add_u32 s50, s63, s3
s_movk_i32 s7, 1152
v_lshrrev_b32 v7, 3, v2
v_mul_u32_u24 v36, 2304, v7
v_and_b32 v7, 7, v2
v_lshlrev_b32 v8, 1, v5
v_xor_b32 v7, v7, v8
v_lshl_add_u32 v36, v7, 4, v36
s_mul_i32 s4, s41, 576
v_lshrrev_b32 v7, 3, v2
v_mov_b32 v199, s4
v_mad_u32_u24 v199, v7, s7, v199
v_and_b32 v7, 4, v3
v_xor_b32 v7, v2, v7
v_and_b32 v7, 7, v7
v_lshl_add_u32 v199, v7, 4, v199
s_mov_b32 s10, 37748736
s_mov_b32 s11, 0x20000
s_mov_b32 s14, 1990656
s_mov_b32 s15, 0x20000
s_lshr_b32 s66, s2, 3
s_lshl2_add_u32 s66, s66, s40
s_lshl_b32 s66, s66, 7
s_sub_u32 m0, s48, 1152
s_waitcnt lgkmcnt(0)
buffer_load_dwordx4 v36, s[8:11], s44 offen offset:1152 lds
s_sub_u32 m0, s48, 128
v_and_b32 v10, 8, v3
buffer_load_dwordx4 v36, s[8:11], s45 offen offset:1152 lds
s_add_u32 m0, s48, 896
v_add_u32 v7, v3, v10
buffer_load_dwordx4 v36, s[8:11], s63 offen offset:1152 lds
s_add_u32 m0, s48, 1920
v_mul_u32_u24 v192, 1152, v7
buffer_load_dwordx4 v36, s[8:11], s83 offen offset:1152 lds
s_add_u32 s66, s66, s12
s_addc_u32 s67, s13, 0
s_load_dword s85, s[66:67], 73728
s_load_dword s85, s[66:67], 90112
s_load_dword s85, s[66:67], 106496
s_load_dword s85, s[66:67], 122880
s_load_dword s85, s[66:67], 139264
s_add_u32 s51, s46, 0
s_add_u32 m0, s43, 0
v_lshl_add_u32 v192, v4, 4, v192
buffer_load_dwordx4 v199, s[12:15], s51 offen lds
s_add_u32 m0, s43, 1920
v_and_b32 v8, 12, v6
buffer_load_dwordx4 v199, s[12:15], s51 offen offset:128 lds
s_add_u32 m0, s43, 3840
v_lshl_add_u32 v8, v10, 1, v8
buffer_load_dwordx4 v199, s[12:15], s51 offen offset:256 lds
s_add_u32 m0, s43, 5760
v_lshl_add_u32 v8, v8, 1, v4
buffer_load_dwordx4 v199, s[12:15], s51 offen offset:384 lds
s_add_u32 s52, s46, 18432
s_add_u32 m0, s43, 1024
v_and_b32 v9, 4, v3
buffer_load_dwordx4 v199, s[12:15], s52 offen lds
s_add_u32 m0, s43, 2944
v_add_u32 v8, v8, v9
buffer_load_dwordx4 v199, s[12:15], s52 offen offset:128 lds
s_add_u32 m0, s43, 4864
v_lshlrev_b32 v32, 4, v2
buffer_load_dwordx4 v199, s[12:15], s52 offen offset:256 lds
s_add_u32 m0, s43, 6784
v_add_u32 v33, 65536, v32
buffer_load_dwordx4 v199, s[12:15], s52 offen offset:384 lds
s_sub_u32 s3, s42, 72
s_min_u32 s3, s3, 17
s_lshr_b32 s59, s42, 2
s_and_b32 s58, s42, 3
s_cmp_lt_u32 s42, 72
s_cselect_b32 s59, s59, s3
s_cselect_b32 s58, s58, 4
s_lshl2_add_u32 s58, s58, s40
s_mul_i32 s6, s41, 18
s_add_u32 s6, s6, s42
s_cmp_lt_u32 s58, 16
s_cselect_b32 s4, s41, 0
s_lshr_b32 s3, s58, 2
s_and_b32 s62, s58, 3
s_mul_i32 s5, s4, 5
s_add_u32 s5, s5, s3
s_lshl_b32 s5, s5, 7
s_lshl2_add_u32 s60, s59, s62
s_mul_i32 s60, s60, 9216
s_add_u32 s60, s60, s5
s_mul_i32 s4, s4, 995328
s_lshl_b32 s62, s62, 8
s_add_u32 s4, s4, s62
s_mul_i32 s61, s59, 9
s_add_u32 s61, s61, s3
s_lshl_b32 s61, s61, 12
s_add_u32 s61, s61, s4
s_mul_i32 s62, s3, 36
s_add_u32 s62, s62, s59
s_lshl_b32 s62, s62, 11
s_add_u32 s62, s62, s4
s_add_u32 s62, s62, 663552
v_lshl_add_u32 v8, v8, 1, s5
s_mul_i32 s3, s41, 576
s_cmp_lt_u32 s6, 90
s_cselect_b32 s3, s3, 0xc0000000
v_subrev_u32 v9, s3, v199
s_lshl_b32 s82, s40, 10
s_sub_u32 s82, 113664, s82
s_mov_b32 s55, 0xffff0000
s_mov_b32 s56, 0xbfb8aa3b
s_mov_b32 s57, 0xbfb8aa3b
s_mul_i32 s3, s40, 9216
s_mul_i32 s47, s41, 995328
s_add_u32 s47, s47, s3
s_mov_b32 s16, s80
s_mov_b32 s17, s81
s_mov_b32 s18, 1994752
s_mov_b32 s19, 0x20000
s_mov_b32 s20, s80
s_mov_b32 s21, s81
s_mov_b32 s22, 1990656
s_mov_b32 s23, 0x20000
s_mov_b32 s24, s76
s_mov_b32 s25, s77
s_mov_b32 s26, 37748736
s_mov_b32 s27, 0x20000
s_mov_b32 s28, s78
s_mov_b32 s29, s79
s_mov_b32 s30, 128
s_mov_b32 s31, 0x20000
s_cmp_lt_u32 s6, 90
s_cselect_b32 s22, s22, 0
s_getpc_b64 s[0:1]
s_and_b32 s0, s0, 0xfffff000
s_lshr_b32 s3, s2, 3
s_and_b32 s4, s40, 1
s_lshl1_add_u32 s3, s3, s4
s_lshl_b32 s3, s3, 6
s_add_u32 s78, s0, s3
s_mov_b32 s79, s1
v_and_b32 v7, 6, v6
v_xor_b32 v7, v5, v7
v_lshlrev_b32 v7, 4, v7
v_lshl_add_u32 v7, v6, 7, v7
v_add_u32 v34, s48, v7
v_xor_b32 v35, 64, v34
v_lshrrev_b32 v20, 1, v5
v_and_b32 v21, 1, v5
v_and_b32 v22, 3, v3
v_lshlrev_b32 v38, 5, v5
v_add_u32 v38, 110624, v38
v_lshl_add_u32 v23, v20, 3, v22
v_lshlrev_b32 v23, 6, v23
v_lshl_add_u32 v23, v4, 4, v23
v_mul_u32_u24 v24, 18440, v21
v_add_u32 v193, v23, v24
v_add_u32 v194, 73744, v193
v_lshlrev_b32 v23, 4, v6
v_lshl_add_u32 v23, v21, 10, v23
s_cmp_lt_u32 s42, 72
s_mov_b32 s3, 995328
s_cselect_b32 s4, 36864, s3
s_cselect_b32 s3, 2048, s3
v_mad_u32_u24 v240, v20, s3, v23
v_mad_u32_u24 v241, v20, s4, v23
v_lshl_add_u32 v23, v20, 3, v22
v_lshlrev_b32 v23, 7, v23
v_lshl_add_u32 v23, v4, 4, v23
v_and_b32 v25, 2, v22
v_lshl_add_u32 v23, v25, 5, v23
v_xor_b32 v25, 64, v23
v_add_u32 v195, v23, v24
v_add_u32 v197, v25, v24
v_add_u32 v196, 73744, v195
v_add_u32 v198, 73744, v197
v_mov_b32 v37, 0
s_lshl_b32 s3, s41, 7
s_add_u32 s28, s28, s3
s_addc_u32 s29, s29, 0
s_lshl_b32 s3, s40, 7
s_add_u32 s3, s3, s6
s_cmp_lt_u32 s3, 90
s_cselect_b32 s6, 1, 0
v_lshrrev_b32 v24, 1, v22
v_xor_b32 v24, v24, v20
v_lshl_add_u32 v24, v22, 1, v24
v_lshl_add_u32 v24, v24, 2, v4
v_lshl_add_u32 v24, v24, 1, v21
v_lshlrev_b32 v24, 3, v24
v_add_u32 v25, s82, v24
v_add_u32 v24, s48, v24
s_cmp_lt_u32 s40, 2
s_cselect_b32 s3, 640, 64
s_mul_i32 s3, s41, s3
v_lshl_add_u32 v26, v0, 2, s3
v_min_u32 v26, 1148, v26
v_min_u32 v27, 144, v0
v_lshlrev_b32 v27, 3, v27
v_add_u32 v27, 110624, v27
s_add_u32 s7, s61, 18432
s_add_u32 s58, s60, 663552
s_add_u32 s59, s58, 663552
s_mov_b32 s53, 0
s_mov_b32 s54, 0
s_mov_b64 vcc, 1
s_cmp_eq_u32 s40, 0
s_cbranch_scc1 L_pg1
s_cmp_eq_u32 s40, 1
s_cbranch_scc1 L_pg2
s_cmp_eq_u32 s40, 2
s_cbranch_scc1 L_pg3
s_branch L_pg4
L_vr0:
s_mov_b64 vcc, 0
s_add_u32 m0, s43, 7680
s_nop 0
buffer_load_dwordx4 v192, s[12:15], s51 offen offset:512 lds
global_load_ushort v238, v8, s[70:71]
global_load_ushort v239, v8, s[72:73]
s_add_u32 m0, s48, 4096
s_nop 0
buffer_load_dwordx4 v9, s[12:15], s60 offen lds
s_add_u32 m0, s48, 5120
s_nop 0
buffer_load_dwordx4 v9, s[12:15], s58 offen lds
s_add_u32 m0, s82, 0
s_nop 0
buffer_load_dwordx4 v9, s[12:15], s59 offen lds
s_mov_b64 vcc, 1
s_cmp_eq_u32 s40, 0
s_cbranch_scc1 L_pg5
s_cmp_eq_u32 s40, 1
s_cbranch_scc1 L_pg6
s_cmp_eq_u32 s40, 2
s_cbranch_scc1 L_pg7
s_branch L_pg8
L_vr1:
s_mov_b64 vcc, 0
s_add_u32 m0, s48, 4864
s_nop 0
buffer_load_dwordx4 v36, s[8:11], s44 offen offset:1280 lds
s_add_u32 m0, s48, 5888
s_nop 0
buffer_load_dwordx4 v36, s[8:11], s45 offen offset:1280 lds
s_mov_b64 vcc, 1
s_cmp_eq_u32 s40, 0
s_cbranch_scc1 L_pg9
s_cmp_eq_u32 s40, 1
s_cbranch_scc1 L_pg10
s_cmp_eq_u32 s40, 2
s_cbranch_scc1 L_pg11
s_branch L_pg12
L_vr2:
s_mov_b64 vcc, 0
s_add_u32 m0, s48, 6912
s_nop 0
buffer_load_dwordx4 v36, s[8:11], s63 offen offset:1280 lds
s_add_u32 m0, s48, 7936
s_nop 0
buffer_load_dwordx4 v36, s[8:11], s83 offen offset:1280 lds
s_mov_b64 vcc, 1
s_cmp_eq_u32 s40, 0
s_cbranch_scc1 L_pg13
s_cmp_eq_u32 s40, 1
s_cbranch_scc1 L_pg14
s_cmp_eq_u32 s40, 2
s_cbranch_scc1 L_pg15
s_branch L_pg16
L_vr3:
s_mov_b64 vcc, 0
s_and_b32 s3, s40, 1
s_lshr_b32 s4, s40, 1
s_sub_u32 s76, s3, s4
s_add_u32 s82, s3, s4
s_sub_u32 s82, s82, 1
s_mul_i32 s76, s76, 27648
s_mul_i32 s82, s82, 27648
s_add_u32 s76, s76, s47
s_add_u32 s82, s82, s47
s_waitcnt vmcnt(9)
s_barrier
ds_read_b128 a[0:3], v34
s_add_u32 s54, s46, 73728
s_add_u32 m0, s43, 36872
ds_read_b64_tr_b16 a[224:225], v195
ds_read_b64_tr_b16 a[226:227], v195 offset:512
buffer_load_dwordx4 v199, s[12:15], s54 offen lds
ds_read_b128 a[8:11], v35
ds_read_b64_tr_b16 a[228:229], v195 offset:9216
ds_read_b64_tr_b16 a[230:231], v195 offset:9728
ds_read_b128 a[12:15], v35 offset:2048
s_add_u32 m0, s43, 38792
ds_read_b64_tr_b16 a[232:233], v195 offset:8
ds_read_b64_tr_b16 a[234:235], v195 offset:520
buffer_load_dwordx4 v199, s[12:15], s54 offen offset:128 lds
ds_read_b128 a[4:7], v34 offset:2048
ds_read_b64_tr_b16 a[236:237], v195 offset:9224
ds_read_b64_tr_b16 a[238:239], v195 offset:9736
s_add_u32 m0, s43, 40712
ds_read_b64_tr_b16 a[240:241], v197
ds_read_b64_tr_b16 a[242:243], v197 offset:512
buffer_load_dwordx4 v199, s[12:15], s54 offen offset:256 lds
ds_read_b64_tr_b16 a[244:245], v197 offset:9216
s_waitcnt lgkmcnt(12)
ds_read_b64_tr_b16 a[246:247], v197 offset:9728
s_waitcnt lgkmcnt(10)
v_mfma_f32_16x16x32_bf16 v[48:51], a[224:227], a[0:3], 0
s_add_u32 m0, s43, 42632
ds_read_b64_tr_b16 a[248:249], v197 offset:8
ds_read_b64_tr_b16 a[250:251], v197 offset:520
v_mfma_f32_16x16x32_bf16 v[48:51], a[228:231], a[8:11], v[48:51]
s_waitcnt lgkmcnt(8)
buffer_load_dwordx4 v199, s[12:15], s54 offen offset:384 lds
v_mfma_f32_16x16x32_bf16 v[52:55], a[228:231], a[12:15], 0
s_add_u32 s53, s46, 92160
ds_read_b64_tr_b16 a[252:253], v197 offset:9224
ds_read_b64_tr_b16 a[254:255], v197 offset:9736
v_mfma_f32_16x16x32_bf16 v[52:55], a[224:227], a[4:7], v[52:55]
s_waitcnt lgkmcnt(8)
v_mfma_f32_16x16x32_bf16 v[60:63], a[232:235], a[4:7], 0
s_add_u32 m0, s43, 37896
ds_read_b64_tr_b16 a[224:225], v195 offset:2048
ds_read_b64_tr_b16 a[226:227], v195 offset:2560
v_mfma_f32_16x16x32_bf16 v[60:63], a[236:239], a[12:15], v[60:63]
buffer_load_dwordx4 v199, s[12:15], s53 offen lds
v_mfma_f32_16x16x32_bf16 v[56:59], a[236:239], a[8:11], 0
ds_read_b64_tr_b16 a[228:229], v195 offset:11264
ds_read_b64_tr_b16 a[230:231], v195 offset:11776
v_mfma_f32_16x16x32_bf16 v[56:59], a[232:235], a[0:3], v[56:59]
s_waitcnt lgkmcnt(8)
v_mfma_f32_16x16x32_bf16 v[64:67], a[240:243], a[0:3], 0
s_add_u32 m0, s43, 39816
ds_read_b64_tr_b16 a[232:233], v195 offset:2056
ds_read_b64_tr_b16 a[234:235], v195 offset:2568
v_mfma_f32_16x16x32_bf16 v[64:67], a[244:247], a[8:11], v[64:67]
buffer_load_dwordx4 v199, s[12:15], s53 offen offset:128 lds
v_mfma_f32_16x16x32_bf16 v[68:71], a[244:247], a[12:15], 0
ds_read_b64_tr_b16 a[236:237], v195 offset:11272
ds_read_b64_tr_b16 a[238:239], v195 offset:11784
v_mfma_f32_16x16x32_bf16 v[68:71], a[240:243], a[4:7], v[68:71]
s_waitcnt vmcnt(10) lgkmcnt(8)
v_mfma_f32_16x16x32_bf16 v[76:79], a[248:251], a[4:7], 0
s_add_u32 m0, s43, 41736
ds_read_b64_tr_b16 a[240:241], v197 offset:2048
ds_read_b64_tr_b16 a[242:243], v197 offset:2560
v_mfma_f32_16x16x32_bf16 v[76:79], a[252:255], a[12:15], v[76:79]
buffer_load_dwordx4 v199, s[12:15], s53 offen offset:256 lds
ds_read_b64_tr_b16 v[200:201], v24 offset:4096
ds_read_b64_tr_b16 v[202:203], v24 offset:4608
v_mfma_f32_16x16x32_bf16 v[72:75], a[252:255], a[8:11], 0
ds_read_b64_tr_b16 a[244:245], v197 offset:11264
ds_read_b64_tr_b16 a[246:247], v197 offset:11776
v_mfma_f32_16x16x32_bf16 v[72:75], a[248:251], a[0:3], v[72:75]
s_waitcnt lgkmcnt(10)
ds_read_b64_tr_b16 v[204:205], v24 offset:5120
ds_read_b64_tr_b16 v[206:207], v24 offset:5632
ds_read_b64_tr_b16 v[208:209], v25
v_mfma_f32_16x16x32_bf16 v[80:83], a[224:227], a[0:3], 0
s_add_u32 m0, s43, 43656
ds_read_b64_tr_b16 a[248:249], v197 offset:2056
ds_read_b64_tr_b16 a[250:251], v197 offset:2568
v_mfma_f32_16x16x32_bf16 v[80:83], a[228:231], a[8:11], v[80:83]
buffer_load_dwordx4 v199, s[12:15], s53 offen offset:384 lds
s_waitcnt lgkmcnt(12)
ds_read_b64_tr_b16 v[210:211], v25 offset:512
v_lshlrev_b32 v238, 16, v238
v_mfma_f32_16x16x32_bf16 v[84:87], a[228:231], a[12:15], 0
ds_read_b64_tr_b16 a[252:253], v197 offset:11272
ds_read_b64_tr_b16 a[254:255], v197 offset:11784
v_mfma_f32_16x16x32_bf16 v[84:87], a[224:227], a[4:7], v[84:87]
s_waitcnt lgkmcnt(14)
v_lshlrev_b32 v239, 16, v239
v_add_f32 v238, 0x3727c5ac, v238
v_cvt_pk_bf16_f32 v238, v238, v238
v_mfma_f32_16x16x32_bf16 v[92:95], a[232:235], a[4:7], 0
s_add_u32 m0, s43, 44552
ds_read_b64_tr_b16 a[224:225], v195 offset:4096
s_waitcnt lgkmcnt(12)
ds_read_b64_tr_b16 a[226:227], v195 offset:4608
v_mfma_f32_16x16x32_bf16 v[92:95], a[236:239], a[12:15], v[92:95]
buffer_load_dwordx4 v192, s[12:15], s54 offen offset:512 lds
v_and_b32 v238, s55, v238
v_mfma_f32_16x16x32_bf16 v[88:91], a[236:239], a[8:11], 0
ds_read_b64_tr_b16 a[228:229], v195 offset:13312
ds_read_b64_tr_b16 a[230:231], v195 offset:13824
v_mfma_f32_16x16x32_bf16 v[88:91], a[232:235], a[0:3], v[88:91]
s_waitcnt lgkmcnt(12)
v_sqrt_f32 v238, v238
s_nop 0
v_cvt_pk_bf16_f32 v238, v238, v238
v_and_b32 v238, s55, v238
v_mfma_f32_16x16x32_bf16 v[96:99], a[240:243], a[0:3], 0
s_sub_u32 m0, s48, 1408
ds_read_b64_tr_b16 a[232:233], v195 offset:4104
ds_read_b64_tr_b16 a[234:235], v195 offset:4616
v_mfma_f32_16x16x32_bf16 v[96:99], a[244:247], a[8:11], v[96:99]
buffer_load_dwordx4 v36, s[8:11], s44 offen offset:1408 lds
v_mfma_f32_16x16x32_bf16 v[100:103], a[244:247], a[12:15], 0
ds_read_b64_tr_b16 a[236:237], v195 offset:13320
s_waitcnt lgkmcnt(12)
ds_read_b64_tr_b16 a[238:239], v195 offset:13832
v_mfma_f32_16x16x32_bf16 v[100:103], a[240:243], a[4:7], v[100:103]
s_waitcnt lgkmcnt(8)
v_rcp_f32 v238, v238
s_nop 0
v_cvt_pk_bf16_f32 v238, v238, v238
v_and_b32 v238, s55, v238
v_mul_f32 v238, v239, v238
v_mfma_f32_16x16x32_bf16 v[108:111], a[248:251], a[4:7], 0
s_sub_u32 m0, s48, 384
ds_read_b64_tr_b16 a[240:241], v197 offset:4096
ds_read_b64_tr_b16 a[242:243], v197 offset:4608
v_mfma_f32_16x16x32_bf16 v[108:111], a[252:255], a[12:15], v[108:111]
buffer_load_dwordx4 v36, s[8:11], s45 offen offset:1408 lds
v_cvt_pk_bf16_f32 v238, v238, v238
v_mfma_f32_16x16x32_bf16 v[104:107], a[252:255], a[8:11], 0
s_add_u32 s51, s46, 147456
ds_read_b64_tr_b16 a[244:245], v197 offset:13312
ds_read_b64_tr_b16 a[246:247], v197 offset:13824
v_mfma_f32_16x16x32_bf16 v[104:107], a[248:251], a[0:3], v[104:107]
s_waitcnt lgkmcnt(8)
v_and_b32 v238, s55, v238
v_mul_f32 v238, 0xbf38aa3b, v238
v_add_f32 v239, v238, v238
v_lshlrev_b32 v224, 16, v200
v_mfma_f32_16x16x32_bf16 v[112:115], a[224:227], a[0:3], 0
s_add_u32 m0, s43, 73744
ds_read_b64_tr_b16 a[248:249], v197 offset:4104
ds_read_b64_tr_b16 a[250:251], v197 offset:4616
v_mfma_f32_16x16x32_bf16 v[112:115], a[228:231], a[8:11], v[112:115]
buffer_load_dwordx4 v199, s[12:15], s51 offen lds
v_and_b32 v225, s55, v200
v_mfma_f32_16x16x32_bf16 v[116:119], a[228:231], a[12:15], 0
ds_read_b64_tr_b16 a[252:253], v197 offset:13320
ds_read_b64_tr_b16 a[254:255], v197 offset:13832
v_mfma_f32_16x16x32_bf16 v[116:119], a[224:227], a[4:7], v[116:119]
s_waitcnt lgkmcnt(8)
v_lshlrev_b32 v226, 16, v204
v_and_b32 v227, s55, v204
v_lshlrev_b32 v228, 16, v208
v_and_b32 v229, s55, v208
v_mfma_f32_16x16x32_bf16 v[124:127], a[232:235], a[4:7], 0
s_add_u32 m0, s43, 75664
ds_read_b64_tr_b16 a[224:225], v195 offset:6144
ds_read_b64_tr_b16 a[226:227], v195 offset:6656
v_mfma_f32_16x16x32_bf16 v[124:127], a[236:239], a[12:15], v[124:127]
buffer_load_dwordx4 v199, s[12:15], s51 offen offset:128 lds
v_add_f32 v224, v224, v228
v_mfma_f32_16x16x32_bf16 v[120:123], a[236:239], a[8:11], 0
ds_read_b64_tr_b16 a[228:229], v195 offset:15360
ds_read_b64_tr_b16 a[230:231], v195 offset:15872
v_mfma_f32_16x16x32_bf16 v[120:123], a[232:235], a[0:3], v[120:123]
s_waitcnt lgkmcnt(8)
v_add_f32 v225, v225, v229
v_mul_f32 v224, v224, v238
v_mul_f32 v225, v225, v238
v_mfma_f32_16x16x32_bf16 v[128:131], a[240:243], a[0:3], 0
s_add_u32 m0, s43, 77584
ds_read_b64_tr_b16 a[232:233], v195 offset:6152
ds_read_b64_tr_b16 a[234:235], v195 offset:6664
v_mfma_f32_16x16x32_bf16 v[128:131], a[244:247], a[8:11], v[128:131]
buffer_load_dwordx4 v199, s[12:15], s51 offen offset:256 lds
v_mul_f32 v228, v228, v239
v_mul_f32 v229, v229, v239
v_mfma_f32_16x16x32_bf16 v[132:135], a[244:247], a[12:15], 0
ds_read_b64_tr_b16 a[236:237], v195 offset:15368
ds_read_b64_tr_b16 a[238:239], v195 offset:15880
v_mfma_f32_16x16x32_bf16 v[132:135], a[240:243], a[4:7], v[132:135]
s_waitcnt lgkmcnt(8)
v_fma_f32 v230, v226, v238, v224
v_fma_f32 v231, v227, v238, v225
v_fma_f32 v224, -v226, v238, v224
v_mfma_f32_16x16x32_bf16 v[140:143], a[248:251], a[4:7], 0
s_add_u32 m0, s43, 79504
ds_read_b64_tr_b16 a[240:241], v197 offset:6144
ds_read_b64_tr_b16 a[242:243], v197 offset:6656
v_mfma_f32_16x16x32_bf16 v[140:143], a[252:255], a[12:15], v[140:143]
buffer_load_dwordx4 v199, s[12:15], s51 offen offset:384 lds
v_fma_f32 v225, -v227, v238, v225
v_cvt_pk_bf16_f32 v212, v230, v231
v_mfma_f32_16x16x32_bf16 v[136:139], a[252:255], a[8:11], 0
s_add_u32 s52, s46, 165888
ds_read_b64_tr_b16 a[244:245], v197 offset:15360
ds_read_b64_tr_b16 a[246:247], v197 offset:15872
v_mfma_f32_16x16x32_bf16 v[136:139], a[248:251], a[0:3], v[136:139]
s_waitcnt lgkmcnt(8)
v_cvt_pk_bf16_f32 v216, v224, v225
L_pg1:
s_cbranch_vccnz L_vr0
v_cvt_pk_bf16_f32 v220, v228, v229
v_lshlrev_b32 v224, 16, v201
v_mfma_f32_16x16x32_bf16 v[144:147], a[224:227], a[0:3], 0
s_add_u32 m0, s43, 74768
ds_read_b64_tr_b16 a[248:249], v197 offset:6152
ds_read_b64_tr_b16 a[250:251], v197 offset:6664
v_mfma_f32_16x16x32_bf16 v[144:147], a[228:231], a[8:11], v[144:147]
buffer_load_dwordx4 v199, s[12:15], s52 offen lds
v_and_b32 v225, s55, v201
v_lshlrev_b32 v226, 16, v205
v_mfma_f32_16x16x32_bf16 v[148:151], a[228:231], a[12:15], 0
ds_read_b64_tr_b16 a[252:253], v197 offset:15368
ds_read_b64_tr_b16 a[254:255], v197 offset:15880
v_mfma_f32_16x16x32_bf16 v[148:151], a[224:227], a[4:7], v[148:151]
s_waitcnt vmcnt(18) lgkmcnt(8)
ds_read_b128 a[16:19], v34 offset:6144
v_and_b32 v227, s55, v205
v_lshlrev_b32 v228, 16, v209
v_mfma_f32_16x16x32_bf16 v[156:159], a[232:235], a[4:7], 0
s_add_u32 m0, s43, 76688
ds_read_b64_tr_b16 a[224:225], v193 offset:8192
ds_read_b64_tr_b16 a[226:227], v193 offset:8448
v_mfma_f32_16x16x32_bf16 v[156:159], a[236:239], a[12:15], v[156:159]
buffer_load_dwordx4 v199, s[12:15], s52 offen offset:128 lds
v_and_b32 v229, s55, v209
v_mfma_f32_16x16x32_bf16 v[152:155], a[236:239], a[8:11], 0
ds_read_b64_tr_b16 a[228:229], v193 offset:17408
ds_read_b64_tr_b16 a[230:231], v193 offset:17664
v_mfma_f32_16x16x32_bf16 v[152:155], a[232:235], a[0:3], v[152:155]
s_waitcnt lgkmcnt(9)
ds_read_b128 a[24:27], v35 offset:6144
v_add_f32 v224, v224, v228
v_add_f32 v225, v225, v229
v_mul_f32 v224, v224, v238
v_mfma_f32_16x16x32_bf16 v[160:163], a[240:243], a[0:3], 0
s_load_dword s77, s[78:79], 8192
ds_read_b64_tr_b16 a[232:233], v193 offset:8200
ds_read_b64_tr_b16 a[234:235], v193 offset:8456
v_mfma_f32_16x16x32_bf16 v[160:163], a[244:247], a[8:11], v[160:163]
v_mul_f32 v225, v225, v238
v_mul_f32 v228, v228, v239
v_mul_f32 v229, v229, v239
v_mfma_f32_16x16x32_bf16 v[164:167], a[244:247], a[12:15], 0
ds_read_b64_tr_b16 a[236:237], v193 offset:17416
ds_read_b64_tr_b16 a[238:239], v193 offset:17672
v_mfma_f32_16x16x32_bf16 v[164:167], a[240:243], a[4:7], v[164:167]
s_waitcnt vmcnt(8) lgkmcnt(10)
s_barrier
ds_read_b128 a[28:31], v35 offset:8192
v_fma_f32 v230, v226, v238, v224
v_fma_f32 v231, v227, v238, v225
v_fma_f32 v224, -v226, v238, v224
v_mfma_f32_16x16x32_bf16 v[172:175], a[248:251], a[4:7], 0
s_add_u32 m0, s43, 78608
ds_read_b64_tr_b16 a[240:241], v195 offset:36872
ds_read_b64_tr_b16 a[242:243], v195 offset:37384
v_mfma_f32_16x16x32_bf16 v[172:175], a[252:255], a[12:15], v[172:175]
buffer_load_dwordx4 v199, s[12:15], s52 offen offset:256 lds
v_fma_f32 v225, -v227, v238, v225
v_mfma_f32_16x16x32_bf16 v[168:171], a[252:255], a[8:11], 0
ds_read_b64_tr_b16 a[244:245], v195 offset:46088
ds_read_b64_tr_b16 a[246:247], v195 offset:46600
v_mfma_f32_16x16x32_bf16 v[168:171], a[248:251], a[0:3], v[168:171]
s_waitcnt lgkmcnt(10)
global_load_dword v16, v26, s[68:69]
ds_read_b128 a[20:23], v34 offset:8192
v_cvt_pk_bf16_f32 v213, v230, v231
v_cvt_pk_bf16_f32 v217, v224, v225
v_mfma_f32_16x16x32_bf16 v[176:179], a[224:227], a[0:3], 0
s_add_u32 m0, s43, 80528
ds_read_b64_tr_b16 a[248:249], v195 offset:36880
ds_read_b64_tr_b16 a[250:251], v195 offset:37392
v_mfma_f32_16x16x32_bf16 v[176:179], a[228:231], a[8:11], v[176:179]
buffer_load_dwordx4 v199, s[12:15], s52 offen offset:384 lds
v_cvt_pk_bf16_f32 v221, v228, v229
v_mfma_f32_16x16x32_bf16 v[180:183], a[228:231], a[12:15], 0
ds_read_b64_tr_b16 a[252:253], v195 offset:46096
ds_read_b64_tr_b16 a[254:255], v195 offset:46608
v_mfma_f32_16x16x32_bf16 v[180:183], a[224:227], a[4:7], v[180:183]
s_waitcnt lgkmcnt(10)
global_load_dword v17, v26, s[70:71]
v_lshlrev_b32 v224, 16, v202
v_mfma_f32_16x16x32_bf16 v[188:191], a[232:235], a[4:7], 0
ds_read_b64_tr_b16 a[224:225], v197 offset:36872
ds_read_b64_tr_b16 a[226:227], v197 offset:37384
v_mfma_f32_16x16x32_bf16 v[188:191], a[236:239], a[12:15], v[188:191]
v_and_b32 v225, s55, v202
v_lshlrev_b32 v226, 16, v206
v_and_b32 v227, s55, v206
v_lshlrev_b32 v228, 16, v210
v_mfma_f32_16x16x32_bf16 v[184:187], a[236:239], a[8:11], 0
s_add_u32 m0, s43, 81424
ds_read_b64_tr_b16 a[228:229], v197 offset:46088
ds_read_b64_tr_b16 a[230:231], v197 offset:46600
v_mfma_f32_16x16x32_bf16 v[184:187], a[232:235], a[0:3], v[184:187]
s_waitcnt lgkmcnt(9)
buffer_load_dwordx4 v192, s[12:15], s51 offen offset:512 lds
v_and_b32 v229, s55, v210
v_mfma_f32_16x16x32_bf16 v[48:51], a[240:243], a[16:19], v[48:51]
ds_read_b64_tr_b16 a[232:233], v197 offset:36880
ds_read_b64_tr_b16 a[234:235], v197 offset:37392
v_mfma_f32_16x16x32_bf16 v[48:51], a[244:247], a[24:27], v[48:51]
s_waitcnt lgkmcnt(10)
global_load_dword v18, v26, s[72:73]
v_add_f32 v224, v224, v228
v_add_f32 v225, v225, v229
v_mfma_f32_16x16x32_bf16 v[52:55], a[244:247], a[28:31], v[52:55]
ds_read_b64_tr_b16 a[236:237], v197 offset:46096
ds_read_b64_tr_b16 a[238:239], v197 offset:46608
v_mfma_f32_16x16x32_bf16 v[52:55], a[240:243], a[20:23], v[52:55]
s_waitcnt lgkmcnt(8)
v_mul_f32 v224, v224, v238
v_mul_f32 v225, v225, v238
v_mul_f32 v228, v228, v239
v_mfma_f32_16x16x32_bf16 v[60:63], a[248:251], a[20:23], v[60:63]
s_add_u32 m0, s48, 640
ds_read_b64_tr_b16 a[240:241], v195 offset:38920
ds_read_b64_tr_b16 a[242:243], v195 offset:39432
v_mfma_f32_16x16x32_bf16 v[60:63], a[252:255], a[28:31], v[60:63]
buffer_load_dwordx4 v36, s[8:11], s63 offen offset:1408 lds
v_mul_f32 v229, v229, v239
v_fma_f32 v230, v226, v238, v224
v_mfma_f32_16x16x32_bf16 v[56:59], a[252:255], a[24:27], v[56:59]
ds_read_b64_tr_b16 a[244:245], v195 offset:48136
ds_read_b64_tr_b16 a[246:247], v195 offset:48648
v_mfma_f32_16x16x32_bf16 v[56:59], a[248:251], a[16:19], v[56:59]
s_waitcnt lgkmcnt(8)
global_load_dword v19, v26, s[74:75]
v_fma_f32 v231, v227, v238, v225
v_mfma_f32_16x16x32_bf16 v[64:67], a[224:227], a[16:19], v[64:67]
s_add_u32 m0, s48, 1664
ds_read_b64_tr_b16 a[248:249], v195 offset:38928
ds_read_b64_tr_b16 a[250:251], v195 offset:39440
v_mfma_f32_16x16x32_bf16 v[64:67], a[228:231], a[24:27], v[64:67]
buffer_load_dwordx4 v36, s[8:11], s83 offen offset:1408 lds
v_fma_f32 v224, -v226, v238, v224
v_mfma_f32_16x16x32_bf16 v[68:71], a[228:231], a[28:31], v[68:71]
ds_read_b64_tr_b16 a[252:253], v195 offset:48144
ds_read_b64_tr_b16 a[254:255], v195 offset:48656
v_mfma_f32_16x16x32_bf16 v[68:71], a[224:227], a[20:23], v[68:71]
s_waitcnt lgkmcnt(8)
v_fma_f32 v225, -v227, v238, v225
v_cvt_pk_bf16_f32 v214, v230, v231
v_cvt_pk_bf16_f32 v218, v224, v225
v_cvt_pk_bf16_f32 v222, v228, v229
v_mfma_f32_16x16x32_bf16 v[76:79], a[232:235], a[20:23], v[76:79]
ds_read_b64_tr_b16 a[224:225], v197 offset:38920
ds_read_b64_tr_b16 a[226:227], v197 offset:39432
v_mfma_f32_16x16x32_bf16 v[76:79], a[236:239], a[28:31], v[76:79]
v_lshlrev_b32 v224, 16, v203
v_and_b32 v225, s55, v203
v_lshlrev_b32 v226, 16, v207
v_mfma_f32_16x16x32_bf16 v[72:75], a[236:239], a[24:27], v[72:75]
s_add_u32 m0, s48, 2560
ds_read_b64_tr_b16 a[228:229], v197 offset:48136
ds_read_b64_tr_b16 a[230:231], v197 offset:48648
v_mfma_f32_16x16x32_bf16 v[72:75], a[232:235], a[16:19], v[72:75]
s_waitcnt lgkmcnt(8)
buffer_load_dwordx4 v36, s[8:11], s44 offen offset:1536 lds
v_and_b32 v227, s55, v207
v_lshlrev_b32 v228, 16, v211
v_mfma_f32_16x16x32_bf16 v[80:83], a[240:243], a[16:19], v[80:83]
ds_read_b64_tr_b16 a[232:233], v197 offset:38928
ds_read_b64_tr_b16 a[234:235], v197 offset:39440
v_mfma_f32_16x16x32_bf16 v[80:83], a[244:247], a[24:27], v[80:83]
v_and_b32 v229, s55, v211
v_add_f32 v224, v224, v228
v_add_f32 v225, v225, v229
v_mfma_f32_16x16x32_bf16 v[84:87], a[244:247], a[28:31], v[84:87]
ds_read_b64_tr_b16 a[236:237], v197 offset:48144
ds_read_b64_tr_b16 a[238:239], v197 offset:48656
v_mfma_f32_16x16x32_bf16 v[84:87], a[240:243], a[20:23], v[84:87]
s_waitcnt lgkmcnt(8)
v_mul_f32 v224, v224, v238
v_mul_f32 v225, v225, v238
v_mul_f32 v228, v228, v239
v_mul_f32 v229, v229, v239
v_mfma_f32_16x16x32_bf16 v[92:95], a[248:251], a[20:23], v[92:95]
s_add_u32 m0, s48, 3584
ds_read_b64_tr_b16 a[240:241], v195 offset:40968
ds_read_b64_tr_b16 a[242:243], v195 offset:41480
v_mfma_f32_16x16x32_bf16 v[92:95], a[252:255], a[28:31], v[92:95]
buffer_load_dwordx4 v36, s[8:11], s45 offen offset:1536 lds
v_fma_f32 v230, v226, v238, v224
v_mfma_f32_16x16x32_bf16 v[88:91], a[252:255], a[24:27], v[88:91]
s_add_u32 s54, s46, 221184
ds_read_b64_tr_b16 a[244:245], v195 offset:50184
ds_read_b64_tr_b16 a[246:247], v195 offset:50696
v_mfma_f32_16x16x32_bf16 v[88:91], a[248:251], a[16:19], v[88:91]
s_waitcnt lgkmcnt(8)
v_fma_f32 v231, v227, v238, v225
v_fma_f32 v224, -v226, v238, v224
v_fma_f32 v225, -v227, v238, v225
v_mfma_f32_16x16x32_bf16 v[96:99], a[224:227], a[16:19], v[96:99]
s_add_u32 m0, s43, 0
ds_read_b64_tr_b16 a[248:249], v195 offset:40976
ds_read_b64_tr_b16 a[250:251], v195 offset:41488
v_mfma_f32_16x16x32_bf16 v[96:99], a[228:231], a[24:27], v[96:99]
buffer_load_dwordx4 v199, s[12:15], s54 offen lds
v_cvt_pk_bf16_f32 v215, v230, v231
v_cvt_pk_bf16_f32 v219, v224, v225
v_mfma_f32_16x16x32_bf16 v[100:103], a[228:231], a[28:31], v[100:103]
ds_read_b64_tr_b16 a[252:253], v195 offset:50192
ds_read_b64_tr_b16 a[254:255], v195 offset:50704
v_mfma_f32_16x16x32_bf16 v[100:103], a[224:227], a[20:23], v[100:103]
s_waitcnt lgkmcnt(8)
v_cvt_pk_bf16_f32 v223, v228, v229
v_mfma_f32_16x16x32_bf16 v[108:111], a[232:235], a[20:23], v[108:111]
ds_read_b64_tr_b16 a[224:225], v197 offset:40968
ds_read_b64_tr_b16 a[226:227], v197 offset:41480
v_mfma_f32_16x16x32_bf16 v[108:111], a[236:239], a[28:31], v[108:111]
buffer_store_dwordx4 v[212:215], v240, s[20:23], s61 offen sc1
v_mfma_f32_16x16x32_bf16 v[104:107], a[236:239], a[24:27], v[104:107]
s_add_u32 m0, s43, 1920
ds_read_b64_tr_b16 a[228:229], v197 offset:50184
ds_read_b64_tr_b16 a[230:231], v197 offset:50696
v_mfma_f32_16x16x32_bf16 v[104:107], a[232:235], a[16:19], v[104:107]
s_waitcnt lgkmcnt(8)
buffer_load_dwordx4 v199, s[12:15], s54 offen offset:128 lds
v_mfma_f32_16x16x32_bf16 v[112:115], a[240:243], a[16:19], v[112:115]
ds_read_b64_tr_b16 a[232:233], v197 offset:40976
ds_read_b64_tr_b16 a[234:235], v197 offset:41488
v_mfma_f32_16x16x32_bf16 v[112:115], a[244:247], a[24:27], v[112:115]
buffer_store_dwordx4 v[216:219], v240, s[20:23], s7 offen sc1
v_mfma_f32_16x16x32_bf16 v[116:119], a[244:247], a[28:31], v[116:119]
ds_read_b64_tr_b16 a[236:237], v197 offset:50192
ds_read_b64_tr_b16 a[238:239], v197 offset:50704
v_mfma_f32_16x16x32_bf16 v[116:119], a[240:243], a[20:23], v[116:119]
s_waitcnt lgkmcnt(8)
v_mfma_f32_16x16x32_bf16 v[124:127], a[248:251], a[20:23], v[124:127]
s_add_u32 m0, s43, 3840
ds_read_b64_tr_b16 a[240:241], v195 offset:43016
ds_read_b64_tr_b16 a[242:243], v195 offset:43528
v_mfma_f32_16x16x32_bf16 v[124:127], a[252:255], a[28:31], v[124:127]
buffer_load_dwordx4 v199, s[12:15], s54 offen offset:256 lds
buffer_store_dwordx4 v[220:223], v241, s[20:23], s62 offen sc1
v_mfma_f32_16x16x32_bf16 v[120:123], a[252:255], a[24:27], v[120:123]
ds_read_b64_tr_b16 a[244:245], v195 offset:52232
ds_read_b64_tr_b16 a[246:247], v195 offset:52744
v_mfma_f32_16x16x32_bf16 v[120:123], a[248:251], a[16:19], v[120:123]
s_waitcnt lgkmcnt(8)
v_mfma_f32_16x16x32_bf16 v[128:131], a[224:227], a[16:19], v[128:131]
s_add_u32 m0, s43, 5760
ds_read_b64_tr_b16 a[248:249], v195 offset:43024
ds_read_b64_tr_b16 a[250:251], v195 offset:43536
v_mfma_f32_16x16x32_bf16 v[128:131], a[228:231], a[24:27], v[128:131]
buffer_load_dwordx4 v199, s[12:15], s54 offen offset:384 lds
v_mfma_f32_16x16x32_bf16 v[132:135], a[228:231], a[28:31], v[132:135]
ds_read_b64_tr_b16 a[252:253], v195 offset:52240
ds_read_b64_tr_b16 a[254:255], v195 offset:52752
v_mfma_f32_16x16x32_bf16 v[132:135], a[224:227], a[20:23], v[132:135]
s_waitcnt lgkmcnt(8)
v_mfma_f32_16x16x32_bf16 v[140:143], a[232:235], a[20:23], v[140:143]
s_add_u32 s53, s46, 239616
ds_read_b64_tr_b16 a[224:225], v197 offset:43016
ds_read_b64_tr_b16 a[226:227], v197 offset:43528
v_mfma_f32_16x16x32_bf16 v[140:143], a[236:239], a[28:31], v[140:143]
v_mfma_f32_16x16x32_bf16 v[136:139], a[236:239], a[24:27], v[136:139]
s_add_u32 m0, s43, 1024
ds_read_b64_tr_b16 a[228:229], v197 offset:52232
ds_read_b64_tr_b16 a[230:231], v197 offset:52744
v_mfma_f32_16x16x32_bf16 v[136:139], a[232:235], a[16:19], v[136:139]
s_waitcnt lgkmcnt(8)
buffer_load_dwordx4 v199, s[12:15], s53 offen lds
v_mfma_f32_16x16x32_bf16 v[144:147], a[240:243], a[16:19], v[144:147]
ds_read_b64_tr_b16 a[232:233], v197 offset:43024
ds_read_b64_tr_b16 a[234:235], v197 offset:43536
v_mfma_f32_16x16x32_bf16 v[144:147], a[244:247], a[24:27], v[144:147]
v_mfma_f32_16x16x32_bf16 v[148:151], a[244:247], a[28:31], v[148:151]
ds_read_b64_tr_b16 a[236:237], v197 offset:52240
ds_read_b64_tr_b16 a[238:239], v197 offset:52752
v_mfma_f32_16x16x32_bf16 v[148:151], a[240:243], a[20:23], v[148:151]
s_waitcnt vmcnt(25) lgkmcnt(8)
ds_read_b128 a[32:35], v34
v_mfma_f32_16x16x32_bf16 v[156:159], a[248:251], a[20:23], v[156:159]
s_add_u32 m0, s43, 2944
ds_read_b64_tr_b16 a[240:241], v193 offset:45064
ds_read_b64_tr_b16 a[242:243], v193 offset:45320
v_mfma_f32_16x16x32_bf16 v[156:159], a[252:255], a[28:31], v[156:159]
buffer_load_dwordx4 v199, s[12:15], s53 offen offset:128 lds
v_mfma_f32_16x16x32_bf16 v[152:155], a[252:255], a[24:27], v[152:155]
ds_read_b64_tr_b16 a[244:245], v193 offset:54280
ds_read_b64_tr_b16 a[246:247], v193 offset:54536
v_mfma_f32_16x16x32_bf16 v[152:155], a[248:251], a[16:19], v[152:155]
s_waitcnt lgkmcnt(9)
ds_read_b128 a[40:43], v35
v_mfma_f32_16x16x32_bf16 v[160:163], a[224:227], a[16:19], v[160:163]
ds_read_b64_tr_b16 a[248:249], v193 offset:45072
ds_read_b64_tr_b16 a[250:251], v193 offset:45328
v_mfma_f32_16x16x32_bf16 v[160:163], a[228:231], a[24:27], v[160:163]
v_mfma_f32_16x16x32_bf16 v[164:167], a[228:231], a[28:31], v[164:167]
ds_read_b64_tr_b16 a[252:253], v193 offset:54288
ds_read_b64_tr_b16 a[254:255], v193 offset:54544
v_mfma_f32_16x16x32_bf16 v[164:167], a[224:227], a[20:23], v[164:167]
s_waitcnt vmcnt(11) lgkmcnt(10)
s_barrier
ds_read_b128 a[44:47], v35 offset:2048
v_mfma_f32_16x16x32_bf16 v[172:175], a[232:235], a[20:23], v[172:175]
s_add_u32 m0, s43, 4864
ds_read_b64_tr_b16 a[224:225], v196
ds_read_b64_tr_b16 a[226:227], v196 offset:512
v_mfma_f32_16x16x32_bf16 v[172:175], a[236:239], a[28:31], v[172:175]
buffer_load_dwordx4 v199, s[12:15], s53 offen offset:256 lds
v_lshlrev_b32 v232, 16, v16
v_mfma_f32_16x16x32_bf16 v[168:171], a[236:239], a[24:27], v[168:171]
ds_read_b64_tr_b16 a[228:229], v196 offset:9216
ds_read_b64_tr_b16 a[230:231], v196 offset:9728
v_mfma_f32_16x16x32_bf16 v[168:171], a[232:235], a[16:19], v[168:171]
s_waitcnt lgkmcnt(10)
ds_read_b128 a[36:39], v34 offset:2048
v_lshlrev_b32 v234, 16, v17
v_mfma_f32_16x16x32_bf16 v[176:179], a[240:243], a[16:19], v[176:179]
s_add_u32 m0, s43, 6784
ds_read_b64_tr_b16 a[232:233], v196 offset:8
ds_read_b64_tr_b16 a[234:235], v196 offset:520
v_mfma_f32_16x16x32_bf16 v[176:179], a[244:247], a[24:27], v[176:179]
buffer_load_dwordx4 v199, s[12:15], s53 offen offset:384 lds
v_mfma_f32_16x16x32_bf16 v[180:183], a[244:247], a[28:31], v[180:183]
ds_read_b64_tr_b16 a[236:237], v196 offset:9224
ds_read_b64_tr_b16 a[238:239], v196 offset:9736
v_mfma_f32_16x16x32_bf16 v[180:183], a[240:243], a[20:23], v[180:183]
s_waitcnt lgkmcnt(10)
v_lshlrev_b32 v236, 16, v18
v_lshlrev_b32 v238, 16, v19
v_and_b32 v233, s55, v16
v_mfma_f32_16x16x32_bf16 v[188:191], a[248:251], a[20:23], v[188:191]
ds_read_b64_tr_b16 a[240:241], v198
ds_read_b64_tr_b16 a[242:243], v198 offset:512
v_mfma_f32_16x16x32_bf16 v[188:191], a[252:255], a[28:31], v[188:191]
v_and_b32 v235, s55, v17
v_and_b32 v237, s55, v18
v_mfma_f32_16x16x32_bf16 v[184:187], a[252:255], a[24:27], v[184:187]
s_add_u32 m0, s43, 7680
ds_read_b64_tr_b16 a[244:245], v198 offset:9216
ds_read_b64_tr_b16 a[246:247], v198 offset:9728
v_mfma_f32_16x16x32_bf16 v[184:187], a[248:251], a[16:19], v[184:187]
s_waitcnt lgkmcnt(9)
buffer_load_dwordx4 v192, s[12:15], s54 offen offset:512 lds
v_mfma_f32_16x16x32_bf16 v[48:51], a[224:227], a[32:35], v[48:51]
ds_read_b64_tr_b16 a[248:249], v198 offset:8
ds_read_b64_tr_b16 a[250:251], v198 offset:520
v_mfma_f32_16x16x32_bf16 v[48:51], a[228:231], a[40:43], v[48:51]
s_waitcnt lgkmcnt(10)
v_and_b32 v239, s55, v19
v_add_f32 v234, 0x3727c5ac, v234
v_cvt_pk_bf16_f32 v234, v234, v234
v_mfma_f32_16x16x32_bf16 v[52:55], a[228:231], a[44:47], v[52:55]
ds_read_b64_tr_b16 a[252:253], v198 offset:9224
ds_read_b64_tr_b16 a[254:255], v198 offset:9736
v_mfma_f32_16x16x32_bf16 v[52:55], a[224:227], a[36:39], v[52:55]
s_waitcnt lgkmcnt(8)
v_and_b32 v234, s55, v234
v_mfma_f32_16x16x32_bf16 v[60:63], a[232:235], a[36:39], v[60:63]
s_sub_u32 m0, s48, 1536
ds_read_b64_tr_b16 a[224:225], v196 offset:2048
ds_read_b64_tr_b16 a[226:227], v196 offset:2560
v_mfma_f32_16x16x32_bf16 v[60:63], a[236:239], a[44:47], v[60:63]
buffer_load_dwordx4 v36, s[8:11], s63 offen offset:1536 lds
v_sqrt_f32 v234, v234
v_mfma_f32_16x16x32_bf16 v[56:59], a[236:239], a[40:43], v[56:59]
ds_read_b64_tr_b16 a[228:229], v196 offset:11264
ds_read_b64_tr_b16 a[230:231], v196 offset:11776
v_mfma_f32_16x16x32_bf16 v[56:59], a[232:235], a[32:35], v[56:59]
s_waitcnt lgkmcnt(8)
v_cvt_pk_bf16_f32 v234, v234, v234
v_and_b32 v234, s55, v234
v_mfma_f32_16x16x32_bf16 v[64:67], a[240:243], a[32:35], v[64:67]
s_sub_u32 m0, s48, 512
ds_read_b64_tr_b16 a[232:233], v196 offset:2056
ds_read_b64_tr_b16 a[234:235], v196 offset:2568
v_mfma_f32_16x16x32_bf16 v[64:67], a[244:247], a[40:43], v[64:67]
buffer_load_dwordx4 v36, s[8:11], s83 offen offset:1536 lds
v_mfma_f32_16x16x32_bf16 v[68:71], a[244:247], a[44:47], v[68:71]
ds_read_b64_tr_b16 a[236:237], v196 offset:11272
ds_read_b64_tr_b16 a[238:239], v196 offset:11784
v_mfma_f32_16x16x32_bf16 v[68:71], a[240:243], a[36:39], v[68:71]
s_waitcnt lgkmcnt(8)
v_rcp_f32 v234, v234
s_nop 0
v_cvt_pk_bf16_f32 v234, v234, v234
v_mfma_f32_16x16x32_bf16 v[76:79], a[248:251], a[36:39], v[76:79]
ds_read_b64_tr_b16 a[240:241], v198 offset:2048
ds_read_b64_tr_b16 a[242:243], v198 offset:2560
v_mfma_f32_16x16x32_bf16 v[76:79], a[252:255], a[44:47], v[76:79]
v_and_b32 v234, s55, v234
v_mul_f32 v234, v236, v234
v_mfma_f32_16x16x32_bf16 v[72:75], a[252:255], a[40:43], v[72:75]
s_add_u32 m0, s48, 384
ds_read_b64_tr_b16 a[244:245], v198 offset:11264
ds_read_b64_tr_b16 a[246:247], v198 offset:11776
v_mfma_f32_16x16x32_bf16 v[72:75], a[248:251], a[32:35], v[72:75]
s_waitcnt lgkmcnt(8)
buffer_load_dwordx4 v36, s[8:11], s44 offen offset:1664 lds
v_mfma_f32_16x16x32_bf16 v[80:83], a[224:227], a[32:35], v[80:83]
ds_read_b64_tr_b16 a[248:249], v198 offset:2056
ds_read_b64_tr_b16 a[250:251], v198 offset:2568
v_mfma_f32_16x16x32_bf16 v[80:83], a[228:231], a[40:43], v[80:83]
v_cvt_pk_bf16_f32 v234, v234, v234
v_and_b32 v234, s55, v234
v_fma_f32 v238, -v232, v234, v238
v_mfma_f32_16x16x32_bf16 v[84:87], a[228:231], a[44:47], v[84:87]
ds_read_b64_tr_b16 a[252:253], v198 offset:11272
ds_read_b64_tr_b16 a[254:255], v198 offset:11784
v_mfma_f32_16x16x32_bf16 v[84:87], a[224:227], a[36:39], v[84:87]
s_waitcnt lgkmcnt(8)
v_mul_f32 v234, 0xbf38aa3b, v234
v_mul_f32 v238, 0xbf38aa3b, v238
v_mfma_f32_16x16x32_bf16 v[92:95], a[232:235], a[36:39], v[92:95]
s_add_u32 m0, s48, 1408
ds_read_b64_tr_b16 a[224:225], v196 offset:4096
ds_read_b64_tr_b16 a[226:227], v196 offset:4608
v_mfma_f32_16x16x32_bf16 v[92:95], a[236:239], a[44:47], v[92:95]
buffer_load_dwordx4 v36, s[8:11], s45 offen offset:1664 lds
v_mfma_f32_16x16x32_bf16 v[88:91], a[236:239], a[40:43], v[88:91]
s_add_u32 s51, s46, 294912
ds_read_b64_tr_b16 a[228:229], v196 offset:13312
ds_read_b64_tr_b16 a[230:231], v196 offset:13824
v_mfma_f32_16x16x32_bf16 v[88:91], a[232:235], a[32:35], v[88:91]
s_waitcnt lgkmcnt(8)
v_add_f32 v235, 0x3727c5ac, v235
v_cvt_pk_bf16_f32 v235, v235, v235
v_and_b32 v235, s55, v235
v_mfma_f32_16x16x32_bf16 v[96:99], a[240:243], a[32:35], v[96:99]
s_add_u32 m0, s43, 36872
ds_read_b64_tr_b16 a[232:233], v196 offset:4104
ds_read_b64_tr_b16 a[234:235], v196 offset:4616
v_mfma_f32_16x16x32_bf16 v[96:99], a[244:247], a[40:43], v[96:99]
buffer_load_dwordx4 v199, s[12:15], s51 offen lds
v_mfma_f32_16x16x32_bf16 v[100:103], a[244:247], a[44:47], v[100:103]
ds_read_b64_tr_b16 a[236:237], v196 offset:13320
ds_read_b64_tr_b16 a[238:239], v196 offset:13832
v_mfma_f32_16x16x32_bf16 v[100:103], a[240:243], a[36:39], v[100:103]
s_waitcnt lgkmcnt(8)
v_sqrt_f32 v235, v235
v_mfma_f32_16x16x32_bf16 v[108:111], a[248:251], a[36:39], v[108:111]
ds_read_b64_tr_b16 a[240:241], v198 offset:4096
ds_read_b64_tr_b16 a[242:243], v198 offset:4608
v_mfma_f32_16x16x32_bf16 v[108:111], a[252:255], a[44:47], v[108:111]
v_cvt_pk_bf16_f32 v235, v235, v235
v_and_b32 v235, s55, v235
v_mfma_f32_16x16x32_bf16 v[104:107], a[252:255], a[40:43], v[104:107]
s_add_u32 m0, s43, 38792
ds_read_b64_tr_b16 a[244:245], v198 offset:13312
ds_read_b64_tr_b16 a[246:247], v198 offset:13824
v_mfma_f32_16x16x32_bf16 v[104:107], a[248:251], a[32:35], v[104:107]
s_waitcnt lgkmcnt(8)
buffer_load_dwordx4 v199, s[12:15], s51 offen offset:128 lds
v_mfma_f32_16x16x32_bf16 v[112:115], a[224:227], a[32:35], v[112:115]
ds_read_b64_tr_b16 a[248:249], v198 offset:4104
ds_read_b64_tr_b16 a[250:251], v198 offset:4616
v_mfma_f32_16x16x32_bf16 v[112:115], a[228:231], a[40:43], v[112:115]
v_rcp_f32 v235, v235
s_nop 0
v_cvt_pk_bf16_f32 v235, v235, v235
v_mfma_f32_16x16x32_bf16 v[116:119], a[228:231], a[44:47], v[116:119]
ds_read_b64_tr_b16 a[252:253], v198 offset:13320
ds_read_b64_tr_b16 a[254:255], v198 offset:13832
v_mfma_f32_16x16x32_bf16 v[116:119], a[224:227], a[36:39], v[116:119]
s_waitcnt lgkmcnt(8)
v_and_b32 v235, s55, v235
v_mul_f32 v235, v237, v235
v_cvt_pk_bf16_f32 v235, v235, v235
v_mfma_f32_16x16x32_bf16 v[124:127], a[232:235], a[36:39], v[124:127]
s_add_u32 m0, s43, 40712
ds_read_b64_tr_b16 a[224:225], v196 offset:6144
ds_read_b64_tr_b16 a[226:227], v196 offset:6656
v_mfma_f32_16x16x32_bf16 v[124:127], a[236:239], a[44:47], v[124:127]
buffer_load_dwordx4 v199, s[12:15], s51 offen offset:256 lds
v_mfma_f32_16x16x32_bf16 v[120:123], a[236:239], a[40:43], v[120:123]
ds_read_b64_tr_b16 a[228:229], v196 offset:15360
ds_read_b64_tr_b16 a[230:231], v196 offset:15872
v_mfma_f32_16x16x32_bf16 v[120:123], a[232:235], a[32:35], v[120:123]
s_waitcnt lgkmcnt(8)
v_and_b32 v235, s55, v235
v_fma_f32 v239, -v233, v235, v239
v_mul_f32 v235, 0xbf38aa3b, v235
v_mfma_f32_16x16x32_bf16 v[128:131], a[240:243], a[32:35], v[128:131]
s_add_u32 m0, s43, 42632
ds_read_b64_tr_b16 a[232:233], v196 offset:6152
ds_read_b64_tr_b16 a[234:235], v196 offset:6664
v_mfma_f32_16x16x32_bf16 v[128:131], a[244:247], a[40:43], v[128:131]
buffer_load_dwordx4 v199, s[12:15], s51 offen offset:384 lds
v_mfma_f32_16x16x32_bf16 v[132:135], a[244:247], a[44:47], v[132:135]
ds_read_b64_tr_b16 a[236:237], v196 offset:15368
ds_read_b64_tr_b16 a[238:239], v196 offset:15880
v_mfma_f32_16x16x32_bf16 v[132:135], a[240:243], a[36:39], v[132:135]
s_waitcnt lgkmcnt(8)
v_mul_f32 v239, 0xbf38aa3b, v239
v_mfma_f32_16x16x32_bf16 v[140:143], a[248:251], a[36:39], v[140:143]
s_add_u32 s52, s46, 313344
ds_read_b64_tr_b16 a[240:241], v198 offset:6144
ds_read_b64_tr_b16 a[242:243], v198 offset:6656
v_mfma_f32_16x16x32_bf16 v[140:143], a[252:255], a[44:47], v[140:143]
ds_write_b64 v27, v[234:235]
v_mfma_f32_16x16x32_bf16 v[136:139], a[252:255], a[40:43], v[136:139]
s_add_u32 m0, s43, 37896
ds_read_b64_tr_b16 a[244:245], v198 offset:15360
ds_read_b64_tr_b16 a[246:247], v198 offset:15872
v_mfma_f32_16x16x32_bf16 v[136:139], a[248:251], a[32:35], v[136:139]
s_waitcnt lgkmcnt(9)
buffer_load_dwordx4 v199, s[12:15], s52 offen lds
v_mfma_f32_16x16x32_bf16 v[144:147], a[224:227], a[32:35], v[144:147]
ds_read_b64_tr_b16 a[248:249], v198 offset:6152
ds_read_b64_tr_b16 a[250:251], v198 offset:6664
v_mfma_f32_16x16x32_bf16 v[144:147], a[228:231], a[40:43], v[144:147]
ds_write_b64 v27, v[238:239] offset:2048
v_mfma_f32_16x16x32_bf16 v[148:151], a[228:231], a[44:47], v[148:151]
ds_read_b64_tr_b16 a[252:253], v198 offset:15368
ds_read_b64_tr_b16 a[254:255], v198 offset:15880
v_mfma_f32_16x16x32_bf16 v[148:151], a[224:227], a[36:39], v[148:151]
s_waitcnt vmcnt(21) lgkmcnt(10)
ds_read_b128 a[48:51], v34 offset:4096
v_mfma_f32_16x16x32_bf16 v[156:159], a[232:235], a[36:39], v[156:159]
s_add_u32 m0, s43, 39816
ds_read_b64_tr_b16 a[224:225], v194 offset:8192
ds_read_b64_tr_b16 a[226:227], v194 offset:8448
v_mfma_f32_16x16x32_bf16 v[156:159], a[236:239], a[44:47], v[156:159]
buffer_load_dwordx4 v199, s[12:15], s52 offen offset:128 lds
v_mfma_f32_16x16x32_bf16 v[152:155], a[236:239], a[40:43], v[152:155]
ds_read_b64_tr_b16 a[228:229], v194 offset:17408
ds_read_b64_tr_b16 a[230:231], v194 offset:17664
v_mfma_f32_16x16x32_bf16 v[152:155], a[232:235], a[32:35], v[152:155]
s_waitcnt lgkmcnt(10)
ds_read_b128 a[56:59], v35 offset:4096
v_mfma_f32_16x16x32_bf16 v[160:163], a[240:243], a[32:35], v[160:163]
ds_read_b64_tr_b16 a[232:233], v194 offset:8200
ds_read_b64_tr_b16 a[234:235], v194 offset:8456
v_mfma_f32_16x16x32_bf16 v[160:163], a[244:247], a[40:43], v[160:163]
v_mfma_f32_16x16x32_bf16 v[164:167], a[244:247], a[44:47], v[164:167]
ds_read_b64_tr_b16 a[236:237], v194 offset:17416
ds_read_b64_tr_b16 a[238:239], v194 offset:17672
v_mfma_f32_16x16x32_bf16 v[164:167], a[240:243], a[36:39], v[164:167]
s_waitcnt vmcnt(8) lgkmcnt(10)
s_barrier
ds_read_b128 a[60:63], v35
s_cmp_eq_u32 s6, 0
s_cbranch_scc1 L_nosig
s_atomic_add s6, s[28:29], 0 glc
s_cmp_lt_u32 s42, 72
s_cbranch_scc1 L_nosig
s_mov_b32 s87, 1
s_atomic_add s87, s[28:29], 128 glc
L_nosig:
v_mfma_f32_16x16x32_bf16 v[172:175], a[248:251], a[36:39], v[172:175]
s_add_u32 m0, s43, 41736
ds_read_b64_tr_b16 a[240:241], v195
ds_read_b64_tr_b16 a[242:243], v195 offset:512
v_mfma_f32_16x16x32_bf16 v[172:175], a[252:255], a[44:47], v[172:175]
buffer_load_dwordx4 v199, s[12:15], s52 offen offset:256 lds
v_mfma_f32_16x16x32_bf16 v[168:171], a[252:255], a[40:43], v[168:171]
ds_read_b64_tr_b16 a[244:245], v195 offset:9216
ds_read_b64_tr_b16 a[246:247], v195 offset:9728
v_mfma_f32_16x16x32_bf16 v[168:171], a[248:251], a[32:35], v[168:171]
s_waitcnt lgkmcnt(10)
ds_read_b128 a[52:55], v34
v_mfma_f32_16x16x32_bf16 v[176:179], a[224:227], a[32:35], v[176:179]
s_add_u32 m0, s43, 43656
ds_read_b64_tr_b16 a[248:249], v195 offset:8
ds_read_b64_tr_b16 a[250:251], v195 offset:520
v_mfma_f32_16x16x32_bf16 v[176:179], a[228:231], a[40:43], v[176:179]
buffer_load_dwordx4 v199, s[12:15], s52 offen offset:384 lds
v_mfma_f32_16x16x32_bf16 v[180:183], a[228:231], a[44:47], v[180:183]
ds_read_b64_tr_b16 a[252:253], v195 offset:9224
ds_read_b64_tr_b16 a[254:255], v195 offset:9736
v_mfma_f32_16x16x32_bf16 v[180:183], a[224:227], a[36:39], v[180:183]
s_waitcnt lgkmcnt(10)
v_mfma_f32_16x16x32_bf16 v[188:191], a[232:235], a[36:39], v[188:191]
s_add_u32 m0, s43, 44552
ds_read_b64_tr_b16 a[224:225], v197
ds_read_b64_tr_b16 a[226:227], v197 offset:512
v_mfma_f32_16x16x32_bf16 v[188:191], a[236:239], a[44:47], v[188:191]
L_pg2:
s_cbranch_vccnz L_vr0
buffer_load_dwordx4 v192, s[12:15], s51 offen offset:512 lds
v_mfma_f32_16x16x32_bf16 v[184:187], a[236:239], a[40:43], v[184:187]
ds_read_b64_tr_b16 a[228:229], v197 offset:9216
ds_read_b64_tr_b16 a[230:231], v197 offset:9728
v_mfma_f32_16x16x32_bf16 v[184:187], a[232:235], a[32:35], v[184:187]
s_waitcnt lgkmcnt(9)
v_mfma_f32_16x16x32_bf16 v[48:51], a[240:243], a[48:51], v[48:51]
ds_read_b64_tr_b16 a[232:233], v197 offset:8
ds_read_b64_tr_b16 a[234:235], v197 offset:520
v_mfma_f32_16x16x32_bf16 v[48:51], a[244:247], a[56:59], v[48:51]
s_waitcnt lgkmcnt(10)
v_mfma_f32_16x16x32_bf16 v[52:55], a[244:247], a[60:63], v[52:55]
s_add_u32 m0, s48, 2432
ds_read_b64_tr_b16 a[236:237], v197 offset:9224
ds_read_b64_tr_b16 a[238:239], v197 offset:9736
v_mfma_f32_16x16x32_bf16 v[52:55], a[240:243], a[52:55], v[52:55]
s_waitcnt lgkmcnt(8)
buffer_load_dwordx4 v36, s[8:11], s63 offen offset:1664 lds
v_mfma_f32_16x16x32_bf16 v[60:63], a[248:251], a[52:55], v[60:63]
ds_read_b64_tr_b16 a[240:241], v195 offset:2048
ds_read_b64_tr_b16 a[242:243], v195 offset:2560
v_mfma_f32_16x16x32_bf16 v[60:63], a[252:255], a[60:63], v[60:63]
v_mfma_f32_16x16x32_bf16 v[56:59], a[252:255], a[56:59], v[56:59]
s_add_u32 m0, s48, 3456
ds_read_b64_tr_b16 a[244:245], v195 offset:11264
ds_read_b64_tr_b16 a[246:247], v195 offset:11776
v_mfma_f32_16x16x32_bf16 v[56:59], a[248:251], a[48:51], v[56:59]
s_waitcnt lgkmcnt(8)
buffer_load_dwordx4 v36, s[8:11], s83 offen offset:1664 lds
v_mfma_f32_16x16x32_bf16 v[64:67], a[224:227], a[48:51], v[64:67]
s_load_dword s77, s[78:79], 12288
ds_read_b64_tr_b16 a[248:249], v195 offset:2056
ds_read_b64_tr_b16 a[250:251], v195 offset:2568
v_mfma_f32_16x16x32_bf16 v[64:67], a[228:231], a[56:59], v[64:67]
v_mfma_f32_16x16x32_bf16 v[68:71], a[228:231], a[60:63], v[68:71]
s_sub_u32 m0, s48, 1792
ds_read_b64_tr_b16 a[252:253], v195 offset:11272
ds_read_b64_tr_b16 a[254:255], v195 offset:11784
v_mfma_f32_16x16x32_bf16 v[68:71], a[224:227], a[52:55], v[68:71]
s_waitcnt lgkmcnt(8)
buffer_load_dwordx4 v36, s[8:11], s44 offen offset:1792 lds
v_mfma_f32_16x16x32_bf16 v[76:79], a[232:235], a[52:55], v[76:79]
ds_read_b64_tr_b16 a[224:225], v197 offset:2048
ds_read_b64_tr_b16 a[226:227], v197 offset:2560
v_mfma_f32_16x16x32_bf16 v[76:79], a[236:239], a[60:63], v[76:79]
v_mfma_f32_16x16x32_bf16 v[72:75], a[236:239], a[56:59], v[72:75]
ds_read_b64_tr_b16 a[228:229], v197 offset:11264
ds_read_b64_tr_b16 a[230:231], v197 offset:11776
v_mfma_f32_16x16x32_bf16 v[72:75], a[232:235], a[48:51], v[72:75]
s_waitcnt lgkmcnt(8)
v_mfma_f32_16x16x32_bf16 v[80:83], a[240:243], a[48:51], v[80:83]
s_sub_u32 m0, s48, 768
ds_read_b64_tr_b16 a[232:233], v197 offset:2056
ds_read_b64_tr_b16 a[234:235], v197 offset:2568
v_mfma_f32_16x16x32_bf16 v[80:83], a[244:247], a[56:59], v[80:83]
buffer_load_dwordx4 v36, s[8:11], s45 offen offset:1792 lds
v_mfma_f32_16x16x32_bf16 v[84:87], a[244:247], a[60:63], v[84:87]
ds_read_b64_tr_b16 a[236:237], v197 offset:11272
ds_read_b64_tr_b16 a[238:239], v197 offset:11784
v_mfma_f32_16x16x32_bf16 v[84:87], a[240:243], a[52:55], v[84:87]
s_waitcnt lgkmcnt(8)
v_mfma_f32_16x16x32_bf16 v[92:95], a[248:251], a[52:55], v[92:95]
s_add_u32 m0, s48, 6144
ds_read_b64_tr_b16 a[240:241], v195 offset:4096
ds_read_b64_tr_b16 a[242:243], v195 offset:4608
v_mfma_f32_16x16x32_bf16 v[92:95], a[252:255], a[60:63], v[92:95]
buffer_load_dwordx4 v36, s[8:11], s44 offen lds
v_mfma_f32_16x16x32_bf16 v[88:91], a[252:255], a[56:59], v[88:91]
ds_read_b64_tr_b16 a[244:245], v195 offset:13312
ds_read_b64_tr_b16 a[246:247], v195 offset:13824
v_mfma_f32_16x16x32_bf16 v[88:91], a[248:251], a[48:51], v[88:91]
s_waitcnt lgkmcnt(8)
v_mfma_f32_16x16x32_bf16 v[96:99], a[224:227], a[48:51], v[96:99]
s_add_u32 m0, s48, 7168
ds_read_b64_tr_b16 a[248:249], v195 offset:4104
ds_read_b64_tr_b16 a[250:251], v195 offset:4616
v_mfma_f32_16x16x32_bf16 v[96:99], a[228:231], a[56:59], v[96:99]
buffer_load_dwordx4 v36, s[8:11], s45 offen lds
v_mfma_f32_16x16x32_bf16 v[100:103], a[228:231], a[60:63], v[100:103]
ds_read_b64_tr_b16 a[252:253], v195 offset:13320
ds_read_b64_tr_b16 a[254:255], v195 offset:13832
v_mfma_f32_16x16x32_bf16 v[100:103], a[224:227], a[52:55], v[100:103]
s_waitcnt lgkmcnt(8)
v_mfma_f32_16x16x32_bf16 v[108:111], a[232:235], a[52:55], v[108:111]
s_add_u32 s54, s46, 368640
ds_read_b64_tr_b16 a[224:225], v197 offset:4096
ds_read_b64_tr_b16 a[226:227], v197 offset:4608
v_mfma_f32_16x16x32_bf16 v[108:111], a[236:239], a[60:63], v[108:111]
v_mfma_f32_16x16x32_bf16 v[104:107], a[236:239], a[56:59], v[104:107]
s_add_u32 m0, s43, 73744
ds_read_b64_tr_b16 a[228:229], v197 offset:13312
ds_read_b64_tr_b16 a[230:231], v197 offset:13824
v_mfma_f32_16x16x32_bf16 v[104:107], a[232:235], a[48:51], v[104:107]
s_waitcnt lgkmcnt(8)
buffer_load_dwordx4 v199, s[12:15], s54 offen lds
v_mfma_f32_16x16x32_bf16 v[112:115], a[240:243], a[48:51], v[112:115]
ds_read_b64_tr_b16 a[232:233], v197 offset:4104
ds_read_b64_tr_b16 a[234:235], v197 offset:4616
v_mfma_f32_16x16x32_bf16 v[112:115], a[244:247], a[56:59], v[112:115]
v_mfma_f32_16x16x32_bf16 v[116:119], a[244:247], a[60:63], v[116:119]
s_add_u32 m0, s43, 75664
ds_read_b64_tr_b16 a[236:237], v197 offset:13320
ds_read_b64_tr_b16 a[238:239], v197 offset:13832
v_mfma_f32_16x16x32_bf16 v[116:119], a[240:243], a[52:55], v[116:119]
s_waitcnt lgkmcnt(8)
buffer_load_dwordx4 v199, s[12:15], s54 offen offset:128 lds
v_mfma_f32_16x16x32_bf16 v[124:127], a[248:251], a[52:55], v[124:127]
ds_read_b64_tr_b16 a[240:241], v195 offset:6144
ds_read_b64_tr_b16 a[242:243], v195 offset:6656
v_mfma_f32_16x16x32_bf16 v[124:127], a[252:255], a[60:63], v[124:127]
v_mfma_f32_16x16x32_bf16 v[120:123], a[252:255], a[56:59], v[120:123]
s_add_u32 m0, s43, 77584
ds_read_b64_tr_b16 a[244:245], v195 offset:15360
ds_read_b64_tr_b16 a[246:247], v195 offset:15872
v_mfma_f32_16x16x32_bf16 v[120:123], a[248:251], a[48:51], v[120:123]
s_waitcnt lgkmcnt(8)
buffer_load_dwordx4 v199, s[12:15], s54 offen offset:256 lds
v_mfma_f32_16x16x32_bf16 v[128:131], a[224:227], a[48:51], v[128:131]
ds_read_b64_tr_b16 a[248:249], v195 offset:6152
ds_read_b64_tr_b16 a[250:251], v195 offset:6664
v_mfma_f32_16x16x32_bf16 v[128:131], a[228:231], a[56:59], v[128:131]
v_mfma_f32_16x16x32_bf16 v[132:135], a[228:231], a[60:63], v[132:135]
ds_read_b64_tr_b16 a[252:253], v195 offset:15368
ds_read_b64_tr_b16 a[254:255], v195 offset:15880
v_mfma_f32_16x16x32_bf16 v[132:135], a[224:227], a[52:55], v[132:135]
s_waitcnt lgkmcnt(8)
v_mfma_f32_16x16x32_bf16 v[140:143], a[232:235], a[52:55], v[140:143]
s_add_u32 m0, s43, 79504
ds_read_b64_tr_b16 a[224:225], v197 offset:6144
ds_read_b64_tr_b16 a[226:227], v197 offset:6656
v_mfma_f32_16x16x32_bf16 v[140:143], a[236:239], a[60:63], v[140:143]
buffer_load_dwordx4 v199, s[12:15], s54 offen offset:384 lds
v_mfma_f32_16x16x32_bf16 v[136:139], a[236:239], a[56:59], v[136:139]
s_add_u32 s53, s46, 387072
ds_read_b64_tr_b16 a[228:229], v197 offset:15360
ds_read_b64_tr_b16 a[230:231], v197 offset:15872
v_mfma_f32_16x16x32_bf16 v[136:139], a[232:235], a[48:51], v[136:139]
s_waitcnt lgkmcnt(8)
v_mfma_f32_16x16x32_bf16 v[144:147], a[240:243], a[48:51], v[144:147]
s_add_u32 m0, s43, 74768
ds_read_b64_tr_b16 a[232:233], v197 offset:6152
ds_read_b64_tr_b16 a[234:235], v197 offset:6664
v_mfma_f32_16x16x32_bf16 v[144:147], a[244:247], a[56:59], v[144:147]
buffer_load_dwordx4 v199, s[12:15], s53 offen lds
v_mfma_f32_16x16x32_bf16 v[148:151], a[244:247], a[60:63], v[148:151]
ds_read_b64_tr_b16 a[236:237], v197 offset:15368
ds_read_b64_tr_b16 a[238:239], v197 offset:15880
v_mfma_f32_16x16x32_bf16 v[148:151], a[240:243], a[52:55], v[148:151]
s_waitcnt vmcnt(20) lgkmcnt(8)
ds_read_b128 a[64:67], v34 offset:2048
v_mfma_f32_16x16x32_bf16 v[156:159], a[248:251], a[52:55], v[156:159]
ds_read_b64_tr_b16 a[240:241], v193 offset:8192
ds_read_b64_tr_b16 a[242:243], v193 offset:8448
v_mfma_f32_16x16x32_bf16 v[156:159], a[252:255], a[60:63], v[156:159]
v_mfma_f32_16x16x32_bf16 v[152:155], a[252:255], a[56:59], v[152:155]
s_add_u32 m0, s43, 76688
ds_read_b64_tr_b16 a[244:245], v193 offset:17408
ds_read_b64_tr_b16 a[246:247], v193 offset:17664
v_mfma_f32_16x16x32_bf16 v[152:155], a[248:251], a[48:51], v[152:155]
s_waitcnt lgkmcnt(9)
buffer_load_dwordx4 v199, s[12:15], s53 offen offset:128 lds
ds_read_b128 a[72:75], v35 offset:2048
v_mfma_f32_16x16x32_bf16 v[160:163], a[224:227], a[48:51], v[160:163]
ds_read_b64_tr_b16 a[248:249], v193 offset:8200
ds_read_b64_tr_b16 a[250:251], v193 offset:8456
v_mfma_f32_16x16x32_bf16 v[160:163], a[228:231], a[56:59], v[160:163]
v_mfma_f32_16x16x32_bf16 v[164:167], a[228:231], a[60:63], v[164:167]
ds_read_b64_tr_b16 a[252:253], v193 offset:17416
ds_read_b64_tr_b16 a[254:255], v193 offset:17672
v_mfma_f32_16x16x32_bf16 v[164:167], a[224:227], a[52:55], v[164:167]
s_waitcnt vmcnt(10) lgkmcnt(10)
s_barrier
ds_read_b128 a[76:79], v35 offset:4096
v_mfma_f32_16x16x32_bf16 v[172:175], a[232:235], a[52:55], v[172:175]
s_add_u32 m0, s43, 78608
ds_read_b64_tr_b16 a[224:225], v195 offset:36872
ds_read_b64_tr_b16 a[226:227], v195 offset:37384
v_mfma_f32_16x16x32_bf16 v[172:175], a[236:239], a[60:63], v[172:175]
buffer_load_dwordx4 v199, s[12:15], s53 offen offset:256 lds
v_mfma_f32_16x16x32_bf16 v[168:171], a[236:239], a[56:59], v[168:171]
ds_read_b64_tr_b16 a[228:229], v195 offset:46088
ds_read_b64_tr_b16 a[230:231], v195 offset:46600
v_mfma_f32_16x16x32_bf16 v[168:171], a[232:235], a[48:51], v[168:171]
s_waitcnt lgkmcnt(10)
ds_read_b128 a[68:71], v34 offset:4096
v_mfma_f32_16x16x32_bf16 v[176:179], a[240:243], a[48:51], v[176:179]
s_add_u32 m0, s43, 80528
ds_read_b64_tr_b16 a[232:233], v195 offset:36880
ds_read_b64_tr_b16 a[234:235], v195 offset:37392
v_mfma_f32_16x16x32_bf16 v[176:179], a[244:247], a[56:59], v[176:179]
buffer_load_dwordx4 v199, s[12:15], s53 offen offset:384 lds
v_mfma_f32_16x16x32_bf16 v[180:183], a[244:247], a[60:63], v[180:183]
ds_read_b64_tr_b16 a[236:237], v195 offset:46096
ds_read_b64_tr_b16 a[238:239], v195 offset:46608
v_mfma_f32_16x16x32_bf16 v[180:183], a[240:243], a[52:55], v[180:183]
s_waitcnt lgkmcnt(10)
v_mfma_f32_16x16x32_bf16 v[188:191], a[248:251], a[52:55], v[188:191]
ds_read_b64_tr_b16 a[240:241], v197 offset:36872
ds_read_b64_tr_b16 a[242:243], v197 offset:37384
v_mfma_f32_16x16x32_bf16 v[188:191], a[252:255], a[60:63], v[188:191]
v_mfma_f32_16x16x32_bf16 v[184:187], a[252:255], a[56:59], v[184:187]
s_add_u32 m0, s43, 81424
ds_read_b64_tr_b16 a[244:245], v197 offset:46088
ds_read_b64_tr_b16 a[246:247], v197 offset:46600
v_mfma_f32_16x16x32_bf16 v[184:187], a[248:251], a[48:51], v[184:187]
s_waitcnt lgkmcnt(9)
buffer_load_dwordx4 v192, s[12:15], s54 offen offset:512 lds
v_mfma_f32_16x16x32_bf16 v[48:51], a[224:227], a[64:67], v[48:51]
ds_read_b64_tr_b16 a[248:249], v197 offset:36880
ds_read_b64_tr_b16 a[250:251], v197 offset:37392
v_mfma_f32_16x16x32_bf16 v[48:51], a[228:231], a[72:75], v[48:51]
s_waitcnt lgkmcnt(10)
v_mfma_f32_16x16x32_bf16 v[52:55], a[228:231], a[76:79], v[52:55]
ds_read_b64_tr_b16 a[252:253], v197 offset:46096
ds_read_b64_tr_b16 a[254:255], v197 offset:46608
v_mfma_f32_16x16x32_bf16 v[52:55], a[224:227], a[68:71], v[52:55]
s_waitcnt lgkmcnt(8)
v_mfma_f32_16x16x32_bf16 v[60:63], a[232:235], a[68:71], v[60:63]
s_add_u32 m0, s48, 256
ds_read_b64_tr_b16 a[224:225], v195 offset:38920
ds_read_b64_tr_b16 a[226:227], v195 offset:39432
v_mfma_f32_16x16x32_bf16 v[60:63], a[236:239], a[76:79], v[60:63]
buffer_load_dwordx4 v36, s[8:11], s63 offen offset:1792 lds
v_mfma_f32_16x16x32_bf16 v[56:59], a[236:239], a[72:75], v[56:59]
ds_read_b64_tr_b16 a[228:229], v195 offset:48136
ds_read_b64_tr_b16 a[230:231], v195 offset:48648
v_mfma_f32_16x16x32_bf16 v[56:59], a[232:235], a[64:67], v[56:59]
s_waitcnt lgkmcnt(8)
v_mfma_f32_16x16x32_bf16 v[64:67], a[240:243], a[64:67], v[64:67]
s_add_u32 m0, s48, 1280
ds_read_b64_tr_b16 a[232:233], v195 offset:38928
ds_read_b64_tr_b16 a[234:235], v195 offset:39440
v_mfma_f32_16x16x32_bf16 v[64:67], a[244:247], a[72:75], v[64:67]
buffer_load_dwordx4 v36, s[8:11], s83 offen offset:1792 lds
v_mfma_f32_16x16x32_bf16 v[68:71], a[244:247], a[76:79], v[68:71]
ds_read_b64_tr_b16 a[236:237], v195 offset:48144
ds_read_b64_tr_b16 a[238:239], v195 offset:48656
v_mfma_f32_16x16x32_bf16 v[68:71], a[240:243], a[68:71], v[68:71]
s_waitcnt lgkmcnt(8)
v_mfma_f32_16x16x32_bf16 v[76:79], a[248:251], a[68:71], v[76:79]
ds_read_b64_tr_b16 a[240:241], v197 offset:38920
ds_read_b64_tr_b16 a[242:243], v197 offset:39432
v_mfma_f32_16x16x32_bf16 v[76:79], a[252:255], a[76:79], v[76:79]
v_mfma_f32_16x16x32_bf16 v[72:75], a[252:255], a[72:75], v[72:75]
s_add_u32 m0, s48, 2176
ds_read_b64_tr_b16 a[244:245], v197 offset:48136
ds_read_b64_tr_b16 a[246:247], v197 offset:48648
v_mfma_f32_16x16x32_bf16 v[72:75], a[248:251], a[64:67], v[72:75]
s_waitcnt lgkmcnt(8)
buffer_load_dwordx4 v36, s[8:11], s44 offen offset:1920 lds
v_mfma_f32_16x16x32_bf16 v[80:83], a[224:227], a[64:67], v[80:83]
ds_read_b64_tr_b16 a[248:249], v197 offset:38928
ds_read_b64_tr_b16 a[250:251], v197 offset:39440
v_mfma_f32_16x16x32_bf16 v[80:83], a[228:231], a[72:75], v[80:83]
v_mfma_f32_16x16x32_bf16 v[84:87], a[228:231], a[76:79], v[84:87]
ds_read_b64_tr_b16 a[252:253], v197 offset:48144
ds_read_b64_tr_b16 a[254:255], v197 offset:48656
v_mfma_f32_16x16x32_bf16 v[84:87], a[224:227], a[68:71], v[84:87]
s_waitcnt lgkmcnt(8)
v_mfma_f32_16x16x32_bf16 v[92:95], a[232:235], a[68:71], v[92:95]
s_add_u32 m0, s48, 3200
ds_read_b64_tr_b16 a[224:225], v195 offset:40968
ds_read_b64_tr_b16 a[226:227], v195 offset:41480
v_mfma_f32_16x16x32_bf16 v[92:95], a[236:239], a[76:79], v[92:95]
buffer_load_dwordx4 v36, s[8:11], s45 offen offset:1920 lds
v_mfma_f32_16x16x32_bf16 v[88:91], a[236:239], a[72:75], v[88:91]
s_add_u32 s51, s46, 442368
ds_read_b64_tr_b16 a[228:229], v195 offset:50184
ds_read_b64_tr_b16 a[230:231], v195 offset:50696
v_mfma_f32_16x16x32_bf16 v[88:91], a[232:235], a[64:67], v[88:91]
s_waitcnt lgkmcnt(8)
v_mfma_f32_16x16x32_bf16 v[96:99], a[240:243], a[64:67], v[96:99]
s_add_u32 m0, s43, 0
ds_read_b64_tr_b16 a[232:233], v195 offset:40976
ds_read_b64_tr_b16 a[234:235], v195 offset:41488
v_mfma_f32_16x16x32_bf16 v[96:99], a[244:247], a[72:75], v[96:99]
buffer_load_dwordx4 v199, s[12:15], s51 offen lds
v_mfma_f32_16x16x32_bf16 v[100:103], a[244:247], a[76:79], v[100:103]
ds_read_b64_tr_b16 a[236:237], v195 offset:50192
ds_read_b64_tr_b16 a[238:239], v195 offset:50704
v_mfma_f32_16x16x32_bf16 v[100:103], a[240:243], a[68:71], v[100:103]
s_waitcnt lgkmcnt(8)
v_mfma_f32_16x16x32_bf16 v[108:111], a[248:251], a[68:71], v[108:111]
ds_read_b64_tr_b16 a[240:241], v197 offset:40968
ds_read_b64_tr_b16 a[242:243], v197 offset:41480
v_mfma_f32_16x16x32_bf16 v[108:111], a[252:255], a[76:79], v[108:111]
v_mfma_f32_16x16x32_bf16 v[104:107], a[252:255], a[72:75], v[104:107]
s_add_u32 m0, s43, 1920
ds_read_b64_tr_b16 a[244:245], v197 offset:50184
ds_read_b64_tr_b16 a[246:247], v197 offset:50696
v_mfma_f32_16x16x32_bf16 v[104:107], a[248:251], a[64:67], v[104:107]
s_waitcnt lgkmcnt(8)
buffer_load_dwordx4 v199, s[12:15], s51 offen offset:128 lds
v_mfma_f32_16x16x32_bf16 v[112:115], a[224:227], a[64:67], v[112:115]
ds_read_b64_tr_b16 a[248:249], v197 offset:40976
ds_read_b64_tr_b16 a[250:251], v197 offset:41488
v_mfma_f32_16x16x32_bf16 v[112:115], a[228:231], a[72:75], v[112:115]
v_mfma_f32_16x16x32_bf16 v[116:119], a[228:231], a[76:79], v[116:119]
ds_read_b64_tr_b16 a[252:253], v197 offset:50192
ds_read_b64_tr_b16 a[254:255], v197 offset:50704
v_mfma_f32_16x16x32_bf16 v[116:119], a[224:227], a[68:71], v[116:119]
s_waitcnt lgkmcnt(8)
v_mfma_f32_16x16x32_bf16 v[124:127], a[232:235], a[68:71], v[124:127]
s_add_u32 m0, s43, 3840
ds_read_b64_tr_b16 a[224:225], v195 offset:43016
ds_read_b64_tr_b16 a[226:227], v195 offset:43528
v_mfma_f32_16x16x32_bf16 v[124:127], a[236:239], a[76:79], v[124:127]
buffer_load_dwordx4 v199, s[12:15], s51 offen offset:256 lds
v_mfma_f32_16x16x32_bf16 v[120:123], a[236:239], a[72:75], v[120:123]
ds_read_b64_tr_b16 a[228:229], v195 offset:52232
ds_read_b64_tr_b16 a[230:231], v195 offset:52744
v_mfma_f32_16x16x32_bf16 v[120:123], a[232:235], a[64:67], v[120:123]
s_waitcnt lgkmcnt(8)
v_mfma_f32_16x16x32_bf16 v[128:131], a[240:243], a[64:67], v[128:131]
s_add_u32 m0, s43, 5760
ds_read_b64_tr_b16 a[232:233], v195 offset:43024
ds_read_b64_tr_b16 a[234:235], v195 offset:43536
v_mfma_f32_16x16x32_bf16 v[128:131], a[244:247], a[72:75], v[128:131]
buffer_load_dwordx4 v199, s[12:15], s51 offen offset:384 lds
v_mfma_f32_16x16x32_bf16 v[132:135], a[244:247], a[76:79], v[132:135]
ds_read_b64_tr_b16 a[236:237], v195 offset:52240
ds_read_b64_tr_b16 a[238:239], v195 offset:52752
v_mfma_f32_16x16x32_bf16 v[132:135], a[240:243], a[68:71], v[132:135]
s_waitcnt lgkmcnt(8)
v_mfma_f32_16x16x32_bf16 v[140:143], a[248:251], a[68:71], v[140:143]
s_add_u32 s52, s46, 460800
ds_read_b64_tr_b16 a[240:241], v197 offset:43016
ds_read_b64_tr_b16 a[242:243], v197 offset:43528
v_mfma_f32_16x16x32_bf16 v[140:143], a[252:255], a[76:79], v[140:143]
v_mfma_f32_16x16x32_bf16 v[136:139], a[252:255], a[72:75], v[136:139]
s_add_u32 m0, s43, 1024
ds_read_b64_tr_b16 a[244:245], v197 offset:52232
ds_read_b64_tr_b16 a[246:247], v197 offset:52744
v_mfma_f32_16x16x32_bf16 v[136:139], a[248:251], a[64:67], v[136:139]
s_waitcnt lgkmcnt(8)
buffer_load_dwordx4 v199, s[12:15], s52 offen lds
v_mfma_f32_16x16x32_bf16 v[144:147], a[224:227], a[64:67], v[144:147]
ds_read_b64_tr_b16 a[248:249], v197 offset:43024
ds_read_b64_tr_b16 a[250:251], v197 offset:43536
v_mfma_f32_16x16x32_bf16 v[144:147], a[228:231], a[72:75], v[144:147]
v_mfma_f32_16x16x32_bf16 v[148:151], a[228:231], a[76:79], v[148:151]
ds_read_b64_tr_b16 a[252:253], v197 offset:52240
ds_read_b64_tr_b16 a[254:255], v197 offset:52752
v_mfma_f32_16x16x32_bf16 v[148:151], a[224:227], a[68:71], v[148:151]
s_waitcnt vmcnt(20) lgkmcnt(8)
ds_read_b128 a[80:83], v34
v_mfma_f32_16x16x32_bf16 v[156:159], a[232:235], a[68:71], v[156:159]
s_add_u32 m0, s43, 2944
ds_read_b64_tr_b16 a[224:225], v193 offset:45064
ds_read_b64_tr_b16 a[226:227], v193 offset:45320
v_mfma_f32_16x16x32_bf16 v[156:159], a[236:239], a[76:79], v[156:159]
buffer_load_dwordx4 v199, s[12:15], s52 offen offset:128 lds
v_mfma_f32_16x16x32_bf16 v[152:155], a[236:239], a[72:75], v[152:155]
ds_read_b64_tr_b16 a[228:229], v193 offset:54280
ds_read_b64_tr_b16 a[230:231], v193 offset:54536
v_mfma_f32_16x16x32_bf16 v[152:155], a[232:235], a[64:67], v[152:155]
s_waitcnt lgkmcnt(9)
ds_read_b128 a[88:91], v35
v_mfma_f32_16x16x32_bf16 v[160:163], a[240:243], a[64:67], v[160:163]
ds_read_b64_tr_b16 a[232:233], v193 offset:45072
ds_read_b64_tr_b16 a[234:235], v193 offset:45328
v_mfma_f32_16x16x32_bf16 v[160:163], a[244:247], a[72:75], v[160:163]
v_mfma_f32_16x16x32_bf16 v[164:167], a[244:247], a[76:79], v[164:167]
ds_read_b64_tr_b16 a[236:237], v193 offset:54288
ds_read_b64_tr_b16 a[238:239], v193 offset:54544
v_mfma_f32_16x16x32_bf16 v[164:167], a[240:243], a[68:71], v[164:167]
s_waitcnt vmcnt(8) lgkmcnt(10)
s_barrier
ds_read_b128 a[92:95], v35 offset:2048
v_mfma_f32_16x16x32_bf16 v[172:175], a[248:251], a[68:71], v[172:175]
s_add_u32 m0, s43, 4864
ds_read_b64_tr_b16 a[240:241], v196
ds_read_b64_tr_b16 a[242:243], v196 offset:512
v_mfma_f32_16x16x32_bf16 v[172:175], a[252:255], a[76:79], v[172:175]
buffer_load_dwordx4 v199, s[12:15], s52 offen offset:256 lds
v_mfma_f32_16x16x32_bf16 v[168:171], a[252:255], a[72:75], v[168:171]
ds_read_b64_tr_b16 a[244:245], v196 offset:9216
ds_read_b64_tr_b16 a[246:247], v196 offset:9728
v_mfma_f32_16x16x32_bf16 v[168:171], a[248:251], a[64:67], v[168:171]
s_waitcnt lgkmcnt(10)
ds_read_b128 a[84:87], v34 offset:2048
v_mfma_f32_16x16x32_bf16 v[176:179], a[224:227], a[64:67], v[176:179]
s_add_u32 m0, s43, 6784
ds_read_b64_tr_b16 a[248:249], v196 offset:8
ds_read_b64_tr_b16 a[250:251], v196 offset:520
v_mfma_f32_16x16x32_bf16 v[176:179], a[228:231], a[72:75], v[176:179]
buffer_load_dwordx4 v199, s[12:15], s52 offen offset:384 lds
v_mfma_f32_16x16x32_bf16 v[180:183], a[228:231], a[76:79], v[180:183]
ds_read_b64_tr_b16 a[252:253], v196 offset:9224
ds_read_b64_tr_b16 a[254:255], v196 offset:9736
v_mfma_f32_16x16x32_bf16 v[180:183], a[224:227], a[68:71], v[180:183]
s_waitcnt lgkmcnt(10)
ds_read_b128 v[16:19], v34 offset:6144
ds_read_b128 v[0:3], v35 offset:6144
v_accvgpr_read_b32 v24, a0
v_mfma_f32_16x16x32_bf16 v[188:191], a[232:235], a[68:71], v[188:191]
s_add_u32 m0, s43, 7680
ds_read_b64_tr_b16 a[224:225], v198
ds_read_b64_tr_b16 a[226:227], v198 offset:512
v_mfma_f32_16x16x32_bf16 v[188:191], a[236:239], a[76:79], v[188:191]
buffer_load_dwordx4 v192, s[12:15], s51 offen offset:512 lds
v_mfma_f32_16x16x32_bf16 v[184:187], a[236:239], a[72:75], v[184:187]
ds_read_b64_tr_b16 a[228:229], v198 offset:9216
s_waitcnt lgkmcnt(12)
ds_read_b64_tr_b16 a[230:231], v198 offset:9728
v_mfma_f32_16x16x32_bf16 v[184:187], a[232:235], a[64:67], v[184:187]
s_waitcnt lgkmcnt(11)
v_accvgpr_read_b32 v25, a1
v_accvgpr_read_b32 v26, a2
v_accvgpr_read_b32 v27, a3
v_mfma_f32_16x16x32_bf16 v[48:51], a[240:243], a[80:83], v[48:51]
ds_read_b64_tr_b16 a[232:233], v198 offset:8
ds_read_b64_tr_b16 a[234:235], v198 offset:520
v_mfma_f32_16x16x32_bf16 v[48:51], a[244:247], a[88:91], v[48:51]
s_waitcnt lgkmcnt(12)
ds_read_b128 a[0:3], v34 offset:6144
v_accvgpr_read_b32 v8, a8
v_accvgpr_read_b32 v9, a9
v_mfma_f32_16x16x32_bf16 v[52:55], a[244:247], a[92:95], v[52:55]
s_sub_u32 m0, s48, 1920
ds_read_b64_tr_b16 a[236:237], v198 offset:9224
ds_read_b64_tr_b16 a[238:239], v198 offset:9736
v_mfma_f32_16x16x32_bf16 v[52:55], a[240:243], a[84:87], v[52:55]
s_waitcnt lgkmcnt(11)
buffer_load_dwordx4 v36, s[8:11], s63 offen offset:1920 lds
v_mfma_f32_16x16x32_bf16 v[60:63], a[248:251], a[84:87], v[60:63]
ds_read_b64_tr_b16 a[240:241], v196 offset:2048
ds_read_b64_tr_b16 a[242:243], v196 offset:2560
v_mfma_f32_16x16x32_bf16 v[60:63], a[252:255], a[92:95], v[60:63]
v_accvgpr_read_b32 v10, a10
v_accvgpr_read_b32 v11, a11
v_mfma_f32_16x16x32_bf16 v[56:59], a[252:255], a[88:91], v[56:59]
s_sub_u32 m0, s48, 896
ds_read_b64_tr_b16 a[244:245], v196 offset:11264
ds_read_b64_tr_b16 a[246:247], v196 offset:11776
v_mfma_f32_16x16x32_bf16 v[56:59], a[248:251], a[80:83], v[56:59]
s_waitcnt lgkmcnt(9)
buffer_load_dwordx4 v36, s[8:11], s83 offen offset:1920 lds
ds_read_b128 a[8:11], v35 offset:6144
v_lshlrev_b32 v43, 16, v24
v_mfma_f32_16x16x32_bf16 v[64:67], a[224:227], a[80:83], v[64:67]
ds_read_b64_tr_b16 a[248:249], v196 offset:2056
ds_read_b64_tr_b16 a[250:251], v196 offset:2568
v_mfma_f32_16x16x32_bf16 v[64:67], a[228:231], a[88:91], v[64:67]
v_and_b32 v24, s55, v24
v_lshlrev_b32 v42, 16, v16
v_mfma_f32_16x16x32_bf16 v[68:71], a[228:231], a[92:95], v[68:71]
s_add_u32 m0, s48, 0
ds_read_b64_tr_b16 a[252:253], v196 offset:11272
ds_read_b64_tr_b16 a[254:255], v196 offset:11784
v_mfma_f32_16x16x32_bf16 v[68:71], a[224:227], a[84:87], v[68:71]
s_waitcnt lgkmcnt(9)
buffer_load_dwordx4 v36, s[8:11], s44 offen offset:2048 lds
v_and_b32 v16, s55, v16
v_mfma_f32_16x16x32_bf16 v[76:79], a[232:235], a[84:87], v[76:79]
ds_read_b64_tr_b16 a[224:225], v198 offset:2048
ds_read_b64_tr_b16 a[226:227], v198 offset:2560
v_mfma_f32_16x16x32_bf16 v[76:79], a[236:239], a[92:95], v[76:79]
v_add_f32 v44, v42, v43
v_subrev_f32 v43, v42, v43
v_add_f32 v42, v16, v24
v_mfma_f32_16x16x32_bf16 v[72:75], a[236:239], a[88:91], v[72:75]
s_max_i32 s68, s76, s47
ds_read_b64_tr_b16 a[228:229], v198 offset:11264
ds_read_b64_tr_b16 a[230:231], v198 offset:11776
v_mfma_f32_16x16x32_bf16 v[72:75], a[232:235], a[80:83], v[72:75]
s_waitcnt lgkmcnt(9)
v_subrev_f32 v24, v16, v24
v_cvt_pk_bf16_f32 v16, v44, v42
v_mfma_f32_16x16x32_bf16 v[80:83], a[240:243], a[80:83], v[80:83]
s_add_u32 m0, s48, 1024
ds_read_b64_tr_b16 a[232:233], v198 offset:2056
ds_read_b64_tr_b16 a[234:235], v198 offset:2568
v_mfma_f32_16x16x32_bf16 v[80:83], a[244:247], a[88:91], v[80:83]
buffer_load_dwordx4 v36, s[8:11], s45 offen offset:2048 lds
v_cvt_pk_bf16_f32 v24, v43, v24
v_mfma_f32_16x16x32_bf16 v[84:87], a[244:247], a[92:95], v[84:87]
s_add_u32 s54, s46, 516096
ds_read_b64_tr_b16 a[236:237], v198 offset:11272
ds_read_b64_tr_b16 a[238:239], v198 offset:11784
v_mfma_f32_16x16x32_bf16 v[84:87], a[240:243], a[84:87], v[84:87]
s_waitcnt lgkmcnt(8)
v_lshlrev_b32 v43, 16, v25
v_and_b32 v25, s55, v25
v_mfma_f32_16x16x32_bf16 v[92:95], a[248:251], a[84:87], v[92:95]
s_add_u32 m0, s43, 36872
ds_read_b64_tr_b16 a[240:241], v196 offset:4096
ds_read_b64_tr_b16 a[242:243], v196 offset:4608
v_mfma_f32_16x16x32_bf16 v[92:95], a[252:255], a[92:95], v[92:95]
buffer_load_dwordx4 v199, s[12:15], s54 offen lds
v_lshlrev_b32 v42, 16, v17
v_mfma_f32_16x16x32_bf16 v[88:91], a[252:255], a[88:91], v[88:91]
ds_read_b64_tr_b16 a[244:245], v196 offset:13312
ds_read_b64_tr_b16 a[246:247], v196 offset:13824
v_mfma_f32_16x16x32_bf16 v[88:91], a[248:251], a[80:83], v[88:91]
s_waitcnt lgkmcnt(8)
v_and_b32 v17, s55, v17
v_add_f32 v44, v42, v43
v_subrev_f32 v43, v42, v43
v_mfma_f32_16x16x32_bf16 v[96:99], a[224:227], a[80:83], v[96:99]
s_add_u32 m0, s43, 38792
ds_read_b64_tr_b16 a[248:249], v196 offset:4104
ds_read_b64_tr_b16 a[250:251], v196 offset:4616
v_mfma_f32_16x16x32_bf16 v[96:99], a[228:231], a[88:91], v[96:99]
buffer_load_dwordx4 v199, s[12:15], s54 offen offset:128 lds
v_mfma_f32_16x16x32_bf16 v[100:103], a[228:231], a[92:95], v[100:103]
ds_read_b64_tr_b16 a[252:253], v196 offset:13320
ds_read_b64_tr_b16 a[254:255], v196 offset:13832
v_mfma_f32_16x16x32_bf16 v[100:103], a[224:227], a[84:87], v[100:103]
s_waitcnt lgkmcnt(8)
v_add_f32 v42, v17, v25
v_subrev_f32 v25, v17, v25
v_cvt_pk_bf16_f32 v17, v44, v42
v_mfma_f32_16x16x32_bf16 v[108:111], a[232:235], a[84:87], v[108:111]
ds_read_b64_tr_b16 a[224:225], v198 offset:4096
ds_read_b64_tr_b16 a[226:227], v198 offset:4608
v_mfma_f32_16x16x32_bf16 v[108:111], a[236:239], a[92:95], v[108:111]
v_cvt_pk_bf16_f32 v25, v43, v25
v_lshlrev_b32 v43, 16, v26
v_and_b32 v26, s55, v26
v_mfma_f32_16x16x32_bf16 v[104:107], a[236:239], a[88:91], v[104:107]
s_add_u32 m0, s43, 40712
ds_read_b64_tr_b16 a[228:229], v198 offset:13312
ds_read_b64_tr_b16 a[230:231], v198 offset:13824
v_mfma_f32_16x16x32_bf16 v[104:107], a[232:235], a[80:83], v[104:107]
s_waitcnt lgkmcnt(8)
buffer_load_dwordx4 v199, s[12:15], s54 offen offset:256 lds
v_mfma_f32_16x16x32_bf16 v[112:115], a[240:243], a[80:83], v[112:115]
s_min_i32 s69, s82, s47
ds_read_b64_tr_b16 a[232:233], v198 offset:4104
ds_read_b64_tr_b16 a[234:235], v198 offset:4616
v_mfma_f32_16x16x32_bf16 v[112:115], a[244:247], a[88:91], v[112:115]
v_lshlrev_b32 v42, 16, v18
v_and_b32 v18, s55, v18
v_add_f32 v44, v42, v43
v_mfma_f32_16x16x32_bf16 v[116:119], a[244:247], a[92:95], v[116:119]
s_add_u32 m0, s43, 42632
ds_read_b64_tr_b16 a[236:237], v198 offset:13320
ds_read_b64_tr_b16 a[238:239], v198 offset:13832
v_mfma_f32_16x16x32_bf16 v[116:119], a[240:243], a[84:87], v[116:119]
s_waitcnt lgkmcnt(8)
buffer_load_dwordx4 v199, s[12:15], s54 offen offset:384 lds
v_subrev_f32 v43, v42, v43
v_mfma_f32_16x16x32_bf16 v[124:127], a[248:251], a[84:87], v[124:127]
s_add_u32 s53, s46, 534528
ds_read_b64_tr_b16 a[240:241], v196 offset:6144
ds_read_b64_tr_b16 a[242:243], v196 offset:6656
v_mfma_f32_16x16x32_bf16 v[124:127], a[252:255], a[92:95], v[124:127]
L_pg3:
s_cbranch_vccnz L_vr0
v_add_f32 v42, v18, v26
v_subrev_f32 v26, v18, v26
v_mfma_f32_16x16x32_bf16 v[120:123], a[252:255], a[88:91], v[120:123]
s_add_u32 m0, s43, 37896
ds_read_b64_tr_b16 a[244:245], v196 offset:15360
ds_read_b64_tr_b16 a[246:247], v196 offset:15872
v_mfma_f32_16x16x32_bf16 v[120:123], a[248:251], a[80:83], v[120:123]
s_waitcnt lgkmcnt(8)
buffer_load_dwordx4 v199, s[12:15], s53 offen lds
v_cvt_pk_bf16_f32 v18, v44, v42
v_mfma_f32_16x16x32_bf16 v[128:131], a[224:227], a[80:83], v[128:131]
ds_read_b64_tr_b16 a[248:249], v196 offset:6152
ds_read_b64_tr_b16 a[250:251], v196 offset:6664
v_mfma_f32_16x16x32_bf16 v[128:131], a[228:231], a[88:91], v[128:131]
v_cvt_pk_bf16_f32 v26, v43, v26
v_lshlrev_b32 v43, 16, v27
v_mfma_f32_16x16x32_bf16 v[132:135], a[228:231], a[92:95], v[132:135]
ds_read_b64_tr_b16 a[252:253], v196 offset:15368
ds_read_b64_tr_b16 a[254:255], v196 offset:15880
v_mfma_f32_16x16x32_bf16 v[132:135], a[224:227], a[84:87], v[132:135]
s_waitcnt lgkmcnt(8)
v_and_b32 v27, s55, v27
v_lshlrev_b32 v42, 16, v19
v_and_b32 v19, s55, v19
v_mfma_f32_16x16x32_bf16 v[140:143], a[232:235], a[84:87], v[140:143]
s_add_u32 m0, s43, 39816
ds_read_b64_tr_b16 a[224:225], v198 offset:6144
ds_read_b64_tr_b16 a[226:227], v198 offset:6656
v_mfma_f32_16x16x32_bf16 v[140:143], a[236:239], a[92:95], v[140:143]
s_load_dword s77, s[78:79], 16384
buffer_load_dwordx4 v199, s[12:15], s53 offen offset:128 lds
v_add_f32 v44, v42, v43
v_mfma_f32_16x16x32_bf16 v[136:139], a[236:239], a[88:91], v[136:139]
ds_read_b64_tr_b16 a[228:229], v198 offset:15360
ds_read_b64_tr_b16 a[230:231], v198 offset:15872
v_mfma_f32_16x16x32_bf16 v[136:139], a[232:235], a[80:83], v[136:139]
s_waitcnt lgkmcnt(8)
v_subrev_f32 v43, v42, v43
v_add_f32 v42, v19, v27
v_mfma_f32_16x16x32_bf16 v[144:147], a[240:243], a[80:83], v[144:147]
s_add_u32 m0, s48, 6144
ds_read_b64_tr_b16 a[232:233], v198 offset:6152
ds_read_b64_tr_b16 a[234:235], v198 offset:6664
v_mfma_f32_16x16x32_bf16 v[144:147], a[244:247], a[88:91], v[144:147]
buffer_load_dwordx4 v36, s[8:11], s63 offen lds
v_subrev_f32 v27, v19, v27
v_mfma_f32_16x16x32_bf16 v[148:151], a[244:247], a[92:95], v[148:151]
ds_read_b64_tr_b16 a[236:237], v198 offset:15368
ds_read_b64_tr_b16 a[238:239], v198 offset:15880
v_mfma_f32_16x16x32_bf16 v[148:151], a[240:243], a[84:87], v[148:151]
s_waitcnt vmcnt(20) lgkmcnt(8)
ds_read_b128 a[96:99], v34 offset:4096
v_cvt_pk_bf16_f32 v19, v44, v42
v_cvt_pk_bf16_f32 v27, v43, v27
v_mfma_f32_16x16x32_bf16 v[156:159], a[248:251], a[84:87], v[156:159]
ds_read_b64_tr_b16 a[240:241], v194 offset:8192
ds_read_b64_tr_b16 a[242:243], v194 offset:8448
v_mfma_f32_16x16x32_bf16 v[156:159], a[252:255], a[92:95], v[156:159]
v_lshlrev_b32 v43, 16, v8
v_and_b32 v8, s55, v8
v_mfma_f32_16x16x32_bf16 v[152:155], a[252:255], a[88:91], v[152:155]
s_add_u32 m0, s48, 7168
ds_read_b64_tr_b16 a[244:245], v194 offset:17408
ds_read_b64_tr_b16 a[246:247], v194 offset:17664
v_mfma_f32_16x16x32_bf16 v[152:155], a[248:251], a[80:83], v[152:155]
s_waitcnt lgkmcnt(9)
buffer_load_dwordx4 v36, s[8:11], s83 offen lds
ds_read_b128 a[104:107], v35 offset:4096
v_lshlrev_b32 v42, 16, v0
v_mfma_f32_16x16x32_bf16 v[160:163], a[224:227], a[80:83], v[160:163]
ds_read_b64_tr_b16 a[248:249], v194 offset:8200
ds_read_b64_tr_b16 a[250:251], v194 offset:8456
v_mfma_f32_16x16x32_bf16 v[160:163], a[228:231], a[88:91], v[160:163]
v_and_b32 v0, s55, v0
v_add_f32 v44, v42, v43
v_mfma_f32_16x16x32_bf16 v[164:167], a[228:231], a[92:95], v[164:167]
ds_read_b64_tr_b16 a[252:253], v194 offset:17416
ds_read_b64_tr_b16 a[254:255], v194 offset:17672
v_mfma_f32_16x16x32_bf16 v[164:167], a[224:227], a[84:87], v[164:167]
s_waitcnt vmcnt(10) lgkmcnt(10)
s_barrier
ds_read_b128 a[108:111], v35
v_subrev_f32 v43, v42, v43
v_add_f32 v42, v0, v8
v_mfma_f32_16x16x32_bf16 v[172:175], a[232:235], a[84:87], v[172:175]
s_add_u32 m0, s43, 41736
ds_read_b64_tr_b16 a[224:225], v195
ds_read_b64_tr_b16 a[226:227], v195 offset:512
v_mfma_f32_16x16x32_bf16 v[172:175], a[236:239], a[92:95], v[172:175]
buffer_load_dwordx4 v199, s[12:15], s53 offen offset:256 lds
v_subrev_f32 v8, v0, v8
v_mfma_f32_16x16x32_bf16 v[168:171], a[236:239], a[88:91], v[168:171]
ds_read_b64_tr_b16 a[228:229], v195 offset:9216
ds_read_b64_tr_b16 a[230:231], v195 offset:9728
v_mfma_f32_16x16x32_bf16 v[168:171], a[232:235], a[80:83], v[168:171]
s_waitcnt lgkmcnt(10)
ds_read_b128 a[100:103], v34
v_cvt_pk_bf16_f32 v0, v44, v42
v_mfma_f32_16x16x32_bf16 v[176:179], a[240:243], a[80:83], v[176:179]
s_add_u32 m0, s43, 43656
ds_read_b64_tr_b16 a[232:233], v195 offset:8
ds_read_b64_tr_b16 a[234:235], v195 offset:520
v_mfma_f32_16x16x32_bf16 v[176:179], a[244:247], a[88:91], v[176:179]
buffer_load_dwordx4 v199, s[12:15], s53 offen offset:384 lds
v_cvt_pk_bf16_f32 v8, v43, v8
v_mfma_f32_16x16x32_bf16 v[180:183], a[244:247], a[92:95], v[180:183]
ds_read_b64_tr_b16 a[236:237], v195 offset:9224
ds_read_b64_tr_b16 a[238:239], v195 offset:9736
v_mfma_f32_16x16x32_bf16 v[180:183], a[240:243], a[84:87], v[180:183]
s_waitcnt lgkmcnt(10)
v_lshlrev_b32 v43, 16, v9
v_and_b32 v9, s55, v9
v_lshlrev_b32 v42, 16, v1
v_mfma_f32_16x16x32_bf16 v[188:191], a[248:251], a[84:87], v[188:191]
ds_read_b64_tr_b16 a[240:241], v197
ds_read_b64_tr_b16 a[242:243], v197 offset:512
v_mfma_f32_16x16x32_bf16 v[188:191], a[252:255], a[92:95], v[188:191]
v_and_b32 v1, s55, v1
v_add_f32 v44, v42, v43
v_mfma_f32_16x16x32_bf16 v[184:187], a[252:255], a[88:91], v[184:187]
s_add_u32 m0, s43, 44552
ds_read_b64_tr_b16 a[244:245], v197 offset:9216
ds_read_b64_tr_b16 a[246:247], v197 offset:9728
v_mfma_f32_16x16x32_bf16 v[184:187], a[248:251], a[80:83], v[184:187]
s_waitcnt lgkmcnt(9)
buffer_load_dwordx4 v192, s[12:15], s54 offen offset:512 lds
v_subrev_f32 v43, v42, v43
v_mfma_f32_16x16x32_bf16 v[48:51], a[224:227], a[96:99], v[48:51]
ds_read_b64_tr_b16 a[248:249], v197 offset:8
ds_read_b64_tr_b16 a[250:251], v197 offset:520
v_mfma_f32_16x16x32_bf16 v[48:51], a[228:231], a[104:107], v[48:51]
s_waitcnt lgkmcnt(10)
v_add_f32 v42, v1, v9
v_subrev_f32 v9, v1, v9
v_cvt_pk_bf16_f32 v1, v44, v42
v_mfma_f32_16x16x32_bf16 v[52:55], a[228:231], a[108:111], v[52:55]
ds_read_b64_tr_b16 a[252:253], v197 offset:9224
ds_read_b64_tr_b16 a[254:255], v197 offset:9736
v_mfma_f32_16x16x32_bf16 v[52:55], a[224:227], a[100:103], v[52:55]
s_waitcnt lgkmcnt(8)
v_cvt_pk_bf16_f32 v9, v43, v9
v_lshlrev_b32 v43, 16, v10
v_mfma_f32_16x16x32_bf16 v[60:63], a[232:235], a[100:103], v[60:63]
s_sub_u32 m0, s48, 2048
ds_read_b64_tr_b16 a[224:225], v195 offset:2048
ds_read_b64_tr_b16 a[226:227], v195 offset:2560
v_mfma_f32_16x16x32_bf16 v[60:63], a[236:239], a[108:111], v[60:63]
buffer_load_dwordx4 v36, s[8:11], s63 offen offset:2048 lds
v_and_b32 v10, s55, v10
v_mfma_f32_16x16x32_bf16 v[56:59], a[236:239], a[104:107], v[56:59]
ds_read_b64_tr_b16 a[228:229], v195 offset:11264
ds_read_b64_tr_b16 a[230:231], v195 offset:11776
v_mfma_f32_16x16x32_bf16 v[56:59], a[232:235], a[96:99], v[56:59]
s_waitcnt lgkmcnt(8)
v_lshlrev_b32 v42, 16, v2
v_and_b32 v2, s55, v2
v_mfma_f32_16x16x32_bf16 v[64:67], a[240:243], a[96:99], v[64:67]
s_sub_u32 m0, s48, 1024
ds_read_b64_tr_b16 a[232:233], v195 offset:2056
ds_read_b64_tr_b16 a[234:235], v195 offset:2568
v_mfma_f32_16x16x32_bf16 v[64:67], a[244:247], a[104:107], v[64:67]
buffer_load_dwordx4 v36, s[8:11], s83 offen offset:2048 lds
v_add_f32 v44, v42, v43
v_mfma_f32_16x16x32_bf16 v[68:71], a[244:247], a[108:111], v[68:71]
ds_read_b64_tr_b16 a[236:237], v195 offset:11272
ds_read_b64_tr_b16 a[238:239], v195 offset:11784
v_mfma_f32_16x16x32_bf16 v[68:71], a[240:243], a[100:103], v[68:71]
s_waitcnt lgkmcnt(8)
v_subrev_f32 v43, v42, v43
v_add_f32 v42, v2, v10
v_subrev_f32 v10, v2, v10
v_mfma_f32_16x16x32_bf16 v[76:79], a[248:251], a[100:103], v[76:79]
ds_read_b64_tr_b16 a[240:241], v197 offset:2048
ds_read_b64_tr_b16 a[242:243], v197 offset:2560
v_mfma_f32_16x16x32_bf16 v[76:79], a[252:255], a[108:111], v[76:79]
v_cvt_pk_bf16_f32 v2, v44, v42
v_cvt_pk_bf16_f32 v10, v43, v10
v_mfma_f32_16x16x32_bf16 v[72:75], a[252:255], a[104:107], v[72:75]
s_add_u32 m0, s48, 1920
ds_read_b64_tr_b16 a[244:245], v197 offset:11264
ds_read_b64_tr_b16 a[246:247], v197 offset:11776
v_mfma_f32_16x16x32_bf16 v[72:75], a[248:251], a[96:99], v[72:75]
s_waitcnt lgkmcnt(8)
buffer_load_dwordx4 v36, s[8:11], s44 offen offset:2176 lds
v_lshlrev_b32 v43, 16, v11
v_mfma_f32_16x16x32_bf16 v[80:83], a[224:227], a[96:99], v[80:83]
ds_read_b64_tr_b16 a[248:249], v197 offset:2056
ds_read_b64_tr_b16 a[250:251], v197 offset:2568
v_mfma_f32_16x16x32_bf16 v[80:83], a[228:231], a[104:107], v[80:83]
v_and_b32 v11, s55, v11
v_lshlrev_b32 v42, 16, v3
v_and_b32 v3, s55, v3
v_mfma_f32_16x16x32_bf16 v[84:87], a[228:231], a[108:111], v[84:87]
ds_read_b64_tr_b16 a[252:253], v197 offset:11272
ds_read_b64_tr_b16 a[254:255], v197 offset:11784
v_mfma_f32_16x16x32_bf16 v[84:87], a[224:227], a[100:103], v[84:87]
s_waitcnt lgkmcnt(8)
v_add_f32 v44, v42, v43
v_subrev_f32 v43, v42, v43
v_mfma_f32_16x16x32_bf16 v[92:95], a[232:235], a[100:103], v[92:95]
s_add_u32 m0, s48, 2944
ds_read_b64_tr_b16 a[224:225], v195 offset:4096
ds_read_b64_tr_b16 a[226:227], v195 offset:4608
v_mfma_f32_16x16x32_bf16 v[92:95], a[236:239], a[108:111], v[92:95]
buffer_load_dwordx4 v36, s[8:11], s45 offen offset:2176 lds
v_add_f32 v42, v3, v11
v_mfma_f32_16x16x32_bf16 v[88:91], a[236:239], a[104:107], v[88:91]
s_add_u32 s51, s46, 589824
ds_read_b64_tr_b16 a[228:229], v195 offset:13312
ds_read_b64_tr_b16 a[230:231], v195 offset:13824
v_mfma_f32_16x16x32_bf16 v[88:91], a[232:235], a[96:99], v[88:91]
s_waitcnt lgkmcnt(8)
v_subrev_f32 v11, v3, v11
v_cvt_pk_bf16_f32 v3, v44, v42
v_cvt_pk_bf16_f32 v11, v43, v11
v_mfma_f32_16x16x32_bf16 v[96:99], a[240:243], a[96:99], v[96:99]
s_add_u32 m0, s43, 73744
ds_read_b64_tr_b16 a[232:233], v195 offset:4104
ds_read_b64_tr_b16 a[234:235], v195 offset:4616
v_mfma_f32_16x16x32_bf16 v[96:99], a[244:247], a[104:107], v[96:99]
buffer_load_dwordx4 v199, s[12:15], s51 offen lds
v_mfma_f32_16x16x32_bf16 v[100:103], a[244:247], a[108:111], v[100:103]
ds_read_b64_tr_b16 a[236:237], v195 offset:13320
ds_read_b64_tr_b16 a[238:239], v195 offset:13832
v_mfma_f32_16x16x32_bf16 v[100:103], a[240:243], a[100:103], v[100:103]
s_waitcnt vmcnt(8) lgkmcnt(8)
s_load_dword s3, s[28:29], 0
ds_read_b128 v[20:23], v34 offset:6144
ds_read_b128 v[4:7], v35 offset:6144
v_accvgpr_read_b32 v28, a4
v_mfma_f32_16x16x32_bf16 v[108:111], a[248:251], a[100:103], v[108:111]
ds_read_b64_tr_b16 a[240:241], v197 offset:4096
ds_read_b64_tr_b16 a[242:243], v197 offset:4608
v_mfma_f32_16x16x32_bf16 v[108:111], a[252:255], a[108:111], v[108:111]
v_accvgpr_read_b32 v29, a5
v_accvgpr_read_b32 v30, a6
v_mfma_f32_16x16x32_bf16 v[104:107], a[252:255], a[104:107], v[104:107]
s_add_u32 m0, s43, 75664
ds_read_b64_tr_b16 a[244:245], v197 offset:13312
ds_read_b64_tr_b16 a[246:247], v197 offset:13824
v_mfma_f32_16x16x32_bf16 v[104:107], a[248:251], a[96:99], v[104:107]
s_waitcnt lgkmcnt(10)
buffer_load_dwordx4 v199, s[12:15], s51 offen offset:128 lds
v_accvgpr_read_b32 v31, a7
v_mfma_f32_16x16x32_bf16 v[112:115], a[224:227], a[96:99], v[112:115]
ds_read_b64_tr_b16 a[248:249], v197 offset:4104
ds_read_b64_tr_b16 a[250:251], v197 offset:4616
v_mfma_f32_16x16x32_bf16 v[112:115], a[228:231], a[104:107], v[112:115]
ds_read_b128 a[4:7], v34 offset:6144
v_accvgpr_read_b32 v12, a12
v_mfma_f32_16x16x32_bf16 v[116:119], a[228:231], a[108:111], v[116:119]
ds_read_b64_tr_b16 a[252:253], v197 offset:13320
ds_read_b64_tr_b16 a[254:255], v197 offset:13832
v_mfma_f32_16x16x32_bf16 v[116:119], a[224:227], a[100:103], v[116:119]
s_waitcnt lgkmcnt(11)
v_accvgpr_read_b32 v13, a13
v_accvgpr_read_b32 v14, a14
v_accvgpr_read_b32 v15, a15
v_mfma_f32_16x16x32_bf16 v[124:127], a[232:235], a[100:103], v[124:127]
s_add_u32 m0, s43, 77584
ds_read_b64_tr_b16 a[224:225], v195 offset:6144
ds_read_b64_tr_b16 a[226:227], v195 offset:6656
v_mfma_f32_16x16x32_bf16 v[124:127], a[236:239], a[108:111], v[124:127]
buffer_load_dwordx4 v199, s[12:15], s51 offen offset:256 lds
v_mfma_f32_16x16x32_bf16 v[120:123], a[236:239], a[104:107], v[120:123]
ds_read_b64_tr_b16 a[228:229], v195 offset:15360
ds_read_b64_tr_b16 a[230:231], v195 offset:15872
v_mfma_f32_16x16x32_bf16 v[120:123], a[232:235], a[96:99], v[120:123]
s_waitcnt lgkmcnt(9)
ds_read_b128 a[12:15], v35 offset:6144
v_lshlrev_b32 v43, 16, v28
v_mfma_f32_16x16x32_bf16 v[128:131], a[240:243], a[96:99], v[128:131]
s_add_u32 m0, s43, 79504
ds_read_b64_tr_b16 a[232:233], v195 offset:6152
ds_read_b64_tr_b16 a[234:235], v195 offset:6664
v_mfma_f32_16x16x32_bf16 v[128:131], a[244:247], a[104:107], v[128:131]
buffer_load_dwordx4 v199, s[12:15], s51 offen offset:384 lds
v_and_b32 v28, s55, v28
v_mfma_f32_16x16x32_bf16 v[132:135], a[244:247], a[108:111], v[132:135]
ds_read_b64_tr_b16 a[236:237], v195 offset:15368
ds_read_b64_tr_b16 a[238:239], v195 offset:15880
v_mfma_f32_16x16x32_bf16 v[132:135], a[240:243], a[100:103], v[132:135]
s_waitcnt lgkmcnt(9)
v_lshlrev_b32 v42, 16, v20
v_and_b32 v20, s55, v20
v_mfma_f32_16x16x32_bf16 v[140:143], a[248:251], a[100:103], v[140:143]
s_add_u32 s52, s46, 608256
ds_read_b64_tr_b16 a[240:241], v197 offset:6144
ds_read_b64_tr_b16 a[242:243], v197 offset:6656
v_mfma_f32_16x16x32_bf16 v[140:143], a[252:255], a[108:111], v[140:143]
v_add_f32 v44, v42, v43
v_subrev_f32 v43, v42, v43
v_add_f32 v42, v20, v28
v_mfma_f32_16x16x32_bf16 v[136:139], a[252:255], a[104:107], v[136:139]
s_add_u32 m0, s43, 74768
ds_read_b64_tr_b16 a[244:245], v197 offset:15360
ds_read_b64_tr_b16 a[246:247], v197 offset:15872
v_mfma_f32_16x16x32_bf16 v[136:139], a[248:251], a[96:99], v[136:139]
s_waitcnt lgkmcnt(9)
buffer_load_dwordx4 v199, s[12:15], s52 offen lds
v_mfma_f32_16x16x32_bf16 v[144:147], a[224:227], a[96:99], v[144:147]
ds_read_b64_tr_b16 a[248:249], v197 offset:6152
ds_read_b64_tr_b16 a[250:251], v197 offset:6664
v_mfma_f32_16x16x32_bf16 v[144:147], a[228:231], a[104:107], v[144:147]
v_subrev_f32 v28, v20, v28
v_cvt_pk_bf16_f32 v20, v44, v42
v_cvt_pk_bf16_f32 v28, v43, v28
v_mfma_f32_16x16x32_bf16 v[148:151], a[228:231], a[108:111], v[148:151]
ds_read_b64_tr_b16 a[252:253], v197 offset:15368
ds_read_b64_tr_b16 a[254:255], v197 offset:15880
v_mfma_f32_16x16x32_bf16 v[148:151], a[224:227], a[100:103], v[148:151]
s_waitcnt lgkmcnt(8)
ds_read_b128 a[112:115], v34 offset:2048
v_lshlrev_b32 v43, 16, v29
v_mfma_f32_16x16x32_bf16 v[156:159], a[232:235], a[100:103], v[156:159]
s_add_u32 m0, s43, 76688
ds_read_b64_tr_b16 a[224:225], v193 offset:8192
ds_read_b64_tr_b16 a[226:227], v193 offset:8448
v_mfma_f32_16x16x32_bf16 v[156:159], a[236:239], a[108:111], v[156:159]
buffer_load_dwordx4 v199, s[12:15], s52 offen offset:128 lds
v_and_b32 v29, s55, v29
v_mfma_f32_16x16x32_bf16 v[152:155], a[236:239], a[104:107], v[152:155]
ds_read_b64_tr_b16 a[228:229], v193 offset:17408
ds_read_b64_tr_b16 a[230:231], v193 offset:17664
v_mfma_f32_16x16x32_bf16 v[152:155], a[232:235], a[96:99], v[152:155]
s_waitcnt lgkmcnt(9)
ds_read_b128 a[120:123], v35 offset:2048
v_lshlrev_b32 v42, 16, v21
v_mfma_f32_16x16x32_bf16 v[160:163], a[240:243], a[96:99], v[160:163]
ds_read_b64_tr_b16 a[232:233], v193 offset:8200
ds_read_b64_tr_b16 a[234:235], v193 offset:8456
v_mfma_f32_16x16x32_bf16 v[160:163], a[244:247], a[104:107], v[160:163]
v_and_b32 v21, s55, v21
v_add_f32 v44, v42, v43
v_subrev_f32 v43, v42, v43
v_mfma_f32_16x16x32_bf16 v[164:167], a[244:247], a[108:111], v[164:167]
ds_read_b64_tr_b16 a[236:237], v193 offset:17416
ds_read_b64_tr_b16 a[238:239], v193 offset:17672
v_mfma_f32_16x16x32_bf16 v[164:167], a[240:243], a[100:103], v[164:167]
s_waitcnt vmcnt(8) lgkmcnt(10)
s_barrier
ds_read_b128 a[124:127], v35
v_add_f32 v42, v21, v29
v_mfma_f32_16x16x32_bf16 v[172:175], a[248:251], a[100:103], v[172:175]
s_add_u32 m0, s43, 78608
ds_read_b64_tr_b16 a[240:241], v195 offset:36872
ds_read_b64_tr_b16 a[242:243], v195 offset:37384
v_mfma_f32_16x16x32_bf16 v[172:175], a[252:255], a[108:111], v[172:175]
buffer_load_dwordx4 v199, s[12:15], s52 offen offset:256 lds
v_subrev_f32 v29, v21, v29
v_mfma_f32_16x16x32_bf16 v[168:171], a[252:255], a[104:107], v[168:171]
ds_read_b64_tr_b16 a[244:245], v195 offset:46088
ds_read_b64_tr_b16 a[246:247], v195 offset:46600
v_mfma_f32_16x16x32_bf16 v[168:171], a[248:251], a[96:99], v[168:171]
s_waitcnt lgkmcnt(10)
ds_read_b128 a[116:119], v34
v_cvt_pk_bf16_f32 v21, v44, v42
v_mfma_f32_16x16x32_bf16 v[176:179], a[224:227], a[96:99], v[176:179]
s_add_u32 m0, s43, 80528
ds_read_b64_tr_b16 a[248:249], v195 offset:36880
ds_read_b64_tr_b16 a[250:251], v195 offset:37392
v_mfma_f32_16x16x32_bf16 v[176:179], a[228:231], a[104:107], v[176:179]
buffer_load_dwordx4 v199, s[12:15], s52 offen offset:384 lds
v_mfma_f32_16x16x32_bf16 v[180:183], a[228:231], a[108:111], v[180:183]
ds_read_b64_tr_b16 a[252:253], v195 offset:46096
ds_read_b64_tr_b16 a[254:255], v195 offset:46608
v_mfma_f32_16x16x32_bf16 v[180:183], a[224:227], a[100:103], v[180:183]
s_waitcnt lgkmcnt(10)
v_cvt_pk_bf16_f32 v29, v43, v29
v_lshlrev_b32 v43, 16, v30
v_and_b32 v30, s55, v30
v_mfma_f32_16x16x32_bf16 v[188:191], a[232:235], a[100:103], v[188:191]
s_add_u32 m0, s43, 81424
ds_read_b64_tr_b16 a[224:225], v197 offset:36872
ds_read_b64_tr_b16 a[226:227], v197 offset:37384
v_mfma_f32_16x16x32_bf16 v[188:191], a[236:239], a[108:111], v[188:191]
buffer_load_dwordx4 v192, s[12:15], s51 offen offset:512 lds
v_mfma_f32_16x16x32_bf16 v[184:187], a[236:239], a[104:107], v[184:187]
ds_read_b64_tr_b16 a[228:229], v197 offset:46088
ds_read_b64_tr_b16 a[230:231], v197 offset:46600
v_mfma_f32_16x16x32_bf16 v[184:187], a[232:235], a[96:99], v[184:187]
s_waitcnt lgkmcnt(9)
v_lshlrev_b32 v42, 16, v22
v_and_b32 v22, s55, v22
v_add_f32 v44, v42, v43
v_mfma_f32_16x16x32_bf16 v[48:51], a[240:243], a[112:115], v[48:51]
ds_read_b64_tr_b16 a[232:233], v197 offset:36880
ds_read_b64_tr_b16 a[234:235], v197 offset:37392
v_mfma_f32_16x16x32_bf16 v[48:51], a[244:247], a[120:123], v[48:51]
s_waitcnt lgkmcnt(10)
v_subrev_f32 v43, v42, v43
v_add_f32 v42, v22, v30
v_mfma_f32_16x16x32_bf16 v[52:55], a[244:247], a[124:127], v[52:55]
s_sub_u32 m0, s48, 128
ds_read_b64_tr_b16 a[236:237], v197 offset:46096
ds_read_b64_tr_b16 a[238:239], v197 offset:46608
v_mfma_f32_16x16x32_bf16 v[52:55], a[240:243], a[116:119], v[52:55]
s_waitcnt lgkmcnt(8)
buffer_load_dwordx4 v36, s[8:11], s63 offen offset:2176 lds
v_subrev_f32 v30, v22, v30
v_mfma_f32_16x16x32_bf16 v[60:63], a[248:251], a[116:119], v[60:63]
ds_read_b64_tr_b16 a[240:241], v195 offset:38920
ds_read_b64_tr_b16 a[242:243], v195 offset:39432
v_mfma_f32_16x16x32_bf16 v[60:63], a[252:255], a[124:127], v[60:63]
v_cvt_pk_bf16_f32 v22, v44, v42
v_cvt_pk_bf16_f32 v30, v43, v30
v_mfma_f32_16x16x32_bf16 v[56:59], a[252:255], a[120:123], v[56:59]
s_add_u32 m0, s48, 896
ds_read_b64_tr_b16 a[244:245], v195 offset:48136
ds_read_b64_tr_b16 a[246:247], v195 offset:48648
v_mfma_f32_16x16x32_bf16 v[56:59], a[248:251], a[112:115], v[56:59]
s_waitcnt lgkmcnt(8)
buffer_load_dwordx4 v36, s[8:11], s83 offen offset:2176 lds
v_lshlrev_b32 v43, 16, v31
v_mfma_f32_16x16x32_bf16 v[64:67], a[224:227], a[112:115], v[64:67]
ds_read_b64_tr_b16 a[248:249], v195 offset:38928
ds_read_b64_tr_b16 a[250:251], v195 offset:39440
v_mfma_f32_16x16x32_bf16 v[64:67], a[228:231], a[120:123], v[64:67]
v_and_b32 v31, s55, v31
v_lshlrev_b32 v42, 16, v23
v_mfma_f32_16x16x32_bf16 v[68:71], a[228:231], a[124:127], v[68:71]
s_sub_u32 m0, s48, 128
ds_read_b64_tr_b16 a[252:253], v195 offset:48144
ds_read_b64_tr_b16 a[254:255], v195 offset:48656
v_mfma_f32_16x16x32_bf16 v[68:71], a[224:227], a[116:119], v[68:71]
s_waitcnt lgkmcnt(8)
s_waitcnt lgkmcnt(0)
s_cmp_lt_u32 s3, 90
s_cbranch_scc1 L_slow
L_back:
buffer_load_dwordx4 v36, s[8:11], s44 offen offset:128 lds
v_and_b32 v23, s55, v23
v_mfma_f32_16x16x32_bf16 v[76:79], a[232:235], a[116:119], v[76:79]
ds_read_b64_tr_b16 a[224:225], v197 offset:38920
ds_read_b64_tr_b16 a[226:227], v197 offset:39432
v_mfma_f32_16x16x32_bf16 v[76:79], a[236:239], a[124:127], v[76:79]
v_add_f32 v44, v42, v43
v_subrev_f32 v43, v42, v43
v_mfma_f32_16x16x32_bf16 v[72:75], a[236:239], a[120:123], v[72:75]
s_mul_i32 s43, s40, 9216
ds_read_b64_tr_b16 a[228:229], v197 offset:48136
ds_read_b64_tr_b16 a[230:231], v197 offset:48648
v_mfma_f32_16x16x32_bf16 v[72:75], a[232:235], a[112:115], v[72:75]
v_add_f32 v42, v23, v31
v_subrev_f32 v31, v23, v31
v_cvt_pk_bf16_f32 v23, v44, v42
v_mfma_f32_16x16x32_bf16 v[80:83], a[240:243], a[112:115], v[80:83]
s_add_u32 m0, s48, 896
ds_read_b64_tr_b16 a[232:233], v197 offset:38928
ds_read_b64_tr_b16 a[234:235], v197 offset:39440
v_mfma_f32_16x16x32_bf16 v[80:83], a[244:247], a[120:123], v[80:83]
buffer_load_dwordx4 v36, s[8:11], s45 offen offset:128 lds
v_mfma_f32_16x16x32_bf16 v[84:87], a[244:247], a[124:127], v[84:87]
s_add_u32 s52, s47, 0
ds_read_b64_tr_b16 a[236:237], v197 offset:48144
ds_read_b64_tr_b16 a[238:239], v197 offset:48656
v_mfma_f32_16x16x32_bf16 v[84:87], a[240:243], a[116:119], v[84:87]
v_cvt_pk_bf16_f32 v31, v43, v31
v_lshlrev_b32 v43, 16, v12
v_mfma_f32_16x16x32_bf16 v[92:95], a[248:251], a[116:119], v[92:95]
s_add_u32 m0, s43, 0
ds_read_b64_tr_b16 a[240:241], v195 offset:40968
ds_read_b64_tr_b16 a[242:243], v195 offset:41480
v_mfma_f32_16x16x32_bf16 v[92:95], a[252:255], a[124:127], v[92:95]
buffer_load_dwordx4 v32, s[16:19], s52 offen sc1 lds
v_and_b32 v12, s55, v12
v_mfma_f32_16x16x32_bf16 v[88:91], a[252:255], a[120:123], v[88:91]
ds_read_b64_tr_b16 a[244:245], v195 offset:50184
ds_read_b64_tr_b16 a[246:247], v195 offset:50696
v_mfma_f32_16x16x32_bf16 v[88:91], a[248:251], a[112:115], v[88:91]
s_waitcnt lgkmcnt(8)
v_lshlrev_b32 v42, 16, v4
v_and_b32 v4, s55, v4
v_mfma_f32_16x16x32_bf16 v[96:99], a[224:227], a[112:115], v[96:99]
ds_read_b64_tr_b16 a[248:249], v195 offset:40976
ds_read_b64_tr_b16 a[250:251], v195 offset:41488
v_mfma_f32_16x16x32_bf16 v[96:99], a[228:231], a[120:123], v[96:99]
buffer_load_dwordx4 v32, s[16:19], s52 offen offset:1024 sc1 lds
v_add_f32 v44, v42, v43
v_mfma_f32_16x16x32_bf16 v[100:103], a[228:231], a[124:127], v[100:103]
ds_read_b64_tr_b16 a[252:253], v195 offset:50192
ds_read_b64_tr_b16 a[254:255], v195 offset:50704
v_mfma_f32_16x16x32_bf16 v[100:103], a[224:227], a[116:119], v[100:103]
s_waitcnt lgkmcnt(8)
v_subrev_f32 v43, v42, v43
v_add_f32 v42, v4, v12
v_mfma_f32_16x16x32_bf16 v[108:111], a[232:235], a[116:119], v[108:111]
ds_read_b64_tr_b16 a[224:225], v197 offset:40968
ds_read_b64_tr_b16 a[226:227], v197 offset:41480
v_mfma_f32_16x16x32_bf16 v[108:111], a[236:239], a[124:127], v[108:111]
v_subrev_f32 v12, v4, v12
v_cvt_pk_bf16_f32 v4, v44, v42
v_cvt_pk_bf16_f32 v12, v43, v12
v_mfma_f32_16x16x32_bf16 v[104:107], a[236:239], a[120:123], v[104:107]
ds_read_b64_tr_b16 a[228:229], v197 offset:50184
ds_read_b64_tr_b16 a[230:231], v197 offset:50696
v_mfma_f32_16x16x32_bf16 v[104:107], a[232:235], a[112:115], v[104:107]
s_waitcnt lgkmcnt(8)
buffer_load_dwordx4 v32, s[16:19], s52 offen offset:2048 sc1 lds
v_mfma_f32_16x16x32_bf16 v[112:115], a[240:243], a[112:115], v[112:115]
ds_read_b64_tr_b16 a[232:233], v197 offset:40976
ds_read_b64_tr_b16 a[234:235], v197 offset:41488
v_mfma_f32_16x16x32_bf16 v[112:115], a[244:247], a[120:123], v[112:115]
v_lshlrev_b32 v43, 16, v13
v_and_b32 v13, s55, v13
v_lshlrev_b32 v42, 16, v5
v_mfma_f32_16x16x32_bf16 v[116:119], a[244:247], a[124:127], v[116:119]
ds_read_b64_tr_b16 a[236:237], v197 offset:50192
ds_read_b64_tr_b16 a[238:239], v197 offset:50704
v_mfma_f32_16x16x32_bf16 v[116:119], a[240:243], a[116:119], v[116:119]
s_waitcnt lgkmcnt(8)
buffer_load_dwordx4 v32, s[16:19], s52 offen offset:3072 sc1 lds
v_mfma_f32_16x16x32_bf16 v[124:127], a[248:251], a[116:119], v[124:127]
s_add_u32 s53, s47, 4096
ds_read_b64_tr_b16 a[240:241], v195 offset:43016
ds_read_b64_tr_b16 a[242:243], v195 offset:43528
v_mfma_f32_16x16x32_bf16 v[124:127], a[252:255], a[124:127], v[124:127]
v_and_b32 v5, s55, v5
v_add_f32 v44, v42, v43
v_subrev_f32 v43, v42, v43
v_mfma_f32_16x16x32_bf16 v[120:123], a[252:255], a[120:123], v[120:123]
s_add_u32 m0, s43, 4096
ds_read_b64_tr_b16 a[244:245], v195 offset:52232
ds_read_b64_tr_b16 a[246:247], v195 offset:52744
v_mfma_f32_16x16x32_bf16 v[120:123], a[248:251], a[112:115], v[120:123]
s_waitcnt lgkmcnt(8)
buffer_load_dwordx4 v32, s[16:19], s53 offen sc1 lds
v_mfma_f32_16x16x32_bf16 v[128:131], a[224:227], a[112:115], v[128:131]
ds_read_b64_tr_b16 a[248:249], v195 offset:43024
ds_read_b64_tr_b16 a[250:251], v195 offset:43536
v_mfma_f32_16x16x32_bf16 v[128:131], a[228:231], a[120:123], v[128:131]
v_add_f32 v42, v5, v13
v_subrev_f32 v13, v5, v13
v_cvt_pk_bf16_f32 v5, v44, v42
v_mfma_f32_16x16x32_bf16 v[132:135], a[228:231], a[124:127], v[132:135]
ds_read_b64_tr_b16 a[252:253], v195 offset:52240
ds_read_b64_tr_b16 a[254:255], v195 offset:52752
v_mfma_f32_16x16x32_bf16 v[132:135], a[224:227], a[116:119], v[132:135]
s_waitcnt lgkmcnt(8)
v_cvt_pk_bf16_f32 v13, v43, v13
v_lshlrev_b32 v43, 16, v14
v_mfma_f32_16x16x32_bf16 v[140:143], a[232:235], a[116:119], v[140:143]
ds_read_b64_tr_b16 a[224:225], v197 offset:43016
ds_read_b64_tr_b16 a[226:227], v197 offset:43528
v_mfma_f32_16x16x32_bf16 v[140:143], a[236:239], a[124:127], v[140:143]
buffer_load_dwordx4 v32, s[16:19], s53 offen offset:1024 sc1 lds
v_mfma_f32_16x16x32_bf16 v[136:139], a[236:239], a[120:123], v[136:139]
ds_read_b64_tr_b16 a[228:229], v197 offset:52232
ds_read_b64_tr_b16 a[230:231], v197 offset:52744
v_mfma_f32_16x16x32_bf16 v[136:139], a[232:235], a[112:115], v[136:139]
s_waitcnt lgkmcnt(8)
v_and_b32 v14, s55, v14
v_lshlrev_b32 v42, 16, v6
v_and_b32 v6, s55, v6
v_mfma_f32_16x16x32_bf16 v[144:147], a[240:243], a[112:115], v[144:147]
ds_read_b64_tr_b16 a[232:233], v197 offset:43024
ds_read_b64_tr_b16 a[234:235], v197 offset:43536
v_mfma_f32_16x16x32_bf16 v[144:147], a[244:247], a[120:123], v[144:147]
buffer_load_dwordx4 v32, s[16:19], s53 offen offset:2048 sc1 lds
v_mfma_f32_16x16x32_bf16 v[148:151], a[244:247], a[124:127], v[148:151]
ds_read_b64_tr_b16 a[236:237], v197 offset:52240
ds_read_b64_tr_b16 a[238:239], v197 offset:52752
v_mfma_f32_16x16x32_bf16 v[148:151], a[240:243], a[116:119], v[148:151]
s_waitcnt vmcnt(20) lgkmcnt(8)
ds_read_b128 a[128:131], v34 offset:4096
v_add_f32 v44, v42, v43
v_subrev_f32 v43, v42, v43
v_mfma_f32_16x16x32_bf16 v[156:159], a[248:251], a[116:119], v[156:159]
ds_read_b64_tr_b16 a[240:241], v193 offset:45064
ds_read_b64_tr_b16 a[242:243], v193 offset:45320
v_mfma_f32_16x16x32_bf16 v[156:159], a[252:255], a[124:127], v[156:159]
v_add_f32 v42, v6, v14
v_subrev_f32 v14, v6, v14
v_mfma_f32_16x16x32_bf16 v[152:155], a[252:255], a[120:123], v[152:155]
ds_read_b64_tr_b16 a[244:245], v193 offset:54280
ds_read_b64_tr_b16 a[246:247], v193 offset:54536
v_mfma_f32_16x16x32_bf16 v[152:155], a[248:251], a[112:115], v[152:155]
s_waitcnt lgkmcnt(9)
buffer_load_dwordx4 v32, s[16:19], s53 offen offset:3072 sc1 lds
ds_read_b128 a[136:139], v35 offset:4096
v_cvt_pk_bf16_f32 v6, v44, v42
v_mfma_f32_16x16x32_bf16 v[160:163], a[224:227], a[112:115], v[160:163]
ds_read_b64_tr_b16 a[248:249], v193 offset:45072
ds_read_b64_tr_b16 a[250:251], v193 offset:45328
v_mfma_f32_16x16x32_bf16 v[160:163], a[228:231], a[120:123], v[160:163]
L_pg4:
s_cbranch_vccnz L_vr0
v_cvt_pk_bf16_f32 v14, v43, v14
v_lshlrev_b32 v43, 16, v15
v_mfma_f32_16x16x32_bf16 v[164:167], a[228:231], a[124:127], v[164:167]
s_add_u32 s54, s47, 8192
ds_read_b64_tr_b16 a[252:253], v193 offset:54288
ds_read_b64_tr_b16 a[254:255], v193 offset:54544
v_mfma_f32_16x16x32_bf16 v[164:167], a[224:227], a[116:119], v[164:167]
s_waitcnt vmcnt(10) lgkmcnt(10)
s_barrier
ds_read_b128 a[140:143], v35 offset:2048
v_and_b32 v15, s55, v15
v_lshlrev_b32 v42, 16, v7
v_mfma_f32_16x16x32_bf16 v[172:175], a[232:235], a[116:119], v[172:175]
s_add_u32 m0, s43, 8192
ds_read_b64_tr_b16 a[224:225], v196
ds_read_b64_tr_b16 a[226:227], v196 offset:512
v_mfma_f32_16x16x32_bf16 v[172:175], a[236:239], a[124:127], v[172:175]
s_load_dword s77, s[78:79], 20480
buffer_load_dwordx4 v32, s[16:19], s54 offen sc1 lds
v_mfma_f32_16x16x32_bf16 v[168:171], a[236:239], a[120:123], v[168:171]
ds_read_b64_tr_b16 a[228:229], v196 offset:9216
ds_read_b64_tr_b16 a[230:231], v196 offset:9728
v_mfma_f32_16x16x32_bf16 v[168:171], a[232:235], a[112:115], v[168:171]
s_waitcnt lgkmcnt(10)
ds_read_b128 a[132:135], v34 offset:2048
v_and_b32 v7, s55, v7
v_add_f32 v44, v42, v43
v_mfma_f32_16x16x32_bf16 v[176:179], a[240:243], a[112:115], v[176:179]
s_add_u32 m0, s48, 6016
ds_read_b64_tr_b16 a[232:233], v196 offset:8
ds_read_b64_tr_b16 a[234:235], v196 offset:520
v_mfma_f32_16x16x32_bf16 v[176:179], a[244:247], a[120:123], v[176:179]
buffer_load_dwordx4 v36, s[8:11], s63 offen offset:128 lds
v_mfma_f32_16x16x32_bf16 v[180:183], a[244:247], a[124:127], v[180:183]
ds_read_b64_tr_b16 a[236:237], v196 offset:9224
ds_read_b64_tr_b16 a[238:239], v196 offset:9736
v_mfma_f32_16x16x32_bf16 v[180:183], a[240:243], a[116:119], v[180:183]
s_waitcnt lgkmcnt(10)
v_subrev_f32 v43, v42, v43
v_add_f32 v42, v7, v15
v_subrev_f32_e64 v15, v7, v15
v_mfma_f32_16x16x32_bf16 v[188:191], a[248:251], a[116:119], v[188:191]
s_add_u32 m0, s48, 7040
ds_read_b64_tr_b16 a[240:241], v198
ds_read_b64_tr_b16 a[242:243], v198 offset:512
v_mfma_f32_16x16x32_bf16 v[188:191], a[252:255], a[124:127], v[188:191]
buffer_load_dwordx4 v36, s[8:11], s83 offen offset:128 lds
v_mfma_f32_16x16x32_bf16 v[184:187], a[252:255], a[120:123], v[184:187]
ds_read_b64_tr_b16 a[244:245], v198 offset:9216
ds_read_b64_tr_b16 a[246:247], v198 offset:9728
v_mfma_f32_16x16x32_bf16 v[184:187], a[248:251], a[112:115], v[184:187]
s_waitcnt lgkmcnt(9)
v_cvt_pk_bf16_f32 v7, v44, v42
v_cvt_pk_bf16_f32 v15, v43, v15
v_mfma_f32_16x16x32_bf16 v[48:51], a[224:227], a[128:131], v[48:51]
ds_read_b64_tr_b16 a[248:249], v198 offset:8
ds_read_b64_tr_b16 a[250:251], v198 offset:520
v_mfma_f32_16x16x32_bf16 v[48:51], a[228:231], a[136:139], v[48:51]
s_waitcnt lgkmcnt(10)
ds_read_b128 v[240:243], v38
ds_read_b128 v[244:247], v38 offset:2048
v_mfma_f32_16x16x32_bf16 v[52:55], a[228:231], a[140:143], v[52:55]
s_add_u32 m0, s48, 3840
ds_read_b64_tr_b16 a[252:253], v198 offset:9224
ds_read_b64_tr_b16 a[254:255], v198 offset:9736
v_mfma_f32_16x16x32_bf16 v[52:55], a[224:227], a[132:135], v[52:55]
s_waitcnt lgkmcnt(10)
buffer_load_dwordx4 v36, s[8:11], s44 offen offset:256 lds
v_mfma_f32_16x16x32_bf16 v[60:63], a[232:235], a[132:135], v[60:63]
ds_read_b64_tr_b16 a[224:225], v196 offset:2048
ds_read_b64_tr_b16 a[226:227], v196 offset:2560
v_mfma_f32_16x16x32_bf16 v[60:63], a[236:239], a[140:143], v[60:63]
ds_read_b128 v[248:251], v38 offset:16
ds_read_b128 v[252:255], v38 offset:2064
v_mfma_f32_16x16x32_bf16 v[56:59], a[236:239], a[136:139], v[56:59]
s_add_u32 m0, s48, 4864
ds_read_b64_tr_b16 a[228:229], v196 offset:11264
s_waitcnt lgkmcnt(12)
ds_read_b64_tr_b16 a[230:231], v196 offset:11776
v_mfma_f32_16x16x32_bf16 v[56:59], a[232:235], a[128:131], v[56:59]
s_waitcnt lgkmcnt(12)
buffer_load_dwordx4 v36, s[8:11], s45 offen offset:256 lds
v_mfma_f32_16x16x32_bf16 v[64:67], a[240:243], a[128:131], v[64:67]
ds_read_b64_tr_b16 a[232:233], v196 offset:2056
ds_read_b64_tr_b16 a[234:235], v196 offset:2568
v_mfma_f32_16x16x32_bf16 v[64:67], a[244:247], a[136:139], v[64:67]
v_sub_f32_dpp v48, v48, v48 row_shr:1 row_mask:0xf bank_mask:0xf bound_ctrl:1
v_sub_f32_dpp v49, v49, v49 row_shr:1 row_mask:0xf bank_mask:0xf bound_ctrl:1
v_sub_f32_dpp v50, v50, v50 row_shr:1 row_mask:0xf bank_mask:0xf bound_ctrl:1
v_mfma_f32_16x16x32_bf16 v[68:71], a[244:247], a[140:143], v[68:71]
s_add_u32 s52, s68, 36864
ds_read_b64_tr_b16 a[236:237], v196 offset:11272
s_waitcnt lgkmcnt(12)
ds_read_b64_tr_b16 a[238:239], v196 offset:11784
v_mfma_f32_16x16x32_bf16 v[68:71], a[240:243], a[132:135], v[68:71]
s_waitcnt lgkmcnt(10)
v_sub_f32_dpp v51, v51, v51 row_shr:1 row_mask:0xf bank_mask:0xf bound_ctrl:1
v_sub_f32_dpp v52, v52, v52 row_shr:1 row_mask:0xf bank_mask:0xf bound_ctrl:1
v_sub_f32_dpp v53, v53, v53 row_shr:1 row_mask:0xf bank_mask:0xf bound_ctrl:1
v_sub_f32_dpp v54, v54, v54 row_shr:1 row_mask:0xf bank_mask:0xf bound_ctrl:1
v_sub_f32_dpp v55, v55, v55 row_shr:1 row_mask:0xf bank_mask:0xf bound_ctrl:1
v_pk_fma_f32 v[48:49], v[48:49], v[240:241], v[244:245]
v_pk_fma_f32 v[50:51], v[50:51], v[242:243], v[246:247]
v_pk_fma_f32 v[52:53], v[52:53], v[240:241], v[244:245]
v_pk_fma_f32 v[54:55], v[54:55], v[242:243], v[246:247]
v_mfma_f32_16x16x32_bf16 v[76:79], a[248:251], a[132:135], v[76:79]
s_add_u32 m0, s43, 36864
ds_read_b64_tr_b16 a[240:241], v198 offset:2048
ds_read_b64_tr_b16 a[242:243], v198 offset:2560
v_mfma_f32_16x16x32_bf16 v[76:79], a[252:255], a[140:143], v[76:79]
buffer_load_dwordx4 v32, s[16:19], s52 offen sc1 lds
ds_read_b128 v[240:243], v38 offset:128
v_mfma_f32_16x16x32_bf16 v[72:75], a[252:255], a[136:139], v[72:75]
ds_read_b64_tr_b16 a[244:245], v198 offset:11264
ds_read_b64_tr_b16 a[246:247], v198 offset:11776
v_mfma_f32_16x16x32_bf16 v[72:75], a[248:251], a[128:131], v[72:75]
s_waitcnt lgkmcnt(9)
ds_read_b128 v[244:247], v38 offset:2176
v_sub_f32_dpp v60, v60, v60 row_shr:1 row_mask:0xf bank_mask:0xf bound_ctrl:1
v_sub_f32_dpp v61, v61, v61 row_shr:1 row_mask:0xf bank_mask:0xf bound_ctrl:1
v_mfma_f32_16x16x32_bf16 v[80:83], a[224:227], a[128:131], v[80:83]
ds_read_b64_tr_b16 a[248:249], v198 offset:2056
ds_read_b64_tr_b16 a[250:251], v198 offset:2568
v_mfma_f32_16x16x32_bf16 v[80:83], a[228:231], a[136:139], v[80:83]
buffer_load_dwordx4 v32, s[16:19], s52 offen offset:1024 sc1 lds
v_sub_f32_dpp v62, v62, v62 row_shr:1 row_mask:0xf bank_mask:0xf bound_ctrl:1
v_mfma_f32_16x16x32_bf16 v[84:87], a[228:231], a[140:143], v[84:87]
ds_read_b64_tr_b16 a[252:253], v198 offset:11272
ds_read_b64_tr_b16 a[254:255], v198 offset:11784
v_mfma_f32_16x16x32_bf16 v[84:87], a[224:227], a[132:135], v[84:87]
s_waitcnt lgkmcnt(10)
v_sub_f32_dpp v63, v63, v63 row_shr:1 row_mask:0xf bank_mask:0xf bound_ctrl:1
v_sub_f32_dpp v56, v56, v56 row_shr:1 row_mask:0xf bank_mask:0xf bound_ctrl:1
v_sub_f32_dpp v57, v57, v57 row_shr:1 row_mask:0xf bank_mask:0xf bound_ctrl:1
v_sub_f32_dpp v58, v58, v58 row_shr:1 row_mask:0xf bank_mask:0xf bound_ctrl:1
v_sub_f32_dpp v59, v59, v59 row_shr:1 row_mask:0xf bank_mask:0xf bound_ctrl:1
v_pk_fma_f32 v[60:61], v[60:61], v[248:249], v[252:253]
v_pk_fma_f32 v[62:63], v[62:63], v[250:251], v[254:255]
v_pk_fma_f32 v[56:57], v[56:57], v[248:249], v[252:253]
v_pk_fma_f32 v[58:59], v[58:59], v[250:251], v[254:255]
v_mfma_f32_16x16x32_bf16 v[92:95], a[232:235], a[132:135], v[92:95]
ds_read_b64_tr_b16 a[224:225], v196 offset:4096
ds_read_b64_tr_b16 a[226:227], v196 offset:4608
v_mfma_f32_16x16x32_bf16 v[92:95], a[236:239], a[140:143], v[92:95]
ds_read_b128 v[248:251], v38 offset:144
ds_read_b128 v[252:255], v38 offset:2192
v_sub_f32_dpp v64, v64, v64 row_shr:1 row_mask:0xf bank_mask:0xf bound_ctrl:1
v_mfma_f32_16x16x32_bf16 v[88:91], a[236:239], a[136:139], v[88:91]
ds_read_b64_tr_b16 a[228:229], v196 offset:13312
s_waitcnt lgkmcnt(12)
ds_read_b64_tr_b16 a[230:231], v196 offset:13824
v_mfma_f32_16x16x32_bf16 v[88:91], a[232:235], a[128:131], v[88:91]
s_waitcnt lgkmcnt(11)
buffer_load_dwordx4 v32, s[16:19], s52 offen offset:2048 sc1 lds
v_sub_f32_dpp v65, v65, v65 row_shr:1 row_mask:0xf bank_mask:0xf bound_ctrl:1
v_mfma_f32_16x16x32_bf16 v[96:99], a[240:243], a[128:131], v[96:99]
ds_read_b64_tr_b16 a[232:233], v196 offset:4104
ds_read_b64_tr_b16 a[234:235], v196 offset:4616
v_mfma_f32_16x16x32_bf16 v[96:99], a[244:247], a[136:139], v[96:99]
v_sub_f32_dpp v66, v66, v66 row_shr:1 row_mask:0xf bank_mask:0xf bound_ctrl:1
v_sub_f32_dpp v67, v67, v67 row_shr:1 row_mask:0xf bank_mask:0xf bound_ctrl:1
v_sub_f32_dpp v68, v68, v68 row_shr:1 row_mask:0xf bank_mask:0xf bound_ctrl:1
v_mfma_f32_16x16x32_bf16 v[100:103], a[244:247], a[140:143], v[100:103]
s_waitcnt vmcnt(63)
ds_read_b64_tr_b16 a[236:237], v196 offset:13320
ds_read_b64_tr_b16 a[238:239], v196 offset:13832
v_mfma_f32_16x16x32_bf16 v[100:103], a[240:243], a[132:135], v[100:103]
s_waitcnt lgkmcnt(10)
buffer_load_dwordx4 v32, s[16:19], s52 offen offset:3072 sc1 lds
v_sub_f32_dpp v69, v69, v69 row_shr:1 row_mask:0xf bank_mask:0xf bound_ctrl:1
v_sub_f32_dpp v70, v70, v70 row_shr:1 row_mask:0xf bank_mask:0xf bound_ctrl:1
v_sub_f32_dpp v71, v71, v71 row_shr:1 row_mask:0xf bank_mask:0xf bound_ctrl:1
v_pk_fma_f32 v[64:65], v[64:65], v[240:241], v[244:245]
v_pk_fma_f32 v[66:67], v[66:67], v[242:243], v[246:247]
v_pk_fma_f32 v[68:69], v[68:69], v[240:241], v[244:245]
v_pk_fma_f32 v[70:71], v[70:71], v[242:243], v[246:247]
v_mfma_f32_16x16x32_bf16 v[108:111], a[248:251], a[132:135], v[108:111]
ds_read_b64_tr_b16 a[240:241], v198 offset:4096
ds_read_b64_tr_b16 a[242:243], v198 offset:4608
v_mfma_f32_16x16x32_bf16 v[108:111], a[252:255], a[140:143], v[108:111]
ds_read_b128 v[240:243], v38 offset:256
ds_read_b128 v[244:247], v38 offset:2304
v_sub_f32_dpp v76, v76, v76 row_shr:1 row_mask:0xf bank_mask:0xf bound_ctrl:1
v_mfma_f32_16x16x32_bf16 v[104:107], a[252:255], a[136:139], v[104:107]
s_add_u32 s53, s68, 40960
ds_read_b64_tr_b16 a[244:245], v198 offset:13312
s_waitcnt lgkmcnt(12)
ds_read_b64_tr_b16 a[246:247], v198 offset:13824
v_mfma_f32_16x16x32_bf16 v[104:107], a[248:251], a[128:131], v[104:107]
s_waitcnt lgkmcnt(10)
v_sub_f32_dpp v77, v77, v77 row_shr:1 row_mask:0xf bank_mask:0xf bound_ctrl:1
v_sub_f32_dpp v78, v78, v78 row_shr:1 row_mask:0xf bank_mask:0xf bound_ctrl:1
v_sub_f32_dpp v79, v79, v79 row_shr:1 row_mask:0xf bank_mask:0xf bound_ctrl:1
v_sub_f32_dpp v72, v72, v72 row_shr:1 row_mask:0xf bank_mask:0xf bound_ctrl:1
v_mfma_f32_16x16x32_bf16 v[112:115], a[224:227], a[128:131], v[112:115]
s_add_u32 m0, s43, 40960
ds_read_b64_tr_b16 a[248:249], v198 offset:4104
ds_read_b64_tr_b16 a[250:251], v198 offset:4616
v_mfma_f32_16x16x32_bf16 v[112:115], a[228:231], a[136:139], v[112:115]
buffer_load_dwordx4 v32, s[16:19], s53 offen sc1 lds
v_sub_f32_dpp v73, v73, v73 row_shr:1 row_mask:0xf bank_mask:0xf bound_ctrl:1
v_sub_f32_dpp v74, v74, v74 row_shr:1 row_mask:0xf bank_mask:0xf bound_ctrl:1
v_sub_f32_dpp v75, v75, v75 row_shr:1 row_mask:0xf bank_mask:0xf bound_ctrl:1
v_pk_fma_f32 v[76:77], v[76:77], v[248:249], v[252:253]
v_pk_fma_f32 v[78:79], v[78:79], v[250:251], v[254:255]
v_pk_fma_f32 v[72:73], v[72:73], v[248:249], v[252:253]
v_pk_fma_f32 v[74:75], v[74:75], v[250:251], v[254:255]
v_mfma_f32_16x16x32_bf16 v[116:119], a[228:231], a[140:143], v[116:119]
ds_read_b64_tr_b16 a[252:253], v198 offset:13320
ds_read_b64_tr_b16 a[254:255], v198 offset:13832
v_mfma_f32_16x16x32_bf16 v[116:119], a[224:227], a[132:135], v[116:119]
s_waitcnt lgkmcnt(10)
ds_read_b128 v[248:251], v38 offset:272
ds_read_b128 v[252:255], v38 offset:2320
v_sub_f32_dpp v80, v80, v80 row_shr:1 row_mask:0xf bank_mask:0xf bound_ctrl:1
v_mfma_f32_16x16x32_bf16 v[124:127], a[232:235], a[132:135], v[124:127]
ds_read_b64_tr_b16 a[224:225], v196 offset:6144
ds_read_b64_tr_b16 a[226:227], v196 offset:6656
v_mfma_f32_16x16x32_bf16 v[124:127], a[236:239], a[140:143], v[124:127]
s_waitcnt vmcnt(63)
buffer_load_dwordx4 v32, s[16:19], s53 offen offset:1024 sc1 lds
v_sub_f32_dpp v81, v81, v81 row_shr:1 row_mask:0xf bank_mask:0xf bound_ctrl:1
v_sub_f32_dpp v82, v82, v82 row_shr:1 row_mask:0xf bank_mask:0xf bound_ctrl:1
v_mfma_f32_16x16x32_bf16 v[120:123], a[236:239], a[136:139], v[120:123]
ds_read_b64_tr_b16 a[228:229], v196 offset:15360
s_waitcnt lgkmcnt(12)
ds_read_b64_tr_b16 a[230:231], v196 offset:15872
v_mfma_f32_16x16x32_bf16 v[120:123], a[232:235], a[128:131], v[120:123]
s_waitcnt lgkmcnt(10)
v_sub_f32_dpp v83, v83, v83 row_shr:1 row_mask:0xf bank_mask:0xf bound_ctrl:1
v_sub_f32_dpp v84, v84, v84 row_shr:1 row_mask:0xf bank_mask:0xf bound_ctrl:1
v_sub_f32_dpp v85, v85, v85 row_shr:1 row_mask:0xf bank_mask:0xf bound_ctrl:1
v_sub_f32_dpp v86, v86, v86 row_shr:1 row_mask:0xf bank_mask:0xf bound_ctrl:1
v_sub_f32_dpp v87, v87, v87 row_shr:1 row_mask:0xf bank_mask:0xf bound_ctrl:1
v_pk_fma_f32 v[80:81], v[80:81], v[240:241], v[244:245]
v_pk_fma_f32 v[82:83], v[82:83], v[242:243], v[246:247]
v_pk_fma_f32 v[84:85], v[84:85], v[240:241], v[244:245]
v_pk_fma_f32 v[86:87], v[86:87], v[242:243], v[246:247]
v_mfma_f32_16x16x32_bf16 v[128:131], a[240:243], a[128:131], v[128:131]
ds_read_b64_tr_b16 a[232:233], v196 offset:6152
ds_read_b64_tr_b16 a[234:235], v196 offset:6664
v_mfma_f32_16x16x32_bf16 v[128:131], a[244:247], a[136:139], v[128:131]
ds_read_b128 v[240:243], v38 offset:384
ds_read_b128 v[244:247], v38 offset:2432
v_sub_f32_dpp v92, v92, v92 row_shr:1 row_mask:0xf bank_mask:0xf bound_ctrl:1
v_mfma_f32_16x16x32_bf16 v[132:135], a[244:247], a[140:143], v[132:135]
ds_read_b64_tr_b16 a[236:237], v196 offset:15368
s_waitcnt lgkmcnt(12)
ds_read_b64_tr_b16 a[238:239], v196 offset:15880
v_mfma_f32_16x16x32_bf16 v[132:135], a[240:243], a[132:135], v[132:135]
s_waitcnt lgkmcnt(12)
buffer_load_dwordx4 v32, s[16:19], s53 offen offset:2048 sc1 lds
v_sub_f32_dpp v93, v93, v93 row_shr:1 row_mask:0xf bank_mask:0xf bound_ctrl:1
v_sub_f32_dpp v94, v94, v94 row_shr:1 row_mask:0xf bank_mask:0xf bound_ctrl:1
v_mfma_f32_16x16x32_bf16 v[140:143], a[248:251], a[132:135], v[140:143]
s_waitcnt vmcnt(63)
ds_read_b64_tr_b16 a[240:241], v198 offset:6144
ds_read_b64_tr_b16 a[242:243], v198 offset:6656
v_mfma_f32_16x16x32_bf16 v[140:143], a[252:255], a[140:143], v[140:143]
s_waitcnt lgkmcnt(12)
v_sub_f32_dpp v95, v95, v95 row_shr:1 row_mask:0xf bank_mask:0xf bound_ctrl:1
v_sub_f32_dpp v88, v88, v88 row_shr:1 row_mask:0xf bank_mask:0xf bound_ctrl:1
v_sub_f32_dpp v89, v89, v89 row_shr:1 row_mask:0xf bank_mask:0xf bound_ctrl:1
v_sub_f32_dpp v90, v90, v90 row_shr:1 row_mask:0xf bank_mask:0xf bound_ctrl:1
v_sub_f32_dpp v91, v91, v91 row_shr:1 row_mask:0xf bank_mask:0xf bound_ctrl:1
v_pk_fma_f32 v[92:93], v[92:93], v[248:249], v[252:253]
v_pk_fma_f32 v[94:95], v[94:95], v[250:251], v[254:255]
v_pk_fma_f32 v[88:89], v[88:89], v[248:249], v[252:253]
v_pk_fma_f32 v[90:91], v[90:91], v[250:251], v[254:255]
v_mfma_f32_16x16x32_bf16 v[136:139], a[252:255], a[136:139], v[136:139]
ds_read_b64_tr_b16 a[244:245], v198 offset:15360
ds_read_b64_tr_b16 a[246:247], v198 offset:15872
v_mfma_f32_16x16x32_bf16 v[136:139], a[248:251], a[128:131], v[136:139]
s_waitcnt lgkmcnt(10)
buffer_load_dwordx4 v32, s[16:19], s53 offen offset:3072 sc1 lds
ds_read_b128 v[248:251], v38 offset:400
v_mfma_f32_16x16x32_bf16 v[144:147], a[224:227], a[128:131], v[144:147]
ds_read_b64_tr_b16 a[248:249], v198 offset:6152
ds_read_b64_tr_b16 a[250:251], v198 offset:6664
v_mfma_f32_16x16x32_bf16 v[144:147], a[228:231], a[136:139], v[144:147]
ds_read_b128 v[252:255], v38 offset:2448
v_sub_f32_dpp v96, v96, v96 row_shr:1 row_mask:0xf bank_mask:0xf bound_ctrl:1
v_sub_f32_dpp v97, v97, v97 row_shr:1 row_mask:0xf bank_mask:0xf bound_ctrl:1
v_mfma_f32_16x16x32_bf16 v[148:151], a[228:231], a[140:143], v[148:151]
s_add_u32 s54, s68, 45056
ds_read_b64_tr_b16 a[252:253], v198 offset:15368
s_waitcnt lgkmcnt(12)
ds_read_b64_tr_b16 a[254:255], v198 offset:15880
v_mfma_f32_16x16x32_bf16 v[148:151], a[224:227], a[132:135], v[148:151]
s_waitcnt lgkmcnt(10)
v_sub_f32_dpp v98, v98, v98 row_shr:1 row_mask:0xf bank_mask:0xf bound_ctrl:1
v_sub_f32_dpp v99, v99, v99 row_shr:1 row_mask:0xf bank_mask:0xf bound_ctrl:1
v_sub_f32_dpp v100, v100, v100 row_shr:1 row_mask:0xf bank_mask:0xf bound_ctrl:1
v_mfma_f32_16x16x32_bf16 v[156:159], a[232:235], a[132:135], v[156:159]
s_add_u32 m0, s43, 45056
ds_read_b64_tr_b16 a[224:225], v194 offset:8192
ds_read_b64_tr_b16 a[226:227], v194 offset:8448
v_mfma_f32_16x16x32_bf16 v[156:159], a[236:239], a[140:143], v[156:159]
s_waitcnt vmcnt(63)
buffer_load_dwordx4 v32, s[16:19], s54 offen sc1 lds
v_sub_f32_dpp v101, v101, v101 row_shr:1 row_mask:0xf bank_mask:0xf bound_ctrl:1
v_sub_f32_dpp v102, v102, v102 row_shr:1 row_mask:0xf bank_mask:0xf bound_ctrl:1
v_sub_f32_dpp v103, v103, v103 row_shr:1 row_mask:0xf bank_mask:0xf bound_ctrl:1
v_pk_fma_f32 v[96:97], v[96:97], v[240:241], v[244:245]
v_pk_fma_f32 v[98:99], v[98:99], v[242:243], v[246:247]
v_pk_fma_f32 v[100:101], v[100:101], v[240:241], v[244:245]
v_pk_fma_f32 v[102:103], v[102:103], v[242:243], v[246:247]
v_mfma_f32_16x16x32_bf16 v[152:155], a[236:239], a[136:139], v[152:155]
ds_read_b64_tr_b16 a[228:229], v194 offset:17408
ds_read_b64_tr_b16 a[230:231], v194 offset:17664
v_mfma_f32_16x16x32_bf16 v[152:155], a[232:235], a[128:131], v[152:155]
s_waitcnt lgkmcnt(10)
ds_read_b128 v[240:243], v38 offset:512
ds_read_b128 v[244:247], v38 offset:2560
v_sub_f32_dpp v108, v108, v108 row_shr:1 row_mask:0xf bank_mask:0xf bound_ctrl:1
v_mfma_f32_16x16x32_bf16 v[160:163], a[240:243], a[128:131], v[160:163]
ds_read_b64_tr_b16 a[232:233], v194 offset:8200
ds_read_b64_tr_b16 a[234:235], v194 offset:8456
v_mfma_f32_16x16x32_bf16 v[160:163], a[244:247], a[136:139], v[160:163]
v_sub_f32_dpp v109, v109, v109 row_shr:1 row_mask:0xf bank_mask:0xf bound_ctrl:1
v_sub_f32_dpp v110, v110, v110 row_shr:1 row_mask:0xf bank_mask:0xf bound_ctrl:1
v_sub_f32_dpp v111, v111, v111 row_shr:1 row_mask:0xf bank_mask:0xf bound_ctrl:1
v_mfma_f32_16x16x32_bf16 v[164:167], a[244:247], a[140:143], v[164:167]
s_add_u32 s52, s82, 73728
ds_read_b64_tr_b16 a[236:237], v194 offset:17416
s_waitcnt lgkmcnt(12)
ds_read_b64_tr_b16 a[238:239], v194 offset:17672
v_mfma_f32_16x16x32_bf16 v[164:167], a[240:243], a[132:135], v[164:167]
s_waitcnt vmcnt(13) lgkmcnt(10)
s_barrier
v_mfma_f32_16x16x32_bf16 v[172:175], a[248:251], a[132:135], v[172:175]
s_add_u32 m0, s43, 73728
ds_read_b128 a[240:243], v32
v_sub_f32_dpp v104, v104, v104 row_shr:1 row_mask:0xf bank_mask:0xf bound_ctrl:1
v_mfma_f32_16x16x32_bf16 v[172:175], a[252:255], a[140:143], v[172:175]
buffer_load_dwordx4 v32, s[16:19], s52 offen sc1 lds
v_sub_f32_dpp v105, v105, v105 row_shr:1 row_mask:0xf bank_mask:0xf bound_ctrl:1
v_sub_f32_dpp v106, v106, v106 row_shr:1 row_mask:0xf bank_mask:0xf bound_ctrl:1
v_sub_f32_dpp v107, v107, v107 row_shr:1 row_mask:0xf bank_mask:0xf bound_ctrl:1
v_pk_fma_f32 v[108:109], v[108:109], v[248:249], v[252:253]
v_pk_fma_f32 v[110:111], v[110:111], v[250:251], v[254:255]
v_pk_fma_f32 v[104:105], v[104:105], v[248:249], v[252:253]
v_pk_fma_f32 v[106:107], v[106:107], v[250:251], v[254:255]
v_mfma_f32_16x16x32_bf16 v[168:171], a[252:255], a[136:139], v[168:171]
ds_read_b128 a[244:247], v32 offset:18432
ds_read_b128 v[40:43], v38 offset:528
v_mfma_f32_16x16x32_bf16 v[168:171], a[248:251], a[128:131], v[168:171]
s_waitcnt lgkmcnt(9)
ds_read_b128 v[44:47], v38 offset:2576
v_sub_f32_dpp v112, v112, v112 row_shr:1 row_mask:0xf bank_mask:0xf bound_ctrl:1
v_sub_f32_dpp v113, v113, v113 row_shr:1 row_mask:0xf bank_mask:0xf bound_ctrl:1
v_mfma_f32_16x16x32_bf16 v[176:179], a[224:227], a[128:131], v[176:179]
ds_read_b128 a[248:251], v32 offset:1024
v_sub_f32_dpp v114, v114, v114 row_shr:1 row_mask:0xf bank_mask:0xf bound_ctrl:1
v_mfma_f32_16x16x32_bf16 v[176:179], a[228:231], a[136:139], v[176:179]
s_waitcnt lgkmcnt(9)
v_sub_f32_dpp v115, v115, v115 row_shr:1 row_mask:0xf bank_mask:0xf bound_ctrl:1
v_sub_f32_dpp v116, v116, v116 row_shr:1 row_mask:0xf bank_mask:0xf bound_ctrl:1
v_sub_f32_dpp v117, v117, v117 row_shr:1 row_mask:0xf bank_mask:0xf bound_ctrl:1
v_sub_f32_dpp v118, v118, v118 row_shr:1 row_mask:0xf bank_mask:0xf bound_ctrl:1
v_sub_f32_dpp v119, v119, v119 row_shr:1 row_mask:0xf bank_mask:0xf bound_ctrl:1
v_pk_fma_f32 v[112:113], v[112:113], v[240:241], v[244:245]
v_pk_fma_f32 v[114:115], v[114:115], v[242:243], v[246:247]
v_pk_fma_f32 v[116:117], v[116:117], v[240:241], v[244:245]
v_pk_fma_f32 v[118:119], v[118:119], v[242:243], v[246:247]
v_mfma_f32_16x16x32_bf16 v[180:183], a[228:231], a[140:143], v[180:183]
ds_read_b128 a[252:255], v32 offset:19456
v_accvgpr_write_b32 a148, v116
v_mfma_f32_16x16x32_bf16 v[180:183], a[224:227], a[132:135], v[180:183]
s_waitcnt lgkmcnt(6)
buffer_load_dwordx4 v32, s[16:19], s52 offen offset:1024 sc1 lds
v_mfma_f32_16x16x32_bf16 v[188:191], a[232:235], a[132:135], v[188:191]
ds_read_b128 a[224:227], v32 offset:2048
v_accvgpr_write_b32 a149, v117
v_mfma_f32_16x16x32_bf16 v[188:191], a[236:239], a[140:143], v[188:191]
v_accvgpr_write_b32 a150, v118
v_accvgpr_write_b32 a151, v119
v_accvgpr_write_b32 a144, v112
v_mfma_f32_16x16x32_bf16 v[184:187], a[236:239], a[136:139], v[184:187]
ds_read_b128 a[228:231], v32 offset:20480
v_accvgpr_write_b32 a145, v113
v_mfma_f32_16x16x32_bf16 v[184:187], a[232:235], a[128:131], v[184:187]
s_waitcnt lgkmcnt(7)
v_accvgpr_write_b32 a146, v114
v_accvgpr_write_b32 a147, v115
v_sub_f32_dpp v124, v124, v124 row_shr:1 row_mask:0xf bank_mask:0xf bound_ctrl:1
v_mfma_f32_16x16x32_bf16 v[192:195], a[240:243], v[16:19], v[48:51]
ds_read_b128 a[232:235], v32 offset:3072
v_sub_f32_dpp v125, v125, v125 row_shr:1 row_mask:0xf bank_mask:0xf bound_ctrl:1
v_sub_f32_dpp v126, v126, v126 row_shr:1 row_mask:0xf bank_mask:0xf bound_ctrl:1
v_mfma_f32_16x16x32_bf16 v[196:199], a[240:243], v[20:23], v[52:55]
s_waitcnt lgkmcnt(5)
buffer_load_dwordx4 v32, s[16:19], s52 offen offset:2048 sc1 lds
v_sub_f32_dpp v127, v127, v127 row_shr:1 row_mask:0xf bank_mask:0xf bound_ctrl:1
v_mfma_f32_16x16x32_bf16 v[52:55], a[244:247], v[28:31], v[52:55]
s_waitcnt vmcnt(63)
ds_read_b128 a[236:239], v32 offset:21504
v_sub_f32_dpp v120, v120, v120 row_shr:1 row_mask:0xf bank_mask:0xf bound_ctrl:1
v_sub_f32_dpp v121, v121, v121 row_shr:1 row_mask:0xf bank_mask:0xf bound_ctrl:1
v_sub_f32_dpp v122, v122, v122 row_shr:1 row_mask:0xf bank_mask:0xf bound_ctrl:1
v_sub_f32_dpp v123, v123, v123 row_shr:1 row_mask:0xf bank_mask:0xf bound_ctrl:1
v_pk_fma_f32 v[124:125], v[124:125], v[40:41], v[44:45]
v_pk_fma_f32 v[126:127], v[126:127], v[42:43], v[46:47]
v_pk_fma_f32 v[120:121], v[120:121], v[40:41], v[44:45]
v_pk_fma_f32 v[122:123], v[122:123], v[42:43], v[46:47]
v_mfma_f32_16x16x32_bf16 v[48:51], a[244:247], v[24:27], v[48:51]
s_waitcnt lgkmcnt(5)
ds_read_b128 v[40:43], v38 offset:640
ds_read_b128 v[44:47], v38 offset:2688
v_mfma_f32_16x16x32_bf16 v[200:203], a[248:251], v[16:19], v[56:59]
ds_read_b128 a[240:243], v32 offset:4096
v_accvgpr_write_b32 a156, v124
v_mfma_f32_16x16x32_bf16 v[204:207], a[248:251], v[20:23], v[60:63]
s_waitcnt lgkmcnt(7)
v_accvgpr_write_b32 a157, v125
v_accvgpr_write_b32 a158, v126
v_accvgpr_write_b32 a159, v127
v_mfma_f32_16x16x32_bf16 v[60:63], a[252:255], v[28:31], v[60:63]
ds_read_b128 a[244:247], v32 offset:22528
v_accvgpr_write_b32 a152, v120
v_accvgpr_write_b32 a153, v121
v_mfma_f32_16x16x32_bf16 v[56:59], a[252:255], v[24:27], v[56:59]
s_waitcnt lgkmcnt(7)
buffer_load_dwordx4 v32, s[16:19], s52 offen offset:3072 sc1 lds
v_accvgpr_write_b32 a154, v122
v_mfma_f32_16x16x32_bf16 v[208:211], a[224:227], v[16:19], v[64:67]
ds_read_b128 a[248:251], v32 offset:5120
v_accvgpr_write_b32 a155, v123
v_sub_f32_dpp v128, v128, v128 row_shr:1 row_mask:0xf bank_mask:0xf bound_ctrl:1
v_mfma_f32_16x16x32_bf16 v[212:215], a[224:227], v[20:23], v[68:71]
s_waitcnt lgkmcnt(3)
v_sub_f32_dpp v129, v129, v129 row_shr:1 row_mask:0xf bank_mask:0xf bound_ctrl:1
v_sub_f32_dpp v130, v130, v130 row_shr:1 row_mask:0xf bank_mask:0xf bound_ctrl:1
v_sub_f32_dpp v131, v131, v131 row_shr:1 row_mask:0xf bank_mask:0xf bound_ctrl:1
v_mfma_f32_16x16x32_bf16 v[68:71], a[228:231], v[28:31], v[68:71]
s_add_u32 s53, s82, 77824
ds_read_b128 a[252:255], v32 offset:23552
v_sub_f32_dpp v132, v132, v132 row_shr:1 row_mask:0xf bank_mask:0xf bound_ctrl:1
v_sub_f32_dpp v133, v133, v133 row_shr:1 row_mask:0xf bank_mask:0xf bound_ctrl:1
v_sub_f32_dpp v134, v134, v134 row_shr:1 row_mask:0xf bank_mask:0xf bound_ctrl:1
v_sub_f32_dpp v135, v135, v135 row_shr:1 row_mask:0xf bank_mask:0xf bound_ctrl:1
v_pk_fma_f32 v[128:129], v[128:129], v[40:41], v[44:45]
v_pk_fma_f32 v[130:131], v[130:131], v[42:43], v[46:47]
v_pk_fma_f32 v[132:133], v[132:133], v[40:41], v[44:45]
v_pk_fma_f32 v[134:135], v[134:135], v[42:43], v[46:47]
v_mfma_f32_16x16x32_bf16 v[64:67], a[228:231], v[24:27], v[64:67]
ds_read_b128 v[40:43], v38 offset:656
ds_read_b128 v[44:47], v38 offset:2704
v_accvgpr_write_b32 a164, v132
v_mfma_f32_16x16x32_bf16 v[216:219], a[232:235], v[16:19], v[72:75]
s_add_u32 m0, s43, 77824
ds_read_b128 a[224:227], v32 offset:6144
v_accvgpr_write_b32 a165, v133
v_accvgpr_write_b32 a166, v134
v_mfma_f32_16x16x32_bf16 v[220:223], a[232:235], v[20:23], v[76:79]
buffer_load_dwordx4 v32, s[16:19], s53 offen sc1 lds
v_accvgpr_write_b32 a167, v135
v_mfma_f32_16x16x32_bf16 v[76:79], a[236:239], v[28:31], v[76:79]
ds_read_b128 a[228:231], v32 offset:24576
v_accvgpr_write_b32 a160, v128
v_accvgpr_write_b32 a161, v129
v_mfma_f32_16x16x32_bf16 v[72:75], a[236:239], v[24:27], v[72:75]
s_waitcnt lgkmcnt(7)
v_accvgpr_write_b32 a162, v130
v_accvgpr_write_b32 a163, v131
v_sub_f32_dpp v140, v140, v140 row_shr:1 row_mask:0xf bank_mask:0xf bound_ctrl:1
v_mfma_f32_16x16x32_bf16 v[224:227], a[240:243], v[16:19], v[80:83]
ds_read_b128 a[232:235], v32 offset:7168
v_sub_f32_dpp v141, v141, v141 row_shr:1 row_mask:0xf bank_mask:0xf bound_ctrl:1
v_sub_f32_dpp v142, v142, v142 row_shr:1 row_mask:0xf bank_mask:0xf bound_ctrl:1
v_mfma_f32_16x16x32_bf16 v[228:231], a[240:243], v[20:23], v[84:87]
s_waitcnt lgkmcnt(3)
v_sub_f32_dpp v143, v143, v143 row_shr:1 row_mask:0xf bank_mask:0xf bound_ctrl:1
v_sub_f32_dpp v136, v136, v136 row_shr:1 row_mask:0xf bank_mask:0xf bound_ctrl:1
v_sub_f32_dpp v137, v137, v137 row_shr:1 row_mask:0xf bank_mask:0xf bound_ctrl:1
v_sub_f32_dpp v138, v138, v138 row_shr:1 row_mask:0xf bank_mask:0xf bound_ctrl:1
v_sub_f32_dpp v139, v139, v139 row_shr:1 row_mask:0xf bank_mask:0xf bound_ctrl:1
v_pk_fma_f32 v[140:141], v[140:141], v[40:41], v[44:45]
v_pk_fma_f32 v[142:143], v[142:143], v[42:43], v[46:47]
v_pk_fma_f32 v[136:137], v[136:137], v[40:41], v[44:45]
v_pk_fma_f32 v[138:139], v[138:139], v[42:43], v[46:47]
v_mfma_f32_16x16x32_bf16 v[84:87], a[244:247], v[28:31], v[84:87]
ds_read_b128 a[236:239], v32 offset:25600
ds_read_b128 v[40:43], v38 offset:768
ds_read_b128 v[44:47], v38 offset:2816
v_mfma_f32_16x16x32_bf16 v[80:83], a[244:247], v[24:27], v[80:83]
buffer_load_dwordx4 v32, s[16:19], s53 offen offset:1024 sc1 lds
v_accvgpr_write_b32 a172, v140
v_mfma_f32_16x16x32_bf16 v[232:235], a[248:251], v[16:19], v[88:91]
ds_read_b128 a[240:243], v32 offset:8192
v_accvgpr_write_b32 a173, v141
v_accvgpr_write_b32 a174, v142
v_mfma_f32_16x16x32_bf16 v[236:239], a[248:251], v[20:23], v[92:95]
v_accvgpr_write_b32 a175, v143
v_accvgpr_write_b32 a168, v136
v_accvgpr_write_b32 a169, v137
v_accvgpr_write_b32 a170, v138
v_mfma_f32_16x16x32_bf16 v[92:95], a[252:255], v[28:31], v[92:95]
ds_read_b128 a[244:247], v32 offset:26624
v_accvgpr_write_b32 a171, v139
v_sub_f32_dpp v144, v144, v144 row_shr:1 row_mask:0xf bank_mask:0xf bound_ctrl:1
v_mfma_f32_16x16x32_bf16 v[88:91], a[252:255], v[24:27], v[88:91]
s_waitcnt lgkmcnt(2)
v_sub_f32_dpp v145, v145, v145 row_shr:1 row_mask:0xf bank_mask:0xf bound_ctrl:1
v_sub_f32_dpp v146, v146, v146 row_shr:1 row_mask:0xf bank_mask:0xf bound_ctrl:1
v_sub_f32_dpp v147, v147, v147 row_shr:1 row_mask:0xf bank_mask:0xf bound_ctrl:1
v_mfma_f32_16x16x32_bf16 v[240:243], a[224:227], v[16:19], v[96:99]
s_waitcnt vmcnt(63)
ds_read_b128 a[248:251], v32 offset:9216
v_sub_f32_dpp v148, v148, v148 row_shr:1 row_mask:0xf bank_mask:0xf bound_ctrl:1
v_sub_f32_dpp v149, v149, v149 row_shr:1 row_mask:0xf bank_mask:0xf bound_ctrl:1
v_sub_f32_dpp v150, v150, v150 row_shr:1 row_mask:0xf bank_mask:0xf bound_ctrl:1
v_sub_f32_dpp v151, v151, v151 row_shr:1 row_mask:0xf bank_mask:0xf bound_ctrl:1
v_pk_fma_f32 v[144:145], v[144:145], v[40:41], v[44:45]
v_pk_fma_f32 v[146:147], v[146:147], v[42:43], v[46:47]
v_pk_fma_f32 v[148:149], v[148:149], v[40:41], v[44:45]
v_pk_fma_f32 v[150:151], v[150:151], v[42:43], v[46:47]
v_mfma_f32_16x16x32_bf16 v[244:247], a[224:227], v[20:23], v[100:103]
buffer_load_dwordx4 v32, s[16:19], s53 offen offset:2048 sc1 lds
ds_read_b128 v[40:43], v38 offset:784
v_mfma_f32_16x16x32_bf16 v[100:103], a[228:231], v[28:31], v[100:103]
ds_read_b128 a[252:255], v32 offset:27648
ds_read_b128 v[44:47], v38 offset:2832
v_accvgpr_write_b32 a180, v148
v_mfma_f32_16x16x32_bf16 v[96:99], a[228:231], v[24:27], v[96:99]
v_accvgpr_write_b32 a181, v149
v_accvgpr_write_b32 a182, v150
v_accvgpr_write_b32 a183, v151
v_mfma_f32_16x16x32_bf16 v[248:251], a[232:235], v[16:19], v[104:107]
ds_read_b128 a[224:227], v32 offset:10240
v_accvgpr_write_b32 a176, v144
v_accvgpr_write_b32 a177, v145
v_mfma_f32_16x16x32_bf16 v[252:255], a[232:235], v[20:23], v[108:111]
v_accvgpr_write_b32 a178, v146
v_accvgpr_write_b32 a179, v147
v_sub_f32_dpp v156, v156, v156 row_shr:1 row_mask:0xf bank_mask:0xf bound_ctrl:1
v_mfma_f32_16x16x32_bf16 v[108:111], a[236:239], v[28:31], v[108:111]
ds_read_b128 a[228:231], v32 offset:28672
v_sub_f32_dpp v157, v157, v157 row_shr:1 row_mask:0xf bank_mask:0xf bound_ctrl:1
L_pg5:
s_cbranch_vccnz L_vr1
v_sub_f32_dpp v158, v158, v158 row_shr:1 row_mask:0xf bank_mask:0xf bound_ctrl:1
v_mfma_f32_16x16x32_bf16 v[104:107], a[236:239], v[24:27], v[104:107]
s_waitcnt lgkmcnt(2)
buffer_load_dwordx4 v32, s[16:19], s53 offen offset:3072 sc1 lds
v_sub_f32_dpp v159, v159, v159 row_shr:1 row_mask:0xf bank_mask:0xf bound_ctrl:1
v_mfma_f32_16x16x32_bf16 a[144:147], a[240:243], v[16:19], a[144:147]
ds_read_b128 a[232:235], v32 offset:11264
v_sub_f32_dpp v152, v152, v152 row_shr:1 row_mask:0xf bank_mask:0xf bound_ctrl:1
v_sub_f32_dpp v153, v153, v153 row_shr:1 row_mask:0xf bank_mask:0xf bound_ctrl:1
v_sub_f32_dpp v154, v154, v154 row_shr:1 row_mask:0xf bank_mask:0xf bound_ctrl:1
v_sub_f32_dpp v155, v155, v155 row_shr:1 row_mask:0xf bank_mask:0xf bound_ctrl:1
v_pk_fma_f32 v[156:157], v[156:157], v[40:41], v[44:45]
v_pk_fma_f32 v[158:159], v[158:159], v[42:43], v[46:47]
v_pk_fma_f32 v[152:153], v[152:153], v[40:41], v[44:45]
v_pk_fma_f32 v[154:155], v[154:155], v[42:43], v[46:47]
v_mfma_f32_16x16x32_bf16 a[148:151], a[240:243], v[20:23], a[148:151]
ds_read_b128 v[40:43], v38 offset:896
ds_read_b128 v[44:47], v38 offset:2944
v_accvgpr_write_b32 a188, v156
v_mfma_f32_16x16x32_bf16 v[116:119], a[244:247], v[28:31], v[116:119]
s_add_u32 s54, s82, 81920
ds_read_b128 a[236:239], v32 offset:29696
v_accvgpr_write_b32 a189, v157
v_accvgpr_write_b32 a190, v158
v_mfma_f32_16x16x32_bf16 v[112:115], a[244:247], v[24:27], v[112:115]
v_accvgpr_write_b32 a191, v159
v_accvgpr_write_b32 a184, v152
v_accvgpr_write_b32 a185, v153
v_mfma_f32_16x16x32_bf16 a[152:155], a[248:251], v[16:19], a[152:155]
s_add_u32 m0, s43, 81920
ds_read_b128 a[240:243], v32 offset:12288
v_accvgpr_write_b32 a186, v154
v_accvgpr_write_b32 a187, v155
v_mfma_f32_16x16x32_bf16 a[156:159], a[248:251], v[20:23], a[156:159]
buffer_load_dwordx4 v32, s[16:19], s54 offen sc1 lds
v_sub_f32_dpp v160, v160, v160 row_shr:1 row_mask:0xf bank_mask:0xf bound_ctrl:1
v_mfma_f32_16x16x32_bf16 v[124:127], a[252:255], v[28:31], v[124:127]
s_load_dword s77, s[78:79], 24576
ds_read_b128 a[244:247], v32 offset:30720
v_sub_f32_dpp v161, v161, v161 row_shr:1 row_mask:0xf bank_mask:0xf bound_ctrl:1
v_sub_f32_dpp v162, v162, v162 row_shr:1 row_mask:0xf bank_mask:0xf bound_ctrl:1
v_mfma_f32_16x16x32_bf16 v[120:123], a[252:255], v[24:27], v[120:123]
s_waitcnt lgkmcnt(3)
v_sub_f32_dpp v163, v163, v163 row_shr:1 row_mask:0xf bank_mask:0xf bound_ctrl:1
v_sub_f32_dpp v164, v164, v164 row_shr:1 row_mask:0xf bank_mask:0xf bound_ctrl:1
v_sub_f32_dpp v165, v165, v165 row_shr:1 row_mask:0xf bank_mask:0xf bound_ctrl:1
v_sub_f32_dpp v166, v166, v166 row_shr:1 row_mask:0xf bank_mask:0xf bound_ctrl:1
v_sub_f32_dpp v167, v167, v167 row_shr:1 row_mask:0xf bank_mask:0xf bound_ctrl:1
v_pk_fma_f32 v[160:161], v[160:161], v[40:41], v[44:45]
v_pk_fma_f32 v[162:163], v[162:163], v[42:43], v[46:47]
v_pk_fma_f32 v[164:165], v[164:165], v[40:41], v[44:45]
v_pk_fma_f32 v[166:167], v[166:167], v[42:43], v[46:47]
v_mfma_f32_16x16x32_bf16 a[160:163], a[224:227], v[16:19], a[160:163]
ds_read_b128 a[248:251], v32 offset:13312
ds_read_b128 v[40:43], v38 offset:912
ds_read_b128 v[44:47], v38 offset:2960
v_mfma_f32_16x16x32_bf16 a[164:167], a[224:227], v[20:23], a[164:167]
v_accvgpr_write_b32 a196, v164
v_accvgpr_write_b32 a197, v165
v_accvgpr_write_b32 a198, v166
v_mfma_f32_16x16x32_bf16 v[132:135], a[228:231], v[28:31], v[132:135]
ds_read_b128 a[252:255], v32 offset:31744
v_accvgpr_write_b32 a199, v167
v_accvgpr_write_b32 a192, v160
v_mfma_f32_16x16x32_bf16 v[128:131], a[228:231], v[24:27], v[128:131]
v_accvgpr_write_b32 a193, v161
v_accvgpr_write_b32 a194, v162
v_accvgpr_write_b32 a195, v163
v_mfma_f32_16x16x32_bf16 a[168:171], a[232:235], v[16:19], a[168:171]
s_add_u32 m0, s48, 1792
ds_read_b128 a[224:227], v32 offset:14336
v_sub_f32_dpp v172, v172, v172 row_shr:1 row_mask:0xf bank_mask:0xf bound_ctrl:1
v_sub_f32_dpp v173, v173, v173 row_shr:1 row_mask:0xf bank_mask:0xf bound_ctrl:1
v_mfma_f32_16x16x32_bf16 a[172:175], a[232:235], v[20:23], a[172:175]
s_waitcnt lgkmcnt(2)
buffer_load_dwordx4 v36, s[8:11], s63 offen offset:256 lds
v_sub_f32_dpp v174, v174, v174 row_shr:1 row_mask:0xf bank_mask:0xf bound_ctrl:1
v_sub_f32_dpp v175, v175, v175 row_shr:1 row_mask:0xf bank_mask:0xf bound_ctrl:1
v_mfma_f32_16x16x32_bf16 v[140:143], a[236:239], v[28:31], v[140:143]
ds_read_b128 a[228:231], v32 offset:32768
v_sub_f32_dpp v168, v168, v168 row_shr:1 row_mask:0xf bank_mask:0xf bound_ctrl:1
v_sub_f32_dpp v169, v169, v169 row_shr:1 row_mask:0xf bank_mask:0xf bound_ctrl:1
v_sub_f32_dpp v170, v170, v170 row_shr:1 row_mask:0xf bank_mask:0xf bound_ctrl:1
v_sub_f32_dpp v171, v171, v171 row_shr:1 row_mask:0xf bank_mask:0xf bound_ctrl:1
v_pk_fma_f32 v[172:173], v[172:173], v[40:41], v[44:45]
v_pk_fma_f32 v[174:175], v[174:175], v[42:43], v[46:47]
v_pk_fma_f32 v[168:169], v[168:169], v[40:41], v[44:45]
v_pk_fma_f32 v[170:171], v[170:171], v[42:43], v[46:47]
v_mfma_f32_16x16x32_bf16 v[136:139], a[236:239], v[24:27], v[136:139]
ds_read_b128 v[40:43], v38 offset:1024
ds_read_b128 v[44:47], v38 offset:3072
v_accvgpr_write_b32 a204, v172
v_mfma_f32_16x16x32_bf16 a[176:179], a[240:243], v[16:19], a[176:179]
ds_read_b128 a[232:235], v32 offset:15360
v_accvgpr_write_b32 a205, v173
v_accvgpr_write_b32 a206, v174
v_mfma_f32_16x16x32_bf16 a[180:183], a[240:243], v[20:23], a[180:183]
v_accvgpr_write_b32 a207, v175
v_accvgpr_write_b32 a200, v168
v_accvgpr_write_b32 a201, v169
v_mfma_f32_16x16x32_bf16 v[148:151], a[244:247], v[28:31], v[148:151]
ds_read_b128 a[236:239], v32 offset:33792
v_accvgpr_write_b32 a202, v170
v_accvgpr_write_b32 a203, v171
v_mfma_f32_16x16x32_bf16 v[144:147], a[244:247], v[24:27], v[144:147]
v_sub_f32_dpp v176, v176, v176 row_shr:1 row_mask:0xf bank_mask:0xf bound_ctrl:1
v_sub_f32_dpp v177, v177, v177 row_shr:1 row_mask:0xf bank_mask:0xf bound_ctrl:1
v_sub_f32_dpp v178, v178, v178 row_shr:1 row_mask:0xf bank_mask:0xf bound_ctrl:1
v_mfma_f32_16x16x32_bf16 a[184:187], a[248:251], v[16:19], a[184:187]
s_add_u32 m0, s48, 2816
ds_read_b128 a[240:243], v32 offset:16384
v_sub_f32_dpp v179, v179, v179 row_shr:1 row_mask:0xf bank_mask:0xf bound_ctrl:1
v_sub_f32_dpp v180, v180, v180 row_shr:1 row_mask:0xf bank_mask:0xf bound_ctrl:1
v_mfma_f32_16x16x32_bf16 a[188:191], a[248:251], v[20:23], a[188:191]
s_waitcnt lgkmcnt(3)
buffer_load_dwordx4 v36, s[8:11], s83 offen offset:256 lds
v_sub_f32_dpp v181, v181, v181 row_shr:1 row_mask:0xf bank_mask:0xf bound_ctrl:1
v_sub_f32_dpp v182, v182, v182 row_shr:1 row_mask:0xf bank_mask:0xf bound_ctrl:1
v_sub_f32_dpp v183, v183, v183 row_shr:1 row_mask:0xf bank_mask:0xf bound_ctrl:1
v_pk_fma_f32 v[176:177], v[176:177], v[40:41], v[44:45]
v_pk_fma_f32 v[178:179], v[178:179], v[42:43], v[46:47]
v_pk_fma_f32 v[180:181], v[180:181], v[40:41], v[44:45]
v_pk_fma_f32 v[182:183], v[182:183], v[42:43], v[46:47]
v_mfma_f32_16x16x32_bf16 v[156:159], a[252:255], v[28:31], v[156:159]
ds_read_b128 a[244:247], v32 offset:34816
ds_read_b128 v[40:43], v38 offset:1040
v_mfma_f32_16x16x32_bf16 v[152:155], a[252:255], v[24:27], v[152:155]
ds_read_b128 v[44:47], v38 offset:3088
v_accvgpr_write_b32 a212, v180
v_accvgpr_write_b32 a213, v181
v_mfma_f32_16x16x32_bf16 a[192:195], a[224:227], v[16:19], a[192:195]
ds_read_b128 a[248:251], v32 offset:17408
v_accvgpr_write_b32 a214, v182
v_accvgpr_write_b32 a215, v183
v_mfma_f32_16x16x32_bf16 a[196:199], a[224:227], v[20:23], a[196:199]
v_accvgpr_write_b32 a208, v176
v_accvgpr_write_b32 a209, v177
v_accvgpr_write_b32 a210, v178
v_mfma_f32_16x16x32_bf16 v[164:167], a[228:231], v[28:31], v[164:167]
s_add_u32 s52, s76, 110592
ds_read_b128 a[252:255], v32 offset:35840
v_accvgpr_write_b32 a211, v179
v_sub_f32_dpp v188, v188, v188 row_shr:1 row_mask:0xf bank_mask:0xf bound_ctrl:1
v_mfma_f32_16x16x32_bf16 v[160:163], a[228:231], v[24:27], v[160:163]
s_waitcnt vmcnt(11) lgkmcnt(7)
s_barrier
v_mfma_f32_16x16x32_bf16 a[200:203], a[232:235], v[16:19], a[200:203]
s_add_u32 m0, s43, 0
ds_read_b128 a[224:227], v32 offset:55296
v_sub_f32_dpp v189, v189, v189 row_shr:1 row_mask:0xf bank_mask:0xf bound_ctrl:1
v_sub_f32_dpp v190, v190, v190 row_shr:1 row_mask:0xf bank_mask:0xf bound_ctrl:1
v_mfma_f32_16x16x32_bf16 a[204:207], a[232:235], v[20:23], a[204:207]
s_waitcnt lgkmcnt(3)
buffer_load_dwordx4 v32, s[16:19], s52 offen sc1 lds
v_sub_f32_dpp v191, v191, v191 row_shr:1 row_mask:0xf bank_mask:0xf bound_ctrl:1
v_mfma_f32_16x16x32_bf16 v[172:175], a[236:239], v[28:31], v[172:175]
s_waitcnt vmcnt(63)
ds_read_b128 a[228:231], v32 offset:56320
v_sub_f32_dpp v184, v184, v184 row_shr:1 row_mask:0xf bank_mask:0xf bound_ctrl:1
v_sub_f32_dpp v185, v185, v185 row_shr:1 row_mask:0xf bank_mask:0xf bound_ctrl:1
v_sub_f32_dpp v186, v186, v186 row_shr:1 row_mask:0xf bank_mask:0xf bound_ctrl:1
v_sub_f32_dpp v187, v187, v187 row_shr:1 row_mask:0xf bank_mask:0xf bound_ctrl:1
v_pk_fma_f32 v[188:189], v[188:189], v[40:41], v[44:45]
v_pk_fma_f32 v[190:191], v[190:191], v[42:43], v[46:47]
v_pk_fma_f32 v[184:185], v[184:185], v[40:41], v[44:45]
v_pk_fma_f32 v[186:187], v[186:187], v[42:43], v[46:47]
v_mfma_f32_16x16x32_bf16 v[168:171], a[236:239], v[24:27], v[168:171]
v_accvgpr_write_b32 a220, v188
v_accvgpr_write_b32 a221, v189
v_mfma_f32_16x16x32_bf16 a[208:211], a[240:243], v[16:19], a[208:211]
ds_read_b128 a[232:235], v32 offset:57344
v_accvgpr_write_b32 a222, v190
v_mfma_f32_16x16x32_bf16 a[212:215], a[240:243], v[20:23], a[212:215]
v_accvgpr_write_b32 a223, v191
v_accvgpr_write_b32 a216, v184
v_accvgpr_write_b32 a217, v185
v_mfma_f32_16x16x32_bf16 v[180:183], a[244:247], v[28:31], v[180:183]
ds_read_b128 a[236:239], v32 offset:58368
v_accvgpr_write_b32 a218, v186
v_accvgpr_write_b32 a219, v187
v_mfma_f32_16x16x32_bf16 v[176:179], a[244:247], v[24:27], v[176:179]
s_waitcnt lgkmcnt(5)
buffer_load_dwordx4 v32, s[16:19], s52 offen offset:1024 sc1 lds
v_mfma_f32_16x16x32_bf16 a[216:219], a[248:251], v[16:19], a[216:219]
ds_read_b128 a[240:243], v32 offset:59392
v_mfma_f32_16x16x32_bf16 a[220:223], a[248:251], v[20:23], a[220:223]
s_waitcnt lgkmcnt(5)
v_mfma_f32_16x16x32_bf16 v[188:191], a[252:255], v[28:31], v[188:191]
ds_read_b128 a[244:247], v32 offset:60416
v_mfma_f32_16x16x32_bf16 v[184:187], a[252:255], v[24:27], v[184:187]
s_waitcnt lgkmcnt(5)
v_mfma_f32_16x16x32_bf16 v[48:51], a[224:227], v[8:11], v[48:51]
ds_read_b128 a[248:251], v32 offset:61440
v_mfma_f32_16x16x32_bf16 v[52:55], a[224:227], v[12:15], v[52:55]
s_waitcnt lgkmcnt(5)
buffer_load_dwordx4 v32, s[16:19], s52 offen offset:2048 sc1 lds
ds_read_b128 v[16:19], v34
v_accvgpr_read_b32 v28, a20
v_accvgpr_read_b32 v29, a21
v_mfma_f32_16x16x32_bf16 v[60:63], a[228:231], v[12:15], v[60:63]
ds_read_b128 a[252:255], v32 offset:62464
v_accvgpr_read_b32 v30, a22
v_accvgpr_read_b32 v31, a23
v_mfma_f32_16x16x32_bf16 v[56:59], a[228:231], v[8:11], v[56:59]
s_waitcnt lgkmcnt(6)
ds_read_b128 v[20:23], v34 offset:6144
ds_read_b128 a[20:23], v34 offset:6144
v_accvgpr_read_b32 v24, a16
v_accvgpr_read_b32 v25, a17
v_mfma_f32_16x16x32_bf16 v[64:67], a[232:235], v[8:11], v[64:67]
ds_read_b128 a[224:227], v32 offset:63488
v_accvgpr_read_b32 v26, a18
v_accvgpr_read_b32 v27, a19
v_mfma_f32_16x16x32_bf16 v[68:71], a[232:235], v[12:15], v[68:71]
s_waitcnt lgkmcnt(4)
ds_read_b128 a[16:19], v34
v_lshlrev_b32 v38, 16, v24
v_and_b32 v24, s55, v24
v_lshlrev_b32 v37, 16, v16
v_mfma_f32_16x16x32_bf16 v[76:79], a[236:239], v[12:15], v[76:79]
ds_read_b128 a[228:231], v32 offset:64512
v_and_b32 v16, s55, v16
v_add_f32 v39, v37, v38
v_mfma_f32_16x16x32_bf16 v[72:75], a[236:239], v[8:11], v[72:75]
buffer_load_dwordx4 v32, s[16:19], s52 offen offset:3072 sc1 lds
v_subrev_f32 v38, v37, v38
v_mfma_f32_16x16x32_bf16 v[80:83], a[240:243], v[8:11], v[80:83]
ds_read_b128 a[232:235], v33
v_add_f32 v37, v16, v24
v_subrev_f32 v24, v16, v24
v_cvt_pk_bf16_f32 v16, v39, v37
v_mfma_f32_16x16x32_bf16 v[84:87], a[240:243], v[12:15], v[84:87]
v_cvt_pk_bf16_f32 v24, v38, v24
v_lshlrev_b32 v38, 16, v25
v_and_b32 v25, s55, v25
v_mfma_f32_16x16x32_bf16 v[92:95], a[244:247], v[12:15], v[92:95]
s_add_u32 s53, s76, 114688
ds_read_b128 a[236:239], v33 offset:1024
v_lshlrev_b32 v37, 16, v17
v_and_b32 v17, s55, v17
v_add_f32 v39, v37, v38
v_mfma_f32_16x16x32_bf16 v[88:91], a[244:247], v[8:11], v[88:91]
v_subrev_f32 v38, v37, v38
v_add_f32 v37, v17, v25
v_subrev_f32 v25, v17, v25
v_mfma_f32_16x16x32_bf16 v[96:99], a[248:251], v[8:11], v[96:99]
s_add_u32 m0, s43, 4096
ds_read_b128 a[240:243], v33 offset:2048
v_cvt_pk_bf16_f32 v17, v39, v37
v_cvt_pk_bf16_f32 v25, v38, v25
v_lshlrev_b32 v38, 16, v26
v_mfma_f32_16x16x32_bf16 v[100:103], a[248:251], v[12:15], v[100:103]
s_waitcnt lgkmcnt(8)
buffer_load_dwordx4 v32, s[16:19], s53 offen sc1 lds
v_and_b32 v26, s55, v26
v_mfma_f32_16x16x32_bf16 v[108:111], a[252:255], v[12:15], v[108:111]
ds_read_b128 a[244:247], v33 offset:3072
v_lshlrev_b32 v37, 16, v18
v_and_b32 v18, s55, v18
v_mfma_f32_16x16x32_bf16 v[104:107], a[252:255], v[8:11], v[104:107]
s_waitcnt lgkmcnt(6)
v_add_f32 v39, v37, v38
v_subrev_f32 v38, v37, v38
v_add_f32 v37, v18, v26
v_subrev_f32 v26, v18, v26
v_mfma_f32_16x16x32_bf16 v[112:115], a[224:227], v[8:11], v[112:115]
ds_read_b128 a[248:251], v33 offset:4096
v_cvt_pk_bf16_f32 v18, v39, v37
v_cvt_pk_bf16_f32 v26, v38, v26
v_mfma_f32_16x16x32_bf16 v[116:119], a[224:227], v[12:15], v[116:119]
s_waitcnt lgkmcnt(5)
v_lshlrev_b32 v38, 16, v27
v_and_b32 v27, s55, v27
v_lshlrev_b32 v37, 16, v19
v_and_b32 v19, s55, v19
v_mfma_f32_16x16x32_bf16 v[124:127], a[228:231], v[12:15], v[124:127]
ds_read_b128 a[252:255], v33 offset:5120
v_add_f32 v39, v37, v38
v_subrev_f32 v38, v37, v38
v_mfma_f32_16x16x32_bf16 v[120:123], a[228:231], v[8:11], v[120:123]
s_waitcnt lgkmcnt(5)
buffer_load_dwordx4 v32, s[16:19], s53 offen offset:1024 sc1 lds
v_add_f32 v37, v19, v27
v_subrev_f32 v27, v19, v27
v_mfma_f32_16x16x32_bf16 v[128:131], a[232:235], v[8:11], v[128:131]
ds_read_b128 a[224:227], v33 offset:6144
v_cvt_pk_bf16_f32 v19, v39, v37
v_cvt_pk_bf16_f32 v27, v38, v27
v_mfma_f32_16x16x32_bf16 v[132:135], a[232:235], v[12:15], v[132:135]
s_waitcnt lgkmcnt(5)
v_lshlrev_b32 v38, 16, v28
v_and_b32 v28, s55, v28
v_lshlrev_b32 v37, 16, v20
v_mfma_f32_16x16x32_bf16 v[140:143], a[236:239], v[12:15], v[140:143]
ds_read_b128 a[228:231], v33 offset:7168
v_and_b32 v20, s55, v20
v_add_f32 v39, v37, v38
v_subrev_f32 v38, v37, v38
v_mfma_f32_16x16x32_bf16 v[136:139], a[236:239], v[8:11], v[136:139]
s_waitcnt lgkmcnt(5)
v_add_f32 v37, v20, v28
v_subrev_f32 v28, v20, v28
v_cvt_pk_bf16_f32 v20, v39, v37
v_mfma_f32_16x16x32_bf16 v[144:147], a[240:243], v[8:11], v[144:147]
ds_read_b128 a[232:235], v32 offset:36864
v_cvt_pk_bf16_f32 v28, v38, v28
v_lshlrev_b32 v38, 16, v29
v_and_b32 v29, s55, v29
v_mfma_f32_16x16x32_bf16 v[148:151], a[240:243], v[12:15], v[148:151]
s_waitcnt lgkmcnt(5)
buffer_load_dwordx4 v32, s[16:19], s53 offen offset:2048 sc1 lds
v_lshlrev_b32 v37, 16, v21
v_mfma_f32_16x16x32_bf16 v[156:159], a[244:247], v[12:15], v[156:159]
ds_read_b128 a[236:239], v32 offset:46080
v_and_b32 v21, s55, v21
v_add_f32 v39, v37, v38
v_subrev_f32 v38, v37, v38
v_mfma_f32_16x16x32_bf16 v[152:155], a[244:247], v[8:11], v[152:155]
s_waitcnt lgkmcnt(5)
v_add_f32 v37, v21, v29
v_subrev_f32 v29, v21, v29
v_cvt_pk_bf16_f32 v21, v39, v37
v_mfma_f32_16x16x32_bf16 v[160:163], a[248:251], v[8:11], v[160:163]
ds_read_b128 a[240:243], v32 offset:37888
v_cvt_pk_bf16_f32 v29, v38, v29
v_lshlrev_b32 v38, 16, v30
v_mfma_f32_16x16x32_bf16 v[164:167], a[248:251], v[12:15], v[164:167]
s_waitcnt lgkmcnt(5)
v_and_b32 v30, s55, v30
v_lshlrev_b32 v37, 16, v22
v_and_b32 v22, s55, v22
v_add_f32 v39, v37, v38
v_mfma_f32_16x16x32_bf16 v[172:175], a[252:255], v[12:15], v[172:175]
ds_read_b128 a[244:247], v32 offset:47104
v_subrev_f32 v38, v37, v38
v_add_f32 v37, v22, v30
v_mfma_f32_16x16x32_bf16 v[168:171], a[252:255], v[8:11], v[168:171]
s_waitcnt lgkmcnt(5)
buffer_load_dwordx4 v32, s[16:19], s53 offen offset:3072 sc1 lds
v_subrev_f32 v30, v22, v30
v_cvt_pk_bf16_f32 v22, v39, v37
v_mfma_f32_16x16x32_bf16 v[176:179], a[224:227], v[8:11], v[176:179]
ds_read_b128 a[248:251], v32 offset:38912
v_cvt_pk_bf16_f32 v30, v38, v30
v_lshlrev_b32 v38, 16, v31
v_mfma_f32_16x16x32_bf16 v[180:183], a[224:227], v[12:15], v[180:183]
s_waitcnt lgkmcnt(5)
v_and_b32 v31, s55, v31
v_lshlrev_b32 v37, 16, v23
v_and_b32 v23, s55, v23
v_add_f32 v39, v37, v38
v_mfma_f32_16x16x32_bf16 v[188:191], a[228:231], v[12:15], v[188:191]
s_add_u32 s54, s76, 118784
ds_read_b128 a[252:255], v32 offset:48128
v_subrev_f32 v38, v37, v38
v_add_f32 v37, v23, v31
v_mfma_f32_16x16x32_bf16 v[184:187], a[228:231], v[8:11], v[184:187]
s_waitcnt lgkmcnt(4)
v_subrev_f32 v31, v23, v31
v_cvt_pk_bf16_f32 v23, v39, v37
v_cvt_pk_bf16_f32 v31, v38, v31
v_mfma_f32_16x16x32_bf16 v[196:199], a[232:235], v[4:7], v[196:199]
s_add_u32 m0, s43, 8192
ds_read_b128 a[224:227], v32 offset:39936
v_mfma_f32_16x16x32_bf16 v[196:199], a[236:239], v[20:23], v[196:199]
buffer_load_dwordx4 v32, s[16:19], s54 offen sc1 lds
ds_read_b128 v[8:11], v35
v_accvgpr_read_b32 v44, a28
v_mfma_f32_16x16x32_bf16 v[192:195], a[236:239], v[16:19], v[192:195]
ds_read_b128 a[228:231], v32 offset:49152
v_accvgpr_read_b32 v45, a29
v_mfma_f32_16x16x32_bf16 v[192:195], a[232:235], v[0:3], v[192:195]
s_waitcnt lgkmcnt(5)
ds_read_b128 v[12:15], v35 offset:6144
v_accvgpr_read_b32 v46, a30
v_mfma_f32_16x16x32_bf16 v[200:203], a[240:243], v[0:3], v[200:203]
ds_read_b128 a[232:235], v32 offset:40960
v_accvgpr_read_b32 v47, a31
v_mfma_f32_16x16x32_bf16 v[200:203], a[244:247], v[16:19], v[200:203]
ds_read_b128 a[28:31], v35 offset:6144
v_accvgpr_read_b32 v40, a24
v_mfma_f32_16x16x32_bf16 v[204:207], a[244:247], v[20:23], v[204:207]
ds_read_b128 a[236:239], v32 offset:50176
v_accvgpr_read_b32 v41, a25
v_mfma_f32_16x16x32_bf16 v[204:207], a[240:243], v[4:7], v[204:207]
s_waitcnt lgkmcnt(7)
v_accvgpr_read_b32 v42, a26
v_accvgpr_read_b32 v43, a27
v_mfma_f32_16x16x32_bf16 v[212:215], a[248:251], v[4:7], v[212:215]
s_add_u32 m0, s48, 7808
ds_read_b128 a[240:243], v32 offset:41984
ds_read_b128 a[24:27], v35
v_mfma_f32_16x16x32_bf16 v[212:215], a[252:255], v[20:23], v[212:215]
buffer_load_dwordx4 v36, s[8:11], s44 offen offset:384 lds
v_mfma_f32_16x16x32_bf16 v[208:211], a[252:255], v[16:19], v[208:211]
ds_read_b128 a[244:247], v32 offset:51200
v_lshlrev_b32 v38, 16, v40
v_mfma_f32_16x16x32_bf16 v[208:211], a[248:251], v[0:3], v[208:211]
s_waitcnt lgkmcnt(7)
v_and_b32 v40, s55, v40
v_lshlrev_b32 v37, 16, v8
v_mfma_f32_16x16x32_bf16 v[216:219], a[224:227], v[0:3], v[216:219]
ds_read_b128 a[248:251], v32 offset:43008
v_and_b32 v8, s55, v8
v_mfma_f32_16x16x32_bf16 v[216:219], a[228:231], v[16:19], v[216:219]
v_add_f32 v39, v37, v38
v_subrev_f32 v38, v37, v38
v_add_f32 v37, v8, v40
v_mfma_f32_16x16x32_bf16 v[220:223], a[228:231], v[20:23], v[220:223]
ds_read_b128 a[252:255], v32 offset:52224
v_subrev_f32 v40, v8, v40
v_mfma_f32_16x16x32_bf16 v[220:223], a[224:227], v[4:7], v[220:223]
s_waitcnt lgkmcnt(5)
v_cvt_pk_bf16_f32 v8, v39, v37
v_cvt_pk_bf16_f32 v40, v38, v40
v_mfma_f32_16x16x32_bf16 v[228:231], a[232:235], v[4:7], v[228:231]
s_add_u32 m0, s48, 8832
ds_read_b128 a[224:227], v32 offset:44032
v_lshlrev_b32 v38, 16, v41
v_mfma_f32_16x16x32_bf16 v[228:231], a[236:239], v[20:23], v[228:231]
buffer_load_dwordx4 v36, s[8:11], s45 offen offset:384 lds
v_mfma_f32_16x16x32_bf16 v[224:227], a[236:239], v[16:19], v[224:227]
ds_read_b128 a[228:231], v32 offset:53248
v_and_b32 v41, s55, v41
v_mfma_f32_16x16x32_bf16 v[224:227], a[232:235], v[0:3], v[224:227]
s_waitcnt lgkmcnt(4)
v_lshlrev_b32 v37, 16, v9
v_and_b32 v9, s55, v9
v_mfma_f32_16x16x32_bf16 v[232:235], a[240:243], v[0:3], v[232:235]
ds_read_b128 a[232:235], v32 offset:45056
v_add_f32 v39, v37, v38
v_mfma_f32_16x16x32_bf16 v[232:235], a[244:247], v[16:19], v[232:235]
v_subrev_f32 v38, v37, v38
v_add_f32 v37, v9, v41
v_mfma_f32_16x16x32_bf16 v[236:239], a[244:247], v[20:23], v[236:239]
s_add_u32 s52, s82, 147456
ds_read_b128 a[236:239], v32 offset:54272
v_subrev_f32 v41, v9, v41
v_mfma_f32_16x16x32_bf16 v[236:239], a[240:243], v[4:7], v[236:239]
s_waitcnt vmcnt(13) lgkmcnt(4)
s_barrier
v_cvt_pk_bf16_f32 v9, v39, v37
v_cvt_pk_bf16_f32 v41, v38, v41
v_mfma_f32_16x16x32_bf16 v[244:247], a[248:251], v[4:7], v[244:247]
s_add_u32 m0, s43, 36864
ds_read_b128 a[240:243], v33 offset:8192
v_lshlrev_b32 v38, 16, v42
v_mfma_f32_16x16x32_bf16 v[244:247], a[252:255], v[20:23], v[244:247]
buffer_load_dwordx4 v32, s[16:19], s52 offen sc1 lds
v_and_b32 v42, s55, v42
v_mfma_f32_16x16x32_bf16 v[240:243], a[252:255], v[16:19], v[240:243]
ds_read_b128 a[244:247], v33 offset:17408
v_lshlrev_b32 v37, 16, v10
v_mfma_f32_16x16x32_bf16 v[240:243], a[248:251], v[0:3], v[240:243]
s_waitcnt lgkmcnt(4)
v_and_b32 v10, s55, v10
v_add_f32 v39, v37, v38
v_mfma_f32_16x16x32_bf16 v[248:251], a[224:227], v[0:3], v[248:251]
ds_read_b128 a[248:251], v33 offset:9216
v_subrev_f32 v38, v37, v38
v_mfma_f32_16x16x32_bf16 v[248:251], a[228:231], v[16:19], v[248:251]
v_add_f32 v37, v10, v42
v_subrev_f32 v42, v10, v42
v_mfma_f32_16x16x32_bf16 v[252:255], a[228:231], v[20:23], v[252:255]
ds_read_b128 a[252:255], v33 offset:18432
v_cvt_pk_bf16_f32 v10, v39, v37
v_mfma_f32_16x16x32_bf16 v[252:255], a[224:227], v[4:7], v[252:255]
s_waitcnt lgkmcnt(4)
buffer_load_dwordx4 v32, s[16:19], s52 offen offset:1024 sc1 lds
v_mfma_f32_16x16x32_bf16 a[148:151], a[232:235], v[4:7], a[148:151]
ds_read_b128 a[224:227], v33 offset:10240
v_cvt_pk_bf16_f32 v42, v38, v42
v_mfma_f32_16x16x32_bf16 a[148:151], a[236:239], v[20:23], a[148:151]
v_lshlrev_b32 v38, 16, v43
v_and_b32 v43, s55, v43
v_mfma_f32_16x16x32_bf16 a[144:147], a[236:239], v[16:19], a[144:147]
ds_read_b128 a[228:231], v33 offset:19456
v_lshlrev_b32 v37, 16, v11
v_mfma_f32_16x16x32_bf16 a[144:147], a[232:235], v[0:3], a[144:147]
s_waitcnt lgkmcnt(4)
v_and_b32 v11, s55, v11
v_add_f32 v39, v37, v38
v_mfma_f32_16x16x32_bf16 a[152:155], a[240:243], v[0:3], a[152:155]
ds_read_b128 a[232:235], v33 offset:11264
v_subrev_f32 v38, v37, v38
v_mfma_f32_16x16x32_bf16 a[152:155], a[244:247], v[16:19], a[152:155]
buffer_load_dwordx4 v32, s[16:19], s52 offen offset:2048 sc1 lds
v_add_f32 v37, v11, v43
v_mfma_f32_16x16x32_bf16 a[156:159], a[244:247], v[20:23], a[156:159]
ds_read_b128 a[236:239], v33 offset:20480
v_subrev_f32 v43, v11, v43
v_mfma_f32_16x16x32_bf16 a[156:159], a[240:243], v[4:7], a[156:159]
s_waitcnt lgkmcnt(4)
v_cvt_pk_bf16_f32 v11, v39, v37
v_cvt_pk_bf16_f32 v43, v38, v43
v_mfma_f32_16x16x32_bf16 a[164:167], a[248:251], v[4:7], a[164:167]
ds_read_b128 a[240:243], v33 offset:12288
v_lshlrev_b32 v38, 16, v44
v_mfma_f32_16x16x32_bf16 a[164:167], a[252:255], v[20:23], a[164:167]
v_and_b32 v44, s55, v44
v_lshlrev_b32 v37, 16, v12
v_mfma_f32_16x16x32_bf16 a[160:163], a[252:255], v[16:19], a[160:163]
ds_read_b128 a[244:247], v33 offset:21504
v_and_b32 v12, s55, v12
v_mfma_f32_16x16x32_bf16 a[160:163], a[248:251], v[0:3], a[160:163]
s_waitcnt lgkmcnt(4)
buffer_load_dwordx4 v32, s[16:19], s52 offen offset:3072 sc1 lds
v_mfma_f32_16x16x32_bf16 a[168:171], a[224:227], v[0:3], a[168:171]
ds_read_b128 a[248:251], v33 offset:13312
v_add_f32 v39, v37, v38
v_mfma_f32_16x16x32_bf16 a[168:171], a[228:231], v[16:19], a[168:171]
v_subrev_f32 v38, v37, v38
v_add_f32 v37, v12, v44
v_mfma_f32_16x16x32_bf16 a[172:175], a[228:231], v[20:23], a[172:175]
s_add_u32 s53, s82, 151552
ds_read_b128 a[252:255], v33 offset:22528
v_subrev_f32 v44, v12, v44
v_mfma_f32_16x16x32_bf16 a[172:175], a[224:227], v[4:7], a[172:175]
s_waitcnt lgkmcnt(4)
v_cvt_pk_bf16_f32 v12, v39, v37
v_cvt_pk_bf16_f32 v44, v38, v44
v_mfma_f32_16x16x32_bf16 a[180:183], a[232:235], v[4:7], a[180:183]
s_add_u32 m0, s43, 40960
ds_read_b128 a[224:227], v33 offset:14336
v_lshlrev_b32 v38, 16, v45
v_mfma_f32_16x16x32_bf16 a[180:183], a[236:239], v[20:23], a[180:183]
buffer_load_dwordx4 v32, s[16:19], s53 offen sc1 lds
v_and_b32 v45, s55, v45
v_mfma_f32_16x16x32_bf16 a[176:179], a[236:239], v[16:19], a[176:179]
ds_read_b128 a[228:231], v33 offset:23552
v_lshlrev_b32 v37, 16, v13
v_mfma_f32_16x16x32_bf16 a[176:179], a[232:235], v[0:3], a[176:179]
s_waitcnt lgkmcnt(4)
v_and_b32 v13, s55, v13
v_add_f32 v39, v37, v38
v_mfma_f32_16x16x32_bf16 a[184:187], a[240:243], v[0:3], a[184:187]
ds_read_b128 a[232:235], v33 offset:15360
v_subrev_f32 v38, v37, v38
v_mfma_f32_16x16x32_bf16 a[184:187], a[244:247], v[16:19], a[184:187]
v_add_f32 v37, v13, v45
v_subrev_f32 v45, v13, v45
v_mfma_f32_16x16x32_bf16 a[188:191], a[244:247], v[20:23], a[188:191]
ds_read_b128 a[236:239], v33 offset:24576
v_cvt_pk_bf16_f32 v13, v39, v37
v_mfma_f32_16x16x32_bf16 a[188:191], a[240:243], v[4:7], a[188:191]
s_waitcnt lgkmcnt(4)
buffer_load_dwordx4 v32, s[16:19], s53 offen offset:1024 sc1 lds
v_mfma_f32_16x16x32_bf16 a[196:199], a[248:251], v[4:7], a[196:199]
ds_read_b128 a[240:243], v33 offset:16384
v_cvt_pk_bf16_f32 v45, v38, v45
v_mfma_f32_16x16x32_bf16 a[196:199], a[252:255], v[20:23], a[196:199]
v_lshlrev_b32 v38, 16, v46
v_and_b32 v46, s55, v46
v_mfma_f32_16x16x32_bf16 a[192:195], a[252:255], v[16:19], a[192:195]
ds_read_b128 a[244:247], v33 offset:25600
v_lshlrev_b32 v37, 16, v14
v_mfma_f32_16x16x32_bf16 a[192:195], a[248:251], v[0:3], a[192:195]
s_waitcnt lgkmcnt(4)
v_and_b32 v14, s55, v14
v_add_f32 v39, v37, v38
v_mfma_f32_16x16x32_bf16 a[200:203], a[224:227], v[0:3], a[200:203]
ds_read_b128 a[248:251], v33 offset:26624
v_subrev_f32 v38, v37, v38
v_mfma_f32_16x16x32_bf16 a[200:203], a[228:231], v[16:19], a[200:203]
buffer_load_dwordx4 v32, s[16:19], s53 offen offset:2048 sc1 lds
v_add_f32 v37, v14, v46
v_mfma_f32_16x16x32_bf16 a[204:207], a[228:231], v[20:23], a[204:207]
ds_read_b128 a[252:255], v33 offset:35840
v_subrev_f32 v46, v14, v46
v_mfma_f32_16x16x32_bf16 a[204:207], a[224:227], v[4:7], a[204:207]
s_waitcnt lgkmcnt(4)
v_cvt_pk_bf16_f32 v14, v39, v37
v_cvt_pk_bf16_f32 v46, v38, v46
v_mfma_f32_16x16x32_bf16 a[212:215], a[232:235], v[4:7], a[212:215]
ds_read_b128 a[224:227], v33 offset:27648
v_lshlrev_b32 v38, 16, v47
v_mfma_f32_16x16x32_bf16 a[212:215], a[236:239], v[20:23], a[212:215]
v_and_b32 v47, s55, v47
v_lshlrev_b32 v37, 16, v15
v_mfma_f32_16x16x32_bf16 a[208:211], a[236:239], v[16:19], a[208:211]
ds_read_b128 a[228:231], v33 offset:36864
v_and_b32 v15, s55, v15
v_mfma_f32_16x16x32_bf16 a[208:211], a[232:235], v[0:3], a[208:211]
s_waitcnt lgkmcnt(4)
buffer_load_dwordx4 v32, s[16:19], s53 offen offset:3072 sc1 lds
v_mfma_f32_16x16x32_bf16 a[216:219], a[240:243], v[0:3], a[216:219]
ds_read_b128 a[232:235], v33 offset:28672
v_add_f32 v39, v37, v38
v_mfma_f32_16x16x32_bf16 a[216:219], a[244:247], v[16:19], a[216:219]
v_subrev_f32 v38, v37, v38
v_add_f32 v37, v15, v47
v_mfma_f32_16x16x32_bf16 a[220:223], a[244:247], v[20:23], a[220:223]
s_add_u32 s54, s82, 155648
ds_read_b128 a[236:239], v33 offset:37888
v_subrev_f32 v47, v15, v47
v_mfma_f32_16x16x32_bf16 a[220:223], a[240:243], v[4:7], a[220:223]
s_waitcnt vmcnt(19) lgkmcnt(4)
v_cvt_pk_bf16_f32 v15, v39, v37
v_cvt_pk_bf16_f32 v47, v38, v47
L_pg6:
s_cbranch_vccnz L_vr1
v_mfma_f32_16x16x32_bf16 v[52:55], a[248:251], v[28:31], v[52:55]
s_add_u32 m0, s43, 45056
ds_read_b128 a[240:243], v33 offset:29696
v_mfma_f32_16x16x32_bf16 v[52:55], a[252:255], v[44:47], v[52:55]
buffer_load_dwordx4 v32, s[16:19], s54 offen sc1 lds
ds_read_b128 v[0:3], v34 offset:4096
v_accvgpr_read_b32 v20, a36
v_mfma_f32_16x16x32_bf16 v[48:51], a[252:255], v[40:43], v[48:51]
ds_read_b128 a[244:247], v33 offset:38912
v_accvgpr_read_b32 v21, a37
v_mfma_f32_16x16x32_bf16 v[48:51], a[248:251], v[24:27], v[48:51]
s_waitcnt lgkmcnt(5)
ds_read_b128 v[4:7], v34 offset:2048
v_accvgpr_read_b32 v22, a38
v_mfma_f32_16x16x32_bf16 v[56:59], a[224:227], v[24:27], v[56:59]
ds_read_b128 a[248:251], v33 offset:30720
v_accvgpr_read_b32 v23, a39
v_mfma_f32_16x16x32_bf16 v[56:59], a[228:231], v[40:43], v[56:59]
ds_read_b128 a[36:39], v34 offset:2048
v_accvgpr_read_b32 v16, a32
v_mfma_f32_16x16x32_bf16 v[60:63], a[228:231], v[44:47], v[60:63]
ds_read_b128 a[252:255], v33 offset:39936
v_accvgpr_read_b32 v17, a33
v_mfma_f32_16x16x32_bf16 v[60:63], a[224:227], v[28:31], v[60:63]
s_waitcnt lgkmcnt(7)
v_accvgpr_read_b32 v18, a34
v_accvgpr_read_b32 v19, a35
v_mfma_f32_16x16x32_bf16 v[68:71], a[232:235], v[28:31], v[68:71]
s_sub_u32 m0, s48, 384
ds_read_b128 a[224:227], v33 offset:31744
ds_read_b128 a[32:35], v34 offset:4096
v_mfma_f32_16x16x32_bf16 v[68:71], a[236:239], v[44:47], v[68:71]
buffer_load_dwordx4 v36, s[8:11], s63 offen offset:384 lds
v_mfma_f32_16x16x32_bf16 v[64:67], a[236:239], v[40:43], v[64:67]
s_load_dword s77, s[78:79], 28672
ds_read_b128 a[228:231], v33 offset:40960
v_lshlrev_b32 v38, 16, v16
v_mfma_f32_16x16x32_bf16 v[64:67], a[232:235], v[24:27], v[64:67]
s_waitcnt lgkmcnt(7)
v_and_b32 v16, s55, v16
v_lshlrev_b32 v37, 16, v0
v_mfma_f32_16x16x32_bf16 v[72:75], a[240:243], v[24:27], v[72:75]
ds_read_b128 a[232:235], v33 offset:32768
v_and_b32 v0, s55, v0
v_mfma_f32_16x16x32_bf16 v[72:75], a[244:247], v[40:43], v[72:75]
v_add_f32 v39, v37, v38
v_subrev_f32 v38, v37, v38
v_add_f32 v37, v0, v16
v_mfma_f32_16x16x32_bf16 v[76:79], a[244:247], v[44:47], v[76:79]
ds_read_b128 a[236:239], v33 offset:41984
v_subrev_f32 v16, v0, v16
v_mfma_f32_16x16x32_bf16 v[76:79], a[240:243], v[28:31], v[76:79]
s_waitcnt lgkmcnt(5)
v_cvt_pk_bf16_f32 v0, v39, v37
v_cvt_pk_bf16_f32 v16, v38, v16
v_mfma_f32_16x16x32_bf16 v[84:87], a[248:251], v[28:31], v[84:87]
s_add_u32 m0, s48, 640
ds_read_b128 a[240:243], v33 offset:33792
v_lshlrev_b32 v38, 16, v17
v_mfma_f32_16x16x32_bf16 v[84:87], a[252:255], v[44:47], v[84:87]
buffer_load_dwordx4 v36, s[8:11], s83 offen offset:384 lds
v_mfma_f32_16x16x32_bf16 v[80:83], a[252:255], v[40:43], v[80:83]
ds_read_b128 a[244:247], v33 offset:43008
v_and_b32 v17, s55, v17
v_mfma_f32_16x16x32_bf16 v[80:83], a[248:251], v[24:27], v[80:83]
s_waitcnt lgkmcnt(4)
v_lshlrev_b32 v37, 16, v1
v_and_b32 v1, s55, v1
v_mfma_f32_16x16x32_bf16 v[88:91], a[224:227], v[24:27], v[88:91]
ds_read_b128 a[248:251], v33 offset:34816
v_add_f32 v39, v37, v38
v_mfma_f32_16x16x32_bf16 v[88:91], a[228:231], v[40:43], v[88:91]
v_subrev_f32 v38, v37, v38
v_add_f32 v37, v1, v17
v_mfma_f32_16x16x32_bf16 v[92:95], a[228:231], v[44:47], v[92:95]
s_add_u32 s52, s76, 184320
ds_read_b128 a[252:255], v33 offset:44032
v_subrev_f32 v17, v1, v17
v_mfma_f32_16x16x32_bf16 v[92:95], a[224:227], v[28:31], v[92:95]
s_waitcnt vmcnt(13) lgkmcnt(4)
s_barrier
v_cvt_pk_bf16_f32 v1, v39, v37
v_cvt_pk_bf16_f32 v17, v38, v17
v_mfma_f32_16x16x32_bf16 v[100:103], a[232:235], v[28:31], v[100:103]
s_add_u32 m0, s43, 73728
ds_read_b128 a[224:227], v32 offset:18432
v_lshlrev_b32 v38, 16, v18
v_mfma_f32_16x16x32_bf16 v[100:103], a[236:239], v[44:47], v[100:103]
buffer_load_dwordx4 v32, s[16:19], s52 offen sc1 lds
v_and_b32 v18, s55, v18
v_mfma_f32_16x16x32_bf16 v[96:99], a[236:239], v[40:43], v[96:99]
ds_read_b128 a[228:231], v32 offset:27648
v_lshlrev_b32 v37, 16, v2
v_mfma_f32_16x16x32_bf16 v[96:99], a[232:235], v[24:27], v[96:99]
s_waitcnt lgkmcnt(4)
v_and_b32 v2, s55, v2
v_add_f32 v39, v37, v38
v_mfma_f32_16x16x32_bf16 v[104:107], a[240:243], v[24:27], v[104:107]
ds_read_b128 a[232:235], v32 offset:19456
v_subrev_f32 v38, v37, v38
v_mfma_f32_16x16x32_bf16 v[104:107], a[244:247], v[40:43], v[104:107]
v_add_f32 v37, v2, v18
v_subrev_f32 v18, v2, v18
v_mfma_f32_16x16x32_bf16 v[108:111], a[244:247], v[44:47], v[108:111]
ds_read_b128 a[236:239], v32 offset:28672
v_cvt_pk_bf16_f32 v2, v39, v37
v_mfma_f32_16x16x32_bf16 v[108:111], a[240:243], v[28:31], v[108:111]
s_waitcnt lgkmcnt(4)
buffer_load_dwordx4 v32, s[16:19], s52 offen offset:1024 sc1 lds
v_mfma_f32_16x16x32_bf16 v[116:119], a[248:251], v[28:31], v[116:119]
ds_read_b128 a[240:243], v32 offset:20480
v_cvt_pk_bf16_f32 v18, v38, v18
v_mfma_f32_16x16x32_bf16 v[116:119], a[252:255], v[44:47], v[116:119]
v_lshlrev_b32 v38, 16, v19
v_and_b32 v19, s55, v19
v_mfma_f32_16x16x32_bf16 v[112:115], a[252:255], v[40:43], v[112:115]
ds_read_b128 a[244:247], v32 offset:29696
v_lshlrev_b32 v37, 16, v3
v_mfma_f32_16x16x32_bf16 v[112:115], a[248:251], v[24:27], v[112:115]
s_waitcnt lgkmcnt(4)
v_and_b32 v3, s55, v3
v_add_f32 v39, v37, v38
v_mfma_f32_16x16x32_bf16 v[120:123], a[224:227], v[24:27], v[120:123]
ds_read_b128 a[248:251], v32 offset:21504
v_subrev_f32 v38, v37, v38
v_mfma_f32_16x16x32_bf16 v[120:123], a[228:231], v[40:43], v[120:123]
buffer_load_dwordx4 v32, s[16:19], s52 offen offset:2048 sc1 lds
v_add_f32 v37, v3, v19
v_mfma_f32_16x16x32_bf16 v[124:127], a[228:231], v[44:47], v[124:127]
ds_read_b128 a[252:255], v32 offset:30720
v_subrev_f32 v19, v3, v19
v_mfma_f32_16x16x32_bf16 v[124:127], a[224:227], v[28:31], v[124:127]
s_waitcnt lgkmcnt(4)
v_cvt_pk_bf16_f32 v3, v39, v37
v_cvt_pk_bf16_f32 v19, v38, v19
v_mfma_f32_16x16x32_bf16 v[132:135], a[232:235], v[28:31], v[132:135]
ds_read_b128 a[224:227], v32 offset:22528
v_lshlrev_b32 v38, 16, v20
v_mfma_f32_16x16x32_bf16 v[132:135], a[236:239], v[44:47], v[132:135]
v_and_b32 v20, s55, v20
v_lshlrev_b32 v37, 16, v4
v_mfma_f32_16x16x32_bf16 v[128:131], a[236:239], v[40:43], v[128:131]
ds_read_b128 a[228:231], v32 offset:31744
v_and_b32 v4, s55, v4
v_mfma_f32_16x16x32_bf16 v[128:131], a[232:235], v[24:27], v[128:131]
s_waitcnt lgkmcnt(4)
buffer_load_dwordx4 v32, s[16:19], s52 offen offset:3072 sc1 lds
v_mfma_f32_16x16x32_bf16 v[136:139], a[240:243], v[24:27], v[136:139]
ds_read_b128 a[232:235], v32 offset:23552
v_add_f32 v39, v37, v38
v_mfma_f32_16x16x32_bf16 v[136:139], a[244:247], v[40:43], v[136:139]
v_subrev_f32 v38, v37, v38
v_add_f32 v37, v4, v20
v_mfma_f32_16x16x32_bf16 v[140:143], a[244:247], v[44:47], v[140:143]
s_add_u32 s53, s76, 188416
ds_read_b128 a[236:239], v32 offset:32768
v_subrev_f32 v20, v4, v20
v_mfma_f32_16x16x32_bf16 v[140:143], a[240:243], v[28:31], v[140:143]
s_waitcnt lgkmcnt(4)
v_cvt_pk_bf16_f32 v4, v39, v37
v_cvt_pk_bf16_f32 v20, v38, v20
v_mfma_f32_16x16x32_bf16 v[148:151], a[248:251], v[28:31], v[148:151]
s_add_u32 m0, s43, 77824
ds_read_b128 a[240:243], v32 offset:24576
v_lshlrev_b32 v38, 16, v21
v_mfma_f32_16x16x32_bf16 v[148:151], a[252:255], v[44:47], v[148:151]
buffer_load_dwordx4 v32, s[16:19], s53 offen sc1 lds
v_and_b32 v21, s55, v21
v_mfma_f32_16x16x32_bf16 v[144:147], a[252:255], v[40:43], v[144:147]
ds_read_b128 a[244:247], v32 offset:33792
v_lshlrev_b32 v37, 16, v5
v_mfma_f32_16x16x32_bf16 v[144:147], a[248:251], v[24:27], v[144:147]
s_waitcnt lgkmcnt(4)
v_and_b32 v5, s55, v5
v_add_f32 v39, v37, v38
v_mfma_f32_16x16x32_bf16 v[152:155], a[224:227], v[24:27], v[152:155]
ds_read_b128 a[248:251], v32 offset:25600
v_subrev_f32 v38, v37, v38
v_mfma_f32_16x16x32_bf16 v[152:155], a[228:231], v[40:43], v[152:155]
v_add_f32 v37, v5, v21
v_subrev_f32 v21, v5, v21
v_mfma_f32_16x16x32_bf16 v[156:159], a[228:231], v[44:47], v[156:159]
s_mul_i32 s59, s41, 576
ds_read_b128 a[252:255], v32 offset:34816
v_cvt_pk_bf16_f32 v5, v39, v37
v_mfma_f32_16x16x32_bf16 v[156:159], a[224:227], v[28:31], v[156:159]
s_waitcnt lgkmcnt(4)
buffer_load_dwordx4 v32, s[16:19], s53 offen offset:1024 sc1 lds
v_mfma_f32_16x16x32_bf16 v[164:167], a[232:235], v[28:31], v[164:167]
ds_read_b128 a[224:227], v32 offset:26624
v_cvt_pk_bf16_f32 v21, v38, v21
v_mfma_f32_16x16x32_bf16 v[164:167], a[236:239], v[44:47], v[164:167]
v_lshlrev_b32 v38, 16, v22
v_and_b32 v22, s55, v22
v_mfma_f32_16x16x32_bf16 v[160:163], a[236:239], v[40:43], v[160:163]
ds_read_b128 a[228:231], v32 offset:35840
v_lshlrev_b32 v37, 16, v6
v_mfma_f32_16x16x32_bf16 v[160:163], a[232:235], v[24:27], v[160:163]
s_waitcnt lgkmcnt(4)
v_and_b32 v6, s55, v6
v_add_f32 v39, v37, v38
v_mfma_f32_16x16x32_bf16 v[168:171], a[240:243], v[24:27], v[168:171]
ds_read_b128 a[232:235], v32
v_subrev_f32 v38, v37, v38
v_mfma_f32_16x16x32_bf16 v[168:171], a[244:247], v[40:43], v[168:171]
buffer_load_dwordx4 v32, s[16:19], s53 offen offset:2048 sc1 lds
v_add_f32 v37, v6, v22
v_mfma_f32_16x16x32_bf16 v[172:175], a[244:247], v[44:47], v[172:175]
ds_read_b128 a[236:239], v32 offset:9216
v_subrev_f32 v22, v6, v22
v_mfma_f32_16x16x32_bf16 v[172:175], a[240:243], v[28:31], v[172:175]
s_waitcnt lgkmcnt(4)
v_cvt_pk_bf16_f32 v6, v39, v37
v_cvt_pk_bf16_f32 v22, v38, v22
v_mfma_f32_16x16x32_bf16 v[180:183], a[248:251], v[28:31], v[180:183]
ds_read_b128 a[240:243], v32 offset:1024
v_lshlrev_b32 v38, 16, v23
v_mfma_f32_16x16x32_bf16 v[180:183], a[252:255], v[44:47], v[180:183]
v_and_b32 v23, s55, v23
v_lshlrev_b32 v37, 16, v7
v_mfma_f32_16x16x32_bf16 v[176:179], a[252:255], v[40:43], v[176:179]
ds_read_b128 a[244:247], v32 offset:10240
v_and_b32 v7, s55, v7
v_mfma_f32_16x16x32_bf16 v[176:179], a[248:251], v[24:27], v[176:179]
s_waitcnt lgkmcnt(4)
buffer_load_dwordx4 v32, s[16:19], s53 offen offset:3072 sc1 lds
v_mfma_f32_16x16x32_bf16 v[184:187], a[224:227], v[24:27], v[184:187]
ds_read_b128 a[248:251], v32 offset:2048
v_add_f32 v39, v37, v38
v_mfma_f32_16x16x32_bf16 v[184:187], a[228:231], v[40:43], v[184:187]
v_subrev_f32 v38, v37, v38
v_add_f32 v37, v7, v23
v_mfma_f32_16x16x32_bf16 v[188:191], a[228:231], v[44:47], v[188:191]
s_add_u32 s54, s76, 192512
ds_read_b128 a[252:255], v32 offset:11264
v_subrev_f32 v23, v7, v23
v_mfma_f32_16x16x32_bf16 v[188:191], a[224:227], v[28:31], v[188:191]
s_waitcnt lgkmcnt(4)
v_cvt_pk_bf16_f32 v7, v39, v37
v_cvt_pk_bf16_f32 v23, v38, v23
v_mfma_f32_16x16x32_bf16 v[196:199], a[232:235], v[12:15], v[196:199]
s_add_u32 m0, s43, 81920
ds_read_b128 a[224:227], v32 offset:3072
v_mfma_f32_16x16x32_bf16 v[196:199], a[236:239], v[4:7], v[196:199]
buffer_load_dwordx4 v32, s[16:19], s54 offen sc1 lds
ds_read_b128 v[24:27], v35 offset:4096
v_accvgpr_read_b32 v44, a44
v_mfma_f32_16x16x32_bf16 v[192:195], a[236:239], v[0:3], v[192:195]
s_sub_u32 s58, s49, s59
ds_read_b128 a[228:231], v32 offset:12288
v_accvgpr_read_b32 v45, a45
v_mfma_f32_16x16x32_bf16 v[192:195], a[232:235], v[8:11], v[192:195]
s_waitcnt lgkmcnt(5)
ds_read_b128 v[28:31], v35 offset:2048
v_accvgpr_read_b32 v46, a46
v_mfma_f32_16x16x32_bf16 v[200:203], a[240:243], v[8:11], v[200:203]
ds_read_b128 a[232:235], v32 offset:4096
v_accvgpr_read_b32 v47, a47
v_mfma_f32_16x16x32_bf16 v[200:203], a[244:247], v[0:3], v[200:203]
ds_read_b128 a[44:47], v35 offset:2048
v_accvgpr_read_b32 v40, a40
v_mfma_f32_16x16x32_bf16 v[204:207], a[244:247], v[4:7], v[204:207]
ds_read_b128 a[236:239], v32 offset:13312
v_accvgpr_read_b32 v41, a41
v_mfma_f32_16x16x32_bf16 v[204:207], a[240:243], v[12:15], v[204:207]
s_waitcnt lgkmcnt(7)
v_accvgpr_read_b32 v42, a42
v_accvgpr_read_b32 v43, a43
v_mfma_f32_16x16x32_bf16 v[212:215], a[248:251], v[12:15], v[212:215]
s_add_u32 m0, s48, 5632
ds_read_b128 a[240:243], v32 offset:5120
ds_read_b128 a[40:43], v35 offset:4096
v_mfma_f32_16x16x32_bf16 v[212:215], a[252:255], v[4:7], v[212:215]
buffer_load_dwordx4 v36, s[8:11], s44 offen offset:512 lds
v_mfma_f32_16x16x32_bf16 v[208:211], a[252:255], v[0:3], v[208:211]
ds_read_b128 a[244:247], v32 offset:14336
v_lshlrev_b32 v38, 16, v40
v_mfma_f32_16x16x32_bf16 v[208:211], a[248:251], v[8:11], v[208:211]
s_waitcnt lgkmcnt(7)
v_and_b32 v40, s55, v40
v_lshlrev_b32 v37, 16, v24
v_mfma_f32_16x16x32_bf16 v[216:219], a[224:227], v[8:11], v[216:219]
ds_read_b128 a[248:251], v32 offset:6144
v_and_b32 v24, s55, v24
v_mfma_f32_16x16x32_bf16 v[216:219], a[228:231], v[0:3], v[216:219]
v_add_f32 v39, v37, v38
v_subrev_f32 v38, v37, v38
v_add_f32 v37, v24, v40
v_mfma_f32_16x16x32_bf16 v[220:223], a[228:231], v[4:7], v[220:223]
ds_read_b128 a[252:255], v32 offset:15360
v_subrev_f32 v40, v24, v40
v_mfma_f32_16x16x32_bf16 v[220:223], a[224:227], v[12:15], v[220:223]
s_waitcnt lgkmcnt(5)
v_cvt_pk_bf16_f32 v24, v39, v37
v_cvt_pk_bf16_f32 v40, v38, v40
v_mfma_f32_16x16x32_bf16 v[228:231], a[232:235], v[12:15], v[228:231]
s_add_u32 m0, s48, 6656
ds_read_b128 a[224:227], v32 offset:7168
v_lshlrev_b32 v38, 16, v41
v_mfma_f32_16x16x32_bf16 v[228:231], a[236:239], v[4:7], v[228:231]
buffer_load_dwordx4 v36, s[8:11], s45 offen offset:512 lds
v_mfma_f32_16x16x32_bf16 v[224:227], a[236:239], v[0:3], v[224:227]
ds_read_b128 a[228:231], v32 offset:16384
v_and_b32 v41, s55, v41
v_mfma_f32_16x16x32_bf16 v[224:227], a[232:235], v[8:11], v[224:227]
s_waitcnt lgkmcnt(4)
v_lshlrev_b32 v37, 16, v25
v_and_b32 v25, s55, v25
v_mfma_f32_16x16x32_bf16 v[232:235], a[240:243], v[8:11], v[232:235]
s_sub_u32 s59, s50, s59
ds_read_b128 a[232:235], v32 offset:8192
v_add_f32 v39, v37, v38
v_mfma_f32_16x16x32_bf16 v[232:235], a[244:247], v[0:3], v[232:235]
v_subrev_f32 v38, v37, v38
v_add_f32 v37, v25, v41
v_mfma_f32_16x16x32_bf16 v[236:239], a[244:247], v[4:7], v[236:239]
s_add_u32 s52, s82, 221184
ds_read_b128 a[236:239], v32 offset:17408
v_subrev_f32 v41, v25, v41
v_mfma_f32_16x16x32_bf16 v[236:239], a[240:243], v[12:15], v[236:239]
s_waitcnt vmcnt(13) lgkmcnt(4)
s_barrier
v_cvt_pk_bf16_f32 v25, v39, v37
v_cvt_pk_bf16_f32 v41, v38, v41
v_mfma_f32_16x16x32_bf16 v[244:247], a[248:251], v[12:15], v[244:247]
s_add_u32 m0, s43, 0
ds_read_b128 a[240:243], v32 offset:36864
v_lshlrev_b32 v38, 16, v42
v_mfma_f32_16x16x32_bf16 v[244:247], a[252:255], v[4:7], v[244:247]
buffer_load_dwordx4 v32, s[16:19], s52 offen sc1 lds
v_and_b32 v42, s55, v42
v_mfma_f32_16x16x32_bf16 v[240:243], a[252:255], v[0:3], v[240:243]
ds_read_b128 a[244:247], v32 offset:46080
v_lshlrev_b32 v37, 16, v26
v_mfma_f32_16x16x32_bf16 v[240:243], a[248:251], v[8:11], v[240:243]
s_waitcnt lgkmcnt(4)
v_and_b32 v26, s55, v26
v_add_f32 v39, v37, v38
v_mfma_f32_16x16x32_bf16 v[248:251], a[224:227], v[8:11], v[248:251]
ds_read_b128 a[248:251], v32 offset:37888
v_subrev_f32 v38, v37, v38
v_mfma_f32_16x16x32_bf16 v[248:251], a[228:231], v[0:3], v[248:251]
v_add_f32 v37, v26, v42
v_subrev_f32 v42, v26, v42
v_mfma_f32_16x16x32_bf16 v[252:255], a[228:231], v[4:7], v[252:255]
ds_read_b128 a[252:255], v32 offset:47104
v_cvt_pk_bf16_f32 v26, v39, v37
v_mfma_f32_16x16x32_bf16 v[252:255], a[224:227], v[12:15], v[252:255]
s_waitcnt lgkmcnt(4)
buffer_load_dwordx4 v32, s[16:19], s52 offen offset:1024 sc1 lds
v_mfma_f32_16x16x32_bf16 a[148:151], a[232:235], v[12:15], a[148:151]
ds_read_b128 a[224:227], v32 offset:38912
v_cvt_pk_bf16_f32 v42, v38, v42
v_mfma_f32_16x16x32_bf16 a[148:151], a[236:239], v[4:7], a[148:151]
v_lshlrev_b32 v38, 16, v43
v_and_b32 v43, s55, v43
v_mfma_f32_16x16x32_bf16 a[144:147], a[236:239], v[0:3], a[144:147]
ds_read_b128 a[228:231], v32 offset:48128
v_lshlrev_b32 v37, 16, v27
v_mfma_f32_16x16x32_bf16 a[144:147], a[232:235], v[8:11], a[144:147]
s_waitcnt lgkmcnt(4)
v_and_b32 v27, s55, v27
v_add_f32 v39, v37, v38
v_mfma_f32_16x16x32_bf16 a[152:155], a[240:243], v[8:11], a[152:155]
ds_read_b128 a[232:235], v32 offset:39936
v_subrev_f32 v38, v37, v38
v_mfma_f32_16x16x32_bf16 a[152:155], a[244:247], v[0:3], a[152:155]
buffer_load_dwordx4 v32, s[16:19], s52 offen offset:2048 sc1 lds
v_add_f32 v37, v27, v43
v_mfma_f32_16x16x32_bf16 a[156:159], a[244:247], v[4:7], a[156:159]
ds_read_b128 a[236:239], v32 offset:49152
v_subrev_f32 v43, v27, v43
v_mfma_f32_16x16x32_bf16 a[156:159], a[240:243], v[12:15], a[156:159]
s_waitcnt lgkmcnt(4)
v_cvt_pk_bf16_f32 v27, v39, v37
v_cvt_pk_bf16_f32 v43, v38, v43
v_mfma_f32_16x16x32_bf16 a[164:167], a[248:251], v[12:15], a[164:167]
ds_read_b128 a[240:243], v32 offset:40960
v_lshlrev_b32 v38, 16, v44
v_mfma_f32_16x16x32_bf16 a[164:167], a[252:255], v[4:7], a[164:167]
v_and_b32 v44, s55, v44
v_lshlrev_b32 v37, 16, v28
v_mfma_f32_16x16x32_bf16 a[160:163], a[252:255], v[0:3], a[160:163]
ds_read_b128 a[244:247], v32 offset:50176
v_and_b32 v28, s55, v28
v_mfma_f32_16x16x32_bf16 a[160:163], a[248:251], v[8:11], a[160:163]
s_waitcnt lgkmcnt(4)
buffer_load_dwordx4 v32, s[16:19], s52 offen offset:3072 sc1 lds
v_mfma_f32_16x16x32_bf16 a[168:171], a[224:227], v[8:11], a[168:171]
ds_read_b128 a[248:251], v32 offset:41984
v_add_f32 v39, v37, v38
v_mfma_f32_16x16x32_bf16 a[168:171], a[228:231], v[0:3], a[168:171]
v_subrev_f32 v38, v37, v38
v_add_f32 v37, v28, v44
v_mfma_f32_16x16x32_bf16 a[172:175], a[228:231], v[4:7], a[172:175]
s_add_u32 s53, s82, 225280
ds_read_b128 a[252:255], v32 offset:51200
v_subrev_f32 v44, v28, v44
v_mfma_f32_16x16x32_bf16 a[172:175], a[224:227], v[12:15], a[172:175]
s_waitcnt lgkmcnt(4)
v_cvt_pk_bf16_f32 v28, v39, v37
v_cvt_pk_bf16_f32 v44, v38, v44
v_mfma_f32_16x16x32_bf16 a[180:183], a[232:235], v[12:15], a[180:183]
s_add_u32 m0, s43, 4096
ds_read_b128 a[224:227], v32 offset:43008
v_lshlrev_b32 v38, 16, v45
v_mfma_f32_16x16x32_bf16 a[180:183], a[236:239], v[4:7], a[180:183]
buffer_load_dwordx4 v32, s[16:19], s53 offen sc1 lds
v_and_b32 v45, s55, v45
v_mfma_f32_16x16x32_bf16 a[176:179], a[236:239], v[0:3], a[176:179]
ds_read_b128 a[228:231], v32 offset:52224
v_lshlrev_b32 v37, 16, v29
v_mfma_f32_16x16x32_bf16 a[176:179], a[232:235], v[8:11], a[176:179]
s_waitcnt lgkmcnt(4)
v_and_b32 v29, s55, v29
v_add_f32 v39, v37, v38
v_mfma_f32_16x16x32_bf16 a[184:187], a[240:243], v[8:11], a[184:187]
ds_read_b128 a[232:235], v32 offset:44032
v_subrev_f32 v38, v37, v38
v_mfma_f32_16x16x32_bf16 a[184:187], a[244:247], v[0:3], a[184:187]
v_add_f32 v37, v29, v45
v_subrev_f32 v45, v29, v45
v_mfma_f32_16x16x32_bf16 a[188:191], a[244:247], v[4:7], a[188:191]
ds_read_b128 a[236:239], v32 offset:53248
v_cvt_pk_bf16_f32 v29, v39, v37
v_mfma_f32_16x16x32_bf16 a[188:191], a[240:243], v[12:15], a[188:191]
s_waitcnt lgkmcnt(4)
buffer_load_dwordx4 v32, s[16:19], s53 offen offset:1024 sc1 lds
v_mfma_f32_16x16x32_bf16 a[196:199], a[248:251], v[12:15], a[196:199]
ds_read_b128 a[240:243], v32 offset:45056
v_cvt_pk_bf16_f32 v45, v38, v45
v_mfma_f32_16x16x32_bf16 a[196:199], a[252:255], v[4:7], a[196:199]
v_lshlrev_b32 v38, 16, v46
v_and_b32 v46, s55, v46
v_mfma_f32_16x16x32_bf16 a[192:195], a[252:255], v[0:3], a[192:195]
ds_read_b128 a[244:247], v32 offset:54272
v_lshlrev_b32 v37, 16, v30
v_mfma_f32_16x16x32_bf16 a[192:195], a[248:251], v[8:11], a[192:195]
s_waitcnt lgkmcnt(4)
v_and_b32 v30, s55, v30
v_add_f32 v39, v37, v38
v_mfma_f32_16x16x32_bf16 a[200:203], a[224:227], v[8:11], a[200:203]
ds_read_b128 a[248:251], v32 offset:55296
v_subrev_f32 v38, v37, v38
v_mfma_f32_16x16x32_bf16 a[200:203], a[228:231], v[0:3], a[200:203]
buffer_load_dwordx4 v32, s[16:19], s53 offen offset:2048 sc1 lds
v_add_f32 v37, v30, v46
v_mfma_f32_16x16x32_bf16 a[204:207], a[228:231], v[4:7], a[204:207]
ds_read_b128 a[252:255], v32 offset:64512
v_subrev_f32 v46, v30, v46
v_mfma_f32_16x16x32_bf16 a[204:207], a[224:227], v[12:15], a[204:207]
s_waitcnt lgkmcnt(4)
v_cvt_pk_bf16_f32 v30, v39, v37
v_cvt_pk_bf16_f32 v46, v38, v46
v_mfma_f32_16x16x32_bf16 a[212:215], a[232:235], v[12:15], a[212:215]
ds_read_b128 a[224:227], v32 offset:56320
v_lshlrev_b32 v38, 16, v47
v_mfma_f32_16x16x32_bf16 a[212:215], a[236:239], v[4:7], a[212:215]
v_and_b32 v47, s55, v47
v_lshlrev_b32 v37, 16, v31
v_mfma_f32_16x16x32_bf16 a[208:211], a[236:239], v[0:3], a[208:211]
ds_read_b128 a[228:231], v33
v_and_b32 v31, s55, v31
v_mfma_f32_16x16x32_bf16 a[208:211], a[232:235], v[8:11], a[208:211]
s_waitcnt lgkmcnt(4)
buffer_load_dwordx4 v32, s[16:19], s53 offen offset:3072 sc1 lds
v_mfma_f32_16x16x32_bf16 a[216:219], a[240:243], v[8:11], a[216:219]
ds_read_b128 a[232:235], v32 offset:57344
v_add_f32 v39, v37, v38
v_mfma_f32_16x16x32_bf16 a[216:219], a[244:247], v[0:3], a[216:219]
v_subrev_f32 v38, v37, v38
v_add_f32 v37, v31, v47
v_mfma_f32_16x16x32_bf16 a[220:223], a[244:247], v[4:7], a[220:223]
s_add_u32 s54, s82, 229376
ds_read_b128 a[236:239], v33 offset:1024
v_subrev_f32 v47, v31, v47
v_mfma_f32_16x16x32_bf16 a[220:223], a[240:243], v[12:15], a[220:223]
s_waitcnt vmcnt(19) lgkmcnt(4)
v_cvt_pk_bf16_f32 v31, v39, v37
v_cvt_pk_bf16_f32 v47, v38, v47
v_mfma_f32_16x16x32_bf16 v[52:55], a[248:251], v[20:23], v[52:55]
s_add_u32 m0, s43, 8192
ds_read_b128 a[240:243], v32 offset:58368
v_mfma_f32_16x16x32_bf16 v[52:55], a[252:255], v[44:47], v[52:55]
buffer_load_dwordx4 v32, s[16:19], s54 offen sc1 lds
ds_read_b128 v[8:11], v34 offset:8192
v_accvgpr_read_b32 v4, a52
v_mfma_f32_16x16x32_bf16 v[48:51], a[252:255], v[40:43], v[48:51]
ds_read_b128 a[244:247], v33 offset:2048
v_accvgpr_read_b32 v5, a53
v_mfma_f32_16x16x32_bf16 v[48:51], a[248:251], v[16:19], v[48:51]
s_waitcnt lgkmcnt(5)
ds_read_b128 v[12:15], v34
v_accvgpr_read_b32 v6, a54
v_mfma_f32_16x16x32_bf16 v[56:59], a[224:227], v[16:19], v[56:59]
ds_read_b128 a[248:251], v32 offset:59392
v_accvgpr_read_b32 v7, a55
v_mfma_f32_16x16x32_bf16 v[56:59], a[228:231], v[40:43], v[56:59]
ds_read_b128 a[52:55], v34
v_accvgpr_read_b32 v0, a48
v_mfma_f32_16x16x32_bf16 v[60:63], a[228:231], v[44:47], v[60:63]
ds_read_b128 a[252:255], v33 offset:3072
v_accvgpr_read_b32 v1, a49
v_mfma_f32_16x16x32_bf16 v[60:63], a[224:227], v[20:23], v[60:63]
s_waitcnt lgkmcnt(7)
v_accvgpr_read_b32 v2, a50
v_accvgpr_read_b32 v3, a51
v_mfma_f32_16x16x32_bf16 v[68:71], a[232:235], v[20:23], v[68:71]
s_add_u32 m0, s48, 1536
ds_read_b128 a[224:227], v32 offset:60416
ds_read_b128 a[48:51], v34 offset:8192
v_mfma_f32_16x16x32_bf16 v[68:71], a[236:239], v[44:47], v[68:71]
buffer_load_dwordx4 v36, s[8:11], s63 offen offset:512 lds
v_mfma_f32_16x16x32_bf16 v[64:67], a[236:239], v[40:43], v[64:67]
ds_read_b128 a[228:231], v33 offset:4096
v_lshlrev_b32 v38, 16, v0
v_mfma_f32_16x16x32_bf16 v[64:67], a[232:235], v[16:19], v[64:67]
s_waitcnt lgkmcnt(7)
v_and_b32 v0, s55, v0
v_lshlrev_b32 v37, 16, v8
v_mfma_f32_16x16x32_bf16 v[72:75], a[240:243], v[16:19], v[72:75]
ds_read_b128 a[232:235], v32 offset:61440
v_and_b32 v8, s55, v8
v_mfma_f32_16x16x32_bf16 v[72:75], a[244:247], v[40:43], v[72:75]
v_add_f32 v39, v37, v38
v_subrev_f32 v38, v37, v38
v_add_f32 v37, v8, v0
v_mfma_f32_16x16x32_bf16 v[76:79], a[244:247], v[44:47], v[76:79]
ds_read_b128 a[236:239], v33 offset:5120
v_subrev_f32 v0, v8, v0
v_mfma_f32_16x16x32_bf16 v[76:79], a[240:243], v[20:23], v[76:79]
s_waitcnt lgkmcnt(5)
v_cvt_pk_bf16_f32 v8, v39, v37
v_cvt_pk_bf16_f32 v0, v38, v0
v_mfma_f32_16x16x32_bf16 v[84:87], a[248:251], v[20:23], v[84:87]
s_add_u32 m0, s48, 2560
ds_read_b128 a[240:243], v32 offset:62464
v_lshlrev_b32 v38, 16, v1
v_mfma_f32_16x16x32_bf16 v[84:87], a[252:255], v[44:47], v[84:87]
buffer_load_dwordx4 v36, s[8:11], s83 offen offset:512 lds
v_mfma_f32_16x16x32_bf16 v[80:83], a[252:255], v[40:43], v[80:83]
ds_read_b128 a[244:247], v33 offset:6144
v_and_b32 v1, s55, v1
v_mfma_f32_16x16x32_bf16 v[80:83], a[248:251], v[16:19], v[80:83]
s_waitcnt lgkmcnt(4)
v_lshlrev_b32 v37, 16, v9
v_and_b32 v9, s55, v9
v_mfma_f32_16x16x32_bf16 v[88:91], a[224:227], v[16:19], v[88:91]
ds_read_b128 a[248:251], v32 offset:63488
v_add_f32 v39, v37, v38
v_mfma_f32_16x16x32_bf16 v[88:91], a[228:231], v[40:43], v[88:91]
v_subrev_f32 v38, v37, v38
v_add_f32 v37, v9, v1
v_mfma_f32_16x16x32_bf16 v[92:95], a[228:231], v[44:47], v[92:95]
s_add_u32 s52, s76, 258048
ds_read_b128 a[252:255], v33 offset:7168
v_subrev_f32 v1, v9, v1
v_mfma_f32_16x16x32_bf16 v[92:95], a[224:227], v[20:23], v[92:95]
s_waitcnt vmcnt(13) lgkmcnt(4)
s_barrier
v_cvt_pk_bf16_f32 v9, v39, v37
v_cvt_pk_bf16_f32 v1, v38, v1
v_mfma_f32_16x16x32_bf16 v[100:103], a[232:235], v[20:23], v[100:103]
s_add_u32 m0, s43, 36864
ds_read_b128 a[224:227], v33 offset:26624
v_lshlrev_b32 v38, 16, v2
v_mfma_f32_16x16x32_bf16 v[100:103], a[236:239], v[44:47], v[100:103]
buffer_load_dwordx4 v32, s[16:19], s52 offen sc1 lds
v_and_b32 v2, s55, v2
v_mfma_f32_16x16x32_bf16 v[96:99], a[236:239], v[40:43], v[96:99]
ds_read_b128 a[228:231], v33 offset:35840
v_lshlrev_b32 v37, 16, v10
v_mfma_f32_16x16x32_bf16 v[96:99], a[232:235], v[16:19], v[96:99]
s_waitcnt lgkmcnt(4)
v_and_b32 v10, s55, v10
v_add_f32 v39, v37, v38
v_mfma_f32_16x16x32_bf16 v[104:107], a[240:243], v[16:19], v[104:107]
ds_read_b128 a[232:235], v33 offset:27648
v_subrev_f32 v38, v37, v38
v_mfma_f32_16x16x32_bf16 v[104:107], a[244:247], v[40:43], v[104:107]
v_add_f32 v37, v10, v2
v_subrev_f32 v2, v10, v2
v_mfma_f32_16x16x32_bf16 v[108:111], a[244:247], v[44:47], v[108:111]
ds_read_b128 a[236:239], v33 offset:36864
v_cvt_pk_bf16_f32 v10, v39, v37
v_mfma_f32_16x16x32_bf16 v[108:111], a[240:243], v[20:23], v[108:111]
s_waitcnt lgkmcnt(4)
buffer_load_dwordx4 v32, s[16:19], s52 offen offset:1024 sc1 lds
v_mfma_f32_16x16x32_bf16 v[116:119], a[248:251], v[20:23], v[116:119]
ds_read_b128 a[240:243], v33 offset:28672
v_cvt_pk_bf16_f32 v2, v38, v2
v_mfma_f32_16x16x32_bf16 v[116:119], a[252:255], v[44:47], v[116:119]
v_lshlrev_b32 v38, 16, v3
v_and_b32 v3, s55, v3
v_mfma_f32_16x16x32_bf16 v[112:115], a[252:255], v[40:43], v[112:115]
ds_read_b128 a[244:247], v33 offset:37888
v_lshlrev_b32 v37, 16, v11
v_mfma_f32_16x16x32_bf16 v[112:115], a[248:251], v[16:19], v[112:115]
s_waitcnt lgkmcnt(4)
v_and_b32 v11, s55, v11
v_add_f32 v39, v37, v38
v_mfma_f32_16x16x32_bf16 v[120:123], a[224:227], v[16:19], v[120:123]
ds_read_b128 a[248:251], v33 offset:29696
v_subrev_f32 v38, v37, v38
v_mfma_f32_16x16x32_bf16 v[120:123], a[228:231], v[40:43], v[120:123]
buffer_load_dwordx4 v32, s[16:19], s52 offen offset:2048 sc1 lds
v_add_f32 v37, v11, v3
v_mfma_f32_16x16x32_bf16 v[124:127], a[228:231], v[44:47], v[124:127]
ds_read_b128 a[252:255], v33 offset:38912
v_subrev_f32 v3, v11, v3
v_mfma_f32_16x16x32_bf16 v[124:127], a[224:227], v[20:23], v[124:127]
s_waitcnt lgkmcnt(4)
v_cvt_pk_bf16_f32 v11, v39, v37
v_cvt_pk_bf16_f32 v3, v38, v3
v_mfma_f32_16x16x32_bf16 v[132:135], a[232:235], v[20:23], v[132:135]
ds_read_b128 a[224:227], v33 offset:30720
v_lshlrev_b32 v38, 16, v4
v_mfma_f32_16x16x32_bf16 v[132:135], a[236:239], v[44:47], v[132:135]
L_pg7:
s_cbranch_vccnz L_vr1
v_and_b32 v4, s55, v4
v_lshlrev_b32 v37, 16, v12
v_mfma_f32_16x16x32_bf16 v[128:131], a[236:239], v[40:43], v[128:131]
ds_read_b128 a[228:231], v33 offset:39936
v_and_b32 v12, s55, v12
v_mfma_f32_16x16x32_bf16 v[128:131], a[232:235], v[16:19], v[128:131]
s_waitcnt lgkmcnt(4)
buffer_load_dwordx4 v32, s[16:19], s52 offen offset:3072 sc1 lds
v_mfma_f32_16x16x32_bf16 v[136:139], a[240:243], v[16:19], v[136:139]
s_load_dword s77, s[78:79], 32768
ds_read_b128 a[232:235], v33 offset:31744
v_add_f32 v39, v37, v38
v_mfma_f32_16x16x32_bf16 v[136:139], a[244:247], v[40:43], v[136:139]
v_subrev_f32 v38, v37, v38
v_add_f32 v37, v12, v4
v_mfma_f32_16x16x32_bf16 v[140:143], a[244:247], v[44:47], v[140:143]
s_add_u32 s53, s76, 262144
ds_read_b128 a[236:239], v33 offset:40960
v_subrev_f32 v4, v12, v4
v_mfma_f32_16x16x32_bf16 v[140:143], a[240:243], v[20:23], v[140:143]
s_waitcnt lgkmcnt(4)
v_cvt_pk_bf16_f32 v12, v39, v37
v_cvt_pk_bf16_f32 v4, v38, v4
v_mfma_f32_16x16x32_bf16 v[148:151], a[248:251], v[20:23], v[148:151]
s_add_u32 m0, s43, 40960
ds_read_b128 a[240:243], v33 offset:32768
v_lshlrev_b32 v38, 16, v5
v_mfma_f32_16x16x32_bf16 v[148:151], a[252:255], v[44:47], v[148:151]
buffer_load_dwordx4 v32, s[16:19], s53 offen sc1 lds
v_and_b32 v5, s55, v5
v_mfma_f32_16x16x32_bf16 v[144:147], a[252:255], v[40:43], v[144:147]
ds_read_b128 a[244:247], v33 offset:41984
v_lshlrev_b32 v37, 16, v13
v_mfma_f32_16x16x32_bf16 v[144:147], a[248:251], v[16:19], v[144:147]
s_waitcnt lgkmcnt(4)
v_and_b32 v13, s55, v13
v_add_f32 v39, v37, v38
v_mfma_f32_16x16x32_bf16 v[152:155], a[224:227], v[16:19], v[152:155]
ds_read_b128 a[248:251], v33 offset:33792
v_subrev_f32 v38, v37, v38
v_mfma_f32_16x16x32_bf16 v[152:155], a[228:231], v[40:43], v[152:155]
v_add_f32 v37, v13, v5
v_subrev_f32 v5, v13, v5
v_mfma_f32_16x16x32_bf16 v[156:159], a[228:231], v[44:47], v[156:159]
ds_read_b128 a[252:255], v33 offset:43008
v_cvt_pk_bf16_f32 v13, v39, v37
v_mfma_f32_16x16x32_bf16 v[156:159], a[224:227], v[20:23], v[156:159]
s_waitcnt lgkmcnt(4)
buffer_load_dwordx4 v32, s[16:19], s53 offen offset:1024 sc1 lds
v_mfma_f32_16x16x32_bf16 v[164:167], a[232:235], v[20:23], v[164:167]
ds_read_b128 a[224:227], v33 offset:34816
v_cvt_pk_bf16_f32 v5, v38, v5
v_mfma_f32_16x16x32_bf16 v[164:167], a[236:239], v[44:47], v[164:167]
v_lshlrev_b32 v38, 16, v6
v_and_b32 v6, s55, v6
v_mfma_f32_16x16x32_bf16 v[160:163], a[236:239], v[40:43], v[160:163]
ds_read_b128 a[228:231], v33 offset:44032
v_lshlrev_b32 v37, 16, v14
v_mfma_f32_16x16x32_bf16 v[160:163], a[232:235], v[16:19], v[160:163]
s_waitcnt lgkmcnt(4)
v_and_b32 v14, s55, v14
v_add_f32 v39, v37, v38
v_mfma_f32_16x16x32_bf16 v[168:171], a[240:243], v[16:19], v[168:171]
ds_read_b128 a[232:235], v33 offset:8192
v_subrev_f32 v38, v37, v38
v_mfma_f32_16x16x32_bf16 v[168:171], a[244:247], v[40:43], v[168:171]
buffer_load_dwordx4 v32, s[16:19], s53 offen offset:2048 sc1 lds
v_add_f32 v37, v14, v6
v_mfma_f32_16x16x32_bf16 v[172:175], a[244:247], v[44:47], v[172:175]
ds_read_b128 a[236:239], v33 offset:17408
v_subrev_f32 v6, v14, v6
v_mfma_f32_16x16x32_bf16 v[172:175], a[240:243], v[20:23], v[172:175]
s_waitcnt lgkmcnt(4)
v_cvt_pk_bf16_f32 v14, v39, v37
v_cvt_pk_bf16_f32 v6, v38, v6
v_mfma_f32_16x16x32_bf16 v[180:183], a[248:251], v[20:23], v[180:183]
ds_read_b128 a[240:243], v33 offset:9216
v_lshlrev_b32 v38, 16, v7
v_mfma_f32_16x16x32_bf16 v[180:183], a[252:255], v[44:47], v[180:183]
v_and_b32 v7, s55, v7
v_lshlrev_b32 v37, 16, v15
v_mfma_f32_16x16x32_bf16 v[176:179], a[252:255], v[40:43], v[176:179]
ds_read_b128 a[244:247], v33 offset:18432
v_and_b32 v15, s55, v15
v_mfma_f32_16x16x32_bf16 v[176:179], a[248:251], v[16:19], v[176:179]
s_waitcnt lgkmcnt(4)
buffer_load_dwordx4 v32, s[16:19], s53 offen offset:3072 sc1 lds
v_mfma_f32_16x16x32_bf16 v[184:187], a[224:227], v[16:19], v[184:187]
ds_read_b128 a[248:251], v33 offset:10240
v_add_f32 v39, v37, v38
v_mfma_f32_16x16x32_bf16 v[184:187], a[228:231], v[40:43], v[184:187]
v_subrev_f32 v38, v37, v38
v_add_f32 v37, v15, v7
v_mfma_f32_16x16x32_bf16 v[188:191], a[228:231], v[44:47], v[188:191]
s_add_u32 s54, s76, 266240
ds_read_b128 a[252:255], v33 offset:19456
v_subrev_f32 v7, v15, v7
v_mfma_f32_16x16x32_bf16 v[188:191], a[224:227], v[20:23], v[188:191]
s_waitcnt lgkmcnt(4)
v_cvt_pk_bf16_f32 v15, v39, v37
v_cvt_pk_bf16_f32 v7, v38, v7
v_mfma_f32_16x16x32_bf16 v[196:199], a[232:235], v[28:31], v[196:199]
s_add_u32 m0, s43, 45056
ds_read_b128 a[224:227], v33 offset:11264
v_mfma_f32_16x16x32_bf16 v[196:199], a[236:239], v[12:15], v[196:199]
buffer_load_dwordx4 v32, s[16:19], s54 offen sc1 lds
ds_read_b128 v[16:19], v35 offset:8192
v_accvgpr_read_b32 v44, a60
v_mfma_f32_16x16x32_bf16 v[192:195], a[236:239], v[8:11], v[192:195]
ds_read_b128 a[228:231], v33 offset:20480
v_accvgpr_read_b32 v45, a61
v_mfma_f32_16x16x32_bf16 v[192:195], a[232:235], v[24:27], v[192:195]
s_waitcnt lgkmcnt(5)
ds_read_b128 v[20:23], v35
v_accvgpr_read_b32 v46, a62
v_mfma_f32_16x16x32_bf16 v[200:203], a[240:243], v[24:27], v[200:203]
ds_read_b128 a[232:235], v33 offset:12288
v_accvgpr_read_b32 v47, a63
v_mfma_f32_16x16x32_bf16 v[200:203], a[244:247], v[8:11], v[200:203]
ds_read_b128 a[60:63], v35
v_accvgpr_read_b32 v40, a56
v_mfma_f32_16x16x32_bf16 v[204:207], a[244:247], v[12:15], v[204:207]
ds_read_b128 a[236:239], v33 offset:21504
v_accvgpr_read_b32 v41, a57
v_mfma_f32_16x16x32_bf16 v[204:207], a[240:243], v[28:31], v[204:207]
s_waitcnt lgkmcnt(7)
v_accvgpr_read_b32 v42, a58
v_accvgpr_read_b32 v43, a59
v_mfma_f32_16x16x32_bf16 v[212:215], a[248:251], v[28:31], v[212:215]
s_add_u32 m0, s48, 3456
ds_read_b128 a[240:243], v33 offset:13312
ds_read_b128 a[56:59], v35 offset:8192
v_mfma_f32_16x16x32_bf16 v[212:215], a[252:255], v[12:15], v[212:215]
buffer_load_dwordx4 v36, s[8:11], s44 offen offset:640 lds
v_mfma_f32_16x16x32_bf16 v[208:211], a[252:255], v[8:11], v[208:211]
ds_read_b128 a[244:247], v33 offset:22528
v_lshlrev_b32 v38, 16, v40
v_mfma_f32_16x16x32_bf16 v[208:211], a[248:251], v[24:27], v[208:211]
s_waitcnt lgkmcnt(7)
v_and_b32 v40, s55, v40
v_lshlrev_b32 v37, 16, v16
v_mfma_f32_16x16x32_bf16 v[216:219], a[224:227], v[24:27], v[216:219]
ds_read_b128 a[248:251], v33 offset:14336
v_and_b32 v16, s55, v16
v_mfma_f32_16x16x32_bf16 v[216:219], a[228:231], v[8:11], v[216:219]
v_add_f32 v39, v37, v38
v_subrev_f32 v38, v37, v38
v_add_f32 v37, v16, v40
v_mfma_f32_16x16x32_bf16 v[220:223], a[228:231], v[12:15], v[220:223]
ds_read_b128 a[252:255], v33 offset:23552
v_subrev_f32 v40, v16, v40
v_mfma_f32_16x16x32_bf16 v[220:223], a[224:227], v[28:31], v[220:223]
s_waitcnt lgkmcnt(5)
v_cvt_pk_bf16_f32 v16, v39, v37
v_cvt_pk_bf16_f32 v40, v38, v40
v_mfma_f32_16x16x32_bf16 v[228:231], a[232:235], v[28:31], v[228:231]
s_add_u32 m0, s48, 4480
ds_read_b128 a[224:227], v33 offset:15360
v_lshlrev_b32 v38, 16, v41
v_mfma_f32_16x16x32_bf16 v[228:231], a[236:239], v[12:15], v[228:231]
buffer_load_dwordx4 v36, s[8:11], s45 offen offset:640 lds
v_mfma_f32_16x16x32_bf16 v[224:227], a[236:239], v[8:11], v[224:227]
ds_read_b128 a[228:231], v33 offset:24576
v_and_b32 v41, s55, v41
v_mfma_f32_16x16x32_bf16 v[224:227], a[232:235], v[24:27], v[224:227]
s_waitcnt lgkmcnt(4)
v_lshlrev_b32 v37, 16, v17
v_and_b32 v17, s55, v17
v_mfma_f32_16x16x32_bf16 v[232:235], a[240:243], v[24:27], v[232:235]
ds_read_b128 a[232:235], v33 offset:16384
v_add_f32 v39, v37, v38
v_mfma_f32_16x16x32_bf16 v[232:235], a[244:247], v[8:11], v[232:235]
v_subrev_f32 v38, v37, v38
v_add_f32 v37, v17, v41
v_mfma_f32_16x16x32_bf16 v[236:239], a[244:247], v[12:15], v[236:239]
s_add_u32 s52, s82, 294912
ds_read_b128 a[236:239], v33 offset:25600
v_subrev_f32 v41, v17, v41
v_mfma_f32_16x16x32_bf16 v[236:239], a[240:243], v[28:31], v[236:239]
s_waitcnt vmcnt(13) lgkmcnt(4)
s_barrier
v_cvt_pk_bf16_f32 v17, v39, v37
v_cvt_pk_bf16_f32 v41, v38, v41
v_mfma_f32_16x16x32_bf16 v[244:247], a[248:251], v[28:31], v[244:247]
s_add_u32 m0, s43, 73728
ds_read_b128 a[240:243], v32
v_lshlrev_b32 v38, 16, v42
v_mfma_f32_16x16x32_bf16 v[244:247], a[252:255], v[12:15], v[244:247]
buffer_load_dwordx4 v32, s[16:19], s52 offen sc1 lds
v_and_b32 v42, s55, v42
v_mfma_f32_16x16x32_bf16 v[240:243], a[252:255], v[8:11], v[240:243]
ds_read_b128 a[244:247], v32 offset:9216
v_lshlrev_b32 v37, 16, v18
v_mfma_f32_16x16x32_bf16 v[240:243], a[248:251], v[24:27], v[240:243]
s_waitcnt lgkmcnt(4)
v_and_b32 v18, s55, v18
v_add_f32 v39, v37, v38
v_mfma_f32_16x16x32_bf16 v[248:251], a[224:227], v[24:27], v[248:251]
ds_read_b128 a[248:251], v32 offset:1024
v_subrev_f32 v38, v37, v38
v_mfma_f32_16x16x32_bf16 v[248:251], a[228:231], v[8:11], v[248:251]
v_add_f32 v37, v18, v42
v_subrev_f32 v42, v18, v42
v_mfma_f32_16x16x32_bf16 v[252:255], a[228:231], v[12:15], v[252:255]
ds_read_b128 a[252:255], v32 offset:10240
v_cvt_pk_bf16_f32 v18, v39, v37
v_mfma_f32_16x16x32_bf16 v[252:255], a[224:227], v[28:31], v[252:255]
s_waitcnt lgkmcnt(4)
buffer_load_dwordx4 v32, s[16:19], s52 offen offset:1024 sc1 lds
v_mfma_f32_16x16x32_bf16 a[148:151], a[232:235], v[28:31], a[148:151]
ds_read_b128 a[224:227], v32 offset:2048
v_cvt_pk_bf16_f32 v42, v38, v42
v_mfma_f32_16x16x32_bf16 a[148:151], a[236:239], v[12:15], a[148:151]
v_lshlrev_b32 v38, 16, v43
v_and_b32 v43, s55, v43
v_mfma_f32_16x16x32_bf16 a[144:147], a[236:239], v[8:11], a[144:147]
ds_read_b128 a[228:231], v32 offset:11264
v_lshlrev_b32 v37, 16, v19
v_mfma_f32_16x16x32_bf16 a[144:147], a[232:235], v[24:27], a[144:147]
s_waitcnt lgkmcnt(4)
v_and_b32 v19, s55, v19
v_add_f32 v39, v37, v38
v_mfma_f32_16x16x32_bf16 a[152:155], a[240:243], v[24:27], a[152:155]
ds_read_b128 a[232:235], v32 offset:3072
v_subrev_f32 v38, v37, v38
v_mfma_f32_16x16x32_bf16 a[152:155], a[244:247], v[8:11], a[152:155]
buffer_load_dwordx4 v32, s[16:19], s52 offen offset:2048 sc1 lds
v_add_f32 v37, v19, v43
v_mfma_f32_16x16x32_bf16 a[156:159], a[244:247], v[12:15], a[156:159]
ds_read_b128 a[236:239], v32 offset:12288
v_subrev_f32 v43, v19, v43
v_mfma_f32_16x16x32_bf16 a[156:159], a[240:243], v[28:31], a[156:159]
s_waitcnt lgkmcnt(4)
v_cvt_pk_bf16_f32 v19, v39, v37
v_cvt_pk_bf16_f32 v43, v38, v43
v_mfma_f32_16x16x32_bf16 a[164:167], a[248:251], v[28:31], a[164:167]
ds_read_b128 a[240:243], v32 offset:4096
v_lshlrev_b32 v38, 16, v44
v_mfma_f32_16x16x32_bf16 a[164:167], a[252:255], v[12:15], a[164:167]
v_and_b32 v44, s55, v44
v_lshlrev_b32 v37, 16, v20
v_mfma_f32_16x16x32_bf16 a[160:163], a[252:255], v[8:11], a[160:163]
ds_read_b128 a[244:247], v32 offset:13312
v_and_b32 v20, s55, v20
v_mfma_f32_16x16x32_bf16 a[160:163], a[248:251], v[24:27], a[160:163]
s_waitcnt lgkmcnt(4)
buffer_load_dwordx4 v32, s[16:19], s52 offen offset:3072 sc1 lds
v_mfma_f32_16x16x32_bf16 a[168:171], a[224:227], v[24:27], a[168:171]
ds_read_b128 a[248:251], v32 offset:5120
v_add_f32 v39, v37, v38
v_mfma_f32_16x16x32_bf16 a[168:171], a[228:231], v[8:11], a[168:171]
v_subrev_f32 v38, v37, v38
v_add_f32 v37, v20, v44
v_mfma_f32_16x16x32_bf16 a[172:175], a[228:231], v[12:15], a[172:175]
s_add_u32 s53, s82, 299008
ds_read_b128 a[252:255], v32 offset:14336
v_subrev_f32 v44, v20, v44
v_mfma_f32_16x16x32_bf16 a[172:175], a[224:227], v[28:31], a[172:175]
s_waitcnt lgkmcnt(4)
v_cvt_pk_bf16_f32 v20, v39, v37
v_cvt_pk_bf16_f32 v44, v38, v44
v_mfma_f32_16x16x32_bf16 a[180:183], a[232:235], v[28:31], a[180:183]
s_add_u32 m0, s43, 77824
ds_read_b128 a[224:227], v32 offset:6144
v_lshlrev_b32 v38, 16, v45
v_mfma_f32_16x16x32_bf16 a[180:183], a[236:239], v[12:15], a[180:183]
buffer_load_dwordx4 v32, s[16:19], s53 offen sc1 lds
v_and_b32 v45, s55, v45
v_mfma_f32_16x16x32_bf16 a[176:179], a[236:239], v[8:11], a[176:179]
ds_read_b128 a[228:231], v32 offset:15360
v_lshlrev_b32 v37, 16, v21
v_mfma_f32_16x16x32_bf16 a[176:179], a[232:235], v[24:27], a[176:179]
s_waitcnt lgkmcnt(4)
v_and_b32 v21, s55, v21
v_add_f32 v39, v37, v38
v_mfma_f32_16x16x32_bf16 a[184:187], a[240:243], v[24:27], a[184:187]
ds_read_b128 a[232:235], v32 offset:7168
v_subrev_f32 v38, v37, v38
v_mfma_f32_16x16x32_bf16 a[184:187], a[244:247], v[8:11], a[184:187]
v_add_f32 v37, v21, v45
v_subrev_f32 v45, v21, v45
v_mfma_f32_16x16x32_bf16 a[188:191], a[244:247], v[12:15], a[188:191]
ds_read_b128 a[236:239], v32 offset:16384
v_cvt_pk_bf16_f32 v21, v39, v37
v_mfma_f32_16x16x32_bf16 a[188:191], a[240:243], v[28:31], a[188:191]
s_waitcnt lgkmcnt(4)
buffer_load_dwordx4 v32, s[16:19], s53 offen offset:1024 sc1 lds
v_mfma_f32_16x16x32_bf16 a[196:199], a[248:251], v[28:31], a[196:199]
ds_read_b128 a[240:243], v32 offset:8192
v_cvt_pk_bf16_f32 v45, v38, v45
v_mfma_f32_16x16x32_bf16 a[196:199], a[252:255], v[12:15], a[196:199]
v_lshlrev_b32 v38, 16, v46
v_and_b32 v46, s55, v46
v_mfma_f32_16x16x32_bf16 a[192:195], a[252:255], v[8:11], a[192:195]
ds_read_b128 a[244:247], v32 offset:17408
v_lshlrev_b32 v37, 16, v22
v_mfma_f32_16x16x32_bf16 a[192:195], a[248:251], v[24:27], a[192:195]
s_waitcnt lgkmcnt(4)
v_and_b32 v22, s55, v22
v_add_f32 v39, v37, v38
v_mfma_f32_16x16x32_bf16 a[200:203], a[224:227], v[24:27], a[200:203]
ds_read_b128 a[248:251], v32 offset:18432
v_subrev_f32 v38, v37, v38
v_mfma_f32_16x16x32_bf16 a[200:203], a[228:231], v[8:11], a[200:203]
buffer_load_dwordx4 v32, s[16:19], s53 offen offset:2048 sc1 lds
v_add_f32 v37, v22, v46
v_mfma_f32_16x16x32_bf16 a[204:207], a[228:231], v[12:15], a[204:207]
ds_read_b128 a[252:255], v32 offset:27648
v_subrev_f32 v46, v22, v46
v_mfma_f32_16x16x32_bf16 a[204:207], a[224:227], v[28:31], a[204:207]
s_waitcnt lgkmcnt(4)
v_cvt_pk_bf16_f32 v22, v39, v37
v_cvt_pk_bf16_f32 v46, v38, v46
v_mfma_f32_16x16x32_bf16 a[212:215], a[232:235], v[28:31], a[212:215]
ds_read_b128 a[224:227], v32 offset:19456
v_lshlrev_b32 v38, 16, v47
v_mfma_f32_16x16x32_bf16 a[212:215], a[236:239], v[12:15], a[212:215]
v_and_b32 v47, s55, v47
v_lshlrev_b32 v37, 16, v23
v_mfma_f32_16x16x32_bf16 a[208:211], a[236:239], v[8:11], a[208:211]
ds_read_b128 a[228:231], v32 offset:28672
v_and_b32 v23, s55, v23
v_mfma_f32_16x16x32_bf16 a[208:211], a[232:235], v[24:27], a[208:211]
s_waitcnt lgkmcnt(4)
buffer_load_dwordx4 v32, s[16:19], s53 offen offset:3072 sc1 lds
v_mfma_f32_16x16x32_bf16 a[216:219], a[240:243], v[24:27], a[216:219]
ds_read_b128 a[232:235], v32 offset:20480
v_add_f32 v39, v37, v38
v_mfma_f32_16x16x32_bf16 a[216:219], a[244:247], v[8:11], a[216:219]
v_subrev_f32 v38, v37, v38
v_add_f32 v37, v23, v47
v_mfma_f32_16x16x32_bf16 a[220:223], a[244:247], v[12:15], a[220:223]
s_add_u32 s54, s82, 303104
ds_read_b128 a[236:239], v32 offset:29696
v_subrev_f32 v47, v23, v47
v_mfma_f32_16x16x32_bf16 a[220:223], a[240:243], v[28:31], a[220:223]
s_waitcnt vmcnt(19) lgkmcnt(4)
v_cvt_pk_bf16_f32 v23, v39, v37
v_cvt_pk_bf16_f32 v47, v38, v47
v_mfma_f32_16x16x32_bf16 v[52:55], a[248:251], v[4:7], v[52:55]
s_add_u32 m0, s43, 81920
ds_read_b128 a[240:243], v32 offset:21504
v_mfma_f32_16x16x32_bf16 v[52:55], a[252:255], v[44:47], v[52:55]
buffer_load_dwordx4 v32, s[16:19], s54 offen sc1 lds
ds_read_b128 v[24:27], v34 offset:6144
v_accvgpr_read_b32 v12, a68
v_mfma_f32_16x16x32_bf16 v[48:51], a[252:255], v[40:43], v[48:51]
ds_read_b128 a[244:247], v32 offset:30720
v_accvgpr_read_b32 v13, a69
v_mfma_f32_16x16x32_bf16 v[48:51], a[248:251], v[0:3], v[48:51]
s_waitcnt lgkmcnt(5)
ds_read_b128 v[28:31], v34 offset:2048
v_accvgpr_read_b32 v14, a70
v_mfma_f32_16x16x32_bf16 v[56:59], a[224:227], v[0:3], v[56:59]
ds_read_b128 a[248:251], v32 offset:22528
v_accvgpr_read_b32 v15, a71
v_mfma_f32_16x16x32_bf16 v[56:59], a[228:231], v[40:43], v[56:59]
ds_read_b128 a[68:71], v34 offset:2048
v_accvgpr_read_b32 v8, a64
v_mfma_f32_16x16x32_bf16 v[60:63], a[228:231], v[44:47], v[60:63]
ds_read_b128 a[252:255], v32 offset:31744
v_accvgpr_read_b32 v9, a65
v_mfma_f32_16x16x32_bf16 v[60:63], a[224:227], v[4:7], v[60:63]
s_waitcnt lgkmcnt(7)
v_accvgpr_read_b32 v10, a66
v_accvgpr_read_b32 v11, a67
v_mfma_f32_16x16x32_bf16 v[68:71], a[232:235], v[4:7], v[68:71]
s_sub_u32 m0, s48, 640
ds_read_b128 a[224:227], v32 offset:23552
ds_read_b128 a[64:67], v34 offset:6144
v_mfma_f32_16x16x32_bf16 v[68:71], a[236:239], v[44:47], v[68:71]
buffer_load_dwordx4 v36, s[8:11], s63 offen offset:640 lds
v_mfma_f32_16x16x32_bf16 v[64:67], a[236:239], v[40:43], v[64:67]
ds_read_b128 a[228:231], v32 offset:32768
v_lshlrev_b32 v38, 16, v8
v_mfma_f32_16x16x32_bf16 v[64:67], a[232:235], v[0:3], v[64:67]
s_waitcnt lgkmcnt(7)
v_and_b32 v8, s55, v8
v_lshlrev_b32 v37, 16, v24
v_mfma_f32_16x16x32_bf16 v[72:75], a[240:243], v[0:3], v[72:75]
ds_read_b128 a[232:235], v32 offset:24576
v_and_b32 v24, s55, v24
v_mfma_f32_16x16x32_bf16 v[72:75], a[244:247], v[40:43], v[72:75]
v_add_f32 v39, v37, v38
v_subrev_f32 v38, v37, v38
v_add_f32 v37, v24, v8
v_mfma_f32_16x16x32_bf16 v[76:79], a[244:247], v[44:47], v[76:79]
ds_read_b128 a[236:239], v32 offset:33792
v_subrev_f32 v8, v24, v8
v_mfma_f32_16x16x32_bf16 v[76:79], a[240:243], v[4:7], v[76:79]
s_waitcnt lgkmcnt(5)
v_cvt_pk_bf16_f32 v24, v39, v37
v_cvt_pk_bf16_f32 v8, v38, v8
v_mfma_f32_16x16x32_bf16 v[84:87], a[248:251], v[4:7], v[84:87]
s_add_u32 m0, s48, 384
ds_read_b128 a[240:243], v32 offset:25600
v_lshlrev_b32 v38, 16, v9
v_mfma_f32_16x16x32_bf16 v[84:87], a[252:255], v[44:47], v[84:87]
buffer_load_dwordx4 v36, s[8:11], s83 offen offset:640 lds
v_mfma_f32_16x16x32_bf16 v[80:83], a[252:255], v[40:43], v[80:83]
ds_read_b128 a[244:247], v32 offset:34816
v_and_b32 v9, s55, v9
v_mfma_f32_16x16x32_bf16 v[80:83], a[248:251], v[0:3], v[80:83]
s_waitcnt lgkmcnt(4)
v_lshlrev_b32 v37, 16, v25
v_and_b32 v25, s55, v25
v_mfma_f32_16x16x32_bf16 v[88:91], a[224:227], v[0:3], v[88:91]
ds_read_b128 a[248:251], v32 offset:26624
v_add_f32 v39, v37, v38
v_mfma_f32_16x16x32_bf16 v[88:91], a[228:231], v[40:43], v[88:91]
v_subrev_f32 v38, v37, v38
v_add_f32 v37, v25, v9
v_mfma_f32_16x16x32_bf16 v[92:95], a[228:231], v[44:47], v[92:95]
s_add_u32 s52, s76, 331776
ds_read_b128 a[252:255], v32 offset:35840
v_subrev_f32 v9, v25, v9
v_mfma_f32_16x16x32_bf16 v[92:95], a[224:227], v[4:7], v[92:95]
s_waitcnt vmcnt(13) lgkmcnt(4)
s_barrier
v_cvt_pk_bf16_f32 v25, v39, v37
v_cvt_pk_bf16_f32 v9, v38, v9
v_mfma_f32_16x16x32_bf16 v[100:103], a[232:235], v[4:7], v[100:103]
s_add_u32 m0, s43, 0
ds_read_b128 a[224:227], v32 offset:55296
v_lshlrev_b32 v38, 16, v10
v_mfma_f32_16x16x32_bf16 v[100:103], a[236:239], v[44:47], v[100:103]
buffer_load_dwordx4 v32, s[16:19], s52 offen sc1 lds
v_and_b32 v10, s55, v10
v_mfma_f32_16x16x32_bf16 v[96:99], a[236:239], v[40:43], v[96:99]
ds_read_b128 a[228:231], v32 offset:64512
v_lshlrev_b32 v37, 16, v26
v_mfma_f32_16x16x32_bf16 v[96:99], a[232:235], v[0:3], v[96:99]
s_waitcnt lgkmcnt(4)
v_and_b32 v26, s55, v26
v_add_f32 v39, v37, v38
v_mfma_f32_16x16x32_bf16 v[104:107], a[240:243], v[0:3], v[104:107]
ds_read_b128 a[232:235], v32 offset:56320
v_subrev_f32 v38, v37, v38
v_mfma_f32_16x16x32_bf16 v[104:107], a[244:247], v[40:43], v[104:107]
v_add_f32 v37, v26, v10
v_subrev_f32 v10, v26, v10
v_mfma_f32_16x16x32_bf16 v[108:111], a[244:247], v[44:47], v[108:111]
ds_read_b128 a[236:239], v33
v_cvt_pk_bf16_f32 v26, v39, v37
v_mfma_f32_16x16x32_bf16 v[108:111], a[240:243], v[4:7], v[108:111]
s_waitcnt lgkmcnt(4)
buffer_load_dwordx4 v32, s[16:19], s52 offen offset:1024 sc1 lds
v_mfma_f32_16x16x32_bf16 v[116:119], a[248:251], v[4:7], v[116:119]
ds_read_b128 a[240:243], v32 offset:57344
v_cvt_pk_bf16_f32 v10, v38, v10
v_mfma_f32_16x16x32_bf16 v[116:119], a[252:255], v[44:47], v[116:119]
v_lshlrev_b32 v38, 16, v11
v_and_b32 v11, s55, v11
v_mfma_f32_16x16x32_bf16 v[112:115], a[252:255], v[40:43], v[112:115]
ds_read_b128 a[244:247], v33 offset:1024
v_lshlrev_b32 v37, 16, v27
v_mfma_f32_16x16x32_bf16 v[112:115], a[248:251], v[0:3], v[112:115]
s_waitcnt lgkmcnt(4)
v_and_b32 v27, s55, v27
v_add_f32 v39, v37, v38
v_mfma_f32_16x16x32_bf16 v[120:123], a[224:227], v[0:3], v[120:123]
ds_read_b128 a[248:251], v32 offset:58368
v_subrev_f32 v38, v37, v38
v_mfma_f32_16x16x32_bf16 v[120:123], a[228:231], v[40:43], v[120:123]
buffer_load_dwordx4 v32, s[16:19], s52 offen offset:2048 sc1 lds
v_add_f32 v37, v27, v11
v_mfma_f32_16x16x32_bf16 v[124:127], a[228:231], v[44:47], v[124:127]
ds_read_b128 a[252:255], v33 offset:2048
v_subrev_f32 v11, v27, v11
v_mfma_f32_16x16x32_bf16 v[124:127], a[224:227], v[4:7], v[124:127]
s_waitcnt lgkmcnt(4)
v_cvt_pk_bf16_f32 v27, v39, v37
v_cvt_pk_bf16_f32 v11, v38, v11
v_mfma_f32_16x16x32_bf16 v[132:135], a[232:235], v[4:7], v[132:135]
ds_read_b128 a[224:227], v32 offset:59392
v_lshlrev_b32 v38, 16, v12
v_mfma_f32_16x16x32_bf16 v[132:135], a[236:239], v[44:47], v[132:135]
v_and_b32 v12, s55, v12
v_lshlrev_b32 v37, 16, v28
v_mfma_f32_16x16x32_bf16 v[128:131], a[236:239], v[40:43], v[128:131]
ds_read_b128 a[228:231], v33 offset:3072
v_and_b32 v28, s55, v28
v_mfma_f32_16x16x32_bf16 v[128:131], a[232:235], v[0:3], v[128:131]
s_waitcnt lgkmcnt(4)
buffer_load_dwordx4 v32, s[16:19], s52 offen offset:3072 sc1 lds
v_mfma_f32_16x16x32_bf16 v[136:139], a[240:243], v[0:3], v[136:139]
ds_read_b128 a[232:235], v32 offset:60416
v_add_f32 v39, v37, v38
v_mfma_f32_16x16x32_bf16 v[136:139], a[244:247], v[40:43], v[136:139]
v_subrev_f32 v38, v37, v38
v_add_f32 v37, v28, v12
v_mfma_f32_16x16x32_bf16 v[140:143], a[244:247], v[44:47], v[140:143]
s_add_u32 s53, s76, 335872
ds_read_b128 a[236:239], v33 offset:4096
v_subrev_f32 v12, v28, v12
v_mfma_f32_16x16x32_bf16 v[140:143], a[240:243], v[4:7], v[140:143]
s_waitcnt lgkmcnt(4)
v_cvt_pk_bf16_f32 v28, v39, v37
v_cvt_pk_bf16_f32 v12, v38, v12
v_mfma_f32_16x16x32_bf16 v[148:151], a[248:251], v[4:7], v[148:151]
s_add_u32 m0, s43, 4096
ds_read_b128 a[240:243], v32 offset:61440
v_lshlrev_b32 v38, 16, v13
v_mfma_f32_16x16x32_bf16 v[148:151], a[252:255], v[44:47], v[148:151]
buffer_load_dwordx4 v32, s[16:19], s53 offen sc1 lds
v_and_b32 v13, s55, v13
v_mfma_f32_16x16x32_bf16 v[144:147], a[252:255], v[40:43], v[144:147]
ds_read_b128 a[244:247], v33 offset:5120
v_lshlrev_b32 v37, 16, v29
v_mfma_f32_16x16x32_bf16 v[144:147], a[248:251], v[0:3], v[144:147]
s_waitcnt lgkmcnt(4)
v_and_b32 v29, s55, v29
v_add_f32 v39, v37, v38
v_mfma_f32_16x16x32_bf16 v[152:155], a[224:227], v[0:3], v[152:155]
ds_read_b128 a[248:251], v32 offset:62464
v_subrev_f32 v38, v37, v38
v_mfma_f32_16x16x32_bf16 v[152:155], a[228:231], v[40:43], v[152:155]
v_add_f32 v37, v29, v13
v_subrev_f32 v13, v29, v13
v_mfma_f32_16x16x32_bf16 v[156:159], a[228:231], v[44:47], v[156:159]
ds_read_b128 a[252:255], v33 offset:6144
v_cvt_pk_bf16_f32 v29, v39, v37
v_mfma_f32_16x16x32_bf16 v[156:159], a[224:227], v[4:7], v[156:159]
s_waitcnt lgkmcnt(4)
buffer_load_dwordx4 v32, s[16:19], s53 offen offset:1024 sc1 lds
v_mfma_f32_16x16x32_bf16 v[164:167], a[232:235], v[4:7], v[164:167]
ds_read_b128 a[224:227], v32 offset:63488
v_cvt_pk_bf16_f32 v13, v38, v13
v_mfma_f32_16x16x32_bf16 v[164:167], a[236:239], v[44:47], v[164:167]
v_lshlrev_b32 v38, 16, v14
v_and_b32 v14, s55, v14
v_mfma_f32_16x16x32_bf16 v[160:163], a[236:239], v[40:43], v[160:163]
ds_read_b128 a[228:231], v33 offset:7168
v_lshlrev_b32 v37, 16, v30
v_mfma_f32_16x16x32_bf16 v[160:163], a[232:235], v[0:3], v[160:163]
s_waitcnt lgkmcnt(4)
v_and_b32 v30, s55, v30
v_add_f32 v39, v37, v38
v_mfma_f32_16x16x32_bf16 v[168:171], a[240:243], v[0:3], v[168:171]
ds_read_b128 a[232:235], v32 offset:36864
v_subrev_f32 v38, v37, v38
v_mfma_f32_16x16x32_bf16 v[168:171], a[244:247], v[40:43], v[168:171]
buffer_load_dwordx4 v32, s[16:19], s53 offen offset:2048 sc1 lds
v_add_f32 v37, v30, v14
v_mfma_f32_16x16x32_bf16 v[172:175], a[244:247], v[44:47], v[172:175]
ds_read_b128 a[236:239], v32 offset:46080
v_subrev_f32 v14, v30, v14
v_mfma_f32_16x16x32_bf16 v[172:175], a[240:243], v[4:7], v[172:175]
s_waitcnt lgkmcnt(4)
v_cvt_pk_bf16_f32 v30, v39, v37
v_cvt_pk_bf16_f32 v14, v38, v14
v_mfma_f32_16x16x32_bf16 v[180:183], a[248:251], v[4:7], v[180:183]
ds_read_b128 a[240:243], v32 offset:37888
v_lshlrev_b32 v38, 16, v15
v_mfma_f32_16x16x32_bf16 v[180:183], a[252:255], v[44:47], v[180:183]
v_and_b32 v15, s55, v15
v_lshlrev_b32 v37, 16, v31
v_mfma_f32_16x16x32_bf16 v[176:179], a[252:255], v[40:43], v[176:179]
ds_read_b128 a[244:247], v32 offset:47104
v_and_b32 v31, s55, v31
v_mfma_f32_16x16x32_bf16 v[176:179], a[248:251], v[0:3], v[176:179]
s_waitcnt lgkmcnt(4)
buffer_load_dwordx4 v32, s[16:19], s53 offen offset:3072 sc1 lds
v_mfma_f32_16x16x32_bf16 v[184:187], a[224:227], v[0:3], v[184:187]
ds_read_b128 a[248:251], v32 offset:38912
v_add_f32 v39, v37, v38
v_mfma_f32_16x16x32_bf16 v[184:187], a[228:231], v[40:43], v[184:187]
v_subrev_f32 v38, v37, v38
v_add_f32 v37, v31, v15
v_mfma_f32_16x16x32_bf16 v[188:191], a[228:231], v[44:47], v[188:191]
s_add_u32 s54, s76, 339968
ds_read_b128 a[252:255], v32 offset:48128
v_subrev_f32 v15, v31, v15
v_mfma_f32_16x16x32_bf16 v[188:191], a[224:227], v[4:7], v[188:191]
s_waitcnt lgkmcnt(4)
v_cvt_pk_bf16_f32 v31, v39, v37
v_cvt_pk_bf16_f32 v15, v38, v15
v_mfma_f32_16x16x32_bf16 v[196:199], a[232:235], v[20:23], v[196:199]
s_add_u32 m0, s43, 8192
ds_read_b128 a[224:227], v32 offset:39936
v_mfma_f32_16x16x32_bf16 v[196:199], a[236:239], v[28:31], v[196:199]
buffer_load_dwordx4 v32, s[16:19], s54 offen sc1 lds
ds_read_b128 v[0:3], v35 offset:6144
v_accvgpr_read_b32 v44, a76
v_mfma_f32_16x16x32_bf16 v[192:195], a[236:239], v[24:27], v[192:195]
ds_read_b128 a[228:231], v32 offset:49152
v_accvgpr_read_b32 v45, a77
v_mfma_f32_16x16x32_bf16 v[192:195], a[232:235], v[16:19], v[192:195]
s_waitcnt lgkmcnt(5)
ds_read_b128 v[4:7], v35 offset:2048
v_accvgpr_read_b32 v46, a78
v_mfma_f32_16x16x32_bf16 v[200:203], a[240:243], v[16:19], v[200:203]
ds_read_b128 a[232:235], v32 offset:40960
v_accvgpr_read_b32 v47, a79
v_mfma_f32_16x16x32_bf16 v[200:203], a[244:247], v[24:27], v[200:203]
ds_read_b128 a[76:79], v35 offset:2048
v_accvgpr_read_b32 v40, a72
v_mfma_f32_16x16x32_bf16 v[204:207], a[244:247], v[28:31], v[204:207]
s_load_dword s77, s[78:79], 36864
ds_read_b128 a[236:239], v32 offset:50176
v_accvgpr_read_b32 v41, a73
v_mfma_f32_16x16x32_bf16 v[204:207], a[240:243], v[20:23], v[204:207]
s_waitcnt lgkmcnt(7)
v_accvgpr_read_b32 v42, a74
v_accvgpr_read_b32 v43, a75
v_mfma_f32_16x16x32_bf16 v[212:215], a[248:251], v[20:23], v[212:215]
s_add_u32 m0, s48, 7424
ds_read_b128 a[240:243], v32 offset:41984
ds_read_b128 a[72:75], v35 offset:6144
v_mfma_f32_16x16x32_bf16 v[212:215], a[252:255], v[28:31], v[212:215]
buffer_load_dwordx4 v36, s[8:11], s44 offen offset:768 lds
v_mfma_f32_16x16x32_bf16 v[208:211], a[252:255], v[24:27], v[208:211]
ds_read_b128 a[244:247], v32 offset:51200
v_lshlrev_b32 v38, 16, v40
v_mfma_f32_16x16x32_bf16 v[208:211], a[248:251], v[16:19], v[208:211]
s_waitcnt lgkmcnt(7)
v_and_b32 v40, s55, v40
v_lshlrev_b32 v37, 16, v0
v_mfma_f32_16x16x32_bf16 v[216:219], a[224:227], v[16:19], v[216:219]
L_pg8:
s_cbranch_vccnz L_vr1
ds_read_b128 a[248:251], v32 offset:43008
v_and_b32 v0, s55, v0
v_mfma_f32_16x16x32_bf16 v[216:219], a[228:231], v[24:27], v[216:219]
v_add_f32 v39, v37, v38
v_subrev_f32 v38, v37, v38
v_add_f32 v37, v0, v40
v_mfma_f32_16x16x32_bf16 v[220:223], a[228:231], v[28:31], v[220:223]
ds_read_b128 a[252:255], v32 offset:52224
v_subrev_f32 v40, v0, v40
v_mfma_f32_16x16x32_bf16 v[220:223], a[224:227], v[20:23], v[220:223]
s_waitcnt lgkmcnt(5)
v_cvt_pk_bf16_f32 v0, v39, v37
v_cvt_pk_bf16_f32 v40, v38, v40
v_mfma_f32_16x16x32_bf16 v[228:231], a[232:235], v[20:23], v[228:231]
s_add_u32 m0, s48, 8448
ds_read_b128 a[224:227], v32 offset:44032
v_lshlrev_b32 v38, 16, v41
v_mfma_f32_16x16x32_bf16 v[228:231], a[236:239], v[28:31], v[228:231]
buffer_load_dwordx4 v36, s[8:11], s45 offen offset:768 lds
v_mfma_f32_16x16x32_bf16 v[224:227], a[236:239], v[24:27], v[224:227]
ds_read_b128 a[228:231], v32 offset:53248
v_and_b32 v41, s55, v41
v_mfma_f32_16x16x32_bf16 v[224:227], a[232:235], v[16:19], v[224:227]
s_waitcnt lgkmcnt(4)
v_lshlrev_b32 v37, 16, v1
v_and_b32 v1, s55, v1
v_mfma_f32_16x16x32_bf16 v[232:235], a[240:243], v[16:19], v[232:235]
ds_read_b128 a[232:235], v32 offset:45056
v_add_f32 v39, v37, v38
v_mfma_f32_16x16x32_bf16 v[232:235], a[244:247], v[24:27], v[232:235]
v_subrev_f32 v38, v37, v38
v_add_f32 v37, v1, v41
v_mfma_f32_16x16x32_bf16 v[236:239], a[244:247], v[28:31], v[236:239]
s_add_u32 s52, s82, 368640
ds_read_b128 a[236:239], v32 offset:54272
v_subrev_f32 v41, v1, v41
v_mfma_f32_16x16x32_bf16 v[236:239], a[240:243], v[20:23], v[236:239]
s_waitcnt vmcnt(13) lgkmcnt(4)
s_barrier
v_cvt_pk_bf16_f32 v1, v39, v37
v_cvt_pk_bf16_f32 v41, v38, v41
v_mfma_f32_16x16x32_bf16 v[244:247], a[248:251], v[20:23], v[244:247]
s_add_u32 m0, s43, 36864
ds_read_b128 a[240:243], v33 offset:8192
v_lshlrev_b32 v38, 16, v42
v_mfma_f32_16x16x32_bf16 v[244:247], a[252:255], v[28:31], v[244:247]
buffer_load_dwordx4 v32, s[16:19], s52 offen sc1 lds
v_and_b32 v42, s55, v42
v_mfma_f32_16x16x32_bf16 v[240:243], a[252:255], v[24:27], v[240:243]
ds_read_b128 a[244:247], v33 offset:17408
v_lshlrev_b32 v37, 16, v2
v_mfma_f32_16x16x32_bf16 v[240:243], a[248:251], v[16:19], v[240:243]
s_waitcnt lgkmcnt(4)
v_and_b32 v2, s55, v2
v_add_f32 v39, v37, v38
v_mfma_f32_16x16x32_bf16 v[248:251], a[224:227], v[16:19], v[248:251]
ds_read_b128 a[248:251], v33 offset:9216
v_subrev_f32 v38, v37, v38
v_mfma_f32_16x16x32_bf16 v[248:251], a[228:231], v[24:27], v[248:251]
v_add_f32 v37, v2, v42
v_subrev_f32 v42, v2, v42
v_mfma_f32_16x16x32_bf16 v[252:255], a[228:231], v[28:31], v[252:255]
ds_read_b128 a[252:255], v33 offset:18432
v_cvt_pk_bf16_f32 v2, v39, v37
v_mfma_f32_16x16x32_bf16 v[252:255], a[224:227], v[20:23], v[252:255]
s_waitcnt lgkmcnt(4)
buffer_load_dwordx4 v32, s[16:19], s52 offen offset:1024 sc1 lds
v_mfma_f32_16x16x32_bf16 a[148:151], a[232:235], v[20:23], a[148:151]
ds_read_b128 a[224:227], v33 offset:10240
v_cvt_pk_bf16_f32 v42, v38, v42
v_mfma_f32_16x16x32_bf16 a[148:151], a[236:239], v[28:31], a[148:151]
v_lshlrev_b32 v38, 16, v43
v_and_b32 v43, s55, v43
v_mfma_f32_16x16x32_bf16 a[144:147], a[236:239], v[24:27], a[144:147]
ds_read_b128 a[228:231], v33 offset:19456
v_lshlrev_b32 v37, 16, v3
v_mfma_f32_16x16x32_bf16 a[144:147], a[232:235], v[16:19], a[144:147]
s_waitcnt lgkmcnt(4)
v_and_b32 v3, s55, v3
v_add_f32 v39, v37, v38
v_mfma_f32_16x16x32_bf16 a[152:155], a[240:243], v[16:19], a[152:155]
ds_read_b128 a[232:235], v33 offset:11264
v_subrev_f32 v38, v37, v38
v_mfma_f32_16x16x32_bf16 a[152:155], a[244:247], v[24:27], a[152:155]
buffer_load_dwordx4 v32, s[16:19], s52 offen offset:2048 sc1 lds
v_add_f32 v37, v3, v43
v_mfma_f32_16x16x32_bf16 a[156:159], a[244:247], v[28:31], a[156:159]
ds_read_b128 a[236:239], v33 offset:20480
v_subrev_f32 v43, v3, v43
v_mfma_f32_16x16x32_bf16 a[156:159], a[240:243], v[20:23], a[156:159]
s_waitcnt lgkmcnt(4)
v_cvt_pk_bf16_f32 v3, v39, v37
v_cvt_pk_bf16_f32 v43, v38, v43
v_mfma_f32_16x16x32_bf16 a[164:167], a[248:251], v[20:23], a[164:167]
ds_read_b128 a[240:243], v33 offset:12288
v_lshlrev_b32 v38, 16, v44
v_mfma_f32_16x16x32_bf16 a[164:167], a[252:255], v[28:31], a[164:167]
v_and_b32 v44, s55, v44
v_lshlrev_b32 v37, 16, v4
v_mfma_f32_16x16x32_bf16 a[160:163], a[252:255], v[24:27], a[160:163]
ds_read_b128 a[244:247], v33 offset:21504
v_and_b32 v4, s55, v4
v_mfma_f32_16x16x32_bf16 a[160:163], a[248:251], v[16:19], a[160:163]
s_waitcnt lgkmcnt(4)
buffer_load_dwordx4 v32, s[16:19], s52 offen offset:3072 sc1 lds
v_mfma_f32_16x16x32_bf16 a[168:171], a[224:227], v[16:19], a[168:171]
ds_read_b128 a[248:251], v33 offset:13312
v_add_f32 v39, v37, v38
v_mfma_f32_16x16x32_bf16 a[168:171], a[228:231], v[24:27], a[168:171]
v_subrev_f32 v38, v37, v38
v_add_f32 v37, v4, v44
v_mfma_f32_16x16x32_bf16 a[172:175], a[228:231], v[28:31], a[172:175]
s_add_u32 s53, s82, 372736
ds_read_b128 a[252:255], v33 offset:22528
v_subrev_f32 v44, v4, v44
v_mfma_f32_16x16x32_bf16 a[172:175], a[224:227], v[20:23], a[172:175]
s_waitcnt lgkmcnt(4)
v_cvt_pk_bf16_f32 v4, v39, v37
v_cvt_pk_bf16_f32 v44, v38, v44
v_mfma_f32_16x16x32_bf16 a[180:183], a[232:235], v[20:23], a[180:183]
s_add_u32 m0, s43, 40960
ds_read_b128 a[224:227], v33 offset:14336
v_lshlrev_b32 v38, 16, v45
v_mfma_f32_16x16x32_bf16 a[180:183], a[236:239], v[28:31], a[180:183]
buffer_load_dwordx4 v32, s[16:19], s53 offen sc1 lds
v_and_b32 v45, s55, v45
v_mfma_f32_16x16x32_bf16 a[176:179], a[236:239], v[24:27], a[176:179]
ds_read_b128 a[228:231], v33 offset:23552
v_lshlrev_b32 v37, 16, v5
v_mfma_f32_16x16x32_bf16 a[176:179], a[232:235], v[16:19], a[176:179]
s_waitcnt lgkmcnt(4)
v_and_b32 v5, s55, v5
v_add_f32 v39, v37, v38
v_mfma_f32_16x16x32_bf16 a[184:187], a[240:243], v[16:19], a[184:187]
ds_read_b128 a[232:235], v33 offset:15360
v_subrev_f32 v38, v37, v38
v_mfma_f32_16x16x32_bf16 a[184:187], a[244:247], v[24:27], a[184:187]
v_add_f32 v37, v5, v45
v_subrev_f32 v45, v5, v45
v_mfma_f32_16x16x32_bf16 a[188:191], a[244:247], v[28:31], a[188:191]
ds_read_b128 a[236:239], v33 offset:24576
v_cvt_pk_bf16_f32 v5, v39, v37
v_mfma_f32_16x16x32_bf16 a[188:191], a[240:243], v[20:23], a[188:191]
s_waitcnt lgkmcnt(4)
buffer_load_dwordx4 v32, s[16:19], s53 offen offset:1024 sc1 lds
v_mfma_f32_16x16x32_bf16 a[196:199], a[248:251], v[20:23], a[196:199]
ds_read_b128 a[240:243], v33 offset:16384
v_cvt_pk_bf16_f32 v45, v38, v45
v_mfma_f32_16x16x32_bf16 a[196:199], a[252:255], v[28:31], a[196:199]
v_lshlrev_b32 v38, 16, v46
v_and_b32 v46, s55, v46
v_mfma_f32_16x16x32_bf16 a[192:195], a[252:255], v[24:27], a[192:195]
ds_read_b128 a[244:247], v33 offset:25600
v_lshlrev_b32 v37, 16, v6
v_mfma_f32_16x16x32_bf16 a[192:195], a[248:251], v[16:19], a[192:195]
s_waitcnt lgkmcnt(4)
v_and_b32 v6, s55, v6
v_add_f32 v39, v37, v38
v_mfma_f32_16x16x32_bf16 a[200:203], a[224:227], v[16:19], a[200:203]
ds_read_b128 a[248:251], v33 offset:26624
v_subrev_f32 v38, v37, v38
v_mfma_f32_16x16x32_bf16 a[200:203], a[228:231], v[24:27], a[200:203]
buffer_load_dwordx4 v32, s[16:19], s53 offen offset:2048 sc1 lds
v_add_f32 v37, v6, v46
v_mfma_f32_16x16x32_bf16 a[204:207], a[228:231], v[28:31], a[204:207]
ds_read_b128 a[252:255], v33 offset:35840
v_subrev_f32 v46, v6, v46
v_mfma_f32_16x16x32_bf16 a[204:207], a[224:227], v[20:23], a[204:207]
s_waitcnt lgkmcnt(4)
v_cvt_pk_bf16_f32 v6, v39, v37
v_cvt_pk_bf16_f32 v46, v38, v46
v_mfma_f32_16x16x32_bf16 a[212:215], a[232:235], v[20:23], a[212:215]
ds_read_b128 a[224:227], v33 offset:27648
v_lshlrev_b32 v38, 16, v47
v_mfma_f32_16x16x32_bf16 a[212:215], a[236:239], v[28:31], a[212:215]
v_and_b32 v47, s55, v47
v_lshlrev_b32 v37, 16, v7
v_mfma_f32_16x16x32_bf16 a[208:211], a[236:239], v[24:27], a[208:211]
ds_read_b128 a[228:231], v33 offset:36864
v_and_b32 v7, s55, v7
v_mfma_f32_16x16x32_bf16 a[208:211], a[232:235], v[16:19], a[208:211]
s_waitcnt lgkmcnt(4)
buffer_load_dwordx4 v32, s[16:19], s53 offen offset:3072 sc1 lds
v_mfma_f32_16x16x32_bf16 a[216:219], a[240:243], v[16:19], a[216:219]
ds_read_b128 a[232:235], v33 offset:28672
v_add_f32 v39, v37, v38
v_mfma_f32_16x16x32_bf16 a[216:219], a[244:247], v[24:27], a[216:219]
v_subrev_f32 v38, v37, v38
v_add_f32 v37, v7, v47
v_mfma_f32_16x16x32_bf16 a[220:223], a[244:247], v[28:31], a[220:223]
s_add_u32 s54, s82, 376832
ds_read_b128 a[236:239], v33 offset:37888
v_subrev_f32 v47, v7, v47
v_mfma_f32_16x16x32_bf16 a[220:223], a[240:243], v[20:23], a[220:223]
s_waitcnt vmcnt(19) lgkmcnt(4)
v_cvt_pk_bf16_f32 v7, v39, v37
v_cvt_pk_bf16_f32 v47, v38, v47
v_mfma_f32_16x16x32_bf16 v[52:55], a[248:251], v[12:15], v[52:55]
s_add_u32 m0, s43, 45056
ds_read_b128 a[240:243], v33 offset:29696
v_mfma_f32_16x16x32_bf16 v[52:55], a[252:255], v[44:47], v[52:55]
buffer_load_dwordx4 v32, s[16:19], s54 offen sc1 lds
ds_read_b128 v[16:19], v34 offset:4096
v_accvgpr_read_b32 v28, a84
v_mfma_f32_16x16x32_bf16 v[48:51], a[252:255], v[40:43], v[48:51]
ds_read_b128 a[244:247], v33 offset:38912
v_accvgpr_read_b32 v29, a85
v_mfma_f32_16x16x32_bf16 v[48:51], a[248:251], v[8:11], v[48:51]
s_waitcnt lgkmcnt(5)
ds_read_b128 v[20:23], v34
v_accvgpr_read_b32 v30, a86
v_mfma_f32_16x16x32_bf16 v[56:59], a[224:227], v[8:11], v[56:59]
ds_read_b128 a[248:251], v33 offset:30720
v_accvgpr_read_b32 v31, a87
v_mfma_f32_16x16x32_bf16 v[56:59], a[228:231], v[40:43], v[56:59]
ds_read_b128 a[84:87], v34
v_accvgpr_read_b32 v24, a80
v_mfma_f32_16x16x32_bf16 v[60:63], a[228:231], v[44:47], v[60:63]
ds_read_b128 a[252:255], v33 offset:39936
v_accvgpr_read_b32 v25, a81
v_mfma_f32_16x16x32_bf16 v[60:63], a[224:227], v[12:15], v[60:63]
s_waitcnt lgkmcnt(7)
v_accvgpr_read_b32 v26, a82
v_accvgpr_read_b32 v27, a83
v_mfma_f32_16x16x32_bf16 v[68:71], a[232:235], v[12:15], v[68:71]
s_add_u32 m0, s48, 1280
ds_read_b128 a[224:227], v33 offset:31744
ds_read_b128 a[80:83], v34 offset:4096
v_mfma_f32_16x16x32_bf16 v[68:71], a[236:239], v[44:47], v[68:71]
buffer_load_dwordx4 v36, s[8:11], s63 offen offset:768 lds
v_mfma_f32_16x16x32_bf16 v[64:67], a[236:239], v[40:43], v[64:67]
ds_read_b128 a[228:231], v33 offset:40960
v_lshlrev_b32 v38, 16, v24
v_mfma_f32_16x16x32_bf16 v[64:67], a[232:235], v[8:11], v[64:67]
s_waitcnt lgkmcnt(7)
v_and_b32 v24, s55, v24
v_lshlrev_b32 v37, 16, v16
v_mfma_f32_16x16x32_bf16 v[72:75], a[240:243], v[8:11], v[72:75]
ds_read_b128 a[232:235], v33 offset:32768
v_and_b32 v16, s55, v16
v_mfma_f32_16x16x32_bf16 v[72:75], a[244:247], v[40:43], v[72:75]
v_add_f32 v39, v37, v38
v_subrev_f32 v38, v37, v38
v_add_f32 v37, v16, v24
v_mfma_f32_16x16x32_bf16 v[76:79], a[244:247], v[44:47], v[76:79]
ds_read_b128 a[236:239], v33 offset:41984
v_subrev_f32 v24, v16, v24
v_mfma_f32_16x16x32_bf16 v[76:79], a[240:243], v[12:15], v[76:79]
s_waitcnt lgkmcnt(5)
v_cvt_pk_bf16_f32 v16, v39, v37
v_cvt_pk_bf16_f32 v24, v38, v24
v_mfma_f32_16x16x32_bf16 v[84:87], a[248:251], v[12:15], v[84:87]
s_add_u32 m0, s48, 2304
ds_read_b128 a[240:243], v33 offset:33792
v_lshlrev_b32 v38, 16, v25
v_mfma_f32_16x16x32_bf16 v[84:87], a[252:255], v[44:47], v[84:87]
buffer_load_dwordx4 v36, s[8:11], s83 offen offset:768 lds
v_mfma_f32_16x16x32_bf16 v[80:83], a[252:255], v[40:43], v[80:83]
ds_read_b128 a[244:247], v33 offset:43008
v_and_b32 v25, s55, v25
v_mfma_f32_16x16x32_bf16 v[80:83], a[248:251], v[8:11], v[80:83]
s_waitcnt lgkmcnt(4)
v_lshlrev_b32 v37, 16, v17
v_and_b32 v17, s55, v17
v_mfma_f32_16x16x32_bf16 v[88:91], a[224:227], v[8:11], v[88:91]
ds_read_b128 a[248:251], v33 offset:34816
v_add_f32 v39, v37, v38
v_mfma_f32_16x16x32_bf16 v[88:91], a[228:231], v[40:43], v[88:91]
v_subrev_f32 v38, v37, v38
v_add_f32 v37, v17, v25
v_mfma_f32_16x16x32_bf16 v[92:95], a[228:231], v[44:47], v[92:95]
s_add_u32 s52, s76, 405504
ds_read_b128 a[252:255], v33 offset:44032
v_subrev_f32 v25, v17, v25
v_mfma_f32_16x16x32_bf16 v[92:95], a[224:227], v[12:15], v[92:95]
s_waitcnt vmcnt(13) lgkmcnt(4)
s_barrier
v_cvt_pk_bf16_f32 v17, v39, v37
v_cvt_pk_bf16_f32 v25, v38, v25
v_mfma_f32_16x16x32_bf16 v[100:103], a[232:235], v[12:15], v[100:103]
s_add_u32 m0, s43, 73728
ds_read_b128 a[224:227], v32 offset:18432
v_lshlrev_b32 v38, 16, v26
v_mfma_f32_16x16x32_bf16 v[100:103], a[236:239], v[44:47], v[100:103]
buffer_load_dwordx4 v32, s[16:19], s52 offen sc1 lds
v_and_b32 v26, s55, v26
v_mfma_f32_16x16x32_bf16 v[96:99], a[236:239], v[40:43], v[96:99]
ds_read_b128 a[228:231], v32 offset:27648
v_lshlrev_b32 v37, 16, v18
v_mfma_f32_16x16x32_bf16 v[96:99], a[232:235], v[8:11], v[96:99]
s_waitcnt lgkmcnt(4)
v_and_b32 v18, s55, v18
v_add_f32 v39, v37, v38
v_mfma_f32_16x16x32_bf16 v[104:107], a[240:243], v[8:11], v[104:107]
ds_read_b128 a[232:235], v32 offset:19456
v_subrev_f32 v38, v37, v38
v_mfma_f32_16x16x32_bf16 v[104:107], a[244:247], v[40:43], v[104:107]
v_add_f32 v37, v18, v26
v_subrev_f32 v26, v18, v26
v_mfma_f32_16x16x32_bf16 v[108:111], a[244:247], v[44:47], v[108:111]
ds_read_b128 a[236:239], v32 offset:28672
v_cvt_pk_bf16_f32 v18, v39, v37
v_mfma_f32_16x16x32_bf16 v[108:111], a[240:243], v[12:15], v[108:111]
s_waitcnt lgkmcnt(4)
buffer_load_dwordx4 v32, s[16:19], s52 offen offset:1024 sc1 lds
v_mfma_f32_16x16x32_bf16 v[116:119], a[248:251], v[12:15], v[116:119]
ds_read_b128 a[240:243], v32 offset:20480
v_cvt_pk_bf16_f32 v26, v38, v26
v_mfma_f32_16x16x32_bf16 v[116:119], a[252:255], v[44:47], v[116:119]
v_lshlrev_b32 v38, 16, v27
v_and_b32 v27, s55, v27
v_mfma_f32_16x16x32_bf16 v[112:115], a[252:255], v[40:43], v[112:115]
ds_read_b128 a[244:247], v32 offset:29696
v_lshlrev_b32 v37, 16, v19
v_mfma_f32_16x16x32_bf16 v[112:115], a[248:251], v[8:11], v[112:115]
s_waitcnt lgkmcnt(4)
v_and_b32 v19, s55, v19
v_add_f32 v39, v37, v38
v_mfma_f32_16x16x32_bf16 v[120:123], a[224:227], v[8:11], v[120:123]
ds_read_b128 a[248:251], v32 offset:21504
v_subrev_f32 v38, v37, v38
v_mfma_f32_16x16x32_bf16 v[120:123], a[228:231], v[40:43], v[120:123]
buffer_load_dwordx4 v32, s[16:19], s52 offen offset:2048 sc1 lds
v_add_f32 v37, v19, v27
v_mfma_f32_16x16x32_bf16 v[124:127], a[228:231], v[44:47], v[124:127]
ds_read_b128 a[252:255], v32 offset:30720
v_subrev_f32 v27, v19, v27
v_mfma_f32_16x16x32_bf16 v[124:127], a[224:227], v[12:15], v[124:127]
s_waitcnt lgkmcnt(4)
v_cvt_pk_bf16_f32 v19, v39, v37
v_cvt_pk_bf16_f32 v27, v38, v27
v_mfma_f32_16x16x32_bf16 v[132:135], a[232:235], v[12:15], v[132:135]
ds_read_b128 a[224:227], v32 offset:22528
v_lshlrev_b32 v38, 16, v28
v_mfma_f32_16x16x32_bf16 v[132:135], a[236:239], v[44:47], v[132:135]
v_and_b32 v28, s55, v28
v_lshlrev_b32 v37, 16, v20
v_mfma_f32_16x16x32_bf16 v[128:131], a[236:239], v[40:43], v[128:131]
ds_read_b128 a[228:231], v32 offset:31744
v_and_b32 v20, s55, v20
v_mfma_f32_16x16x32_bf16 v[128:131], a[232:235], v[8:11], v[128:131]
s_waitcnt lgkmcnt(4)
buffer_load_dwordx4 v32, s[16:19], s52 offen offset:3072 sc1 lds
v_mfma_f32_16x16x32_bf16 v[136:139], a[240:243], v[8:11], v[136:139]
ds_read_b128 a[232:235], v32 offset:23552
v_add_f32 v39, v37, v38
v_mfma_f32_16x16x32_bf16 v[136:139], a[244:247], v[40:43], v[136:139]
v_subrev_f32 v38, v37, v38
v_add_f32 v37, v20, v28
v_mfma_f32_16x16x32_bf16 v[140:143], a[244:247], v[44:47], v[140:143]
s_add_u32 s53, s76, 409600
ds_read_b128 a[236:239], v32 offset:32768
v_subrev_f32 v28, v20, v28
v_mfma_f32_16x16x32_bf16 v[140:143], a[240:243], v[12:15], v[140:143]
s_waitcnt lgkmcnt(4)
v_cvt_pk_bf16_f32 v20, v39, v37
v_cvt_pk_bf16_f32 v28, v38, v28
v_mfma_f32_16x16x32_bf16 v[148:151], a[248:251], v[12:15], v[148:151]
s_add_u32 m0, s43, 77824
ds_read_b128 a[240:243], v32 offset:24576
v_lshlrev_b32 v38, 16, v29
v_mfma_f32_16x16x32_bf16 v[148:151], a[252:255], v[44:47], v[148:151]
buffer_load_dwordx4 v32, s[16:19], s53 offen sc1 lds
v_and_b32 v29, s55, v29
v_mfma_f32_16x16x32_bf16 v[144:147], a[252:255], v[40:43], v[144:147]
ds_read_b128 a[244:247], v32 offset:33792
v_lshlrev_b32 v37, 16, v21
v_mfma_f32_16x16x32_bf16 v[144:147], a[248:251], v[8:11], v[144:147]
s_waitcnt lgkmcnt(4)
v_and_b32 v21, s55, v21
v_add_f32 v39, v37, v38
v_mfma_f32_16x16x32_bf16 v[152:155], a[224:227], v[8:11], v[152:155]
ds_read_b128 a[248:251], v32 offset:25600
v_subrev_f32 v38, v37, v38
v_mfma_f32_16x16x32_bf16 v[152:155], a[228:231], v[40:43], v[152:155]
v_add_f32 v37, v21, v29
v_subrev_f32 v29, v21, v29
v_mfma_f32_16x16x32_bf16 v[156:159], a[228:231], v[44:47], v[156:159]
ds_read_b128 a[252:255], v32 offset:34816
v_cvt_pk_bf16_f32 v21, v39, v37
v_mfma_f32_16x16x32_bf16 v[156:159], a[224:227], v[12:15], v[156:159]
s_waitcnt lgkmcnt(4)
buffer_load_dwordx4 v32, s[16:19], s53 offen offset:1024 sc1 lds
v_mfma_f32_16x16x32_bf16 v[164:167], a[232:235], v[12:15], v[164:167]
ds_read_b128 a[224:227], v32 offset:26624
v_cvt_pk_bf16_f32 v29, v38, v29
v_mfma_f32_16x16x32_bf16 v[164:167], a[236:239], v[44:47], v[164:167]
v_lshlrev_b32 v38, 16, v30
v_and_b32 v30, s55, v30
v_mfma_f32_16x16x32_bf16 v[160:163], a[236:239], v[40:43], v[160:163]
ds_read_b128 a[228:231], v32 offset:35840
v_lshlrev_b32 v37, 16, v22
v_mfma_f32_16x16x32_bf16 v[160:163], a[232:235], v[8:11], v[160:163]
s_waitcnt lgkmcnt(4)
v_and_b32 v22, s55, v22
v_add_f32 v39, v37, v38
v_mfma_f32_16x16x32_bf16 v[168:171], a[240:243], v[8:11], v[168:171]
ds_read_b128 a[232:235], v32
v_subrev_f32 v38, v37, v38
v_mfma_f32_16x16x32_bf16 v[168:171], a[244:247], v[40:43], v[168:171]
buffer_load_dwordx4 v32, s[16:19], s53 offen offset:2048 sc1 lds
v_add_f32 v37, v22, v30
v_mfma_f32_16x16x32_bf16 v[172:175], a[244:247], v[44:47], v[172:175]
ds_read_b128 a[236:239], v32 offset:9216
v_subrev_f32 v30, v22, v30
v_mfma_f32_16x16x32_bf16 v[172:175], a[240:243], v[12:15], v[172:175]
s_waitcnt lgkmcnt(4)
v_cvt_pk_bf16_f32 v22, v39, v37
v_cvt_pk_bf16_f32 v30, v38, v30
v_mfma_f32_16x16x32_bf16 v[180:183], a[248:251], v[12:15], v[180:183]
ds_read_b128 a[240:243], v32 offset:1024
v_lshlrev_b32 v38, 16, v31
v_mfma_f32_16x16x32_bf16 v[180:183], a[252:255], v[44:47], v[180:183]
v_and_b32 v31, s55, v31
v_lshlrev_b32 v37, 16, v23
v_mfma_f32_16x16x32_bf16 v[176:179], a[252:255], v[40:43], v[176:179]
ds_read_b128 a[244:247], v32 offset:10240
v_and_b32 v23, s55, v23
v_mfma_f32_16x16x32_bf16 v[176:179], a[248:251], v[8:11], v[176:179]
s_waitcnt lgkmcnt(4)
buffer_load_dwordx4 v32, s[16:19], s53 offen offset:3072 sc1 lds
v_mfma_f32_16x16x32_bf16 v[184:187], a[224:227], v[8:11], v[184:187]
ds_read_b128 a[248:251], v32 offset:2048
v_add_f32 v39, v37, v38
v_mfma_f32_16x16x32_bf16 v[184:187], a[228:231], v[40:43], v[184:187]
v_subrev_f32 v38, v37, v38
v_add_f32 v37, v23, v31
v_mfma_f32_16x16x32_bf16 v[188:191], a[228:231], v[44:47], v[188:191]
s_add_u32 s54, s76, 413696
ds_read_b128 a[252:255], v32 offset:11264
v_subrev_f32 v31, v23, v31
v_mfma_f32_16x16x32_bf16 v[188:191], a[224:227], v[12:15], v[188:191]
s_waitcnt lgkmcnt(4)
v_cvt_pk_bf16_f32 v23, v39, v37
v_cvt_pk_bf16_f32 v31, v38, v31
v_mfma_f32_16x16x32_bf16 v[196:199], a[232:235], v[4:7], v[196:199]
s_add_u32 m0, s43, 81920
ds_read_b128 a[224:227], v32 offset:3072
v_mfma_f32_16x16x32_bf16 v[196:199], a[236:239], v[20:23], v[196:199]
buffer_load_dwordx4 v32, s[16:19], s54 offen sc1 lds
ds_read_b128 v[8:11], v35 offset:4096
v_accvgpr_read_b32 v44, a92
v_mfma_f32_16x16x32_bf16 v[192:195], a[236:239], v[16:19], v[192:195]
ds_read_b128 a[228:231], v32 offset:12288
v_accvgpr_read_b32 v45, a93
v_mfma_f32_16x16x32_bf16 v[192:195], a[232:235], v[0:3], v[192:195]
s_waitcnt lgkmcnt(5)
ds_read_b128 v[12:15], v35
v_accvgpr_read_b32 v46, a94
v_mfma_f32_16x16x32_bf16 v[200:203], a[240:243], v[0:3], v[200:203]
ds_read_b128 a[232:235], v32 offset:4096
v_accvgpr_read_b32 v47, a95
v_mfma_f32_16x16x32_bf16 v[200:203], a[244:247], v[16:19], v[200:203]
ds_read_b128 a[92:95], v35
v_accvgpr_read_b32 v40, a88
v_mfma_f32_16x16x32_bf16 v[204:207], a[244:247], v[20:23], v[204:207]
ds_read_b128 a[236:239], v32 offset:13312
v_accvgpr_read_b32 v41, a89
v_mfma_f32_16x16x32_bf16 v[204:207], a[240:243], v[4:7], v[204:207]
s_waitcnt lgkmcnt(7)
v_accvgpr_read_b32 v42, a90
v_accvgpr_read_b32 v43, a91
v_mfma_f32_16x16x32_bf16 v[212:215], a[248:251], v[4:7], v[212:215]
s_add_u32 m0, s48, 5248
ds_read_b128 a[240:243], v32 offset:5120
ds_read_b128 a[88:91], v35 offset:4096
v_mfma_f32_16x16x32_bf16 v[212:215], a[252:255], v[20:23], v[212:215]
buffer_load_dwordx4 v36, s[8:11], s44 offen offset:896 lds
v_mfma_f32_16x16x32_bf16 v[208:211], a[252:255], v[16:19], v[208:211]
ds_read_b128 a[244:247], v32 offset:14336
v_lshlrev_b32 v38, 16, v40
v_mfma_f32_16x16x32_bf16 v[208:211], a[248:251], v[0:3], v[208:211]
s_waitcnt lgkmcnt(7)
v_and_b32 v40, s55, v40
v_lshlrev_b32 v37, 16, v8
v_mfma_f32_16x16x32_bf16 v[216:219], a[224:227], v[0:3], v[216:219]
ds_read_b128 a[248:251], v32 offset:6144
v_and_b32 v8, s55, v8
v_mfma_f32_16x16x32_bf16 v[216:219], a[228:231], v[16:19], v[216:219]
v_add_f32 v39, v37, v38
v_subrev_f32 v38, v37, v38
v_add_f32 v37, v8, v40
v_mfma_f32_16x16x32_bf16 v[220:223], a[228:231], v[20:23], v[220:223]
ds_read_b128 a[252:255], v32 offset:15360
v_subrev_f32 v40, v8, v40
v_mfma_f32_16x16x32_bf16 v[220:223], a[224:227], v[4:7], v[220:223]
s_waitcnt lgkmcnt(5)
v_cvt_pk_bf16_f32 v8, v39, v37
v_cvt_pk_bf16_f32 v40, v38, v40
v_mfma_f32_16x16x32_bf16 v[228:231], a[232:235], v[4:7], v[228:231]
s_add_u32 m0, s48, 6272
ds_read_b128 a[224:227], v32 offset:7168
v_lshlrev_b32 v38, 16, v41
v_mfma_f32_16x16x32_bf16 v[228:231], a[236:239], v[20:23], v[228:231]
buffer_load_dwordx4 v36, s[8:11], s45 offen offset:896 lds
v_mfma_f32_16x16x32_bf16 v[224:227], a[236:239], v[16:19], v[224:227]
ds_read_b128 a[228:231], v32 offset:16384
v_and_b32 v41, s55, v41
v_mfma_f32_16x16x32_bf16 v[224:227], a[232:235], v[0:3], v[224:227]
s_waitcnt lgkmcnt(4)
v_lshlrev_b32 v37, 16, v9
v_and_b32 v9, s55, v9
v_mfma_f32_16x16x32_bf16 v[232:235], a[240:243], v[0:3], v[232:235]
ds_read_b128 a[232:235], v32 offset:8192
v_add_f32 v39, v37, v38
v_mfma_f32_16x16x32_bf16 v[232:235], a[244:247], v[16:19], v[232:235]
v_subrev_f32 v38, v37, v38
v_add_f32 v37, v9, v41
v_mfma_f32_16x16x32_bf16 v[236:239], a[244:247], v[20:23], v[236:239]
s_add_u32 s52, s82, 442368
ds_read_b128 a[236:239], v32 offset:17408
v_subrev_f32 v41, v9, v41
v_mfma_f32_16x16x32_bf16 v[236:239], a[240:243], v[4:7], v[236:239]
s_waitcnt vmcnt(13) lgkmcnt(4)
s_barrier
v_cvt_pk_bf16_f32 v9, v39, v37
v_cvt_pk_bf16_f32 v41, v38, v41
v_mfma_f32_16x16x32_bf16 v[244:247], a[248:251], v[4:7], v[244:247]
s_add_u32 m0, s43, 0
ds_read_b128 a[240:243], v32 offset:36864
v_lshlrev_b32 v38, 16, v42
v_mfma_f32_16x16x32_bf16 v[244:247], a[252:255], v[20:23], v[244:247]
buffer_load_dwordx4 v32, s[16:19], s52 offen sc1 lds
v_and_b32 v42, s55, v42
v_mfma_f32_16x16x32_bf16 v[240:243], a[252:255], v[16:19], v[240:243]
ds_read_b128 a[244:247], v32 offset:46080
v_lshlrev_b32 v37, 16, v10
v_mfma_f32_16x16x32_bf16 v[240:243], a[248:251], v[0:3], v[240:243]
s_waitcnt lgkmcnt(4)
v_and_b32 v10, s55, v10
v_add_f32 v39, v37, v38
v_mfma_f32_16x16x32_bf16 v[248:251], a[224:227], v[0:3], v[248:251]
ds_read_b128 a[248:251], v32 offset:37888
v_subrev_f32 v38, v37, v38
v_mfma_f32_16x16x32_bf16 v[248:251], a[228:231], v[16:19], v[248:251]
v_add_f32 v37, v10, v42
v_subrev_f32 v42, v10, v42
v_mfma_f32_16x16x32_bf16 v[252:255], a[228:231], v[20:23], v[252:255]
ds_read_b128 a[252:255], v32 offset:47104
v_cvt_pk_bf16_f32 v10, v39, v37
v_mfma_f32_16x16x32_bf16 v[252:255], a[224:227], v[4:7], v[252:255]
s_waitcnt lgkmcnt(4)
buffer_load_dwordx4 v32, s[16:19], s52 offen offset:1024 sc1 lds
v_mfma_f32_16x16x32_bf16 a[148:151], a[232:235], v[4:7], a[148:151]
ds_read_b128 a[224:227], v32 offset:38912
v_cvt_pk_bf16_f32 v42, v38, v42
v_mfma_f32_16x16x32_bf16 a[148:151], a[236:239], v[20:23], a[148:151]
v_lshlrev_b32 v38, 16, v43
v_and_b32 v43, s55, v43
v_mfma_f32_16x16x32_bf16 a[144:147], a[236:239], v[16:19], a[144:147]
ds_read_b128 a[228:231], v32 offset:48128
v_lshlrev_b32 v37, 16, v11
v_mfma_f32_16x16x32_bf16 a[144:147], a[232:235], v[0:3], a[144:147]
s_waitcnt lgkmcnt(4)
v_and_b32 v11, s55, v11
v_add_f32 v39, v37, v38
v_mfma_f32_16x16x32_bf16 a[152:155], a[240:243], v[0:3], a[152:155]
ds_read_b128 a[232:235], v32 offset:39936
v_subrev_f32 v38, v37, v38
v_mfma_f32_16x16x32_bf16 a[152:155], a[244:247], v[16:19], a[152:155]
buffer_load_dwordx4 v32, s[16:19], s52 offen offset:2048 sc1 lds
v_add_f32 v37, v11, v43
v_mfma_f32_16x16x32_bf16 a[156:159], a[244:247], v[20:23], a[156:159]
ds_read_b128 a[236:239], v32 offset:49152
v_subrev_f32 v43, v11, v43
v_mfma_f32_16x16x32_bf16 a[156:159], a[240:243], v[4:7], a[156:159]
s_waitcnt lgkmcnt(4)
v_cvt_pk_bf16_f32 v11, v39, v37
v_cvt_pk_bf16_f32 v43, v38, v43
v_mfma_f32_16x16x32_bf16 a[164:167], a[248:251], v[4:7], a[164:167]
s_load_dword s77, s[78:79], 40960
ds_read_b128 a[240:243], v32 offset:40960
v_lshlrev_b32 v38, 16, v44
v_mfma_f32_16x16x32_bf16 a[164:167], a[252:255], v[20:23], a[164:167]
v_and_b32 v44, s55, v44
v_lshlrev_b32 v37, 16, v12
v_mfma_f32_16x16x32_bf16 a[160:163], a[252:255], v[16:19], a[160:163]
ds_read_b128 a[244:247], v32 offset:50176
v_and_b32 v12, s55, v12
v_mfma_f32_16x16x32_bf16 a[160:163], a[248:251], v[0:3], a[160:163]
s_waitcnt lgkmcnt(4)
buffer_load_dwordx4 v32, s[16:19], s52 offen offset:3072 sc1 lds
v_mfma_f32_16x16x32_bf16 a[168:171], a[224:227], v[0:3], a[168:171]
ds_read_b128 a[248:251], v32 offset:41984
v_add_f32 v39, v37, v38
v_mfma_f32_16x16x32_bf16 a[168:171], a[228:231], v[16:19], a[168:171]
v_subrev_f32 v38, v37, v38
v_add_f32 v37, v12, v44
v_mfma_f32_16x16x32_bf16 a[172:175], a[228:231], v[20:23], a[172:175]
s_add_u32 s53, s82, 446464
ds_read_b128 a[252:255], v32 offset:51200
v_subrev_f32 v44, v12, v44
v_mfma_f32_16x16x32_bf16 a[172:175], a[224:227], v[4:7], a[172:175]
s_waitcnt lgkmcnt(4)
v_cvt_pk_bf16_f32 v12, v39, v37
v_cvt_pk_bf16_f32 v44, v38, v44
v_mfma_f32_16x16x32_bf16 a[180:183], a[232:235], v[4:7], a[180:183]
s_add_u32 m0, s43, 4096
ds_read_b128 a[224:227], v32 offset:43008
v_lshlrev_b32 v38, 16, v45
v_mfma_f32_16x16x32_bf16 a[180:183], a[236:239], v[20:23], a[180:183]
buffer_load_dwordx4 v32, s[16:19], s53 offen sc1 lds
v_and_b32 v45, s55, v45
v_mfma_f32_16x16x32_bf16 a[176:179], a[236:239], v[16:19], a[176:179]
ds_read_b128 a[228:231], v32 offset:52224
v_lshlrev_b32 v37, 16, v13
v_mfma_f32_16x16x32_bf16 a[176:179], a[232:235], v[0:3], a[176:179]
s_waitcnt lgkmcnt(4)
v_and_b32 v13, s55, v13
v_add_f32 v39, v37, v38
v_mfma_f32_16x16x32_bf16 a[184:187], a[240:243], v[0:3], a[184:187]
ds_read_b128 a[232:235], v32 offset:44032
v_subrev_f32 v38, v37, v38
v_mfma_f32_16x16x32_bf16 a[184:187], a[244:247], v[16:19], a[184:187]
v_add_f32 v37, v13, v45
v_subrev_f32 v45, v13, v45
v_mfma_f32_16x16x32_bf16 a[188:191], a[244:247], v[20:23], a[188:191]
ds_read_b128 a[236:239], v32 offset:53248
v_cvt_pk_bf16_f32 v13, v39, v37
v_mfma_f32_16x16x32_bf16 a[188:191], a[240:243], v[4:7], a[188:191]
s_waitcnt lgkmcnt(4)
buffer_load_dwordx4 v32, s[16:19], s53 offen offset:1024 sc1 lds
v_mfma_f32_16x16x32_bf16 a[196:199], a[248:251], v[4:7], a[196:199]
L_pg9:
s_cbranch_vccnz L_vr2
ds_read_b128 a[240:243], v32 offset:45056
v_cvt_pk_bf16_f32 v45, v38, v45
v_mfma_f32_16x16x32_bf16 a[196:199], a[252:255], v[20:23], a[196:199]
v_lshlrev_b32 v38, 16, v46
v_and_b32 v46, s55, v46
v_mfma_f32_16x16x32_bf16 a[192:195], a[252:255], v[16:19], a[192:195]
ds_read_b128 a[244:247], v32 offset:54272
v_lshlrev_b32 v37, 16, v14
v_mfma_f32_16x16x32_bf16 a[192:195], a[248:251], v[0:3], a[192:195]
s_waitcnt lgkmcnt(4)
v_and_b32 v14, s55, v14
v_add_f32 v39, v37, v38
v_mfma_f32_16x16x32_bf16 a[200:203], a[224:227], v[0:3], a[200:203]
ds_read_b128 a[248:251], v32 offset:55296
v_subrev_f32 v38, v37, v38
v_mfma_f32_16x16x32_bf16 a[200:203], a[228:231], v[16:19], a[200:203]
buffer_load_dwordx4 v32, s[16:19], s53 offen offset:2048 sc1 lds
v_add_f32 v37, v14, v46
v_mfma_f32_16x16x32_bf16 a[204:207], a[228:231], v[20:23], a[204:207]
ds_read_b128 a[252:255], v32 offset:64512
v_subrev_f32 v46, v14, v46
v_mfma_f32_16x16x32_bf16 a[204:207], a[224:227], v[4:7], a[204:207]
s_waitcnt lgkmcnt(4)
v_cvt_pk_bf16_f32 v14, v39, v37
v_cvt_pk_bf16_f32 v46, v38, v46
v_mfma_f32_16x16x32_bf16 a[212:215], a[232:235], v[4:7], a[212:215]
ds_read_b128 a[224:227], v32 offset:56320
v_lshlrev_b32 v38, 16, v47
v_mfma_f32_16x16x32_bf16 a[212:215], a[236:239], v[20:23], a[212:215]
v_and_b32 v47, s55, v47
v_lshlrev_b32 v37, 16, v15
v_mfma_f32_16x16x32_bf16 a[208:211], a[236:239], v[16:19], a[208:211]
ds_read_b128 a[228:231], v33
v_and_b32 v15, s55, v15
v_mfma_f32_16x16x32_bf16 a[208:211], a[232:235], v[0:3], a[208:211]
s_waitcnt lgkmcnt(4)
buffer_load_dwordx4 v32, s[16:19], s53 offen offset:3072 sc1 lds
v_mfma_f32_16x16x32_bf16 a[216:219], a[240:243], v[0:3], a[216:219]
ds_read_b128 a[232:235], v32 offset:57344
v_add_f32 v39, v37, v38
v_mfma_f32_16x16x32_bf16 a[216:219], a[244:247], v[16:19], a[216:219]
v_subrev_f32 v38, v37, v38
v_add_f32 v37, v15, v47
v_mfma_f32_16x16x32_bf16 a[220:223], a[244:247], v[20:23], a[220:223]
s_add_u32 s54, s82, 450560
ds_read_b128 a[236:239], v33 offset:1024
v_subrev_f32 v47, v15, v47
v_mfma_f32_16x16x32_bf16 a[220:223], a[240:243], v[4:7], a[220:223]
s_waitcnt vmcnt(19) lgkmcnt(4)
v_cvt_pk_bf16_f32 v15, v39, v37
v_cvt_pk_bf16_f32 v47, v38, v47
v_mfma_f32_16x16x32_bf16 v[52:55], a[248:251], v[28:31], v[52:55]
s_add_u32 m0, s43, 8192
ds_read_b128 a[240:243], v32 offset:58368
v_mfma_f32_16x16x32_bf16 v[52:55], a[252:255], v[44:47], v[52:55]
buffer_load_dwordx4 v32, s[16:19], s54 offen sc1 lds
ds_read_b128 v[16:19], v34 offset:8192
v_accvgpr_read_b32 v4, a100
v_mfma_f32_16x16x32_bf16 v[48:51], a[252:255], v[40:43], v[48:51]
ds_read_b128 a[244:247], v33 offset:2048
v_accvgpr_read_b32 v5, a101
v_mfma_f32_16x16x32_bf16 v[48:51], a[248:251], v[24:27], v[48:51]
s_waitcnt lgkmcnt(5)
ds_read_b128 v[20:23], v34 offset:2048
v_accvgpr_read_b32 v6, a102
v_mfma_f32_16x16x32_bf16 v[56:59], a[224:227], v[24:27], v[56:59]
ds_read_b128 a[248:251], v32 offset:59392
v_accvgpr_read_b32 v7, a103
v_mfma_f32_16x16x32_bf16 v[56:59], a[228:231], v[40:43], v[56:59]
ds_read_b128 a[100:103], v34 offset:2048
v_accvgpr_read_b32 v0, a96
v_mfma_f32_16x16x32_bf16 v[60:63], a[228:231], v[44:47], v[60:63]
ds_read_b128 a[252:255], v33 offset:3072
v_accvgpr_read_b32 v1, a97
v_mfma_f32_16x16x32_bf16 v[60:63], a[224:227], v[28:31], v[60:63]
s_waitcnt lgkmcnt(7)
v_accvgpr_read_b32 v2, a98
v_accvgpr_read_b32 v3, a99
v_mfma_f32_16x16x32_bf16 v[68:71], a[232:235], v[28:31], v[68:71]
s_sub_u32 m0, s48, 896
ds_read_b128 a[224:227], v32 offset:60416
ds_read_b128 a[96:99], v34 offset:8192
v_mfma_f32_16x16x32_bf16 v[68:71], a[236:239], v[44:47], v[68:71]
buffer_load_dwordx4 v36, s[8:11], s63 offen offset:896 lds
v_mfma_f32_16x16x32_bf16 v[64:67], a[236:239], v[40:43], v[64:67]
ds_read_b128 a[228:231], v33 offset:4096
v_lshlrev_b32 v38, 16, v0
v_mfma_f32_16x16x32_bf16 v[64:67], a[232:235], v[24:27], v[64:67]
s_waitcnt lgkmcnt(7)
v_and_b32 v0, s55, v0
v_lshlrev_b32 v37, 16, v16
v_mfma_f32_16x16x32_bf16 v[72:75], a[240:243], v[24:27], v[72:75]
ds_read_b128 a[232:235], v32 offset:61440
v_and_b32 v16, s55, v16
v_mfma_f32_16x16x32_bf16 v[72:75], a[244:247], v[40:43], v[72:75]
v_add_f32 v39, v37, v38
v_subrev_f32 v38, v37, v38
v_add_f32 v37, v16, v0
v_mfma_f32_16x16x32_bf16 v[76:79], a[244:247], v[44:47], v[76:79]
ds_read_b128 a[236:239], v33 offset:5120
v_subrev_f32 v0, v16, v0
v_mfma_f32_16x16x32_bf16 v[76:79], a[240:243], v[28:31], v[76:79]
s_waitcnt lgkmcnt(5)
v_cvt_pk_bf16_f32 v16, v39, v37
v_cvt_pk_bf16_f32 v0, v38, v0
v_mfma_f32_16x16x32_bf16 v[84:87], a[248:251], v[28:31], v[84:87]
s_add_u32 m0, s48, 128
ds_read_b128 a[240:243], v32 offset:62464
v_lshlrev_b32 v38, 16, v1
v_mfma_f32_16x16x32_bf16 v[84:87], a[252:255], v[44:47], v[84:87]
buffer_load_dwordx4 v36, s[8:11], s83 offen offset:896 lds
v_mfma_f32_16x16x32_bf16 v[80:83], a[252:255], v[40:43], v[80:83]
ds_read_b128 a[244:247], v33 offset:6144
v_and_b32 v1, s55, v1
v_mfma_f32_16x16x32_bf16 v[80:83], a[248:251], v[24:27], v[80:83]
s_waitcnt lgkmcnt(4)
v_lshlrev_b32 v37, 16, v17
v_and_b32 v17, s55, v17
v_mfma_f32_16x16x32_bf16 v[88:91], a[224:227], v[24:27], v[88:91]
ds_read_b128 a[248:251], v32 offset:63488
v_add_f32 v39, v37, v38
v_mfma_f32_16x16x32_bf16 v[88:91], a[228:231], v[40:43], v[88:91]
v_subrev_f32 v38, v37, v38
v_add_f32 v37, v17, v1
v_mfma_f32_16x16x32_bf16 v[92:95], a[228:231], v[44:47], v[92:95]
s_add_u32 s52, s76, 479232
ds_read_b128 a[252:255], v33 offset:7168
v_subrev_f32 v1, v17, v1
v_mfma_f32_16x16x32_bf16 v[92:95], a[224:227], v[28:31], v[92:95]
s_waitcnt vmcnt(13) lgkmcnt(4)
s_barrier
v_cvt_pk_bf16_f32 v17, v39, v37
v_cvt_pk_bf16_f32 v1, v38, v1
v_mfma_f32_16x16x32_bf16 v[100:103], a[232:235], v[28:31], v[100:103]
s_add_u32 m0, s43, 36864
ds_read_b128 a[224:227], v33 offset:26624
v_lshlrev_b32 v38, 16, v2
v_mfma_f32_16x16x32_bf16 v[100:103], a[236:239], v[44:47], v[100:103]
buffer_load_dwordx4 v32, s[16:19], s52 offen sc1 lds
v_and_b32 v2, s55, v2
v_mfma_f32_16x16x32_bf16 v[96:99], a[236:239], v[40:43], v[96:99]
ds_read_b128 a[228:231], v33 offset:35840
v_lshlrev_b32 v37, 16, v18
v_mfma_f32_16x16x32_bf16 v[96:99], a[232:235], v[24:27], v[96:99]
s_waitcnt lgkmcnt(4)
v_and_b32 v18, s55, v18
v_add_f32 v39, v37, v38
v_mfma_f32_16x16x32_bf16 v[104:107], a[240:243], v[24:27], v[104:107]
ds_read_b128 a[232:235], v33 offset:27648
v_subrev_f32 v38, v37, v38
v_mfma_f32_16x16x32_bf16 v[104:107], a[244:247], v[40:43], v[104:107]
v_add_f32 v37, v18, v2
v_subrev_f32 v2, v18, v2
v_mfma_f32_16x16x32_bf16 v[108:111], a[244:247], v[44:47], v[108:111]
ds_read_b128 a[236:239], v33 offset:36864
v_cvt_pk_bf16_f32 v18, v39, v37
v_mfma_f32_16x16x32_bf16 v[108:111], a[240:243], v[28:31], v[108:111]
s_waitcnt lgkmcnt(4)
buffer_load_dwordx4 v32, s[16:19], s52 offen offset:1024 sc1 lds
v_mfma_f32_16x16x32_bf16 v[116:119], a[248:251], v[28:31], v[116:119]
ds_read_b128 a[240:243], v33 offset:28672
v_cvt_pk_bf16_f32 v2, v38, v2
v_mfma_f32_16x16x32_bf16 v[116:119], a[252:255], v[44:47], v[116:119]
v_lshlrev_b32 v38, 16, v3
v_and_b32 v3, s55, v3
v_mfma_f32_16x16x32_bf16 v[112:115], a[252:255], v[40:43], v[112:115]
ds_read_b128 a[244:247], v33 offset:37888
v_lshlrev_b32 v37, 16, v19
v_mfma_f32_16x16x32_bf16 v[112:115], a[248:251], v[24:27], v[112:115]
s_waitcnt lgkmcnt(4)
v_and_b32 v19, s55, v19
v_add_f32 v39, v37, v38
v_mfma_f32_16x16x32_bf16 v[120:123], a[224:227], v[24:27], v[120:123]
ds_read_b128 a[248:251], v33 offset:29696
v_subrev_f32 v38, v37, v38
v_mfma_f32_16x16x32_bf16 v[120:123], a[228:231], v[40:43], v[120:123]
buffer_load_dwordx4 v32, s[16:19], s52 offen offset:2048 sc1 lds
v_add_f32 v37, v19, v3
v_mfma_f32_16x16x32_bf16 v[124:127], a[228:231], v[44:47], v[124:127]
ds_read_b128 a[252:255], v33 offset:38912
v_subrev_f32 v3, v19, v3
v_mfma_f32_16x16x32_bf16 v[124:127], a[224:227], v[28:31], v[124:127]
s_waitcnt lgkmcnt(4)
v_cvt_pk_bf16_f32 v19, v39, v37
v_cvt_pk_bf16_f32 v3, v38, v3
v_mfma_f32_16x16x32_bf16 v[132:135], a[232:235], v[28:31], v[132:135]
ds_read_b128 a[224:227], v33 offset:30720
v_lshlrev_b32 v38, 16, v4
v_mfma_f32_16x16x32_bf16 v[132:135], a[236:239], v[44:47], v[132:135]
v_and_b32 v4, s55, v4
v_lshlrev_b32 v37, 16, v20
v_mfma_f32_16x16x32_bf16 v[128:131], a[236:239], v[40:43], v[128:131]
ds_read_b128 a[228:231], v33 offset:39936
v_and_b32 v20, s55, v20
v_mfma_f32_16x16x32_bf16 v[128:131], a[232:235], v[24:27], v[128:131]
s_waitcnt lgkmcnt(4)
buffer_load_dwordx4 v32, s[16:19], s52 offen offset:3072 sc1 lds
v_mfma_f32_16x16x32_bf16 v[136:139], a[240:243], v[24:27], v[136:139]
ds_read_b128 a[232:235], v33 offset:31744
v_add_f32 v39, v37, v38
v_mfma_f32_16x16x32_bf16 v[136:139], a[244:247], v[40:43], v[136:139]
v_subrev_f32 v38, v37, v38
v_add_f32 v37, v20, v4
v_mfma_f32_16x16x32_bf16 v[140:143], a[244:247], v[44:47], v[140:143]
s_add_u32 s53, s76, 483328
ds_read_b128 a[236:239], v33 offset:40960
v_subrev_f32 v4, v20, v4
v_mfma_f32_16x16x32_bf16 v[140:143], a[240:243], v[28:31], v[140:143]
s_waitcnt lgkmcnt(4)
v_cvt_pk_bf16_f32 v20, v39, v37
v_cvt_pk_bf16_f32 v4, v38, v4
v_mfma_f32_16x16x32_bf16 v[148:151], a[248:251], v[28:31], v[148:151]
s_add_u32 m0, s43, 40960
ds_read_b128 a[240:243], v33 offset:32768
v_lshlrev_b32 v38, 16, v5
v_mfma_f32_16x16x32_bf16 v[148:151], a[252:255], v[44:47], v[148:151]
buffer_load_dwordx4 v32, s[16:19], s53 offen sc1 lds
v_and_b32 v5, s55, v5
v_mfma_f32_16x16x32_bf16 v[144:147], a[252:255], v[40:43], v[144:147]
ds_read_b128 a[244:247], v33 offset:41984
v_lshlrev_b32 v37, 16, v21
v_mfma_f32_16x16x32_bf16 v[144:147], a[248:251], v[24:27], v[144:147]
s_waitcnt lgkmcnt(4)
v_and_b32 v21, s55, v21
v_add_f32 v39, v37, v38
v_mfma_f32_16x16x32_bf16 v[152:155], a[224:227], v[24:27], v[152:155]
ds_read_b128 a[248:251], v33 offset:33792
v_subrev_f32 v38, v37, v38
v_mfma_f32_16x16x32_bf16 v[152:155], a[228:231], v[40:43], v[152:155]
v_add_f32 v37, v21, v5
v_subrev_f32 v5, v21, v5
v_mfma_f32_16x16x32_bf16 v[156:159], a[228:231], v[44:47], v[156:159]
ds_read_b128 a[252:255], v33 offset:43008
v_cvt_pk_bf16_f32 v21, v39, v37
v_mfma_f32_16x16x32_bf16 v[156:159], a[224:227], v[28:31], v[156:159]
s_waitcnt lgkmcnt(4)
buffer_load_dwordx4 v32, s[16:19], s53 offen offset:1024 sc1 lds
v_mfma_f32_16x16x32_bf16 v[164:167], a[232:235], v[28:31], v[164:167]
ds_read_b128 a[224:227], v33 offset:34816
v_cvt_pk_bf16_f32 v5, v38, v5
v_mfma_f32_16x16x32_bf16 v[164:167], a[236:239], v[44:47], v[164:167]
v_lshlrev_b32 v38, 16, v6
v_and_b32 v6, s55, v6
v_mfma_f32_16x16x32_bf16 v[160:163], a[236:239], v[40:43], v[160:163]
ds_read_b128 a[228:231], v33 offset:44032
v_lshlrev_b32 v37, 16, v22
v_mfma_f32_16x16x32_bf16 v[160:163], a[232:235], v[24:27], v[160:163]
s_waitcnt lgkmcnt(4)
v_and_b32 v22, s55, v22
v_add_f32 v39, v37, v38
v_mfma_f32_16x16x32_bf16 v[168:171], a[240:243], v[24:27], v[168:171]
ds_read_b128 a[232:235], v33 offset:8192
v_subrev_f32 v38, v37, v38
v_mfma_f32_16x16x32_bf16 v[168:171], a[244:247], v[40:43], v[168:171]
buffer_load_dwordx4 v32, s[16:19], s53 offen offset:2048 sc1 lds
v_add_f32 v37, v22, v6
v_mfma_f32_16x16x32_bf16 v[172:175], a[244:247], v[44:47], v[172:175]
ds_read_b128 a[236:239], v33 offset:17408
v_subrev_f32 v6, v22, v6
v_mfma_f32_16x16x32_bf16 v[172:175], a[240:243], v[28:31], v[172:175]
s_waitcnt lgkmcnt(4)
v_cvt_pk_bf16_f32 v22, v39, v37
v_cvt_pk_bf16_f32 v6, v38, v6
v_mfma_f32_16x16x32_bf16 v[180:183], a[248:251], v[28:31], v[180:183]
ds_read_b128 a[240:243], v33 offset:9216
v_lshlrev_b32 v38, 16, v7
v_mfma_f32_16x16x32_bf16 v[180:183], a[252:255], v[44:47], v[180:183]
v_and_b32 v7, s55, v7
v_lshlrev_b32 v37, 16, v23
v_mfma_f32_16x16x32_bf16 v[176:179], a[252:255], v[40:43], v[176:179]
ds_read_b128 a[244:247], v33 offset:18432
v_and_b32 v23, s55, v23
v_mfma_f32_16x16x32_bf16 v[176:179], a[248:251], v[24:27], v[176:179]
s_waitcnt lgkmcnt(4)
buffer_load_dwordx4 v32, s[16:19], s53 offen offset:3072 sc1 lds
v_mfma_f32_16x16x32_bf16 v[184:187], a[224:227], v[24:27], v[184:187]
ds_read_b128 a[248:251], v33 offset:10240
v_add_f32 v39, v37, v38
v_mfma_f32_16x16x32_bf16 v[184:187], a[228:231], v[40:43], v[184:187]
v_subrev_f32 v38, v37, v38
v_add_f32 v37, v23, v7
v_mfma_f32_16x16x32_bf16 v[188:191], a[228:231], v[44:47], v[188:191]
s_add_u32 s54, s76, 487424
ds_read_b128 a[252:255], v33 offset:19456
v_subrev_f32 v7, v23, v7
v_mfma_f32_16x16x32_bf16 v[188:191], a[224:227], v[28:31], v[188:191]
s_waitcnt lgkmcnt(4)
v_cvt_pk_bf16_f32 v23, v39, v37
v_cvt_pk_bf16_f32 v7, v38, v7
v_mfma_f32_16x16x32_bf16 v[196:199], a[232:235], v[12:15], v[196:199]
s_add_u32 m0, s43, 45056
ds_read_b128 a[224:227], v33 offset:11264
v_mfma_f32_16x16x32_bf16 v[196:199], a[236:239], v[20:23], v[196:199]
buffer_load_dwordx4 v32, s[16:19], s54 offen sc1 lds
ds_read_b128 v[24:27], v35 offset:8192
v_accvgpr_read_b32 v44, a108
v_mfma_f32_16x16x32_bf16 v[192:195], a[236:239], v[16:19], v[192:195]
ds_read_b128 a[228:231], v33 offset:20480
v_accvgpr_read_b32 v45, a109
v_mfma_f32_16x16x32_bf16 v[192:195], a[232:235], v[8:11], v[192:195]
s_waitcnt lgkmcnt(5)
ds_read_b128 v[28:31], v35 offset:2048
v_accvgpr_read_b32 v46, a110
v_mfma_f32_16x16x32_bf16 v[200:203], a[240:243], v[8:11], v[200:203]
ds_read_b128 a[232:235], v33 offset:12288
v_accvgpr_read_b32 v47, a111
v_mfma_f32_16x16x32_bf16 v[200:203], a[244:247], v[16:19], v[200:203]
ds_read_b128 a[108:111], v35 offset:2048
v_accvgpr_read_b32 v40, a104
v_mfma_f32_16x16x32_bf16 v[204:207], a[244:247], v[20:23], v[204:207]
ds_read_b128 a[236:239], v33 offset:21504
v_accvgpr_read_b32 v41, a105
v_mfma_f32_16x16x32_bf16 v[204:207], a[240:243], v[12:15], v[204:207]
s_waitcnt lgkmcnt(7)
v_accvgpr_read_b32 v42, a106
v_accvgpr_read_b32 v43, a107
v_mfma_f32_16x16x32_bf16 v[212:215], a[248:251], v[12:15], v[212:215]
s_add_u32 m0, s48, 3072
ds_read_b128 a[240:243], v33 offset:13312
ds_read_b128 a[104:107], v35 offset:8192
v_mfma_f32_16x16x32_bf16 v[212:215], a[252:255], v[20:23], v[212:215]
buffer_load_dwordx4 v36, s[8:11], s44 offen offset:1024 lds
v_mfma_f32_16x16x32_bf16 v[208:211], a[252:255], v[16:19], v[208:211]
ds_read_b128 a[244:247], v33 offset:22528
v_lshlrev_b32 v38, 16, v40
v_mfma_f32_16x16x32_bf16 v[208:211], a[248:251], v[8:11], v[208:211]
s_waitcnt lgkmcnt(7)
v_and_b32 v40, s55, v40
v_lshlrev_b32 v37, 16, v24
v_mfma_f32_16x16x32_bf16 v[216:219], a[224:227], v[8:11], v[216:219]
ds_read_b128 a[248:251], v33 offset:14336
v_and_b32 v24, s55, v24
v_mfma_f32_16x16x32_bf16 v[216:219], a[228:231], v[16:19], v[216:219]
v_add_f32 v39, v37, v38
v_subrev_f32 v38, v37, v38
v_add_f32 v37, v24, v40
v_mfma_f32_16x16x32_bf16 v[220:223], a[228:231], v[20:23], v[220:223]
ds_read_b128 a[252:255], v33 offset:23552
v_subrev_f32 v40, v24, v40
v_mfma_f32_16x16x32_bf16 v[220:223], a[224:227], v[12:15], v[220:223]
s_waitcnt lgkmcnt(5)
v_cvt_pk_bf16_f32 v24, v39, v37
v_cvt_pk_bf16_f32 v40, v38, v40
v_mfma_f32_16x16x32_bf16 v[228:231], a[232:235], v[12:15], v[228:231]
s_add_u32 m0, s48, 4096
ds_read_b128 a[224:227], v33 offset:15360
v_lshlrev_b32 v38, 16, v41
v_mfma_f32_16x16x32_bf16 v[228:231], a[236:239], v[20:23], v[228:231]
buffer_load_dwordx4 v36, s[8:11], s45 offen offset:1024 lds
v_mfma_f32_16x16x32_bf16 v[224:227], a[236:239], v[16:19], v[224:227]
ds_read_b128 a[228:231], v33 offset:24576
v_and_b32 v41, s55, v41
v_mfma_f32_16x16x32_bf16 v[224:227], a[232:235], v[8:11], v[224:227]
s_waitcnt lgkmcnt(4)
v_lshlrev_b32 v37, 16, v25
v_and_b32 v25, s55, v25
v_mfma_f32_16x16x32_bf16 v[232:235], a[240:243], v[8:11], v[232:235]
ds_read_b128 a[232:235], v33 offset:16384
v_add_f32 v39, v37, v38
v_mfma_f32_16x16x32_bf16 v[232:235], a[244:247], v[16:19], v[232:235]
v_subrev_f32 v38, v37, v38
v_add_f32 v37, v25, v41
v_mfma_f32_16x16x32_bf16 v[236:239], a[244:247], v[20:23], v[236:239]
s_add_u32 s52, s82, 516096
ds_read_b128 a[236:239], v33 offset:25600
v_subrev_f32 v41, v25, v41
v_mfma_f32_16x16x32_bf16 v[236:239], a[240:243], v[12:15], v[236:239]
s_waitcnt vmcnt(13) lgkmcnt(4)
s_barrier
v_cvt_pk_bf16_f32 v25, v39, v37
v_cvt_pk_bf16_f32 v41, v38, v41
v_mfma_f32_16x16x32_bf16 v[244:247], a[248:251], v[12:15], v[244:247]
s_add_u32 m0, s43, 73728
ds_read_b128 a[240:243], v32
v_lshlrev_b32 v38, 16, v42
v_mfma_f32_16x16x32_bf16 v[244:247], a[252:255], v[20:23], v[244:247]
buffer_load_dwordx4 v32, s[16:19], s52 offen sc1 lds
v_and_b32 v42, s55, v42
v_mfma_f32_16x16x32_bf16 v[240:243], a[252:255], v[16:19], v[240:243]
ds_read_b128 a[244:247], v32 offset:9216
v_lshlrev_b32 v37, 16, v26
v_mfma_f32_16x16x32_bf16 v[240:243], a[248:251], v[8:11], v[240:243]
s_waitcnt lgkmcnt(4)
v_and_b32 v26, s55, v26
v_add_f32 v39, v37, v38
v_mfma_f32_16x16x32_bf16 v[248:251], a[224:227], v[8:11], v[248:251]
ds_read_b128 a[248:251], v32 offset:1024
v_subrev_f32 v38, v37, v38
v_mfma_f32_16x16x32_bf16 v[248:251], a[228:231], v[16:19], v[248:251]
v_add_f32 v37, v26, v42
v_subrev_f32 v42, v26, v42
v_mfma_f32_16x16x32_bf16 v[252:255], a[228:231], v[20:23], v[252:255]
ds_read_b128 a[252:255], v32 offset:10240
v_cvt_pk_bf16_f32 v26, v39, v37
v_mfma_f32_16x16x32_bf16 v[252:255], a[224:227], v[12:15], v[252:255]
s_waitcnt lgkmcnt(4)
buffer_load_dwordx4 v32, s[16:19], s52 offen offset:1024 sc1 lds
v_mfma_f32_16x16x32_bf16 a[148:151], a[232:235], v[12:15], a[148:151]
ds_read_b128 a[224:227], v32 offset:2048
v_cvt_pk_bf16_f32 v42, v38, v42
v_mfma_f32_16x16x32_bf16 a[148:151], a[236:239], v[20:23], a[148:151]
v_lshlrev_b32 v38, 16, v43
v_and_b32 v43, s55, v43
v_mfma_f32_16x16x32_bf16 a[144:147], a[236:239], v[16:19], a[144:147]
ds_read_b128 a[228:231], v32 offset:11264
v_lshlrev_b32 v37, 16, v27
v_mfma_f32_16x16x32_bf16 a[144:147], a[232:235], v[8:11], a[144:147]
s_waitcnt lgkmcnt(4)
v_and_b32 v27, s55, v27
v_add_f32 v39, v37, v38
v_mfma_f32_16x16x32_bf16 a[152:155], a[240:243], v[8:11], a[152:155]
ds_read_b128 a[232:235], v32 offset:3072
v_subrev_f32 v38, v37, v38
v_mfma_f32_16x16x32_bf16 a[152:155], a[244:247], v[16:19], a[152:155]
buffer_load_dwordx4 v32, s[16:19], s52 offen offset:2048 sc1 lds
v_add_f32 v37, v27, v43
v_mfma_f32_16x16x32_bf16 a[156:159], a[244:247], v[20:23], a[156:159]
ds_read_b128 a[236:239], v32 offset:12288
v_subrev_f32 v43, v27, v43
v_mfma_f32_16x16x32_bf16 a[156:159], a[240:243], v[12:15], a[156:159]
s_waitcnt lgkmcnt(4)
v_cvt_pk_bf16_f32 v27, v39, v37
v_cvt_pk_bf16_f32 v43, v38, v43
v_mfma_f32_16x16x32_bf16 a[164:167], a[248:251], v[12:15], a[164:167]
ds_read_b128 a[240:243], v32 offset:4096
v_lshlrev_b32 v38, 16, v44
v_mfma_f32_16x16x32_bf16 a[164:167], a[252:255], v[20:23], a[164:167]
v_and_b32 v44, s55, v44
v_lshlrev_b32 v37, 16, v28
v_mfma_f32_16x16x32_bf16 a[160:163], a[252:255], v[16:19], a[160:163]
ds_read_b128 a[244:247], v32 offset:13312
v_and_b32 v28, s55, v28
v_mfma_f32_16x16x32_bf16 a[160:163], a[248:251], v[8:11], a[160:163]
s_waitcnt lgkmcnt(4)
buffer_load_dwordx4 v32, s[16:19], s52 offen offset:3072 sc1 lds
v_mfma_f32_16x16x32_bf16 a[168:171], a[224:227], v[8:11], a[168:171]
ds_read_b128 a[248:251], v32 offset:5120
v_add_f32 v39, v37, v38
v_mfma_f32_16x16x32_bf16 a[168:171], a[228:231], v[16:19], a[168:171]
v_subrev_f32 v38, v37, v38
v_add_f32 v37, v28, v44
v_mfma_f32_16x16x32_bf16 a[172:175], a[228:231], v[20:23], a[172:175]
s_add_u32 s53, s82, 520192
ds_read_b128 a[252:255], v32 offset:14336
v_subrev_f32 v44, v28, v44
v_mfma_f32_16x16x32_bf16 a[172:175], a[224:227], v[12:15], a[172:175]
s_waitcnt lgkmcnt(4)
v_cvt_pk_bf16_f32 v28, v39, v37
v_cvt_pk_bf16_f32 v44, v38, v44
v_mfma_f32_16x16x32_bf16 a[180:183], a[232:235], v[12:15], a[180:183]
s_add_u32 m0, s43, 77824
ds_read_b128 a[224:227], v32 offset:6144
v_lshlrev_b32 v38, 16, v45
v_mfma_f32_16x16x32_bf16 a[180:183], a[236:239], v[20:23], a[180:183]
buffer_load_dwordx4 v32, s[16:19], s53 offen sc1 lds
v_and_b32 v45, s55, v45
v_mfma_f32_16x16x32_bf16 a[176:179], a[236:239], v[16:19], a[176:179]
ds_read_b128 a[228:231], v32 offset:15360
v_lshlrev_b32 v37, 16, v29
v_mfma_f32_16x16x32_bf16 a[176:179], a[232:235], v[8:11], a[176:179]
s_waitcnt lgkmcnt(4)
v_and_b32 v29, s55, v29
v_add_f32 v39, v37, v38
v_mfma_f32_16x16x32_bf16 a[184:187], a[240:243], v[8:11], a[184:187]
ds_read_b128 a[232:235], v32 offset:7168
v_subrev_f32 v38, v37, v38
v_mfma_f32_16x16x32_bf16 a[184:187], a[244:247], v[16:19], a[184:187]
v_add_f32 v37, v29, v45
v_subrev_f32 v45, v29, v45
v_mfma_f32_16x16x32_bf16 a[188:191], a[244:247], v[20:23], a[188:191]
ds_read_b128 a[236:239], v32 offset:16384
v_cvt_pk_bf16_f32 v29, v39, v37
v_mfma_f32_16x16x32_bf16 a[188:191], a[240:243], v[12:15], a[188:191]
s_waitcnt lgkmcnt(4)
buffer_load_dwordx4 v32, s[16:19], s53 offen offset:1024 sc1 lds
v_mfma_f32_16x16x32_bf16 a[196:199], a[248:251], v[12:15], a[196:199]
ds_read_b128 a[240:243], v32 offset:8192
v_cvt_pk_bf16_f32 v45, v38, v45
v_mfma_f32_16x16x32_bf16 a[196:199], a[252:255], v[20:23], a[196:199]
v_lshlrev_b32 v38, 16, v46
v_and_b32 v46, s55, v46
v_mfma_f32_16x16x32_bf16 a[192:195], a[252:255], v[16:19], a[192:195]
ds_read_b128 a[244:247], v32 offset:17408
v_lshlrev_b32 v37, 16, v30
v_mfma_f32_16x16x32_bf16 a[192:195], a[248:251], v[8:11], a[192:195]
s_waitcnt lgkmcnt(4)
v_and_b32 v30, s55, v30
v_add_f32 v39, v37, v38
v_mfma_f32_16x16x32_bf16 a[200:203], a[224:227], v[8:11], a[200:203]
ds_read_b128 a[248:251], v32 offset:18432
v_subrev_f32 v38, v37, v38
v_mfma_f32_16x16x32_bf16 a[200:203], a[228:231], v[16:19], a[200:203]
buffer_load_dwordx4 v32, s[16:19], s53 offen offset:2048 sc1 lds
v_add_f32 v37, v30, v46
v_mfma_f32_16x16x32_bf16 a[204:207], a[228:231], v[20:23], a[204:207]
ds_read_b128 a[252:255], v32 offset:27648
v_subrev_f32 v46, v30, v46
v_mfma_f32_16x16x32_bf16 a[204:207], a[224:227], v[12:15], a[204:207]
s_waitcnt lgkmcnt(4)
v_cvt_pk_bf16_f32 v30, v39, v37
v_cvt_pk_bf16_f32 v46, v38, v46
v_mfma_f32_16x16x32_bf16 a[212:215], a[232:235], v[12:15], a[212:215]
ds_read_b128 a[224:227], v32 offset:19456
v_lshlrev_b32 v38, 16, v47
v_mfma_f32_16x16x32_bf16 a[212:215], a[236:239], v[20:23], a[212:215]
v_and_b32 v47, s55, v47
v_lshlrev_b32 v37, 16, v31
v_mfma_f32_16x16x32_bf16 a[208:211], a[236:239], v[16:19], a[208:211]
ds_read_b128 a[228:231], v32 offset:28672
v_and_b32 v31, s55, v31
v_mfma_f32_16x16x32_bf16 a[208:211], a[232:235], v[8:11], a[208:211]
s_waitcnt lgkmcnt(4)
buffer_load_dwordx4 v32, s[16:19], s53 offen offset:3072 sc1 lds
v_mfma_f32_16x16x32_bf16 a[216:219], a[240:243], v[8:11], a[216:219]
ds_read_b128 a[232:235], v32 offset:20480
v_add_f32 v39, v37, v38
v_mfma_f32_16x16x32_bf16 a[216:219], a[244:247], v[16:19], a[216:219]
v_subrev_f32 v38, v37, v38
v_add_f32 v37, v31, v47
v_mfma_f32_16x16x32_bf16 a[220:223], a[244:247], v[20:23], a[220:223]
s_add_u32 s54, s82, 524288
ds_read_b128 a[236:239], v32 offset:29696
v_subrev_f32 v47, v31, v47
v_mfma_f32_16x16x32_bf16 a[220:223], a[240:243], v[12:15], a[220:223]
s_waitcnt vmcnt(19) lgkmcnt(4)
v_cvt_pk_bf16_f32 v31, v39, v37
v_cvt_pk_bf16_f32 v47, v38, v47
v_mfma_f32_16x16x32_bf16 v[52:55], a[248:251], v[4:7], v[52:55]
s_add_u32 m0, s43, 81920
ds_read_b128 a[240:243], v32 offset:21504
v_mfma_f32_16x16x32_bf16 v[52:55], a[252:255], v[44:47], v[52:55]
buffer_load_dwordx4 v32, s[16:19], s54 offen sc1 lds
ds_read_b128 v[16:19], v34 offset:6144
v_accvgpr_read_b32 v12, a116
v_mfma_f32_16x16x32_bf16 v[48:51], a[252:255], v[40:43], v[48:51]
ds_read_b128 a[244:247], v32 offset:30720
v_accvgpr_read_b32 v13, a117
v_mfma_f32_16x16x32_bf16 v[48:51], a[248:251], v[0:3], v[48:51]
s_waitcnt lgkmcnt(5)
ds_read_b128 v[20:23], v34
v_accvgpr_read_b32 v14, a118
v_mfma_f32_16x16x32_bf16 v[56:59], a[224:227], v[0:3], v[56:59]
s_load_dword s77, s[78:79], 45056
ds_read_b128 a[248:251], v32 offset:22528
v_accvgpr_read_b32 v15, a119
v_mfma_f32_16x16x32_bf16 v[56:59], a[228:231], v[40:43], v[56:59]
ds_read_b128 a[116:119], v34
v_accvgpr_read_b32 v8, a112
v_mfma_f32_16x16x32_bf16 v[60:63], a[228:231], v[44:47], v[60:63]
ds_read_b128 a[252:255], v32 offset:31744
v_accvgpr_read_b32 v9, a113
v_mfma_f32_16x16x32_bf16 v[60:63], a[224:227], v[4:7], v[60:63]
s_waitcnt lgkmcnt(7)
v_accvgpr_read_b32 v10, a114
v_accvgpr_read_b32 v11, a115
v_mfma_f32_16x16x32_bf16 v[68:71], a[232:235], v[4:7], v[68:71]
s_add_u32 m0, s48, 1024
ds_read_b128 a[224:227], v32 offset:23552
ds_read_b128 a[112:115], v34 offset:6144
v_mfma_f32_16x16x32_bf16 v[68:71], a[236:239], v[44:47], v[68:71]
buffer_load_dwordx4 v36, s[8:11], s63 offen offset:1024 lds
v_mfma_f32_16x16x32_bf16 v[64:67], a[236:239], v[40:43], v[64:67]
ds_read_b128 a[228:231], v32 offset:32768
v_lshlrev_b32 v38, 16, v8
v_mfma_f32_16x16x32_bf16 v[64:67], a[232:235], v[0:3], v[64:67]
s_waitcnt lgkmcnt(7)
v_and_b32 v8, s55, v8
v_lshlrev_b32 v37, 16, v16
v_mfma_f32_16x16x32_bf16 v[72:75], a[240:243], v[0:3], v[72:75]
ds_read_b128 a[232:235], v32 offset:24576
v_and_b32 v16, s55, v16
v_mfma_f32_16x16x32_bf16 v[72:75], a[244:247], v[40:43], v[72:75]
v_add_f32 v39, v37, v38
v_subrev_f32 v38, v37, v38
v_mfma_f32_16x16x32_bf16 v[76:79], a[244:247], v[44:47], v[76:79]
ds_read_b128 a[236:239], v32 offset:33792
v_add_f32 v37, v16, v8
v_mfma_f32_16x16x32_bf16 v[76:79], a[240:243], v[4:7], v[76:79]
s_waitcnt lgkmcnt(5)
v_subrev_f32 v8, v16, v8
v_cvt_pk_bf16_f32 v16, v39, v37
v_mfma_f32_16x16x32_bf16 v[84:87], a[248:251], v[4:7], v[84:87]
s_add_u32 m0, s48, 2048
ds_read_b128 a[240:243], v32 offset:25600
v_cvt_pk_bf16_f32 v8, v38, v8
v_mfma_f32_16x16x32_bf16 v[84:87], a[252:255], v[44:47], v[84:87]
buffer_load_dwordx4 v36, s[8:11], s83 offen offset:1024 lds
v_mfma_f32_16x16x32_bf16 v[80:83], a[252:255], v[40:43], v[80:83]
ds_read_b128 a[244:247], v32 offset:34816
v_lshlrev_b32 v38, 16, v9
v_mfma_f32_16x16x32_bf16 v[80:83], a[248:251], v[0:3], v[80:83]
s_waitcnt lgkmcnt(4)
v_and_b32 v9, s55, v9
v_lshlrev_b32 v37, 16, v17
v_mfma_f32_16x16x32_bf16 v[88:91], a[224:227], v[0:3], v[88:91]
ds_read_b128 a[248:251], v32 offset:26624
v_and_b32 v17, s55, v17
v_mfma_f32_16x16x32_bf16 v[88:91], a[228:231], v[40:43], v[88:91]
v_add_f32 v39, v37, v38
v_subrev_f32 v38, v37, v38
v_mfma_f32_16x16x32_bf16 v[92:95], a[228:231], v[44:47], v[92:95]
s_add_u32 s52, s76, 552960
ds_read_b128 a[252:255], v32 offset:35840
v_add_f32 v37, v17, v9
v_mfma_f32_16x16x32_bf16 v[92:95], a[224:227], v[4:7], v[92:95]
s_waitcnt vmcnt(13) lgkmcnt(4)
s_barrier
v_subrev_f32 v9, v17, v9
v_cvt_pk_bf16_f32 v17, v39, v37
v_mfma_f32_16x16x32_bf16 v[100:103], a[232:235], v[4:7], v[100:103]
s_add_u32 m0, s43, 0
ds_read_b128 a[224:227], v32 offset:55296
v_cvt_pk_bf16_f32 v9, v38, v9
v_mfma_f32_16x16x32_bf16 v[100:103], a[236:239], v[44:47], v[100:103]
buffer_load_dwordx4 v32, s[16:19], s52 offen sc1 lds
v_mfma_f32_16x16x32_bf16 v[96:99], a[236:239], v[40:43], v[96:99]
L_pg10:
s_cbranch_vccnz L_vr2
ds_read_b128 a[228:231], v32 offset:64512
v_lshlrev_b32 v38, 16, v10
v_mfma_f32_16x16x32_bf16 v[96:99], a[232:235], v[0:3], v[96:99]
s_waitcnt lgkmcnt(4)
v_and_b32 v10, s55, v10
v_lshlrev_b32 v37, 16, v18
v_mfma_f32_16x16x32_bf16 v[104:107], a[240:243], v[0:3], v[104:107]
ds_read_b128 a[232:235], v32 offset:56320
v_and_b32 v18, s55, v18
v_mfma_f32_16x16x32_bf16 v[104:107], a[244:247], v[40:43], v[104:107]
v_add_f32 v39, v37, v38
v_subrev_f32 v38, v37, v38
v_mfma_f32_16x16x32_bf16 v[108:111], a[244:247], v[44:47], v[108:111]
ds_read_b128 a[236:239], v33
v_add_f32 v37, v18, v10
v_mfma_f32_16x16x32_bf16 v[108:111], a[240:243], v[4:7], v[108:111]
s_waitcnt lgkmcnt(4)
v_subrev_f32 v10, v18, v10
v_cvt_pk_bf16_f32 v18, v39, v37
v_mfma_f32_16x16x32_bf16 v[116:119], a[248:251], v[4:7], v[116:119]
ds_read_b128 a[240:243], v32 offset:57344
v_cvt_pk_bf16_f32 v10, v38, v10
v_mfma_f32_16x16x32_bf16 v[116:119], a[252:255], v[44:47], v[116:119]
buffer_load_dwordx4 v32, s[16:19], s52 offen offset:1024 sc1 lds
v_mfma_f32_16x16x32_bf16 v[112:115], a[252:255], v[40:43], v[112:115]
ds_read_b128 a[244:247], v33 offset:1024
v_lshlrev_b32 v38, 16, v11
v_mfma_f32_16x16x32_bf16 v[112:115], a[248:251], v[0:3], v[112:115]
s_waitcnt lgkmcnt(4)
v_and_b32 v11, s55, v11
v_lshlrev_b32 v37, 16, v19
v_mfma_f32_16x16x32_bf16 v[120:123], a[224:227], v[0:3], v[120:123]
ds_read_b128 a[248:251], v32 offset:58368
v_and_b32 v19, s55, v19
v_mfma_f32_16x16x32_bf16 v[120:123], a[228:231], v[40:43], v[120:123]
v_add_f32 v39, v37, v38
v_subrev_f32 v38, v37, v38
v_add_f32 v37, v19, v11
v_mfma_f32_16x16x32_bf16 v[124:127], a[228:231], v[44:47], v[124:127]
ds_read_b128 a[252:255], v33 offset:2048
v_subrev_f32 v11, v19, v11
v_mfma_f32_16x16x32_bf16 v[124:127], a[224:227], v[4:7], v[124:127]
s_waitcnt lgkmcnt(4)
v_cvt_pk_bf16_f32 v19, v39, v37
v_cvt_pk_bf16_f32 v11, v38, v11
v_mfma_f32_16x16x32_bf16 v[132:135], a[232:235], v[4:7], v[132:135]
ds_read_b128 a[224:227], v32 offset:59392
v_lshlrev_b32 v38, 16, v12
v_mfma_f32_16x16x32_bf16 v[132:135], a[236:239], v[44:47], v[132:135]
buffer_load_dwordx4 v32, s[16:19], s52 offen offset:2048 sc1 lds
v_mfma_f32_16x16x32_bf16 v[128:131], a[236:239], v[40:43], v[128:131]
ds_read_b128 a[228:231], v33 offset:3072
v_and_b32 v12, s55, v12
v_mfma_f32_16x16x32_bf16 v[128:131], a[232:235], v[0:3], v[128:131]
s_waitcnt lgkmcnt(4)
v_lshlrev_b32 v37, 16, v20
v_and_b32 v20, s55, v20
v_mfma_f32_16x16x32_bf16 v[136:139], a[240:243], v[0:3], v[136:139]
ds_read_b128 a[232:235], v32 offset:60416
v_add_f32 v39, v37, v38
v_mfma_f32_16x16x32_bf16 v[136:139], a[244:247], v[40:43], v[136:139]
v_subrev_f32 v38, v37, v38
v_add_f32 v37, v20, v12
v_mfma_f32_16x16x32_bf16 v[140:143], a[244:247], v[44:47], v[140:143]
ds_read_b128 a[236:239], v33 offset:4096
v_subrev_f32 v12, v20, v12
v_mfma_f32_16x16x32_bf16 v[140:143], a[240:243], v[4:7], v[140:143]
s_waitcnt lgkmcnt(4)
v_cvt_pk_bf16_f32 v20, v39, v37
v_cvt_pk_bf16_f32 v12, v38, v12
v_mfma_f32_16x16x32_bf16 v[148:151], a[248:251], v[4:7], v[148:151]
ds_read_b128 a[240:243], v32 offset:61440
v_lshlrev_b32 v38, 16, v13
v_mfma_f32_16x16x32_bf16 v[148:151], a[252:255], v[44:47], v[148:151]
buffer_load_dwordx4 v32, s[16:19], s52 offen offset:3072 sc1 lds
v_mfma_f32_16x16x32_bf16 v[144:147], a[252:255], v[40:43], v[144:147]
ds_read_b128 a[244:247], v33 offset:5120
v_and_b32 v13, s55, v13
v_mfma_f32_16x16x32_bf16 v[144:147], a[248:251], v[0:3], v[144:147]
s_waitcnt lgkmcnt(4)
v_lshlrev_b32 v37, 16, v21
v_and_b32 v21, s55, v21
v_mfma_f32_16x16x32_bf16 v[152:155], a[224:227], v[0:3], v[152:155]
ds_read_b128 a[248:251], v32 offset:62464
v_add_f32 v39, v37, v38
v_mfma_f32_16x16x32_bf16 v[152:155], a[228:231], v[40:43], v[152:155]
v_subrev_f32 v38, v37, v38
v_add_f32 v37, v21, v13
v_mfma_f32_16x16x32_bf16 v[156:159], a[228:231], v[44:47], v[156:159]
s_add_u32 s53, s76, 557056
ds_read_b128 a[252:255], v33 offset:6144
v_subrev_f32 v13, v21, v13
v_mfma_f32_16x16x32_bf16 v[156:159], a[224:227], v[4:7], v[156:159]
s_waitcnt lgkmcnt(4)
v_cvt_pk_bf16_f32 v21, v39, v37
v_cvt_pk_bf16_f32 v13, v38, v13
v_mfma_f32_16x16x32_bf16 v[164:167], a[232:235], v[4:7], v[164:167]
s_add_u32 m0, s43, 4096
ds_read_b128 a[224:227], v32 offset:63488
v_lshlrev_b32 v38, 16, v14
v_mfma_f32_16x16x32_bf16 v[164:167], a[236:239], v[44:47], v[164:167]
buffer_load_dwordx4 v32, s[16:19], s53 offen sc1 lds
v_mfma_f32_16x16x32_bf16 v[160:163], a[236:239], v[40:43], v[160:163]
ds_read_b128 a[228:231], v33 offset:7168
v_and_b32 v14, s55, v14
v_mfma_f32_16x16x32_bf16 v[160:163], a[232:235], v[0:3], v[160:163]
s_waitcnt lgkmcnt(4)
v_lshlrev_b32 v37, 16, v22
v_and_b32 v22, s55, v22
v_mfma_f32_16x16x32_bf16 v[168:171], a[240:243], v[0:3], v[168:171]
ds_read_b128 a[232:235], v32 offset:36864
v_add_f32 v39, v37, v38
v_mfma_f32_16x16x32_bf16 v[168:171], a[244:247], v[40:43], v[168:171]
v_subrev_f32 v38, v37, v38
v_add_f32 v37, v22, v14
v_mfma_f32_16x16x32_bf16 v[172:175], a[244:247], v[44:47], v[172:175]
ds_read_b128 a[236:239], v32 offset:46080
v_subrev_f32 v14, v22, v14
v_mfma_f32_16x16x32_bf16 v[172:175], a[240:243], v[4:7], v[172:175]
s_waitcnt lgkmcnt(4)
v_cvt_pk_bf16_f32 v22, v39, v37
v_cvt_pk_bf16_f32 v14, v38, v14
v_mfma_f32_16x16x32_bf16 v[180:183], a[248:251], v[4:7], v[180:183]
ds_read_b128 a[240:243], v32 offset:37888
v_lshlrev_b32 v38, 16, v15
v_mfma_f32_16x16x32_bf16 v[180:183], a[252:255], v[44:47], v[180:183]
buffer_load_dwordx4 v32, s[16:19], s53 offen offset:1024 sc1 lds
v_mfma_f32_16x16x32_bf16 v[176:179], a[252:255], v[40:43], v[176:179]
ds_read_b128 a[244:247], v32 offset:47104
v_and_b32 v15, s55, v15
v_mfma_f32_16x16x32_bf16 v[176:179], a[248:251], v[0:3], v[176:179]
s_waitcnt lgkmcnt(4)
v_lshlrev_b32 v37, 16, v23
v_and_b32 v23, s55, v23
v_mfma_f32_16x16x32_bf16 v[184:187], a[224:227], v[0:3], v[184:187]
ds_read_b128 a[248:251], v32 offset:38912
v_add_f32 v39, v37, v38
v_mfma_f32_16x16x32_bf16 v[184:187], a[228:231], v[40:43], v[184:187]
v_subrev_f32 v38, v37, v38
v_add_f32 v37, v23, v15
v_mfma_f32_16x16x32_bf16 v[188:191], a[228:231], v[44:47], v[188:191]
ds_read_b128 a[252:255], v32 offset:48128
v_subrev_f32 v15, v23, v15
v_mfma_f32_16x16x32_bf16 v[188:191], a[224:227], v[4:7], v[188:191]
s_waitcnt lgkmcnt(4)
v_cvt_pk_bf16_f32 v23, v39, v37
v_cvt_pk_bf16_f32 v15, v38, v15
v_mfma_f32_16x16x32_bf16 v[196:199], a[232:235], v[28:31], v[196:199]
ds_read_b128 a[224:227], v32 offset:39936
v_mfma_f32_16x16x32_bf16 v[196:199], a[236:239], v[20:23], v[196:199]
buffer_load_dwordx4 v32, s[16:19], s53 offen offset:2048 sc1 lds
ds_read_b128 v[40:43], v35 offset:6144
v_accvgpr_read_b32 v4, a124
v_mfma_f32_16x16x32_bf16 v[192:195], a[236:239], v[16:19], v[192:195]
ds_read_b128 a[228:231], v32 offset:49152
v_accvgpr_read_b32 v5, a125
v_mfma_f32_16x16x32_bf16 v[192:195], a[232:235], v[24:27], v[192:195]
s_waitcnt lgkmcnt(5)
ds_read_b128 v[44:47], v35
v_accvgpr_read_b32 v6, a126
v_mfma_f32_16x16x32_bf16 v[200:203], a[240:243], v[24:27], v[200:203]
ds_read_b128 a[232:235], v32 offset:40960
v_accvgpr_read_b32 v7, a127
v_mfma_f32_16x16x32_bf16 v[200:203], a[244:247], v[16:19], v[200:203]
ds_read_b128 a[124:127], v35
v_accvgpr_read_b32 v0, a120
v_mfma_f32_16x16x32_bf16 v[204:207], a[244:247], v[20:23], v[204:207]
ds_read_b128 a[236:239], v32 offset:50176
v_accvgpr_read_b32 v1, a121
v_mfma_f32_16x16x32_bf16 v[204:207], a[240:243], v[28:31], v[204:207]
s_waitcnt lgkmcnt(7)
v_accvgpr_read_b32 v2, a122
v_accvgpr_read_b32 v3, a123
v_mfma_f32_16x16x32_bf16 v[212:215], a[248:251], v[28:31], v[212:215]
ds_read_b128 a[240:243], v32 offset:41984
ds_read_b128 a[120:123], v35 offset:6144
v_mfma_f32_16x16x32_bf16 v[212:215], a[252:255], v[20:23], v[212:215]
buffer_load_dwordx4 v32, s[16:19], s53 offen offset:3072 sc1 lds
v_mfma_f32_16x16x32_bf16 v[208:211], a[252:255], v[16:19], v[208:211]
ds_read_b128 a[244:247], v32 offset:51200
v_lshlrev_b32 v38, 16, v0
v_mfma_f32_16x16x32_bf16 v[208:211], a[248:251], v[24:27], v[208:211]
s_waitcnt lgkmcnt(7)
v_and_b32 v0, s55, v0
v_lshlrev_b32 v37, 16, v40
v_mfma_f32_16x16x32_bf16 v[216:219], a[224:227], v[24:27], v[216:219]
ds_read_b128 a[248:251], v32 offset:43008
v_and_b32 v40, s55, v40
v_mfma_f32_16x16x32_bf16 v[216:219], a[228:231], v[16:19], v[216:219]
v_add_f32 v39, v37, v38
v_subrev_f32 v38, v37, v38
v_mfma_f32_16x16x32_bf16 v[220:223], a[228:231], v[20:23], v[220:223]
s_add_u32 s54, s76, 561152
ds_read_b128 a[252:255], v32 offset:52224
v_add_f32 v37, v40, v0
v_mfma_f32_16x16x32_bf16 v[220:223], a[224:227], v[28:31], v[220:223]
s_waitcnt lgkmcnt(5)
v_subrev_f32 v0, v40, v0
v_cvt_pk_bf16_f32 v40, v39, v37
v_mfma_f32_16x16x32_bf16 v[228:231], a[232:235], v[28:31], v[228:231]
s_add_u32 m0, s43, 8192
ds_read_b128 a[224:227], v32 offset:44032
v_cvt_pk_bf16_f32 v0, v38, v0
v_mfma_f32_16x16x32_bf16 v[228:231], a[236:239], v[20:23], v[228:231]
buffer_load_dwordx4 v32, s[16:19], s54 offen sc1 lds
v_mfma_f32_16x16x32_bf16 v[224:227], a[236:239], v[16:19], v[224:227]
ds_read_b128 a[228:231], v32 offset:53248
v_lshlrev_b32 v38, 16, v1
v_mfma_f32_16x16x32_bf16 v[224:227], a[232:235], v[24:27], v[224:227]
s_waitcnt lgkmcnt(4)
v_and_b32 v1, s55, v1
v_lshlrev_b32 v37, 16, v41
v_mfma_f32_16x16x32_bf16 v[232:235], a[240:243], v[24:27], v[232:235]
ds_read_b128 a[232:235], v32 offset:45056
v_and_b32 v41, s55, v41
v_mfma_f32_16x16x32_bf16 v[232:235], a[244:247], v[16:19], v[232:235]
v_add_f32 v39, v37, v38
v_subrev_f32 v38, v37, v38
v_mfma_f32_16x16x32_bf16 v[236:239], a[244:247], v[20:23], v[236:239]
s_add_u32 s52, s69, 589824
ds_read_b128 a[236:239], v32 offset:54272
v_add_f32 v37, v41, v1
v_mfma_f32_16x16x32_bf16 v[236:239], a[240:243], v[28:31], v[236:239]
s_waitcnt vmcnt(11) lgkmcnt(4)
s_barrier
v_subrev_f32 v1, v41, v1
v_cvt_pk_bf16_f32 v41, v39, v37
v_mfma_f32_16x16x32_bf16 v[244:247], a[248:251], v[28:31], v[244:247]
s_add_u32 m0, s43, 36864
ds_read_b128 a[240:243], v33 offset:8192
v_cvt_pk_bf16_f32 v1, v38, v1
v_mfma_f32_16x16x32_bf16 v[244:247], a[252:255], v[20:23], v[244:247]
buffer_load_dwordx4 v32, s[16:19], s52 offen sc1 lds
v_mfma_f32_16x16x32_bf16 v[240:243], a[252:255], v[16:19], v[240:243]
ds_read_b128 a[244:247], v33 offset:17408
v_lshlrev_b32 v38, 16, v2
v_mfma_f32_16x16x32_bf16 v[240:243], a[248:251], v[24:27], v[240:243]
s_waitcnt lgkmcnt(4)
v_and_b32 v2, s55, v2
v_lshlrev_b32 v37, 16, v42
v_mfma_f32_16x16x32_bf16 v[248:251], a[224:227], v[24:27], v[248:251]
ds_read_b128 a[248:251], v33 offset:9216
v_and_b32 v42, s55, v42
v_mfma_f32_16x16x32_bf16 v[248:251], a[228:231], v[16:19], v[248:251]
v_add_f32 v39, v37, v38
v_subrev_f32 v38, v37, v38
v_mfma_f32_16x16x32_bf16 v[252:255], a[228:231], v[20:23], v[252:255]
ds_read_b128 a[252:255], v33 offset:18432
v_add_f32 v37, v42, v2
v_mfma_f32_16x16x32_bf16 v[252:255], a[224:227], v[28:31], v[252:255]
s_waitcnt lgkmcnt(4)
v_subrev_f32 v2, v42, v2
v_cvt_pk_bf16_f32 v42, v39, v37
v_mfma_f32_16x16x32_bf16 a[148:151], a[232:235], v[28:31], a[148:151]
ds_read_b128 a[224:227], v33 offset:10240
v_cvt_pk_bf16_f32 v2, v38, v2
v_mfma_f32_16x16x32_bf16 a[148:151], a[236:239], v[20:23], a[148:151]
buffer_load_dwordx4 v32, s[16:19], s52 offen offset:1024 sc1 lds
v_mfma_f32_16x16x32_bf16 a[144:147], a[236:239], v[16:19], a[144:147]
ds_read_b128 a[228:231], v33 offset:19456
v_lshlrev_b32 v38, 16, v3
v_mfma_f32_16x16x32_bf16 a[144:147], a[232:235], v[24:27], a[144:147]
s_waitcnt lgkmcnt(4)
v_and_b32 v3, s55, v3
v_lshlrev_b32 v37, 16, v43
v_mfma_f32_16x16x32_bf16 a[152:155], a[240:243], v[24:27], a[152:155]
ds_read_b128 a[232:235], v33 offset:11264
v_and_b32 v43, s55, v43
v_mfma_f32_16x16x32_bf16 a[152:155], a[244:247], v[16:19], a[152:155]
v_add_f32 v39, v37, v38
v_subrev_f32 v38, v37, v38
v_add_f32 v37, v43, v3
v_mfma_f32_16x16x32_bf16 a[156:159], a[244:247], v[20:23], a[156:159]
ds_read_b128 a[236:239], v33 offset:20480
v_subrev_f32 v3, v43, v3
v_mfma_f32_16x16x32_bf16 a[156:159], a[240:243], v[28:31], a[156:159]
s_waitcnt lgkmcnt(4)
v_cvt_pk_bf16_f32 v43, v39, v37
v_cvt_pk_bf16_f32 v3, v38, v3
v_mfma_f32_16x16x32_bf16 a[164:167], a[248:251], v[28:31], a[164:167]
ds_read_b128 a[240:243], v33 offset:12288
v_lshlrev_b32 v38, 16, v4
v_mfma_f32_16x16x32_bf16 a[164:167], a[252:255], v[20:23], a[164:167]
buffer_load_dwordx4 v32, s[16:19], s52 offen offset:2048 sc1 lds
v_mfma_f32_16x16x32_bf16 a[160:163], a[252:255], v[16:19], a[160:163]
ds_read_b128 a[244:247], v33 offset:21504
v_and_b32 v4, s55, v4
v_mfma_f32_16x16x32_bf16 a[160:163], a[248:251], v[24:27], a[160:163]
s_waitcnt lgkmcnt(4)
v_lshlrev_b32 v37, 16, v44
v_and_b32 v44, s55, v44
v_mfma_f32_16x16x32_bf16 a[168:171], a[224:227], v[24:27], a[168:171]
ds_read_b128 a[248:251], v33 offset:13312
v_add_f32 v39, v37, v38
v_mfma_f32_16x16x32_bf16 a[168:171], a[228:231], v[16:19], a[168:171]
v_subrev_f32 v38, v37, v38
v_add_f32 v37, v44, v4
v_mfma_f32_16x16x32_bf16 a[172:175], a[228:231], v[20:23], a[172:175]
ds_read_b128 a[252:255], v33 offset:22528
v_subrev_f32 v4, v44, v4
v_mfma_f32_16x16x32_bf16 a[172:175], a[224:227], v[28:31], a[172:175]
s_waitcnt lgkmcnt(4)
v_cvt_pk_bf16_f32 v44, v39, v37
v_cvt_pk_bf16_f32 v4, v38, v4
v_mfma_f32_16x16x32_bf16 a[180:183], a[232:235], v[28:31], a[180:183]
ds_read_b128 a[224:227], v33 offset:14336
v_lshlrev_b32 v38, 16, v5
v_mfma_f32_16x16x32_bf16 a[180:183], a[236:239], v[20:23], a[180:183]
buffer_load_dwordx4 v32, s[16:19], s52 offen offset:3072 sc1 lds
v_mfma_f32_16x16x32_bf16 a[176:179], a[236:239], v[16:19], a[176:179]
ds_read_b128 a[228:231], v33 offset:23552
v_and_b32 v5, s55, v5
v_mfma_f32_16x16x32_bf16 a[176:179], a[232:235], v[24:27], a[176:179]
s_waitcnt lgkmcnt(4)
v_lshlrev_b32 v37, 16, v45
v_and_b32 v45, s55, v45
v_mfma_f32_16x16x32_bf16 a[184:187], a[240:243], v[24:27], a[184:187]
ds_read_b128 a[232:235], v33 offset:15360
v_add_f32 v39, v37, v38
v_mfma_f32_16x16x32_bf16 a[184:187], a[244:247], v[16:19], a[184:187]
v_subrev_f32 v38, v37, v38
v_add_f32 v37, v45, v5
v_mfma_f32_16x16x32_bf16 a[188:191], a[244:247], v[20:23], a[188:191]
s_add_u32 s53, s69, 593920
ds_read_b128 a[236:239], v33 offset:24576
v_subrev_f32 v5, v45, v5
v_mfma_f32_16x16x32_bf16 a[188:191], a[240:243], v[28:31], a[188:191]
s_waitcnt lgkmcnt(4)
v_cvt_pk_bf16_f32 v45, v39, v37
v_cvt_pk_bf16_f32 v5, v38, v5
v_mfma_f32_16x16x32_bf16 a[196:199], a[248:251], v[28:31], a[196:199]
s_add_u32 m0, s43, 40960
ds_read_b128 a[240:243], v33 offset:16384
v_lshlrev_b32 v38, 16, v6
v_mfma_f32_16x16x32_bf16 a[196:199], a[252:255], v[20:23], a[196:199]
buffer_load_dwordx4 v32, s[16:19], s53 offen sc1 lds
v_mfma_f32_16x16x32_bf16 a[192:195], a[252:255], v[16:19], a[192:195]
ds_read_b128 a[244:247], v33 offset:25600
v_and_b32 v6, s55, v6
v_mfma_f32_16x16x32_bf16 a[192:195], a[248:251], v[24:27], a[192:195]
s_waitcnt lgkmcnt(4)
v_lshlrev_b32 v37, 16, v46
v_and_b32 v46, s55, v46
v_mfma_f32_16x16x32_bf16 a[200:203], a[224:227], v[24:27], a[200:203]
ds_read_b128 a[248:251], v33 offset:26624
v_add_f32 v39, v37, v38
v_mfma_f32_16x16x32_bf16 a[200:203], a[228:231], v[16:19], a[200:203]
v_subrev_f32 v38, v37, v38
v_add_f32 v37, v46, v6
v_mfma_f32_16x16x32_bf16 a[204:207], a[228:231], v[20:23], a[204:207]
ds_read_b128 a[252:255], v33 offset:35840
v_subrev_f32 v6, v46, v6
v_mfma_f32_16x16x32_bf16 a[204:207], a[224:227], v[28:31], a[204:207]
s_waitcnt lgkmcnt(4)
v_cvt_pk_bf16_f32 v46, v39, v37
v_cvt_pk_bf16_f32 v6, v38, v6
v_mfma_f32_16x16x32_bf16 a[212:215], a[232:235], v[28:31], a[212:215]
ds_read_b128 a[224:227], v33 offset:27648
v_lshlrev_b32 v38, 16, v7
v_mfma_f32_16x16x32_bf16 a[212:215], a[236:239], v[20:23], a[212:215]
buffer_load_dwordx4 v32, s[16:19], s53 offen offset:1024 sc1 lds
v_mfma_f32_16x16x32_bf16 a[208:211], a[236:239], v[16:19], a[208:211]
ds_read_b128 a[228:231], v33 offset:36864
v_and_b32 v7, s55, v7
v_mfma_f32_16x16x32_bf16 a[208:211], a[232:235], v[24:27], a[208:211]
s_waitcnt lgkmcnt(4)
v_lshlrev_b32 v37, 16, v47
v_and_b32 v47, s55, v47
v_mfma_f32_16x16x32_bf16 a[216:219], a[240:243], v[24:27], a[216:219]
ds_read_b128 a[232:235], v33 offset:28672
v_add_f32 v39, v37, v38
v_mfma_f32_16x16x32_bf16 a[216:219], a[244:247], v[16:19], a[216:219]
v_subrev_f32 v38, v37, v38
v_add_f32 v37, v47, v7
v_mfma_f32_16x16x32_bf16 a[220:223], a[244:247], v[20:23], a[220:223]
ds_read_b128 a[236:239], v33 offset:37888
v_subrev_f32 v7, v47, v7
v_mfma_f32_16x16x32_bf16 a[220:223], a[240:243], v[28:31], a[220:223]
s_waitcnt vmcnt(15) lgkmcnt(4)
v_cvt_pk_bf16_f32 v47, v39, v37
v_cvt_pk_bf16_f32 v7, v38, v7
v_mfma_f32_16x16x32_bf16 v[52:55], a[248:251], v[12:15], v[52:55]
ds_read_b128 a[240:243], v33 offset:29696
v_mfma_f32_16x16x32_bf16 v[52:55], a[252:255], v[4:7], v[52:55]
buffer_load_dwordx4 v32, s[16:19], s53 offen offset:2048 sc1 lds
ds_read_b128 v[24:27], v34 offset:4096
v_accvgpr_read_b32 v20, a132
v_mfma_f32_16x16x32_bf16 v[48:51], a[252:255], v[0:3], v[48:51]
ds_read_b128 a[244:247], v33 offset:38912
v_accvgpr_read_b32 v21, a133
v_mfma_f32_16x16x32_bf16 v[48:51], a[248:251], v[8:11], v[48:51]
s_waitcnt lgkmcnt(5)
ds_read_b128 v[28:31], v34 offset:2048
v_accvgpr_read_b32 v22, a134
v_mfma_f32_16x16x32_bf16 v[56:59], a[224:227], v[8:11], v[56:59]
ds_read_b128 a[248:251], v33 offset:30720
v_accvgpr_read_b32 v23, a135
v_mfma_f32_16x16x32_bf16 v[56:59], a[228:231], v[0:3], v[56:59]
ds_read_b128 a[132:135], v34 offset:2048
v_accvgpr_read_b32 v16, a128
v_mfma_f32_16x16x32_bf16 v[60:63], a[228:231], v[4:7], v[60:63]
ds_read_b128 a[252:255], v33 offset:39936
v_accvgpr_read_b32 v17, a129
v_mfma_f32_16x16x32_bf16 v[60:63], a[224:227], v[12:15], v[60:63]
s_waitcnt lgkmcnt(7)
v_accvgpr_read_b32 v18, a130
v_accvgpr_read_b32 v19, a131
v_mfma_f32_16x16x32_bf16 v[68:71], a[232:235], v[12:15], v[68:71]
ds_read_b128 a[224:227], v33 offset:31744
ds_read_b128 a[128:131], v34 offset:4096
v_mfma_f32_16x16x32_bf16 v[68:71], a[236:239], v[4:7], v[68:71]
buffer_load_dwordx4 v32, s[16:19], s53 offen offset:3072 sc1 lds
v_mfma_f32_16x16x32_bf16 v[64:67], a[236:239], v[0:3], v[64:67]
ds_read_b128 a[228:231], v33 offset:40960
v_lshlrev_b32 v38, 16, v16
v_mfma_f32_16x16x32_bf16 v[64:67], a[232:235], v[8:11], v[64:67]
s_waitcnt lgkmcnt(7)
v_and_b32 v16, s55, v16
v_lshlrev_b32 v37, 16, v24
v_mfma_f32_16x16x32_bf16 v[72:75], a[240:243], v[8:11], v[72:75]
ds_read_b128 a[232:235], v33 offset:32768
v_and_b32 v24, s55, v24
v_mfma_f32_16x16x32_bf16 v[72:75], a[244:247], v[0:3], v[72:75]
v_add_f32 v39, v37, v38
v_subrev_f32 v38, v37, v38
v_mfma_f32_16x16x32_bf16 v[76:79], a[244:247], v[4:7], v[76:79]
s_add_u32 s54, s69, 598016
ds_read_b128 a[236:239], v33 offset:41984
v_add_f32 v37, v24, v16
v_mfma_f32_16x16x32_bf16 v[76:79], a[240:243], v[12:15], v[76:79]
s_waitcnt lgkmcnt(5)
v_subrev_f32 v16, v24, v16
v_cvt_pk_bf16_f32 v24, v39, v37
v_mfma_f32_16x16x32_bf16 v[84:87], a[248:251], v[12:15], v[84:87]
s_add_u32 m0, s43, 45056
ds_read_b128 a[240:243], v33 offset:33792
v_cvt_pk_bf16_f32 v16, v38, v16
v_mfma_f32_16x16x32_bf16 v[84:87], a[252:255], v[4:7], v[84:87]
buffer_load_dwordx4 v32, s[16:19], s54 offen sc1 lds
v_mfma_f32_16x16x32_bf16 v[80:83], a[252:255], v[0:3], v[80:83]
ds_read_b128 a[244:247], v33 offset:43008
v_lshlrev_b32 v38, 16, v17
v_mfma_f32_16x16x32_bf16 v[80:83], a[248:251], v[8:11], v[80:83]
s_waitcnt lgkmcnt(4)
v_and_b32 v17, s55, v17
v_lshlrev_b32 v37, 16, v25
v_mfma_f32_16x16x32_bf16 v[88:91], a[224:227], v[8:11], v[88:91]
ds_read_b128 a[248:251], v33 offset:34816
v_and_b32 v25, s55, v25
v_mfma_f32_16x16x32_bf16 v[88:91], a[228:231], v[0:3], v[88:91]
v_add_f32 v39, v37, v38
v_subrev_f32 v38, v37, v38
v_mfma_f32_16x16x32_bf16 v[92:95], a[228:231], v[4:7], v[92:95]
s_add_u32 s52, s47, 626688
ds_read_b128 a[252:255], v33 offset:44032
v_add_f32 v37, v25, v17
v_mfma_f32_16x16x32_bf16 v[92:95], a[224:227], v[12:15], v[92:95]
s_waitcnt vmcnt(9) lgkmcnt(4)
s_barrier
v_subrev_f32 v17, v25, v17
v_cvt_pk_bf16_f32 v25, v39, v37
v_mfma_f32_16x16x32_bf16 v[100:103], a[232:235], v[12:15], v[100:103]
s_add_u32 m0, s43, 73728
ds_read_b128 a[224:227], v32 offset:18432
v_cvt_pk_bf16_f32 v17, v38, v17
v_mfma_f32_16x16x32_bf16 v[100:103], a[236:239], v[4:7], v[100:103]
buffer_load_dwordx4 v32, s[16:19], s52 offen sc1 lds
v_mfma_f32_16x16x32_bf16 v[96:99], a[236:239], v[0:3], v[96:99]
ds_read_b128 a[228:231], v32 offset:27648
v_lshlrev_b32 v38, 16, v18
v_mfma_f32_16x16x32_bf16 v[96:99], a[232:235], v[8:11], v[96:99]
s_waitcnt lgkmcnt(4)
v_and_b32 v18, s55, v18
v_lshlrev_b32 v37, 16, v26
v_mfma_f32_16x16x32_bf16 v[104:107], a[240:243], v[8:11], v[104:107]
ds_read_b128 a[232:235], v32 offset:19456
v_and_b32 v26, s55, v26
v_mfma_f32_16x16x32_bf16 v[104:107], a[244:247], v[0:3], v[104:107]
v_add_f32 v39, v37, v38
v_subrev_f32 v38, v37, v38
v_mfma_f32_16x16x32_bf16 v[108:111], a[244:247], v[4:7], v[108:111]
ds_read_b128 a[236:239], v32 offset:28672
v_add_f32 v37, v26, v18
v_mfma_f32_16x16x32_bf16 v[108:111], a[240:243], v[12:15], v[108:111]
s_waitcnt lgkmcnt(4)
v_subrev_f32 v18, v26, v18
v_cvt_pk_bf16_f32 v26, v39, v37
v_mfma_f32_16x16x32_bf16 v[116:119], a[248:251], v[12:15], v[116:119]
ds_read_b128 a[240:243], v32 offset:20480
v_cvt_pk_bf16_f32 v18, v38, v18
v_mfma_f32_16x16x32_bf16 v[116:119], a[252:255], v[4:7], v[116:119]
buffer_load_dwordx4 v32, s[16:19], s52 offen offset:1024 sc1 lds
v_mfma_f32_16x16x32_bf16 v[112:115], a[252:255], v[0:3], v[112:115]
ds_read_b128 a[244:247], v32 offset:29696
v_lshlrev_b32 v38, 16, v19
v_mfma_f32_16x16x32_bf16 v[112:115], a[248:251], v[8:11], v[112:115]
s_waitcnt lgkmcnt(4)
v_and_b32 v19, s55, v19
v_lshlrev_b32 v37, 16, v27
v_mfma_f32_16x16x32_bf16 v[120:123], a[224:227], v[8:11], v[120:123]
ds_read_b128 a[248:251], v32 offset:21504
v_and_b32 v27, s55, v27
v_mfma_f32_16x16x32_bf16 v[120:123], a[228:231], v[0:3], v[120:123]
v_add_f32 v39, v37, v38
v_subrev_f32 v38, v37, v38
v_add_f32 v37, v27, v19
v_mfma_f32_16x16x32_bf16 v[124:127], a[228:231], v[4:7], v[124:127]
ds_read_b128 a[252:255], v32 offset:30720
v_subrev_f32 v19, v27, v19
v_mfma_f32_16x16x32_bf16 v[124:127], a[224:227], v[12:15], v[124:127]
s_waitcnt lgkmcnt(4)
v_cvt_pk_bf16_f32 v27, v39, v37
v_cvt_pk_bf16_f32 v19, v38, v19
v_mfma_f32_16x16x32_bf16 v[132:135], a[232:235], v[12:15], v[132:135]
s_load_dword s77, s[78:79], 49152
ds_read_b128 a[224:227], v32 offset:22528
v_lshlrev_b32 v38, 16, v20
v_mfma_f32_16x16x32_bf16 v[132:135], a[236:239], v[4:7], v[132:135]
buffer_load_dwordx4 v32, s[16:19], s52 offen offset:2048 sc1 lds
v_mfma_f32_16x16x32_bf16 v[128:131], a[236:239], v[0:3], v[128:131]
ds_read_b128 a[228:231], v32 offset:31744
v_and_b32 v20, s55, v20
v_mfma_f32_16x16x32_bf16 v[128:131], a[232:235], v[8:11], v[128:131]
s_waitcnt lgkmcnt(4)
v_lshlrev_b32 v37, 16, v28
v_and_b32 v28, s55, v28
v_mfma_f32_16x16x32_bf16 v[136:139], a[240:243], v[8:11], v[136:139]
ds_read_b128 a[232:235], v32 offset:23552
v_add_f32 v39, v37, v38
v_mfma_f32_16x16x32_bf16 v[136:139], a[244:247], v[0:3], v[136:139]
v_subrev_f32 v38, v37, v38
v_add_f32 v37, v28, v20
v_mfma_f32_16x16x32_bf16 v[140:143], a[244:247], v[4:7], v[140:143]
ds_read_b128 a[236:239], v32 offset:32768
v_subrev_f32 v20, v28, v20
v_mfma_f32_16x16x32_bf16 v[140:143], a[240:243], v[12:15], v[140:143]
s_waitcnt lgkmcnt(4)
v_cvt_pk_bf16_f32 v28, v39, v37
v_cvt_pk_bf16_f32 v20, v38, v20
v_mfma_f32_16x16x32_bf16 v[148:151], a[248:251], v[12:15], v[148:151]
ds_read_b128 a[240:243], v32 offset:24576
v_lshlrev_b32 v38, 16, v21
v_mfma_f32_16x16x32_bf16 v[148:151], a[252:255], v[4:7], v[148:151]
buffer_load_dwordx4 v32, s[16:19], s52 offen offset:3072 sc1 lds
v_mfma_f32_16x16x32_bf16 v[144:147], a[252:255], v[0:3], v[144:147]
ds_read_b128 a[244:247], v32 offset:33792
v_and_b32 v21, s55, v21
v_mfma_f32_16x16x32_bf16 v[144:147], a[248:251], v[8:11], v[144:147]
s_waitcnt lgkmcnt(4)
v_lshlrev_b32 v37, 16, v29
v_and_b32 v29, s55, v29
v_mfma_f32_16x16x32_bf16 v[152:155], a[224:227], v[8:11], v[152:155]
ds_read_b128 a[248:251], v32 offset:25600
v_add_f32 v39, v37, v38
v_mfma_f32_16x16x32_bf16 v[152:155], a[228:231], v[0:3], v[152:155]
v_subrev_f32 v38, v37, v38
v_add_f32 v37, v29, v21
v_mfma_f32_16x16x32_bf16 v[156:159], a[228:231], v[4:7], v[156:159]
s_add_u32 s53, s47, 630784
ds_read_b128 a[252:255], v32 offset:34816
v_subrev_f32 v21, v29, v21
v_mfma_f32_16x16x32_bf16 v[156:159], a[224:227], v[12:15], v[156:159]
s_waitcnt lgkmcnt(4)
v_cvt_pk_bf16_f32 v29, v39, v37
v_cvt_pk_bf16_f32 v21, v38, v21
v_mfma_f32_16x16x32_bf16 v[164:167], a[232:235], v[12:15], v[164:167]
s_add_u32 m0, s43, 77824
ds_read_b128 a[224:227], v32 offset:26624
v_lshlrev_b32 v38, 16, v22
v_mfma_f32_16x16x32_bf16 v[164:167], a[236:239], v[4:7], v[164:167]
buffer_load_dwordx4 v32, s[16:19], s53 offen sc1 lds
v_mfma_f32_16x16x32_bf16 v[160:163], a[236:239], v[0:3], v[160:163]
ds_read_b128 a[228:231], v32 offset:35840
v_and_b32 v22, s55, v22
v_mfma_f32_16x16x32_bf16 v[160:163], a[232:235], v[8:11], v[160:163]
s_waitcnt lgkmcnt(4)
v_lshlrev_b32 v37, 16, v30
v_and_b32 v30, s55, v30
v_mfma_f32_16x16x32_bf16 v[168:171], a[240:243], v[8:11], v[168:171]
ds_read_b128 a[232:235], v32
v_add_f32 v39, v37, v38
v_mfma_f32_16x16x32_bf16 v[168:171], a[244:247], v[0:3], v[168:171]
v_subrev_f32 v38, v37, v38
v_add_f32 v37, v30, v22
v_mfma_f32_16x16x32_bf16 v[172:175], a[244:247], v[4:7], v[172:175]
ds_read_b128 a[236:239], v32 offset:9216
v_subrev_f32 v22, v30, v22
v_mfma_f32_16x16x32_bf16 v[172:175], a[240:243], v[12:15], v[172:175]
s_waitcnt lgkmcnt(4)
v_cvt_pk_bf16_f32 v30, v39, v37
v_cvt_pk_bf16_f32 v22, v38, v22
v_mfma_f32_16x16x32_bf16 v[180:183], a[248:251], v[12:15], v[180:183]
ds_read_b128 a[240:243], v32 offset:1024
v_lshlrev_b32 v38, 16, v23
v_mfma_f32_16x16x32_bf16 v[180:183], a[252:255], v[4:7], v[180:183]
buffer_load_dwordx4 v32, s[16:19], s53 offen offset:1024 sc1 lds
v_mfma_f32_16x16x32_bf16 v[176:179], a[252:255], v[0:3], v[176:179]
ds_read_b128 a[244:247], v32 offset:10240
v_and_b32 v23, s55, v23
v_mfma_f32_16x16x32_bf16 v[176:179], a[248:251], v[8:11], v[176:179]
s_waitcnt lgkmcnt(4)
v_lshlrev_b32 v37, 16, v31
v_and_b32 v31, s55, v31
v_mfma_f32_16x16x32_bf16 v[184:187], a[224:227], v[8:11], v[184:187]
ds_read_b128 a[248:251], v32 offset:2048
v_add_f32 v39, v37, v38
v_mfma_f32_16x16x32_bf16 v[184:187], a[228:231], v[0:3], v[184:187]
v_subrev_f32 v38, v37, v38
v_add_f32 v37, v31, v23
v_mfma_f32_16x16x32_bf16 v[188:191], a[228:231], v[4:7], v[188:191]
ds_read_b128 a[252:255], v32 offset:11264
v_subrev_f32 v23, v31, v23
v_mfma_f32_16x16x32_bf16 v[188:191], a[224:227], v[12:15], v[188:191]
s_waitcnt lgkmcnt(4)
v_cvt_pk_bf16_f32 v31, v39, v37
v_cvt_pk_bf16_f32 v23, v38, v23
v_mfma_f32_16x16x32_bf16 v[196:199], a[232:235], v[44:47], v[196:199]
ds_read_b128 a[224:227], v32 offset:3072
v_mfma_f32_16x16x32_bf16 v[196:199], a[236:239], v[28:31], v[196:199]
buffer_load_dwordx4 v32, s[16:19], s53 offen offset:2048 sc1 lds
ds_read_b128 v[8:11], v35 offset:4096
v_mfma_f32_16x16x32_bf16 v[192:195], a[236:239], v[24:27], v[192:195]
ds_read_b128 a[228:231], v32 offset:12288
v_accvgpr_read_b32 v4, a140
L_pg11:
s_cbranch_vccnz L_vr2
v_mfma_f32_16x16x32_bf16 v[192:195], a[232:235], v[40:43], v[192:195]
s_waitcnt lgkmcnt(5)
ds_read_b128 v[12:15], v35 offset:2048
v_accvgpr_read_b32 v5, a141
v_mfma_f32_16x16x32_bf16 v[200:203], a[240:243], v[40:43], v[200:203]
ds_read_b128 a[232:235], v32 offset:4096
v_accvgpr_read_b32 v6, a142
v_mfma_f32_16x16x32_bf16 v[200:203], a[244:247], v[24:27], v[200:203]
v_accvgpr_read_b32 v7, a143
v_mfma_f32_16x16x32_bf16 v[204:207], a[244:247], v[28:31], v[204:207]
ds_read_b128 a[236:239], v32 offset:13312
ds_read_b128 a[140:143], v35 offset:2048
v_mfma_f32_16x16x32_bf16 v[204:207], a[240:243], v[44:47], v[204:207]
s_waitcnt lgkmcnt(7)
v_accvgpr_read_b32 v0, a136
v_accvgpr_read_b32 v1, a137
v_mfma_f32_16x16x32_bf16 v[212:215], a[248:251], v[44:47], v[212:215]
ds_read_b128 a[240:243], v32 offset:5120
v_accvgpr_read_b32 v2, a138
v_mfma_f32_16x16x32_bf16 v[212:215], a[252:255], v[28:31], v[212:215]
buffer_load_dwordx4 v32, s[16:19], s53 offen offset:3072 sc1 lds
v_mfma_f32_16x16x32_bf16 v[208:211], a[252:255], v[24:27], v[208:211]
ds_read_b128 a[244:247], v32 offset:14336
v_accvgpr_read_b32 v3, a139
v_mfma_f32_16x16x32_bf16 v[208:211], a[248:251], v[40:43], v[208:211]
s_waitcnt lgkmcnt(6)
ds_read_b128 a[136:139], v35 offset:4096
v_lshlrev_b32 v38, 16, v0
v_mfma_f32_16x16x32_bf16 v[216:219], a[224:227], v[40:43], v[216:219]
ds_read_b128 a[248:251], v32 offset:6144
v_and_b32 v0, s55, v0
v_mfma_f32_16x16x32_bf16 v[216:219], a[228:231], v[24:27], v[216:219]
v_lshlrev_b32 v37, 16, v8
v_and_b32 v8, s55, v8
v_mfma_f32_16x16x32_bf16 v[220:223], a[228:231], v[28:31], v[220:223]
s_add_u32 s54, s47, 634880
ds_read_b128 a[252:255], v32 offset:15360
v_add_f32 v39, v37, v38
v_mfma_f32_16x16x32_bf16 v[220:223], a[224:227], v[44:47], v[220:223]
s_waitcnt lgkmcnt(6)
v_subrev_f32 v38, v37, v38
v_add_f32 v37, v8, v0
v_mfma_f32_16x16x32_bf16 v[228:231], a[232:235], v[44:47], v[228:231]
s_add_u32 m0, s43, 81920
ds_read_b128 a[224:227], v32 offset:7168
v_subrev_f32 v0, v8, v0
v_mfma_f32_16x16x32_bf16 v[228:231], a[236:239], v[28:31], v[228:231]
buffer_load_dwordx4 v32, s[16:19], s54 offen sc1 lds
v_mfma_f32_16x16x32_bf16 v[224:227], a[236:239], v[24:27], v[224:227]
ds_read_b128 a[228:231], v32 offset:16384
v_cvt_pk_bf16_f32 v8, v39, v37
v_mfma_f32_16x16x32_bf16 v[224:227], a[232:235], v[40:43], v[224:227]
s_waitcnt lgkmcnt(5)
v_cvt_pk_bf16_f32 v0, v38, v0
v_lshlrev_b32 v38, 16, v1
v_mfma_f32_16x16x32_bf16 v[232:235], a[240:243], v[40:43], v[232:235]
ds_read_b128 a[232:235], v32 offset:8192
v_and_b32 v1, s55, v1
v_mfma_f32_16x16x32_bf16 v[232:235], a[244:247], v[24:27], v[232:235]
v_lshlrev_b32 v37, 16, v9
v_and_b32 v9, s55, v9
v_mfma_f32_16x16x32_bf16 v[236:239], a[244:247], v[28:31], v[236:239]
s_add_u32 s52, s47, 663552
ds_read_b128 a[236:239], v32 offset:17408
v_add_f32 v39, v37, v38
v_mfma_f32_16x16x32_bf16 v[236:239], a[240:243], v[44:47], v[236:239]
s_waitcnt vmcnt(9) lgkmcnt(4)
s_barrier
v_subrev_f32 v38, v37, v38
v_add_f32 v37, v9, v1
v_mfma_f32_16x16x32_bf16 v[244:247], a[248:251], v[44:47], v[244:247]
s_add_u32 m0, s43, 0
ds_read_b128 a[240:243], v32 offset:36864
v_subrev_f32 v1, v9, v1
v_mfma_f32_16x16x32_bf16 v[244:247], a[252:255], v[28:31], v[244:247]
buffer_load_dwordx4 v32, s[16:19], s52 offen sc1 lds
v_mfma_f32_16x16x32_bf16 v[240:243], a[252:255], v[24:27], v[240:243]
ds_read_b128 a[244:247], v32 offset:46080
v_cvt_pk_bf16_f32 v9, v39, v37
v_mfma_f32_16x16x32_bf16 v[240:243], a[248:251], v[40:43], v[240:243]
s_waitcnt lgkmcnt(4)
v_cvt_pk_bf16_f32 v1, v38, v1
v_lshlrev_b32 v38, 16, v2
v_mfma_f32_16x16x32_bf16 v[248:251], a[224:227], v[40:43], v[248:251]
ds_read_b128 a[248:251], v32 offset:37888
v_and_b32 v2, s55, v2
v_mfma_f32_16x16x32_bf16 v[248:251], a[228:231], v[24:27], v[248:251]
v_lshlrev_b32 v37, 16, v10
v_and_b32 v10, s55, v10
v_mfma_f32_16x16x32_bf16 v[252:255], a[228:231], v[28:31], v[252:255]
ds_read_b128 a[252:255], v32 offset:47104
v_add_f32 v39, v37, v38
v_mfma_f32_16x16x32_bf16 v[252:255], a[224:227], v[44:47], v[252:255]
s_waitcnt lgkmcnt(4)
v_subrev_f32 v38, v37, v38
v_add_f32 v37, v10, v2
v_mfma_f32_16x16x32_bf16 a[148:151], a[232:235], v[44:47], a[148:151]
ds_read_b128 a[224:227], v32 offset:38912
v_subrev_f32 v2, v10, v2
v_mfma_f32_16x16x32_bf16 a[148:151], a[236:239], v[28:31], a[148:151]
buffer_load_dwordx4 v32, s[16:19], s52 offen offset:1024 sc1 lds
v_mfma_f32_16x16x32_bf16 a[144:147], a[236:239], v[24:27], a[144:147]
ds_read_b128 a[228:231], v32 offset:48128
v_cvt_pk_bf16_f32 v10, v39, v37
v_mfma_f32_16x16x32_bf16 a[144:147], a[232:235], v[40:43], a[144:147]
s_waitcnt lgkmcnt(4)
v_cvt_pk_bf16_f32 v2, v38, v2
v_lshlrev_b32 v38, 16, v3
v_mfma_f32_16x16x32_bf16 a[152:155], a[240:243], v[40:43], a[152:155]
ds_read_b128 a[232:235], v32 offset:39936
v_and_b32 v3, s55, v3
v_mfma_f32_16x16x32_bf16 a[152:155], a[244:247], v[24:27], a[152:155]
v_lshlrev_b32 v37, 16, v11
v_and_b32 v11, s55, v11
v_mfma_f32_16x16x32_bf16 a[156:159], a[244:247], v[28:31], a[156:159]
ds_read_b128 a[236:239], v32 offset:49152
v_add_f32 v39, v37, v38
v_mfma_f32_16x16x32_bf16 a[156:159], a[240:243], v[44:47], a[156:159]
s_waitcnt lgkmcnt(4)
v_subrev_f32 v38, v37, v38
v_add_f32 v37, v11, v3
v_mfma_f32_16x16x32_bf16 a[164:167], a[248:251], v[44:47], a[164:167]
ds_read_b128 a[240:243], v32 offset:40960
v_subrev_f32 v3, v11, v3
v_mfma_f32_16x16x32_bf16 a[164:167], a[252:255], v[28:31], a[164:167]
buffer_load_dwordx4 v32, s[16:19], s52 offen offset:2048 sc1 lds
v_mfma_f32_16x16x32_bf16 a[160:163], a[252:255], v[24:27], a[160:163]
ds_read_b128 a[244:247], v32 offset:50176
v_cvt_pk_bf16_f32 v11, v39, v37
v_mfma_f32_16x16x32_bf16 a[160:163], a[248:251], v[40:43], a[160:163]
s_waitcnt lgkmcnt(4)
v_cvt_pk_bf16_f32 v3, v38, v3
v_lshlrev_b32 v38, 16, v4
v_mfma_f32_16x16x32_bf16 a[168:171], a[224:227], v[40:43], a[168:171]
ds_read_b128 a[248:251], v32 offset:41984
v_and_b32 v4, s55, v4
v_mfma_f32_16x16x32_bf16 a[168:171], a[228:231], v[24:27], a[168:171]
v_lshlrev_b32 v37, 16, v12
v_and_b32 v12, s55, v12
v_mfma_f32_16x16x32_bf16 a[172:175], a[228:231], v[28:31], a[172:175]
ds_read_b128 a[252:255], v32 offset:51200
v_add_f32 v39, v37, v38
v_mfma_f32_16x16x32_bf16 a[172:175], a[224:227], v[44:47], a[172:175]
s_waitcnt lgkmcnt(4)
v_subrev_f32 v38, v37, v38
v_add_f32 v37, v12, v4
v_mfma_f32_16x16x32_bf16 a[180:183], a[232:235], v[44:47], a[180:183]
ds_read_b128 a[224:227], v32 offset:43008
v_subrev_f32 v4, v12, v4
v_mfma_f32_16x16x32_bf16 a[180:183], a[236:239], v[28:31], a[180:183]
buffer_load_dwordx4 v32, s[16:19], s52 offen offset:3072 sc1 lds
v_mfma_f32_16x16x32_bf16 a[176:179], a[236:239], v[24:27], a[176:179]
ds_read_b128 a[228:231], v32 offset:52224
v_cvt_pk_bf16_f32 v12, v39, v37
v_mfma_f32_16x16x32_bf16 a[176:179], a[232:235], v[40:43], a[176:179]
s_waitcnt lgkmcnt(4)
v_cvt_pk_bf16_f32 v4, v38, v4
v_lshlrev_b32 v38, 16, v5
v_mfma_f32_16x16x32_bf16 a[184:187], a[240:243], v[40:43], a[184:187]
ds_read_b128 a[232:235], v32 offset:44032
v_and_b32 v5, s55, v5
v_mfma_f32_16x16x32_bf16 a[184:187], a[244:247], v[24:27], a[184:187]
v_lshlrev_b32 v37, 16, v13
v_and_b32 v13, s55, v13
v_mfma_f32_16x16x32_bf16 a[188:191], a[244:247], v[28:31], a[188:191]
s_add_u32 s53, s47, 667648
ds_read_b128 a[236:239], v32 offset:53248
v_add_f32 v39, v37, v38
v_mfma_f32_16x16x32_bf16 a[188:191], a[240:243], v[44:47], a[188:191]
s_waitcnt lgkmcnt(4)
v_subrev_f32 v38, v37, v38
v_add_f32 v37, v13, v5
v_mfma_f32_16x16x32_bf16 a[196:199], a[248:251], v[44:47], a[196:199]
s_add_u32 m0, s43, 4096
ds_read_b128 a[240:243], v32 offset:45056
v_subrev_f32 v5, v13, v5
v_mfma_f32_16x16x32_bf16 a[196:199], a[252:255], v[28:31], a[196:199]
buffer_load_dwordx4 v32, s[16:19], s53 offen sc1 lds
v_mfma_f32_16x16x32_bf16 a[192:195], a[252:255], v[24:27], a[192:195]
ds_read_b128 a[244:247], v32 offset:54272
v_cvt_pk_bf16_f32 v13, v39, v37
v_mfma_f32_16x16x32_bf16 a[192:195], a[248:251], v[40:43], a[192:195]
s_waitcnt lgkmcnt(4)
v_cvt_pk_bf16_f32 v5, v38, v5
v_lshlrev_b32 v38, 16, v6
v_mfma_f32_16x16x32_bf16 a[200:203], a[224:227], v[40:43], a[200:203]
ds_read_b128 a[248:251], v32 offset:55296
v_and_b32 v6, s55, v6
v_mfma_f32_16x16x32_bf16 a[200:203], a[228:231], v[24:27], a[200:203]
v_lshlrev_b32 v37, 16, v14
v_and_b32 v14, s55, v14
v_mfma_f32_16x16x32_bf16 a[204:207], a[228:231], v[28:31], a[204:207]
ds_read_b128 a[252:255], v32 offset:56320
v_add_f32 v39, v37, v38
v_mfma_f32_16x16x32_bf16 a[204:207], a[224:227], v[44:47], a[204:207]
s_waitcnt lgkmcnt(4)
v_subrev_f32 v38, v37, v38
v_add_f32 v37, v14, v6
v_mfma_f32_16x16x32_bf16 a[212:215], a[232:235], v[44:47], a[212:215]
ds_read_b128 a[224:227], v32 offset:57344
v_subrev_f32 v6, v14, v6
v_mfma_f32_16x16x32_bf16 a[212:215], a[236:239], v[28:31], a[212:215]
buffer_load_dwordx4 v32, s[16:19], s53 offen offset:1024 sc1 lds
v_mfma_f32_16x16x32_bf16 a[208:211], a[236:239], v[24:27], a[208:211]
ds_read_b128 a[228:231], v32 offset:58368
v_cvt_pk_bf16_f32 v14, v39, v37
v_mfma_f32_16x16x32_bf16 a[208:211], a[232:235], v[40:43], a[208:211]
s_waitcnt lgkmcnt(4)
v_cvt_pk_bf16_f32 v6, v38, v6
v_lshlrev_b32 v38, 16, v7
v_mfma_f32_16x16x32_bf16 a[216:219], a[240:243], v[40:43], a[216:219]
ds_read_b128 a[232:235], v32 offset:59392
v_and_b32 v7, s55, v7
v_mfma_f32_16x16x32_bf16 a[216:219], a[244:247], v[24:27], a[216:219]
v_lshlrev_b32 v37, 16, v15
v_and_b32 v15, s55, v15
v_mfma_f32_16x16x32_bf16 a[220:223], a[244:247], v[28:31], a[220:223]
ds_read_b128 a[236:239], v32 offset:60416
v_add_f32 v39, v37, v38
v_mfma_f32_16x16x32_bf16 a[220:223], a[240:243], v[44:47], a[220:223]
s_waitcnt lgkmcnt(5)
v_subrev_f32 v38, v37, v38
v_add_f32 v37, v15, v7
v_mfma_f32_16x16x32_bf16 v[48:51], a[248:251], v[16:19], v[48:51]
ds_read_b128 a[240:243], v32 offset:61440
v_subrev_f32 v7, v15, v7
v_mfma_f32_16x16x32_bf16 v[52:55], a[248:251], v[20:23], v[52:55]
s_waitcnt lgkmcnt(5)
buffer_load_dwordx4 v32, s[16:19], s53 offen offset:2048 sc1 lds
v_mfma_f32_16x16x32_bf16 v[60:63], a[252:255], v[20:23], v[60:63]
ds_read_b128 a[244:247], v32 offset:62464
v_cvt_pk_bf16_f32 v15, v39, v37
v_mfma_f32_16x16x32_bf16 v[56:59], a[252:255], v[16:19], v[56:59]
s_waitcnt lgkmcnt(5)
v_cvt_pk_bf16_f32 v7, v38, v7
v_mfma_f32_16x16x32_bf16 v[64:67], a[224:227], v[16:19], v[64:67]
ds_read_b128 a[248:251], v32 offset:63488
v_mfma_f32_16x16x32_bf16 v[68:71], a[224:227], v[20:23], v[68:71]
s_waitcnt lgkmcnt(5)
v_mfma_f32_16x16x32_bf16 v[76:79], a[228:231], v[20:23], v[76:79]
ds_read_b128 a[252:255], v32 offset:64512
v_mfma_f32_16x16x32_bf16 v[72:75], a[228:231], v[16:19], v[72:75]
s_waitcnt lgkmcnt(5)
v_mfma_f32_16x16x32_bf16 v[80:83], a[232:235], v[16:19], v[80:83]
ds_read_b128 a[224:227], v33
v_mfma_f32_16x16x32_bf16 v[84:87], a[232:235], v[20:23], v[84:87]
s_waitcnt lgkmcnt(5)
buffer_load_dwordx4 v32, s[16:19], s53 offen offset:3072 sc1 lds
v_mfma_f32_16x16x32_bf16 v[92:95], a[236:239], v[20:23], v[92:95]
ds_read_b128 a[228:231], v33 offset:1024
v_mfma_f32_16x16x32_bf16 v[88:91], a[236:239], v[16:19], v[88:91]
s_waitcnt lgkmcnt(5)
v_mfma_f32_16x16x32_bf16 v[96:99], a[240:243], v[16:19], v[96:99]
ds_read_b128 a[232:235], v33 offset:2048
v_mfma_f32_16x16x32_bf16 v[100:103], a[240:243], v[20:23], v[100:103]
s_waitcnt lgkmcnt(5)
v_mfma_f32_16x16x32_bf16 v[108:111], a[244:247], v[20:23], v[108:111]
s_add_u32 s54, s47, 671744
ds_read_b128 a[236:239], v33 offset:3072
v_mfma_f32_16x16x32_bf16 v[104:107], a[244:247], v[16:19], v[104:107]
s_waitcnt lgkmcnt(5)
v_mfma_f32_16x16x32_bf16 v[112:115], a[248:251], v[16:19], v[112:115]
s_add_u32 m0, s43, 8192
ds_read_b128 a[240:243], v33 offset:4096
v_lshrrev_b32 v38, 8, v32
v_mfma_f32_16x16x32_bf16 v[116:119], a[248:251], v[20:23], v[116:119]
s_waitcnt lgkmcnt(5)
buffer_load_dwordx4 v32, s[16:19], s54 offen sc1 lds
v_mfma_f32_16x16x32_bf16 v[124:127], a[252:255], v[20:23], v[124:127]
ds_read_b128 a[244:247], v33 offset:5120
v_bfe_u32 v37, v32, 4, 4
v_mfma_f32_16x16x32_bf16 v[120:123], a[252:255], v[16:19], v[120:123]
s_waitcnt lgkmcnt(5)
v_mul_u32_u24 v37, 2304, v37
v_lshl_add_u32 v37, v38, 4, v37
v_mfma_f32_16x16x32_bf16 v[128:131], a[224:227], v[16:19], v[128:131]
ds_read_b128 a[248:251], v33 offset:6144
v_lshlrev_b32 v38, 5, v38
v_mfma_f32_16x16x32_bf16 v[132:135], a[224:227], v[20:23], v[132:135]
s_waitcnt lgkmcnt(5)
v_add_u32 v38, 110624, v38
v_mfma_f32_16x16x32_bf16 v[140:143], a[228:231], v[20:23], v[140:143]
s_add_u32 s52, s47, 700416
ds_read_b128 a[252:255], v33 offset:7168
v_mfma_f32_16x16x32_bf16 v[136:139], a[228:231], v[16:19], v[136:139]
s_waitcnt vmcnt(9) lgkmcnt(5)
s_barrier
v_mfma_f32_16x16x32_bf16 v[144:147], a[232:235], v[16:19], v[144:147]
s_add_u32 m0, s43, 36864
ds_read_b128 a[224:227], v33 offset:8192
v_mfma_f32_16x16x32_bf16 v[148:151], a[232:235], v[20:23], v[148:151]
s_waitcnt lgkmcnt(5)
buffer_load_dwordx4 v32, s[16:19], s52 offen sc1 lds
v_mfma_f32_16x16x32_bf16 v[156:159], a[236:239], v[20:23], v[156:159]
ds_read_b128 a[228:231], v33 offset:26624
v_mfma_f32_16x16x32_bf16 v[152:155], a[236:239], v[16:19], v[152:155]
s_waitcnt lgkmcnt(5)
v_mfma_f32_16x16x32_bf16 v[160:163], a[240:243], v[16:19], v[160:163]
ds_read_b128 a[232:235], v33 offset:9216
v_mfma_f32_16x16x32_bf16 v[164:167], a[240:243], v[20:23], v[164:167]
s_waitcnt lgkmcnt(5)
v_mfma_f32_16x16x32_bf16 v[172:175], a[244:247], v[20:23], v[172:175]
ds_read_b128 a[236:239], v33 offset:27648
v_mfma_f32_16x16x32_bf16 v[168:171], a[244:247], v[16:19], v[168:171]
s_waitcnt lgkmcnt(5)
v_mfma_f32_16x16x32_bf16 v[176:179], a[248:251], v[16:19], v[176:179]
ds_read_b128 a[240:243], v33 offset:10240
v_mfma_f32_16x16x32_bf16 v[180:183], a[248:251], v[20:23], v[180:183]
s_waitcnt lgkmcnt(5)
buffer_load_dwordx4 v32, s[16:19], s52 offen offset:1024 sc1 lds
v_mfma_f32_16x16x32_bf16 v[188:191], a[252:255], v[20:23], v[188:191]
ds_read_b128 a[244:247], v33 offset:28672
v_mfma_f32_16x16x32_bf16 v[184:187], a[252:255], v[16:19], v[184:187]
s_waitcnt lgkmcnt(5)
v_mfma_f32_16x16x32_bf16 v[192:195], a[224:227], v[8:11], v[192:195]
ds_read_b128 a[248:251], v33 offset:11264
v_bfe_u32 v36, v32, 4, 4
v_mfma_f32_16x16x32_bf16 v[196:199], a[224:227], v[12:15], v[196:199]
s_waitcnt lgkmcnt(5)
v_subrev_u32 v36, 16, v36
v_cvt_f32_i32 v36, v36
v_mfma_f32_16x16x32_bf16 v[52:55], a[228:231], v[4:7], v[52:55]
ds_read_b128 a[252:255], v33 offset:29696
v_add_f32 v36, v36, v36
v_mfma_f32_16x16x32_bf16 v[48:51], a[228:231], v[0:3], v[48:51]
s_waitcnt lgkmcnt(5)
ds_read_b128 v[20:23], v38 offset:2048
v_mfma_f32_16x16x32_bf16 v[200:203], a[232:235], v[8:11], v[200:203]
ds_read_b128 a[224:227], v33 offset:12288
ds_read_b128 v[24:27], v38 offset:2064
v_mfma_f32_16x16x32_bf16 v[204:207], a[232:235], v[12:15], v[204:207]
s_waitcnt lgkmcnt(2)
buffer_load_dwordx4 v32, s[16:19], s52 offen offset:2048 sc1 lds
v_mfma_f32_16x16x32_bf16 v[60:63], a[236:239], v[4:7], v[60:63]
ds_read_b128 a[228:231], v33 offset:30720
v_mul_f32 v20, v36, v20
v_mul_f32 v21, v36, v21
v_mfma_f32_16x16x32_bf16 v[56:59], a[236:239], v[0:3], v[56:59]
s_waitcnt lgkmcnt(1)
v_mul_f32 v22, v36, v22
v_mul_f32 v23, v36, v23
v_mfma_f32_16x16x32_bf16 v[208:211], a[240:243], v[8:11], v[208:211]
ds_read_b128 a[232:235], v33 offset:13312
v_mul_f32 v24, v36, v24
v_mul_f32 v25, v36, v25
v_mfma_f32_16x16x32_bf16 v[212:215], a[240:243], v[12:15], v[212:215]
v_mul_f32 v26, v36, v26
v_mul_f32 v27, v36, v27
v_mfma_f32_16x16x32_bf16 v[68:71], a[244:247], v[4:7], v[68:71]
ds_read_b128 a[236:239], v33 offset:31744
v_add_f32 v40, v192, v48
v_add_f32 v41, v193, v49
v_sub_f32 v48, v192, v48
v_sub_f32 v49, v193, v49
v_pk_add_f32 v[42:43], v[194:195], v[50:51]
v_pk_add_f32 v[50:51], v[194:195], v[50:51] neg_lo:[0,1] neg_hi:[0,1]
v_pk_add_f32 v[44:45], v[200:201], v[56:57]
v_pk_add_f32 v[56:57], v[200:201], v[56:57] neg_lo:[0,1] neg_hi:[0,1]
v_pk_add_f32 v[46:47], v[202:203], v[58:59]
v_pk_add_f32 v[58:59], v[202:203], v[58:59] neg_lo:[0,1] neg_hi:[0,1]
v_mfma_f32_16x16x32_bf16 v[64:67], a[244:247], v[0:3], v[64:67]
v_exp_f32 v192, v40
v_mfma_f32_16x16x32_bf16 v[216:219], a[248:251], v[8:11], v[216:219]
ds_read_b128 a[240:243], v33 offset:14336
v_exp_f32 v193, v41
v_mfma_f32_16x16x32_bf16 v[220:223], a[248:251], v[12:15], v[220:223]
buffer_load_dwordx4 v32, s[16:19], s52 offen offset:3072 sc1 lds
v_mfma_f32_16x16x32_bf16 v[76:79], a[252:255], v[4:7], v[76:79]
ds_read_b128 a[244:247], v33 offset:32768
v_exp_f32 v194, v42
v_mfma_f32_16x16x32_bf16 v[72:75], a[252:255], v[0:3], v[72:75]
v_exp_f32 v195, v43
v_mfma_f32_16x16x32_bf16 v[224:227], a[224:227], v[8:11], v[224:227]
ds_read_b128 a[248:251], v33 offset:15360
v_exp_f32 v200, v44
v_mfma_f32_16x16x32_bf16 v[228:231], a[224:227], v[12:15], v[228:231]
s_waitcnt lgkmcnt(5)
v_exp_f32 v201, v45
v_mfma_f32_16x16x32_bf16 v[84:87], a[228:231], v[4:7], v[84:87]
s_add_u32 s53, s47, 704512
ds_read_b128 a[252:255], v33 offset:33792
v_exp_f32 v202, v46
v_exp_f32 v203, v47
v_pk_fma_f32 v[192:193], v[192:193], s[56:57], s[56:57]
v_pk_fma_f32 v[194:195], v[194:195], s[56:57], s[56:57]
v_pk_fma_f32 v[200:201], v[200:201], s[56:57], s[56:57]
v_pk_fma_f32 v[202:203], v[202:203], s[56:57], s[56:57]
v_mfma_f32_16x16x32_bf16 v[80:83], a[228:231], v[0:3], v[80:83]
s_waitcnt lgkmcnt(5)
v_rcp_f32 v192, v192
v_mfma_f32_16x16x32_bf16 v[232:235], a[232:235], v[8:11], v[232:235]
s_add_u32 m0, s43, 40960
ds_read_b128 a[224:227], v33 offset:16384
v_rcp_f32 v193, v193
v_mfma_f32_16x16x32_bf16 v[236:239], a[232:235], v[12:15], v[236:239]
s_waitcnt lgkmcnt(5)
buffer_load_dwordx4 v32, s[16:19], s53 offen sc1 lds
v_mfma_f32_16x16x32_bf16 v[92:95], a[236:239], v[4:7], v[92:95]
ds_read_b128 a[228:231], v33 offset:34816
v_rcp_f32 v194, v194
v_mfma_f32_16x16x32_bf16 v[88:91], a[236:239], v[0:3], v[88:91]
s_waitcnt lgkmcnt(5)
v_rcp_f32 v195, v195
v_mfma_f32_16x16x32_bf16 v[240:243], a[240:243], v[8:11], v[240:243]
ds_read_b128 a[232:235], v33 offset:17408
v_rcp_f32 v200, v200
v_mfma_f32_16x16x32_bf16 v[244:247], a[240:243], v[12:15], v[244:247]
s_waitcnt lgkmcnt(5)
v_rcp_f32 v201, v201
v_mfma_f32_16x16x32_bf16 v[100:103], a[244:247], v[4:7], v[100:103]
ds_read_b128 a[236:239], v33 offset:35840
v_rcp_f32 v202, v202
v_rcp_f32 v203, v203
v_pk_mul_f32 v[40:41], v[40:41], v[192:193]
v_pk_mul_f32 v[42:43], v[42:43], v[194:195]
v_pk_mul_f32 v[44:45], v[44:45], v[200:201]
v_pk_mul_f32 v[46:47], v[46:47], v[202:203]
v_mfma_f32_16x16x32_bf16 v[96:99], a[244:247], v[0:3], v[96:99]
s_waitcnt lgkmcnt(5)
v_cvt_pk_bf16_f32 v192, v40, v41
v_cvt_pk_bf16_f32 v193, v42, v43
v_mfma_f32_16x16x32_bf16 v[248:251], a[248:251], v[8:11], v[248:251]
ds_read_b128 a[240:243], v33 offset:18432
v_cvt_pk_bf16_f32 v194, v44, v45
v_mfma_f32_16x16x32_bf16 v[252:255], a[248:251], v[12:15], v[252:255]
s_waitcnt lgkmcnt(5)
buffer_load_dwordx4 v32, s[16:19], s53 offen offset:1024 sc1 lds
v_cvt_pk_bf16_f32 v195, v46, v47
v_mfma_f32_16x16x32_bf16 v[108:111], a[252:255], v[4:7], v[108:111]
ds_read_b128 a[244:247], v33 offset:36864
buffer_store_dwordx4 v[192:195], v37, s[24:27], s49 offen sc1
v_add_f32 v40, v196, v52
v_add_f32_e64 v41, v197, v53
v_pk_add_f32 v[52:53], v[196:197], v[52:53] neg_lo:[0,1] neg_hi:[0,1]
v_pk_add_f32 v[42:43], v[198:199], v[54:55]
v_pk_add_f32 v[54:55], v[198:199], v[54:55] neg_lo:[0,1] neg_hi:[0,1]
v_pk_add_f32 v[44:45], v[204:205], v[60:61]
v_pk_add_f32 v[60:61], v[204:205], v[60:61] neg_lo:[0,1] neg_hi:[0,1]
v_pk_add_f32 v[46:47], v[206:207], v[62:63]
v_pk_add_f32 v[62:63], v[206:207], v[62:63] neg_lo:[0,1] neg_hi:[0,1]
v_exp_f32 v200, v40
v_mfma_f32_16x16x32_bf16 v[104:107], a[252:255], v[0:3], v[104:107]
s_waitcnt lgkmcnt(5)
v_exp_f32 v201, v41
v_mfma_f32_16x16x32_bf16 a[144:147], a[224:227], v[8:11], a[144:147]
ds_read_b128 a[248:251], v33 offset:19456
v_exp_f32 v202, v42
v_mfma_f32_16x16x32_bf16 a[148:151], a[224:227], v[12:15], a[148:151]
s_waitcnt lgkmcnt(5)
v_exp_f32 v203, v43
v_mfma_f32_16x16x32_bf16 v[116:119], a[228:231], v[4:7], v[116:119]
ds_read_b128 a[252:255], v33 offset:37888
v_exp_f32 v196, v44
v_mfma_f32_16x16x32_bf16 v[112:115], a[228:231], v[0:3], v[112:115]
s_waitcnt lgkmcnt(5)
v_exp_f32 v197, v45
v_mfma_f32_16x16x32_bf16 a[152:155], a[232:235], v[8:11], a[152:155]
ds_read_b128 a[224:227], v33 offset:20480
v_exp_f32 v198, v46
v_exp_f32 v199, v47
v_pk_fma_f32 v[200:201], v[200:201], s[56:57], s[56:57]
v_pk_fma_f32 v[202:203], v[202:203], s[56:57], s[56:57]
v_pk_fma_f32 v[196:197], v[196:197], s[56:57], s[56:57]
v_pk_fma_f32 v[198:199], v[198:199], s[56:57], s[56:57]
v_mfma_f32_16x16x32_bf16 a[156:159], a[232:235], v[12:15], a[156:159]
s_waitcnt lgkmcnt(5)
buffer_load_dwordx4 v32, s[16:19], s53 offen offset:2048 sc1 lds
v_mfma_f32_16x16x32_bf16 v[124:127], a[236:239], v[4:7], v[124:127]
ds_read_b128 a[228:231], v33 offset:38912
v_rcp_f32 v200, v200
v_mfma_f32_16x16x32_bf16 v[120:123], a[236:239], v[0:3], v[120:123]
s_waitcnt lgkmcnt(5)
v_rcp_f32 v201, v201
v_mfma_f32_16x16x32_bf16 a[160:163], a[240:243], v[8:11], a[160:163]
ds_read_b128 a[232:235], v33 offset:21504
v_rcp_f32 v202, v202
v_mfma_f32_16x16x32_bf16 a[164:167], a[240:243], v[12:15], a[164:167]
s_waitcnt lgkmcnt(5)
v_rcp_f32 v203, v203
v_mfma_f32_16x16x32_bf16 v[132:135], a[244:247], v[4:7], v[132:135]
ds_read_b128 a[236:239], v33 offset:39936
v_rcp_f32 v196, v196
v_mfma_f32_16x16x32_bf16 v[128:131], a[244:247], v[0:3], v[128:131]
s_waitcnt lgkmcnt(5)
v_rcp_f32 v197, v197
v_mfma_f32_16x16x32_bf16 a[168:171], a[248:251], v[8:11], a[168:171]
ds_read_b128 a[240:243], v33 offset:22528
v_rcp_f32 v198, v198
v_rcp_f32 v199, v199
v_pk_mul_f32 v[40:41], v[40:41], v[200:201]
v_pk_mul_f32 v[42:43], v[42:43], v[202:203]
v_pk_mul_f32 v[44:45], v[44:45], v[196:197]
v_pk_mul_f32 v[46:47], v[46:47], v[198:199]
v_mfma_f32_16x16x32_bf16 a[172:175], a[248:251], v[12:15], a[172:175]
s_waitcnt lgkmcnt(5)
buffer_load_dwordx4 v32, s[16:19], s53 offen offset:3072 sc1 lds
v_mfma_f32_16x16x32_bf16 v[140:143], a[252:255], v[4:7], v[140:143]
ds_read_b128 a[244:247], v33 offset:40960
v_cvt_pk_bf16_f32 v200, v40, v41
v_cvt_pk_bf16_f32 v201, v42, v43
v_cvt_pk_bf16_f32 v202, v44, v45
v_cvt_pk_bf16_f32 v203, v46, v47
v_pk_add_f32 v[204:205], v[208:209], v[64:65]
v_pk_add_f32 v[64:65], v[208:209], v[64:65] neg_lo:[0,1] neg_hi:[0,1]
v_pk_add_f32 v[206:207], v[210:211], v[66:67]
v_pk_add_f32 v[66:67], v[210:211], v[66:67] neg_lo:[0,1] neg_hi:[0,1]
v_pk_add_f32 v[192:193], v[216:217], v[72:73]
v_pk_add_f32 v[72:73], v[216:217], v[72:73] neg_lo:[0,1] neg_hi:[0,1]
v_pk_add_f32 v[194:195], v[218:219], v[74:75]
v_pk_add_f32 v[74:75], v[218:219], v[74:75] neg_lo:[0,1] neg_hi:[0,1]
v_mfma_f32_16x16x32_bf16 v[136:139], a[252:255], v[0:3], v[136:139]
s_waitcnt lgkmcnt(5)
v_exp_f32 v40, v204
v_mfma_f32_16x16x32_bf16 a[176:179], a[224:227], v[8:11], a[176:179]
s_load_dword s77, s[78:79], 53248
ds_read_b128 a[248:251], v33 offset:23552
v_exp_f32 v41, v205
v_mfma_f32_16x16x32_bf16 a[180:183], a[224:227], v[12:15], a[180:183]
s_waitcnt lgkmcnt(5)
v_exp_f32 v42, v206
v_mfma_f32_16x16x32_bf16 v[148:151], a[228:231], v[4:7], v[148:151]
s_add_u32 s54, s47, 708608
ds_read_b128 a[252:255], v33 offset:41984
v_exp_f32 v43, v207
v_mfma_f32_16x16x32_bf16 v[144:147], a[228:231], v[0:3], v[144:147]
s_waitcnt lgkmcnt(5)
v_exp_f32 v44, v192
v_mfma_f32_16x16x32_bf16 a[184:187], a[232:235], v[8:11], a[184:187]
s_add_u32 m0, s43, 45056
ds_read_b128 a[224:227], v33 offset:24576
v_exp_f32 v45, v193
v_mfma_f32_16x16x32_bf16 a[188:191], a[232:235], v[12:15], a[188:191]
s_waitcnt lgkmcnt(5)
buffer_load_dwordx4 v32, s[16:19], s54 offen sc1 lds
v_mfma_f32_16x16x32_bf16 v[156:159], a[236:239], v[4:7], v[156:159]
ds_read_b128 a[228:231], v33 offset:43008
v_exp_f32 v46, v194
v_exp_f32 v47, v195
v_pk_fma_f32 v[40:41], v[40:41], s[56:57], s[56:57]
v_pk_fma_f32 v[42:43], v[42:43], s[56:57], s[56:57]
v_pk_fma_f32 v[44:45], v[44:45], s[56:57], s[56:57]
v_pk_fma_f32 v[46:47], v[46:47], s[56:57], s[56:57]
v_mfma_f32_16x16x32_bf16 v[152:155], a[236:239], v[0:3], v[152:155]
s_waitcnt lgkmcnt(5)
v_rcp_f32 v40, v40
v_mfma_f32_16x16x32_bf16 a[192:195], a[240:243], v[8:11], a[192:195]
ds_read_b128 a[232:235], v33 offset:25600
v_rcp_f32 v41, v41
v_mfma_f32_16x16x32_bf16 a[196:199], a[240:243], v[12:15], a[196:199]
s_waitcnt lgkmcnt(5)
v_rcp_f32 v42, v42
v_mfma_f32_16x16x32_bf16 v[164:167], a[244:247], v[4:7], v[164:167]
ds_read_b128 a[236:239], v33 offset:44032
v_rcp_f32 v43, v43
v_mfma_f32_16x16x32_bf16 v[160:163], a[244:247], v[0:3], v[160:163]
s_waitcnt vmcnt(10) lgkmcnt(5)
s_barrier
v_mfma_f32_16x16x32_bf16 a[200:203], a[248:251], v[8:11], a[200:203]
ds_read_b128 a[240:243], v32
v_rcp_f32 v44, v44
v_mfma_f32_16x16x32_bf16 a[204:207], a[248:251], v[12:15], a[204:207]
s_waitcnt lgkmcnt(5)
v_rcp_f32 v45, v45
v_mfma_f32_16x16x32_bf16 v[172:175], a[252:255], v[4:7], v[172:175]
s_add_u32 s52, s47, 737280
ds_read_b128 a[244:247], v32 offset:2048
v_rcp_f32 v46, v46
v_rcp_f32 v47, v47
v_pk_mul_f32 v[204:205], v[204:205], v[40:41]
v_pk_mul_f32 v[206:207], v[206:207], v[42:43]
v_pk_mul_f32 v[192:193], v[192:193], v[44:45]
v_pk_mul_f32 v[194:195], v[194:195], v[46:47]
v_mfma_f32_16x16x32_bf16 v[168:171], a[252:255], v[0:3], v[168:171]
s_waitcnt lgkmcnt(5)
v_cvt_pk_bf16_f32 v40, v204, v205
v_cvt_pk_bf16_f32 v41, v206, v207
v_mfma_f32_16x16x32_bf16 a[208:211], a[224:227], v[8:11], a[208:211]
s_add_u32 m0, s43, 73728
ds_read_b128 a[248:251], v32 offset:4096
buffer_store_dwordx4 v[200:203], v37, s[24:27], s50 offen sc1
v_cvt_pk_bf16_f32 v42, v192, v193
v_cvt_pk_bf16_f32 v43, v194, v195
v_pk_add_f32 v[196:197], v[212:213], v[68:69]
v_pk_add_f32 v[68:69], v[212:213], v[68:69] neg_lo:[0,1] neg_hi:[0,1]
v_pk_add_f32 v[198:199], v[214:215], v[70:71]
v_pk_add_f32 v[70:71], v[214:215], v[70:71] neg_lo:[0,1] neg_hi:[0,1]
v_pk_add_f32 v[208:209], v[220:221], v[76:77]
v_pk_add_f32 v[76:77], v[220:221], v[76:77] neg_lo:[0,1] neg_hi:[0,1]
v_pk_add_f32 v[210:211], v[222:223], v[78:79]
v_pk_add_f32 v[78:79], v[222:223], v[78:79] neg_lo:[0,1] neg_hi:[0,1]
v_mfma_f32_16x16x32_bf16 a[212:215], a[224:227], v[12:15], a[212:215]
s_waitcnt lgkmcnt(5)
buffer_load_dwordx4 v32, s[16:19], s52 offen sc1 lds
v_mfma_f32_16x16x32_bf16 v[180:183], a[228:231], v[4:7], v[180:183]
ds_read_b128 a[252:255], v32 offset:6144
v_exp_f32 v216, v196
v_mfma_f32_16x16x32_bf16 v[176:179], a[228:231], v[0:3], v[176:179]
s_waitcnt lgkmcnt(5)
v_exp_f32 v217, v197
v_mfma_f32_16x16x32_bf16 a[216:219], a[232:235], v[8:11], a[216:219]
ds_read_b128 a[224:227], v32 offset:8192
v_exp_f32 v218, v198
v_mfma_f32_16x16x32_bf16 a[220:223], a[232:235], v[12:15], a[220:223]
s_waitcnt lgkmcnt(5)
v_exp_f32 v219, v199
v_mfma_f32_16x16x32_bf16 v[188:191], a[236:239], v[4:7], v[188:191]
ds_read_b128 a[228:231], v32 offset:10240
v_exp_f32 v200, v208
v_mfma_f32_16x16x32_bf16 v[184:187], a[236:239], v[0:3], v[184:187]
s_waitcnt lgkmcnt(4)
buffer_store_dwordx4 v[40:43], v37, s[24:27], s49 offen offset:64 sc1
v_exp_f32 v201, v209
v_exp_f32 v202, v210
v_exp_f32 v203, v211
v_pk_fma_f32 v[216:217], v[216:217], s[56:57], s[56:57]
v_pk_fma_f32 v[218:219], v[218:219], s[56:57], s[56:57]
v_pk_fma_f32 v[200:201], v[200:201], s[56:57], s[56:57]
v_pk_fma_f32 v[202:203], v[202:203], s[56:57], s[56:57]
v_mfma_f32_16x16x32_bf16 v[16:19], a[240:243], a[0:3], v[20:23]
L_pg12:
s_cbranch_vccnz L_vr2
v_rcp_f32 v216, v216
v_mfma_f32_16x16x32_bf16 v[16:19], a[244:247], a[8:11], v[16:19]
buffer_load_dwordx4 v32, s[16:19], s52 offen offset:1024 sc1 lds
ds_read_b128 a[232:235], v32 offset:12288
ds_read_b128 a[236:239], v32 offset:14336
v_mfma_f32_16x16x32_bf16 v[20:23], a[244:247], a[12:15], v[20:23]
v_rcp_f32 v217, v217
v_mfma_f32_16x16x32_bf16 v[20:23], a[240:243], a[4:7], v[20:23]
s_waitcnt lgkmcnt(4)
v_rcp_f32 v218, v218
v_mfma_f32_16x16x32_bf16 v[20:23], a[248:251], a[20:23], v[20:23]
v_rcp_f32 v219, v219
v_mfma_f32_16x16x32_bf16 v[20:23], a[252:255], a[28:31], v[20:23]
ds_read_b128 a[240:243], v32 offset:16384
ds_read_b128 a[244:247], v32 offset:18432
v_mfma_f32_16x16x32_bf16 v[16:19], a[252:255], a[24:27], v[16:19]
v_rcp_f32 v200, v200
v_mfma_f32_16x16x32_bf16 v[16:19], a[248:251], a[16:19], v[16:19]
s_waitcnt lgkmcnt(4)
v_rcp_f32 v201, v201
v_mfma_f32_16x16x32_bf16 v[16:19], a[224:227], a[32:35], v[16:19]
v_rcp_f32 v202, v202
v_mfma_f32_16x16x32_bf16 v[16:19], a[228:231], a[40:43], v[16:19]
buffer_load_dwordx4 v32, s[16:19], s52 offen offset:2048 sc1 lds
ds_read_b128 a[248:251], v32 offset:20480
ds_read_b128 a[252:255], v32 offset:22528
v_rcp_f32_e64 v203, v203
v_pk_mul_f32 v[196:197], v[196:197], v[216:217]
v_pk_mul_f32 v[198:199], v[198:199], v[218:219]
v_pk_mul_f32 v[208:209], v[208:209], v[200:201]
v_pk_mul_f32 v[210:211], v[210:211], v[202:203]
v_cvt_pk_bf16_f32 v216, v196, v197
v_cvt_pk_bf16_f32 v217, v198, v199
v_cvt_pk_bf16_f32 v218, v208, v209
v_cvt_pk_bf16_f32 v219, v210, v211
v_pk_add_f32 v[204:205], v[224:225], v[80:81]
v_pk_add_f32 v[80:81], v[224:225], v[80:81] neg_lo:[0,1] neg_hi:[0,1]
v_pk_add_f32 v[206:207], v[226:227], v[82:83]
v_pk_add_f32 v[82:83], v[226:227], v[82:83] neg_lo:[0,1] neg_hi:[0,1]
v_pk_add_f32 v[192:193], v[232:233], v[88:89]
v_pk_add_f32 v[88:89], v[232:233], v[88:89] neg_lo:[0,1] neg_hi:[0,1]
v_pk_add_f32 v[194:195], v[234:235], v[90:91]
v_pk_add_f32 v[90:91], v[234:235], v[90:91] neg_lo:[0,1] neg_hi:[0,1]
v_mfma_f32_16x16x32_bf16 v[20:23], a[228:231], a[44:47], v[20:23]
v_exp_f32 v44, v204
v_mfma_f32_16x16x32_bf16 v[20:23], a[224:227], a[36:39], v[20:23]
s_waitcnt lgkmcnt(4)
v_exp_f32 v45, v205
v_mfma_f32_16x16x32_bf16 v[20:23], a[232:235], a[52:55], v[20:23]
v_exp_f32 v46, v206
v_mfma_f32_16x16x32_bf16 v[20:23], a[236:239], a[60:63], v[20:23]
ds_read_b128 a[224:227], v32 offset:24576
ds_read_b128 a[228:231], v32 offset:26624
buffer_store_dwordx4 v[216:219], v37, s[24:27], s50 offen offset:64 sc1
v_exp_f32 v47, v207
v_exp_f32 v212, v192
v_exp_f32 v213, v193
v_exp_f32 v214, v194
v_exp_f32 v215, v195
v_pk_fma_f32 v[44:45], v[44:45], s[56:57], s[56:57]
v_pk_fma_f32 v[46:47], v[46:47], s[56:57], s[56:57]
v_pk_fma_f32 v[212:213], v[212:213], s[56:57], s[56:57]
v_pk_fma_f32 v[214:215], v[214:215], s[56:57], s[56:57]
v_mfma_f32_16x16x32_bf16 v[16:19], a[236:239], a[56:59], v[16:19]
v_rcp_f32 v44, v44
v_mfma_f32_16x16x32_bf16 v[16:19], a[232:235], a[48:51], v[16:19]
s_waitcnt lgkmcnt(4)
v_rcp_f32 v45, v45
v_mfma_f32_16x16x32_bf16 v[16:19], a[240:243], a[64:67], v[16:19]
v_rcp_f32 v46, v46
v_mfma_f32_16x16x32_bf16 v[16:19], a[244:247], a[72:75], v[16:19]
buffer_load_dwordx4 v32, s[16:19], s52 offen offset:3072 sc1 lds
ds_read_b128 a[232:235], v32 offset:28672
ds_read_b128 a[236:239], v32 offset:30720
v_mfma_f32_16x16x32_bf16 v[20:23], a[244:247], a[76:79], v[20:23]
v_rcp_f32 v47, v47
v_mfma_f32_16x16x32_bf16 v[20:23], a[240:243], a[68:71], v[20:23]
s_waitcnt lgkmcnt(4)
v_rcp_f32 v212, v212
v_mfma_f32_16x16x32_bf16 v[20:23], a[248:251], a[84:87], v[20:23]
v_rcp_f32 v213, v213
v_mfma_f32_16x16x32_bf16 v[20:23], a[252:255], a[92:95], v[20:23]
ds_read_b128 a[240:243], v32 offset:32768
ds_read_b128 a[244:247], v32 offset:34816
v_rcp_f32 v214, v214
v_rcp_f32_e64 v215, v215
v_pk_mul_f32 v[204:205], v[204:205], v[44:45]
v_pk_mul_f32 v[206:207], v[206:207], v[46:47]
v_pk_mul_f32 v[192:193], v[192:193], v[212:213]
v_pk_mul_f32 v[194:195], v[194:195], v[214:215]
v_cvt_pk_bf16_f32 v44, v204, v205
v_cvt_pk_bf16_f32 v45, v206, v207
v_cvt_pk_bf16_f32 v46, v192, v193
v_cvt_pk_bf16_f32 v47, v194, v195
v_pk_add_f32 v[220:221], v[228:229], v[84:85]
v_pk_add_f32 v[84:85], v[228:229], v[84:85] neg_lo:[0,1] neg_hi:[0,1]
v_pk_add_f32 v[222:223], v[230:231], v[86:87]
v_pk_add_f32 v[86:87], v[230:231], v[86:87] neg_lo:[0,1] neg_hi:[0,1]
v_pk_add_f32 v[40:41], v[236:237], v[92:93]
v_pk_add_f32 v[92:93], v[236:237], v[92:93] neg_lo:[0,1] neg_hi:[0,1]
v_pk_add_f32 v[42:43], v[238:239], v[94:95]
v_pk_add_f32 v[94:95], v[238:239], v[94:95] neg_lo:[0,1] neg_hi:[0,1]
v_mfma_f32_16x16x32_bf16 v[16:19], a[252:255], a[88:91], v[16:19]
s_add_u32 s53, s47, 741376
v_exp_f32 v196, v220
v_mfma_f32_16x16x32_bf16 v[16:19], a[248:251], a[80:83], v[16:19]
s_waitcnt lgkmcnt(4)
v_exp_f32 v197, v221
v_mfma_f32_16x16x32_bf16 v[16:19], a[224:227], a[96:99], v[16:19]
s_add_u32 m0, s43, 77824
v_exp_f32 v198, v222
v_mfma_f32_16x16x32_bf16 v[16:19], a[228:231], a[104:107], v[16:19]
buffer_load_dwordx4 v32, s[16:19], s53 offen sc1 lds
ds_read_b128 a[248:251], v32 offset:33792
ds_read_b128 a[252:255], v32 offset:35840
v_mfma_f32_16x16x32_bf16 v[20:23], a[228:231], a[108:111], v[20:23]
v_exp_f32 v199, v223
v_mfma_f32_16x16x32_bf16 v[20:23], a[224:227], a[100:103], v[20:23]
s_waitcnt lgkmcnt(4)
v_exp_f32 v208, v40
v_mfma_f32_16x16x32_bf16 v[20:23], a[232:235], a[116:119], v[20:23]
v_exp_f32 v209, v41
v_mfma_f32_16x16x32_bf16 v[20:23], a[236:239], a[124:127], v[20:23]
ds_read_b128 a[224:227], v32 offset:29696
ds_read_b128 a[228:231], v32 offset:31744
buffer_store_dwordx4 v[44:47], v37, s[24:27], s49 offen offset:128 sc1
v_exp_f32 v210, v42
v_exp_f32 v211, v43
v_pk_fma_f32 v[196:197], v[196:197], s[56:57], s[56:57]
v_pk_fma_f32 v[198:199], v[198:199], s[56:57], s[56:57]
v_pk_fma_f32 v[208:209], v[208:209], s[56:57], s[56:57]
v_pk_fma_f32 v[210:211], v[210:211], s[56:57], s[56:57]
v_rcp_f32 v196, v196
v_mfma_f32_16x16x32_bf16 v[16:19], a[236:239], a[120:123], v[16:19]
v_rcp_f32 v197, v197
v_mfma_f32_16x16x32_bf16 v[16:19], a[232:235], a[112:115], v[16:19]
s_waitcnt lgkmcnt(4)
v_rcp_f32 v198, v198
v_mfma_f32_16x16x32_bf16 v[16:19], a[240:243], a[128:131], v[16:19]
v_rcp_f32 v199, v199
v_mfma_f32_16x16x32_bf16 v[16:19], a[244:247], a[136:139], v[16:19]
buffer_load_dwordx4 v32, s[16:19], s53 offen offset:1024 sc1 lds
ds_read_b128 a[232:235], v32 offset:25600
ds_read_b128 a[236:239], v32 offset:27648
v_mfma_f32_16x16x32_bf16 v[20:23], a[244:247], a[140:143], v[20:23]
v_rcp_f32 v208, v208
v_mfma_f32_16x16x32_bf16 v[20:23], a[240:243], a[132:135], v[20:23]
s_waitcnt lgkmcnt(4)
v_rcp_f32 v209, v209
v_rcp_f32 v210, v210
v_rcp_f32 v211, v211
v_pk_mul_f32 v[220:221], v[220:221], v[196:197]
v_pk_mul_f32 v[222:223], v[222:223], v[198:199]
v_pk_mul_f32 v[40:41], v[40:41], v[208:209]
v_pk_mul_f32 v[42:43], v[42:43], v[210:211]
v_cvt_pk_bf16_f32 v196, v220, v221
v_cvt_pk_bf16_f32 v197, v222, v223
v_mfma_f32_16x16x32_bf16 v[28:31], a[248:251], a[132:135], v[24:27]
v_cvt_pk_bf16_f32 v198, v40, v41
v_cvt_pk_bf16_f32 v199, v42, v43
v_mfma_f32_16x16x32_bf16 v[28:31], a[252:255], a[140:143], v[28:31]
ds_read_b128 a[240:243], v32 offset:21504
ds_read_b128 a[244:247], v32 offset:23552
buffer_store_dwordx4 v[196:199], v37, s[24:27], s50 offen offset:128 sc1
ds_read_b128 v[4:7], v38 offset:2176
ds_read_b128 v[8:11], v38 offset:2192
v_pk_add_f32 v[200:201], v[240:241], v[96:97]
v_pk_add_f32 v[96:97], v[240:241], v[96:97] neg_lo:[0,1] neg_hi:[0,1]
v_pk_add_f32 v[202:203], v[242:243], v[98:99]
v_pk_add_f32 v[98:99], v[242:243], v[98:99] neg_lo:[0,1] neg_hi:[0,1]
v_pk_add_f32 v[224:225], v[248:249], v[104:105]
v_pk_add_f32 v[104:105], v[248:249], v[104:105] neg_lo:[0,1] neg_hi:[0,1]
v_pk_add_f32 v[226:227], v[250:251], v[106:107]
v_pk_add_f32 v[106:107], v[250:251], v[106:107] neg_lo:[0,1] neg_hi:[0,1]
v_mfma_f32_16x16x32_bf16 v[24:27], a[252:255], a[136:139], v[24:27]
v_exp_f32 v232, v200
v_mfma_f32_16x16x32_bf16 v[24:27], a[248:251], a[128:131], v[24:27]
s_waitcnt lgkmcnt(6)
v_exp_f32 v233, v201
v_mfma_f32_16x16x32_bf16 v[24:27], a[224:227], a[112:115], v[24:27]
v_exp_f32 v234, v202
v_mfma_f32_16x16x32_bf16 v[24:27], a[228:231], a[120:123], v[24:27]
buffer_load_dwordx4 v32, s[16:19], s53 offen offset:2048 sc1 lds
ds_read_b128 a[248:251], v32 offset:17408
ds_read_b128 a[252:255], v32 offset:19456
v_mfma_f32_16x16x32_bf16 v[28:31], a[228:231], a[124:127], v[28:31]
v_exp_f32 v235, v203
v_mfma_f32_16x16x32_bf16 v[28:31], a[224:227], a[116:119], v[28:31]
s_waitcnt lgkmcnt(6)
v_exp_f32 v216, v224
v_mfma_f32_16x16x32_bf16 v[28:31], a[232:235], a[100:103], v[28:31]
v_exp_f32 v217, v225
v_mfma_f32_16x16x32_bf16 v[28:31], a[236:239], a[108:111], v[28:31]
ds_read_b128 a[224:227], v32 offset:13312
ds_read_b128 a[228:231], v32 offset:15360
v_exp_f32 v218, v226
v_exp_f32 v219, v227
v_pk_fma_f32 v[232:233], v[232:233], s[56:57], s[56:57]
v_pk_fma_f32 v[234:235], v[234:235], s[56:57], s[56:57]
v_pk_fma_f32 v[216:217], v[216:217], s[56:57], s[56:57]
v_pk_fma_f32 v[218:219], v[218:219], s[56:57], s[56:57]
v_mfma_f32_16x16x32_bf16 v[24:27], a[236:239], a[104:107], v[24:27]
v_rcp_f32 v232, v232
v_mfma_f32_16x16x32_bf16 v[24:27], a[232:235], a[96:99], v[24:27]
s_waitcnt lgkmcnt(6)
v_rcp_f32 v233, v233
v_mfma_f32_16x16x32_bf16 v[24:27], a[240:243], a[80:83], v[24:27]
v_rcp_f32 v234, v234
v_mfma_f32_16x16x32_bf16 v[24:27], a[244:247], a[88:91], v[24:27]
buffer_load_dwordx4 v32, s[16:19], s53 offen offset:3072 sc1 lds
ds_read_b128 a[232:235], v32 offset:9216
ds_read_b128 a[236:239], v32 offset:11264
v_mfma_f32_16x16x32_bf16 v[28:31], a[244:247], a[92:95], v[28:31]
v_rcp_f32 v235, v235
v_mfma_f32_16x16x32_bf16 v[28:31], a[240:243], a[84:87], v[28:31]
s_waitcnt lgkmcnt(4)
v_rcp_f32 v216, v216
v_mfma_f32_16x16x32_bf16 v[28:31], a[248:251], a[68:71], v[28:31]
v_rcp_f32 v217, v217
v_mfma_f32_16x16x32_bf16 v[28:31], a[252:255], a[76:79], v[28:31]
ds_read_b128 a[240:243], v32 offset:5120
ds_read_b128 a[244:247], v32 offset:7168
v_rcp_f32 v218, v218
v_rcp_f32 v219, v219
v_pk_mul_f32 v[200:201], v[200:201], v[232:233]
v_pk_mul_f32 v[202:203], v[202:203], v[234:235]
v_pk_mul_f32 v[224:225], v[224:225], v[216:217]
v_pk_mul_f32 v[226:227], v[226:227], v[218:219]
v_cvt_pk_bf16_f32 v232, v200, v201
v_cvt_pk_bf16_f32 v233, v202, v203
v_cvt_pk_bf16_f32 v234, v224, v225
v_cvt_pk_bf16_f32 v235, v226, v227
v_pk_add_f32 v[204:205], v[244:245], v[100:101]
v_pk_add_f32 v[100:101], v[244:245], v[100:101] neg_lo:[0,1] neg_hi:[0,1]
v_pk_add_f32 v[206:207], v[246:247], v[102:103]
v_pk_add_f32 v[102:103], v[246:247], v[102:103] neg_lo:[0,1] neg_hi:[0,1]
v_pk_add_f32 v[192:193], v[252:253], v[108:109]
v_pk_add_f32 v[108:109], v[252:253], v[108:109] neg_lo:[0,1] neg_hi:[0,1]
v_pk_add_f32 v[194:195], v[254:255], v[110:111]
v_pk_add_f32 v[110:111], v[254:255], v[110:111] neg_lo:[0,1] neg_hi:[0,1]
v_pk_mul_f32 v[4:5], v[4:5], v[36:37] op_sel_hi:[1,0]
v_pk_mul_f32 v[6:7], v[6:7], v[36:37] op_sel_hi:[1,0]
v_pk_mul_f32 v[8:9], v[8:9], v[36:37] op_sel_hi:[1,0]
v_pk_mul_f32 v[10:11], v[10:11], v[36:37] op_sel_hi:[1,0]
v_mfma_f32_16x16x32_bf16 v[24:27], a[252:255], a[72:75], v[24:27]
s_add_u32 s54, s47, 745472
v_exp_f32 v212, v204
v_mfma_f32_16x16x32_bf16 v[24:27], a[248:251], a[64:67], v[24:27]
s_waitcnt lgkmcnt(4)
v_exp_f32 v213, v205
v_mfma_f32_16x16x32_bf16 v[24:27], a[224:227], a[48:51], v[24:27]
s_add_u32 m0, s43, 81920
v_exp_f32 v214, v206
v_mfma_f32_16x16x32_bf16 v[24:27], a[228:231], a[56:59], v[24:27]
buffer_load_dwordx4 v32, s[16:19], s54 offen sc1 lds
ds_read_b128 a[248:251], v32 offset:1024
ds_read_b128 a[252:255], v32 offset:3072
v_mfma_f32_16x16x32_bf16 v[28:31], a[228:231], a[60:63], v[28:31]
v_exp_f32 v215, v207
v_mfma_f32_16x16x32_bf16 v[28:31], a[224:227], a[52:55], v[28:31]
s_waitcnt lgkmcnt(4)
v_exp_f32 v228, v192
v_mfma_f32_16x16x32_bf16 v[28:31], a[232:235], a[36:39], v[28:31]
buffer_store_dwordx4 v[232:235], v37, s[24:27], s49 offen offset:192 sc1
v_exp_f32 v229, v193
v_exp_f32 v230, v194
v_exp_f32 v231, v195
v_pk_fma_f32 v[212:213], v[212:213], s[56:57], s[56:57]
v_pk_fma_f32 v[214:215], v[214:215], s[56:57], s[56:57]
v_pk_fma_f32 v[228:229], v[228:229], s[56:57], s[56:57]
v_pk_fma_f32 v[230:231], v[230:231], s[56:57], s[56:57]
v_mfma_f32_16x16x32_bf16 v[28:31], a[236:239], a[44:47], v[28:31]
s_waitcnt vmcnt(15)
s_barrier
ds_read_b128 a[224:227], v32 offset:36864
ds_read_b128 a[228:231], v32 offset:38912
v_mfma_f32_16x16x32_bf16 v[24:27], a[236:239], a[40:43], v[24:27]
s_add_u32 s52, s47, 774144
v_rcp_f32 v212, v212
v_mfma_f32_16x16x32_bf16 v[24:27], a[232:235], a[32:35], v[24:27]
s_waitcnt lgkmcnt(4)
v_rcp_f32 v213, v213
v_mfma_f32_16x16x32_bf16 v[24:27], a[240:243], a[16:19], v[24:27]
s_add_u32 m0, s43, 0
v_rcp_f32 v214, v214
v_mfma_f32_16x16x32_bf16 v[24:27], a[244:247], a[24:27], v[24:27]
buffer_load_dwordx4 v32, s[16:19], s52 offen sc1 lds
ds_read_b128 a[232:235], v32 offset:40960
ds_read_b128 a[236:239], v32 offset:43008
v_mfma_f32_16x16x32_bf16 v[28:31], a[244:247], a[28:31], v[28:31]
v_rcp_f32 v215, v215
v_mfma_f32_16x16x32_bf16 v[28:31], a[240:243], a[20:23], v[28:31]
s_waitcnt lgkmcnt(4)
v_rcp_f32 v228, v228
v_mfma_f32_16x16x32_bf16 v[28:31], a[248:251], a[4:7], v[28:31]
v_rcp_f32 v229, v229
v_mfma_f32_16x16x32_bf16 v[28:31], a[252:255], a[12:15], v[28:31]
ds_read_b128 a[240:243], v32 offset:45056
ds_read_b128 a[244:247], v32 offset:47104
v_rcp_f32 v230, v230
v_rcp_f32_e64 v231, v231
v_pk_mul_f32 v[204:205], v[204:205], v[212:213]
v_pk_mul_f32 v[206:207], v[206:207], v[214:215]
v_pk_mul_f32 v[192:193], v[192:193], v[228:229]
v_pk_mul_f32 v[194:195], v[194:195], v[230:231]
v_mfma_f32_16x16x32_bf16 v[24:27], a[252:255], a[8:11], v[24:27]
v_cvt_pk_bf16_f32 v212, v204, v205
v_cvt_pk_bf16_f32 v213, v206, v207
v_mfma_f32_16x16x32_bf16 v[24:27], a[248:251], a[0:3], v[24:27]
s_waitcnt lgkmcnt(4)
v_cvt_pk_bf16_f32 v214, v192, v193
v_cvt_pk_bf16_f32 v215, v194, v195
v_mfma_f32_16x16x32_bf16 v[0:3], a[224:227], a[0:3], v[4:7]
v_accvgpr_read_b32 v236, a144
v_accvgpr_read_b32 v237, a145
v_mfma_f32_16x16x32_bf16 v[0:3], a[228:231], a[8:11], v[0:3]
s_waitcnt vmcnt(63)
buffer_load_dwordx4 v32, s[16:19], s52 offen offset:1024 sc1 lds
ds_read_b128 a[248:251], v32 offset:49152
ds_read_b128 a[252:255], v32 offset:51200
v_accvgpr_read_b32 v238, a146
v_accvgpr_read_b32 v239, a147
v_accvgpr_read_b32 v44, a152
v_mfma_f32_16x16x32_bf16 v[4:7], a[228:231], a[12:15], v[4:7]
buffer_store_dwordx4 v[212:215], v37, s[24:27], s50 offen offset:192 sc1
v_accvgpr_read_b32 v45, a153
v_accvgpr_read_b32 v46, a154
v_accvgpr_read_b32 v47, a155
v_pk_add_f32 v[220:221], v[236:237], v[112:113]
v_pk_add_f32 v[112:113], v[236:237], v[112:113] neg_lo:[0,1] neg_hi:[0,1]
v_pk_add_f32 v[222:223], v[238:239], v[114:115]
v_pk_add_f32 v[114:115], v[238:239], v[114:115] neg_lo:[0,1] neg_hi:[0,1]
v_pk_add_f32 v[40:41], v[44:45], v[120:121]
v_pk_add_f32 v[120:121], v[44:45], v[120:121] neg_lo:[0,1] neg_hi:[0,1]
v_pk_add_f32 v[42:43], v[46:47], v[122:123]
v_pk_add_f32 v[122:123], v[46:47], v[122:123] neg_lo:[0,1] neg_hi:[0,1]
v_mfma_f32_16x16x32_bf16 v[4:7], a[224:227], a[4:7], v[4:7]
s_waitcnt lgkmcnt(4)
v_exp_f32 v208, v220
v_mfma_f32_16x16x32_bf16 v[4:7], a[232:235], a[20:23], v[4:7]
v_exp_f32 v209, v221
v_mfma_f32_16x16x32_bf16 v[4:7], a[236:239], a[28:31], v[4:7]
ds_read_b128 a[224:227], v32 offset:53248
ds_read_b128 a[228:231], v32 offset:55296
v_exp_f32 v210, v222
v_exp_f32 v211, v223
v_mfma_f32_16x16x32_bf16 v[0:3], a[236:239], a[24:27], v[0:3]
v_exp_f32 v240, v40
v_mfma_f32_16x16x32_bf16 v[0:3], a[232:235], a[16:19], v[0:3]
s_waitcnt lgkmcnt(4)
v_exp_f32 v241, v41
v_mfma_f32_16x16x32_bf16 v[0:3], a[240:243], a[32:35], v[0:3]
v_exp_f32 v242, v42
v_mfma_f32_16x16x32_bf16 v[0:3], a[244:247], a[40:43], v[0:3]
buffer_load_dwordx4 v32, s[16:19], s52 offen offset:2048 sc1 lds
ds_read_b128 a[232:235], v32 offset:57344
ds_read_b128 a[236:239], v32 offset:59392
v_exp_f32 v243, v43
v_pk_fma_f32 v[208:209], v[208:209], s[56:57], s[56:57]
v_pk_fma_f32 v[210:211], v[210:211], s[56:57], s[56:57]
v_pk_fma_f32 v[240:241], v[240:241], s[56:57], s[56:57]
v_pk_fma_f32 v[242:243], v[242:243], s[56:57], s[56:57]
v_mfma_f32_16x16x32_bf16 v[4:7], a[244:247], a[44:47], v[4:7]
v_rcp_f32 v208, v208
v_mfma_f32_16x16x32_bf16 v[4:7], a[240:243], a[36:39], v[4:7]
s_waitcnt lgkmcnt(4)
v_rcp_f32 v209, v209
v_mfma_f32_16x16x32_bf16 v[4:7], a[248:251], a[52:55], v[4:7]
v_rcp_f32 v210, v210
v_mfma_f32_16x16x32_bf16 v[4:7], a[252:255], a[60:63], v[4:7]
ds_read_b128 a[240:243], v32 offset:61440
ds_read_b128 a[244:247], v32 offset:63488
v_rcp_f32 v211, v211
v_mfma_f32_16x16x32_bf16 v[0:3], a[252:255], a[56:59], v[0:3]
v_rcp_f32 v240, v240
v_mfma_f32_16x16x32_bf16 v[0:3], a[248:251], a[48:51], v[0:3]
s_waitcnt lgkmcnt(4)
v_rcp_f32 v241, v241
v_mfma_f32_16x16x32_bf16 v[0:3], a[224:227], a[64:67], v[0:3]
v_rcp_f32 v242, v242
v_mfma_f32_16x16x32_bf16 v[0:3], a[228:231], a[72:75], v[0:3]
buffer_load_dwordx4 v32, s[16:19], s52 offen offset:3072 sc1 lds
ds_read_b128 a[248:251], v33
ds_read_b128 a[252:255], v33 offset:2048
v_rcp_f32 v243, v243
v_pk_mul_f32 v[220:221], v[220:221], v[208:209]
v_pk_mul_f32 v[222:223], v[222:223], v[210:211]
v_pk_mul_f32 v[40:41], v[40:41], v[240:241]
v_pk_mul_f32 v[42:43], v[42:43], v[242:243]
v_mfma_f32_16x16x32_bf16 v[4:7], a[228:231], a[76:79], v[4:7]
v_cvt_pk_bf16_f32 v208, v220, v221
v_cvt_pk_bf16_f32 v209, v222, v223
v_mfma_f32_16x16x32_bf16 v[4:7], a[224:227], a[68:71], v[4:7]
s_waitcnt lgkmcnt(4)
v_cvt_pk_bf16_f32 v210, v40, v41
v_cvt_pk_bf16_f32 v211, v42, v43
v_mfma_f32_16x16x32_bf16 v[4:7], a[232:235], a[84:87], v[4:7]
v_sub_f32_dpp v16, v16, v16 row_shl:1 row_mask:0xf bank_mask:0xf bound_ctrl:1
v_sub_f32_dpp v17, v17, v17 row_shl:1 row_mask:0xf bank_mask:0xf bound_ctrl:1
v_mfma_f32_16x16x32_bf16 v[4:7], a[236:239], a[92:95], v[4:7]
s_waitcnt vmcnt(63)
ds_read_b128 a[224:227], v33 offset:4096
ds_read_b128 a[228:231], v33 offset:6144
buffer_store_dwordx4 v[208:211], v37, s[24:27], s49 offen offset:256 sc1
v_sub_f32_dpp v18, v18, v18 row_shl:1 row_mask:0xf bank_mask:0xf bound_ctrl:1
v_sub_f32_dpp v19, v19, v19 row_shl:1 row_mask:0xf bank_mask:0xf bound_ctrl:1
v_sub_f32_dpp v24, v24, v24 row_shl:1 row_mask:0xf bank_mask:0xf bound_ctrl:1
v_sub_f32_dpp v25, v25, v25 row_shl:1 row_mask:0xf bank_mask:0xf bound_ctrl:1
v_sub_f32_dpp v26, v26, v26 row_shl:1 row_mask:0xf bank_mask:0xf bound_ctrl:1
v_sub_f32_dpp v27, v27, v27 row_shl:1 row_mask:0xf bank_mask:0xf bound_ctrl:1
v_pk_add_f32 v[48:49], v[48:49], v[16:17]
v_pk_add_f32 v[50:51], v[50:51], v[18:19]
v_pk_add_f32 v[56:57], v[56:57], v[24:25]
v_pk_add_f32 v[58:59], v[58:59], v[26:27]
v_mfma_f32_16x16x32_bf16 v[0:3], a[236:239], a[88:91], v[0:3]
s_add_u32 s53, s47, 778240
v_sub_f32_dpp v20, v20, v20 row_shl:1 row_mask:0xf bank_mask:0xf bound_ctrl:1
v_sub_f32_dpp v21, v21, v21 row_shl:1 row_mask:0xf bank_mask:0xf bound_ctrl:1
v_mfma_f32_16x16x32_bf16 v[0:3], a[232:235], a[80:83], v[0:3]
s_waitcnt lgkmcnt(4)
v_sub_f32_dpp v22, v22, v22 row_shl:1 row_mask:0xf bank_mask:0xf bound_ctrl:1
v_sub_f32_dpp v23, v23, v23 row_shl:1 row_mask:0xf bank_mask:0xf bound_ctrl:1
v_mfma_f32_16x16x32_bf16 v[0:3], a[240:243], a[96:99], v[0:3]
s_add_u32 m0, s43, 4096
v_sub_f32_dpp v28, v28, v28 row_shl:1 row_mask:0xf bank_mask:0xf bound_ctrl:1
v_sub_f32_dpp v29, v29, v29 row_shl:1 row_mask:0xf bank_mask:0xf bound_ctrl:1
v_mfma_f32_16x16x32_bf16 v[0:3], a[244:247], a[104:107], v[0:3]
s_waitcnt vmcnt(63)
buffer_load_dwordx4 v32, s[16:19], s53 offen sc1 lds
ds_read_b128 a[232:235], v33 offset:5120
ds_read_b128 a[236:239], v33 offset:7168
v_sub_f32_dpp v30, v30, v30 row_shl:1 row_mask:0xf bank_mask:0xf bound_ctrl:1
v_sub_f32_dpp v31, v31, v31 row_shl:1 row_mask:0xf bank_mask:0xf bound_ctrl:1
v_pk_add_f32 v[52:53], v[52:53], v[20:21]
v_pk_add_f32 v[54:55], v[54:55], v[22:23]
v_pk_add_f32 v[60:61], v[60:61], v[28:29]
v_pk_add_f32 v[62:63], v[62:63], v[30:31]
v_mfma_f32_16x16x32_bf16 v[4:7], a[244:247], a[108:111], v[4:7]
ds_read_b128 v[20:23], v38 offset:2304
ds_read_b128 v[24:27], v38 offset:2320
v_mfma_f32_16x16x32_bf16 v[4:7], a[240:243], a[100:103], v[4:7]
s_waitcnt lgkmcnt(6)
v_exp_f32 v248, v48
v_mfma_f32_16x16x32_bf16 v[4:7], a[248:251], a[116:119], v[4:7]
v_exp_f32 v249, v49
v_mfma_f32_16x16x32_bf16 v[4:7], a[252:255], a[124:127], v[4:7]
ds_read_b128 a[240:243], v33 offset:1024
ds_read_b128 a[244:247], v33 offset:3072
v_exp_f32 v250, v50
v_exp_f32 v251, v51
v_mfma_f32_16x16x32_bf16 v[0:3], a[252:255], a[120:123], v[0:3]
v_exp_f32 v196, v56
v_mfma_f32_16x16x32_bf16 v[0:3], a[248:251], a[112:115], v[0:3]
s_waitcnt lgkmcnt(6)
v_exp_f32 v197, v57
v_mfma_f32_16x16x32_bf16 v[0:3], a[224:227], a[128:131], v[0:3]
v_exp_f32 v198, v58
v_mfma_f32_16x16x32_bf16 v[0:3], a[228:231], a[136:139], v[0:3]
buffer_load_dwordx4 v32, s[16:19], s53 offen offset:1024 sc1 lds
ds_read_b128 a[248:251], v32 offset:62464
ds_read_b128 a[252:255], v32 offset:64512
v_exp_f32 v199, v59
v_pk_fma_f32 v[248:249], v[248:249], s[56:57], s[56:57]
v_pk_fma_f32 v[250:251], v[250:251], s[56:57], s[56:57]
v_pk_fma_f32 v[196:197], v[196:197], s[56:57], s[56:57]
v_pk_fma_f32 v[198:199], v[198:199], s[56:57], s[56:57]
v_mfma_f32_16x16x32_bf16 v[4:7], a[228:231], a[140:143], v[4:7]
v_rcp_f32 v248, v248
v_mfma_f32_16x16x32_bf16 v[4:7], a[224:227], a[132:135], v[4:7]
s_waitcnt lgkmcnt(6)
v_rcp_f32 v249, v249
v_rcp_f32 v250, v250
v_rcp_f32 v251, v251
v_rcp_f32 v196, v196
v_mfma_f32_16x16x32_bf16 v[12:15], a[232:235], a[132:135], v[8:11]
v_rcp_f32 v197, v197
v_mfma_f32_16x16x32_bf16 v[12:15], a[236:239], a[140:143], v[12:15]
s_waitcnt lgkmcnt(4)
ds_read_b128 a[224:227], v32 offset:58368
ds_read_b128 a[228:231], v32 offset:60416
v_rcp_f32 v198, v198
v_rcp_f32 v199, v199
v_pk_mul_f32 v[48:49], v[48:49], v[248:249]
v_pk_mul_f32 v[50:51], v[50:51], v[250:251]
v_pk_mul_f32 v[56:57], v[56:57], v[196:197]
v_pk_mul_f32 v[58:59], v[58:59], v[198:199]
v_cvt_pk_bf16_f32 v248, v48, v49
v_cvt_pk_bf16_f32 v249, v50, v51
v_cvt_pk_bf16_f32 v250, v56, v57
v_cvt_pk_bf16_f32 v251, v58, v59
v_pk_mul_f32 v[20:21], v[20:21], v[36:37] op_sel_hi:[1,0]
v_pk_mul_f32 v[22:23], v[22:23], v[36:37] op_sel_hi:[1,0]
v_pk_mul_f32 v[24:25], v[24:25], v[36:37] op_sel_hi:[1,0]
v_pk_mul_f32 v[26:27], v[26:27], v[36:37] op_sel_hi:[1,0]
v_mfma_f32_16x16x32_bf16 v[8:11], a[236:239], a[136:139], v[8:11]
v_exp_f32 v200, v52
v_mfma_f32_16x16x32_bf16 v[8:11], a[232:235], a[128:131], v[8:11]
s_waitcnt lgkmcnt(4)
v_exp_f32 v201, v53
v_mfma_f32_16x16x32_bf16 v[8:11], a[240:243], a[112:115], v[8:11]
v_exp_f32 v202, v54
v_mfma_f32_16x16x32_bf16 v[8:11], a[244:247], a[120:123], v[8:11]
buffer_load_dwordx4 v32, s[16:19], s53 offen offset:2048 sc1 lds
ds_read_b128 a[232:235], v32 offset:54272
ds_read_b128 a[236:239], v32 offset:56320
v_exp_f32 v203, v55
v_mfma_f32_16x16x32_bf16 v[12:15], a[244:247], a[124:127], v[12:15]
v_exp_f32 v224, v60
v_mfma_f32_16x16x32_bf16 v[12:15], a[240:243], a[116:119], v[12:15]
s_waitcnt lgkmcnt(4)
v_exp_f32 v225, v61
v_mfma_f32_16x16x32_bf16 v[12:15], a[248:251], a[100:103], v[12:15]
v_exp_f32 v226, v62
v_mfma_f32_16x16x32_bf16 v[12:15], a[252:255], a[108:111], v[12:15]
ds_read_b128 a[240:243], v32 offset:50176
ds_read_b128 a[244:247], v32 offset:52224
buffer_store_dwordx4 v[248:251], v37, s[24:27], s49 offen offset:1152 sc1
v_exp_f32 v227, v63
v_pk_fma_f32 v[200:201], v[200:201], s[56:57], s[56:57]
v_pk_fma_f32 v[202:203], v[202:203], s[56:57], s[56:57]
v_pk_fma_f32 v[224:225], v[224:225], s[56:57], s[56:57]
v_pk_fma_f32 v[226:227], v[226:227], s[56:57], s[56:57]
v_rcp_f32 v200, v200
v_rcp_f32 v201, v201
v_mfma_f32_16x16x32_bf16 v[8:11], a[252:255], a[104:107], v[8:11]
v_rcp_f32 v202, v202
v_mfma_f32_16x16x32_bf16 v[8:11], a[248:251], a[96:99], v[8:11]
s_waitcnt lgkmcnt(4)
v_rcp_f32 v203, v203
v_mfma_f32_16x16x32_bf16 v[8:11], a[224:227], a[80:83], v[8:11]
v_rcp_f32 v224, v224
v_mfma_f32_16x16x32_bf16 v[8:11], a[228:231], a[88:91], v[8:11]
buffer_load_dwordx4 v32, s[16:19], s53 offen offset:3072 sc1 lds
ds_read_b128 a[248:251], v32 offset:46080
ds_read_b128 a[252:255], v32 offset:48128
v_rcp_f32 v225, v225
v_rcp_f32 v226, v226
v_rcp_f32 v227, v227
v_pk_mul_f32 v[52:53], v[52:53], v[200:201]
v_pk_mul_f32 v[54:55], v[54:55], v[202:203]
v_pk_mul_f32 v[60:61], v[60:61], v[224:225]
v_pk_mul_f32 v[62:63], v[62:63], v[226:227]
v_mfma_f32_16x16x32_bf16 v[12:15], a[228:231], a[92:95], v[12:15]
s_load_dword s77, s[78:79], 57344
v_cvt_pk_bf16_f32 v200, v52, v53
v_cvt_pk_bf16_f32 v201, v54, v55
v_mfma_f32_16x16x32_bf16 v[12:15], a[224:227], a[84:87], v[12:15]
s_waitcnt lgkmcnt(4)
v_cvt_pk_bf16_f32 v202, v60, v61
v_cvt_pk_bf16_f32 v203, v62, v63
v_mfma_f32_16x16x32_bf16 v[12:15], a[232:235], a[68:71], v[12:15]
v_accvgpr_read_b32 v216, a148
v_accvgpr_read_b32 v217, a149
v_mfma_f32_16x16x32_bf16 v[12:15], a[236:239], a[76:79], v[12:15]
ds_read_b128 a[224:227], v32 offset:41984
ds_read_b128 a[228:231], v32 offset:44032
buffer_store_dwordx4 v[200:203], v37, s[24:27], s50 offen offset:1152 sc1
v_accvgpr_read_b32 v218, a150
v_accvgpr_read_b32 v219, a151
v_accvgpr_read_b32 v244, a156
v_accvgpr_read_b32 v245, a157
v_accvgpr_read_b32 v246, a158
v_accvgpr_read_b32 v247, a159
v_pk_add_f32 v[252:253], v[216:217], v[116:117]
v_pk_add_f32 v[116:117], v[216:217], v[116:117] neg_lo:[0,1] neg_hi:[0,1]
v_pk_add_f32 v[254:255], v[218:219], v[118:119]
v_pk_add_f32 v[118:119], v[218:219], v[118:119] neg_lo:[0,1] neg_hi:[0,1]
v_pk_add_f32 v[232:233], v[244:245], v[124:125]
v_pk_add_f32 v[124:125], v[244:245], v[124:125] neg_lo:[0,1] neg_hi:[0,1]
v_pk_add_f32 v[234:235], v[246:247], v[126:127]
v_pk_add_f32 v[126:127], v[246:247], v[126:127] neg_lo:[0,1] neg_hi:[0,1]
v_mfma_f32_16x16x32_bf16 v[8:11], a[236:239], a[72:75], v[8:11]
s_add_u32 s54, s47, 782336
v_exp_f32 v204, v252
v_mfma_f32_16x16x32_bf16 v[8:11], a[232:235], a[64:67], v[8:11]
s_waitcnt lgkmcnt(4)
v_exp_f32 v205, v253
v_mfma_f32_16x16x32_bf16 v[8:11], a[240:243], a[48:51], v[8:11]
s_add_u32 m0, s43, 8192
v_exp_f32 v206, v254
v_mfma_f32_16x16x32_bf16 v[8:11], a[244:247], a[56:59], v[8:11]
buffer_load_dwordx4 v32, s[16:19], s54 offen sc1 lds
ds_read_b128 a[232:235], v32 offset:37888
ds_read_b128 a[236:239], v32 offset:39936
v_exp_f32 v207, v255
v_exp_f32 v192, v232
v_mfma_f32_16x16x32_bf16 v[12:15], a[244:247], a[60:63], v[12:15]
v_exp_f32 v193, v233
v_mfma_f32_16x16x32_bf16 v[12:15], a[240:243], a[52:55], v[12:15]
s_waitcnt lgkmcnt(4)
v_exp_f32 v194, v234
v_mfma_f32_16x16x32_bf16 v[12:15], a[248:251], a[36:39], v[12:15]
L_pg13:
s_cbranch_vccnz L_vr3
v_exp_f32 v195, v235
v_mfma_f32_16x16x32_bf16 v[12:15], a[252:255], a[44:47], v[12:15]
s_waitcnt vmcnt(14)
s_barrier
ds_read_b128 a[240:243], v33 offset:8192
ds_read_b128 a[244:247], v33 offset:10240
v_pk_fma_f32 v[204:205], v[204:205], s[56:57], s[56:57]
v_pk_fma_f32 v[206:207], v[206:207], s[56:57], s[56:57]
v_pk_fma_f32 v[192:193], v[192:193], s[56:57], s[56:57]
v_pk_fma_f32 v[194:195], v[194:195], s[56:57], s[56:57]
v_mfma_f32_16x16x32_bf16 v[8:11], a[252:255], a[40:43], v[8:11]
s_add_u32 s52, s47, 811008
v_rcp_f32 v204, v204
v_mfma_f32_16x16x32_bf16 v[8:11], a[248:251], a[32:35], v[8:11]
s_waitcnt lgkmcnt(4)
v_rcp_f32 v205, v205
v_mfma_f32_16x16x32_bf16 v[8:11], a[224:227], a[16:19], v[8:11]
s_add_u32 m0, s43, 36864
v_rcp_f32 v206, v206
v_mfma_f32_16x16x32_bf16 v[8:11], a[228:231], a[24:27], v[8:11]
buffer_load_dwordx4 v32, s[16:19], s52 offen sc1 lds
ds_read_b128 a[248:251], v33 offset:12288
ds_read_b128 a[252:255], v33 offset:14336
v_mfma_f32_16x16x32_bf16 v[12:15], a[228:231], a[28:31], v[12:15]
v_rcp_f32 v207, v207
v_mfma_f32_16x16x32_bf16 v[12:15], a[224:227], a[20:23], v[12:15]
s_waitcnt lgkmcnt(4)
v_rcp_f32 v192, v192
v_mfma_f32_16x16x32_bf16 v[12:15], a[232:235], a[4:7], v[12:15]
v_rcp_f32 v193, v193
v_mfma_f32_16x16x32_bf16 v[12:15], a[236:239], a[12:15], v[12:15]
ds_read_b128 a[224:227], v33 offset:16384
ds_read_b128 a[228:231], v33 offset:18432
v_rcp_f32 v194, v194
v_rcp_f32 v195, v195
v_pk_mul_f32 v[252:253], v[252:253], v[204:205]
v_pk_mul_f32 v[254:255], v[254:255], v[206:207]
v_pk_mul_f32 v[232:233], v[232:233], v[192:193]
v_pk_mul_f32 v[234:235], v[234:235], v[194:195]
v_mfma_f32_16x16x32_bf16 v[8:11], a[236:239], a[8:11], v[8:11]
v_cvt_pk_bf16_f32 v204, v252, v253
v_cvt_pk_bf16_f32 v205, v254, v255
v_mfma_f32_16x16x32_bf16 v[8:11], a[232:235], a[0:3], v[8:11]
s_waitcnt lgkmcnt(4)
v_cvt_pk_bf16_f32 v206, v232, v233
v_cvt_pk_bf16_f32 v207, v234, v235
v_mfma_f32_16x16x32_bf16 v[16:19], a[240:243], a[0:3], v[20:23]
v_accvgpr_read_b32 v228, a160
v_accvgpr_read_b32 v229, a161
v_mfma_f32_16x16x32_bf16 v[16:19], a[244:247], a[8:11], v[16:19]
buffer_load_dwordx4 v32, s[16:19], s52 offen offset:1024 sc1 lds
ds_read_b128 a[232:235], v33 offset:20480
ds_read_b128 a[236:239], v33 offset:22528
v_accvgpr_read_b32 v230, a162
v_accvgpr_read_b32 v231, a163
v_accvgpr_read_b32 v236, a168
v_mfma_f32_16x16x32_bf16 v[20:23], a[244:247], a[12:15], v[20:23]
buffer_store_dwordx4 v[204:207], v37, s[24:27], s50 offen offset:256 sc1
v_accvgpr_read_b32 v237, a169
v_accvgpr_read_b32 v238, a170
v_accvgpr_read_b32 v239, a171
v_pk_add_f32 v[44:45], v[228:229], v[128:129]
v_pk_add_f32 v[128:129], v[228:229], v[128:129] neg_lo:[0,1] neg_hi:[0,1]
v_pk_add_f32 v[46:47], v[230:231], v[130:131]
v_pk_add_f32 v[130:131], v[230:231], v[130:131] neg_lo:[0,1] neg_hi:[0,1]
v_pk_add_f32 v[212:213], v[236:237], v[136:137]
v_pk_add_f32 v[136:137], v[236:237], v[136:137] neg_lo:[0,1] neg_hi:[0,1]
v_pk_add_f32 v[214:215], v[238:239], v[138:139]
v_pk_add_f32 v[138:139], v[238:239], v[138:139] neg_lo:[0,1] neg_hi:[0,1]
v_mfma_f32_16x16x32_bf16 v[20:23], a[240:243], a[4:7], v[20:23]
s_waitcnt lgkmcnt(4)
v_exp_f32 v220, v44
v_mfma_f32_16x16x32_bf16 v[20:23], a[248:251], a[20:23], v[20:23]
v_exp_f32 v221, v45
v_mfma_f32_16x16x32_bf16 v[20:23], a[252:255], a[28:31], v[20:23]
ds_read_b128 a[240:243], v33 offset:24576
ds_read_b128 a[244:247], v33 offset:26624
v_exp_f32 v222, v46
v_exp_f32 v223, v47
v_mfma_f32_16x16x32_bf16 v[16:19], a[252:255], a[24:27], v[16:19]
v_exp_f32 v40, v212
v_mfma_f32_16x16x32_bf16 v[16:19], a[248:251], a[16:19], v[16:19]
s_waitcnt lgkmcnt(4)
v_exp_f32 v41, v213
v_mfma_f32_16x16x32_bf16 v[16:19], a[224:227], a[32:35], v[16:19]
v_exp_f32 v42, v214
v_mfma_f32_16x16x32_bf16 v[16:19], a[228:231], a[40:43], v[16:19]
buffer_load_dwordx4 v32, s[16:19], s52 offen offset:2048 sc1 lds
ds_read_b128 a[248:251], v33 offset:28672
ds_read_b128 a[252:255], v33 offset:30720
v_exp_f32 v43, v215
v_pk_fma_f32 v[220:221], v[220:221], s[56:57], s[56:57]
v_pk_fma_f32 v[222:223], v[222:223], s[56:57], s[56:57]
v_pk_fma_f32 v[40:41], v[40:41], s[56:57], s[56:57]
v_pk_fma_f32 v[42:43], v[42:43], s[56:57], s[56:57]
v_mfma_f32_16x16x32_bf16 v[20:23], a[228:231], a[44:47], v[20:23]
v_rcp_f32 v220, v220
v_mfma_f32_16x16x32_bf16 v[20:23], a[224:227], a[36:39], v[20:23]
s_waitcnt lgkmcnt(4)
v_rcp_f32 v221, v221
v_mfma_f32_16x16x32_bf16 v[20:23], a[232:235], a[52:55], v[20:23]
v_rcp_f32 v222, v222
v_mfma_f32_16x16x32_bf16 v[20:23], a[236:239], a[60:63], v[20:23]
ds_read_b128 a[224:227], v33 offset:32768
ds_read_b128 a[228:231], v33 offset:34816
v_rcp_f32 v223, v223
v_mfma_f32_16x16x32_bf16 v[16:19], a[236:239], a[56:59], v[16:19]
v_rcp_f32 v40, v40
v_mfma_f32_16x16x32_bf16 v[16:19], a[232:235], a[48:51], v[16:19]
s_waitcnt lgkmcnt(4)
v_rcp_f32 v41, v41
v_mfma_f32_16x16x32_bf16 v[16:19], a[240:243], a[64:67], v[16:19]
v_rcp_f32 v42, v42
v_mfma_f32_16x16x32_bf16 v[16:19], a[244:247], a[72:75], v[16:19]
buffer_load_dwordx4 v32, s[16:19], s52 offen offset:3072 sc1 lds
ds_read_b128 a[232:235], v33 offset:36864
ds_read_b128 a[236:239], v33 offset:38912
v_rcp_f32 v43, v43
v_pk_mul_f32 v[44:45], v[44:45], v[220:221]
v_pk_mul_f32 v[46:47], v[46:47], v[222:223]
v_pk_mul_f32 v[212:213], v[212:213], v[40:41]
v_pk_mul_f32 v[214:215], v[214:215], v[42:43]
v_mfma_f32_16x16x32_bf16 v[20:23], a[244:247], a[76:79], v[20:23]
v_cvt_pk_bf16_f32 v220, v44, v45
v_cvt_pk_bf16_f32 v221, v46, v47
v_mfma_f32_16x16x32_bf16 v[20:23], a[240:243], a[68:71], v[20:23]
s_waitcnt lgkmcnt(4)
v_cvt_pk_bf16_f32 v222, v212, v213
v_cvt_pk_bf16_f32 v223, v214, v215
v_mfma_f32_16x16x32_bf16 v[20:23], a[248:251], a[84:87], v[20:23]
v_sub_f32_dpp v0, v0, v0 row_shl:1 row_mask:0xf bank_mask:0xf bound_ctrl:1
v_sub_f32_dpp v1, v1, v1 row_shl:1 row_mask:0xf bank_mask:0xf bound_ctrl:1
v_mfma_f32_16x16x32_bf16 v[20:23], a[252:255], a[92:95], v[20:23]
s_waitcnt vmcnt(63)
ds_read_b128 a[240:243], v33 offset:40960
ds_read_b128 a[244:247], v33 offset:43008
buffer_store_dwordx4 v[220:223], v37, s[24:27], s49 offen offset:320 sc1
v_sub_f32_dpp v2, v2, v2 row_shl:1 row_mask:0xf bank_mask:0xf bound_ctrl:1
v_sub_f32_dpp v3, v3, v3 row_shl:1 row_mask:0xf bank_mask:0xf bound_ctrl:1
v_sub_f32_dpp v8, v8, v8 row_shl:1 row_mask:0xf bank_mask:0xf bound_ctrl:1
v_sub_f32_dpp v9, v9, v9 row_shl:1 row_mask:0xf bank_mask:0xf bound_ctrl:1
v_sub_f32_dpp v10, v10, v10 row_shl:1 row_mask:0xf bank_mask:0xf bound_ctrl:1
v_sub_f32_dpp v11, v11, v11 row_shl:1 row_mask:0xf bank_mask:0xf bound_ctrl:1
v_pk_add_f32 v[64:65], v[64:65], v[0:1]
v_pk_add_f32 v[66:67], v[66:67], v[2:3]
v_pk_add_f32 v[72:73], v[72:73], v[8:9]
v_pk_add_f32 v[74:75], v[74:75], v[10:11]
v_mfma_f32_16x16x32_bf16 v[16:19], a[252:255], a[88:91], v[16:19]
s_add_u32 s53, s47, 815104
v_sub_f32_dpp v4, v4, v4 row_shl:1 row_mask:0xf bank_mask:0xf bound_ctrl:1
v_sub_f32_dpp v5, v5, v5 row_shl:1 row_mask:0xf bank_mask:0xf bound_ctrl:1
v_mfma_f32_16x16x32_bf16 v[16:19], a[248:251], a[80:83], v[16:19]
s_waitcnt lgkmcnt(4)
v_sub_f32_dpp v6, v6, v6 row_shl:1 row_mask:0xf bank_mask:0xf bound_ctrl:1
v_sub_f32_dpp v7, v7, v7 row_shl:1 row_mask:0xf bank_mask:0xf bound_ctrl:1
v_mfma_f32_16x16x32_bf16 v[16:19], a[224:227], a[96:99], v[16:19]
s_add_u32 m0, s43, 40960
v_sub_f32_dpp v12, v12, v12 row_shl:1 row_mask:0xf bank_mask:0xf bound_ctrl:1
v_sub_f32_dpp v13, v13, v13 row_shl:1 row_mask:0xf bank_mask:0xf bound_ctrl:1
v_mfma_f32_16x16x32_bf16 v[16:19], a[228:231], a[104:107], v[16:19]
s_waitcnt vmcnt(63)
buffer_load_dwordx4 v32, s[16:19], s53 offen sc1 lds
ds_read_b128 a[248:251], v33 offset:41984
ds_read_b128 a[252:255], v33 offset:44032
v_sub_f32_dpp v14, v14, v14 row_shl:1 row_mask:0xf bank_mask:0xf bound_ctrl:1
v_sub_f32_dpp v15, v15, v15 row_shl:1 row_mask:0xf bank_mask:0xf bound_ctrl:1
v_pk_add_f32 v[68:69], v[68:69], v[4:5]
v_pk_add_f32 v[70:71], v[70:71], v[6:7]
v_pk_add_f32 v[76:77], v[76:77], v[12:13]
v_pk_add_f32 v[78:79], v[78:79], v[14:15]
v_mfma_f32_16x16x32_bf16 v[20:23], a[228:231], a[108:111], v[20:23]
ds_read_b128 v[4:7], v38 offset:2432
ds_read_b128 v[8:11], v38 offset:2448
v_mfma_f32_16x16x32_bf16 v[20:23], a[224:227], a[100:103], v[20:23]
s_waitcnt lgkmcnt(6)
v_exp_f32 v240, v64
v_mfma_f32_16x16x32_bf16 v[20:23], a[232:235], a[116:119], v[20:23]
v_exp_f32 v241, v65
v_mfma_f32_16x16x32_bf16 v[20:23], a[236:239], a[124:127], v[20:23]
ds_read_b128 a[224:227], v33 offset:37888
ds_read_b128 a[228:231], v33 offset:39936
v_exp_f32 v242, v66
v_exp_f32 v243, v67
v_mfma_f32_16x16x32_bf16 v[16:19], a[236:239], a[120:123], v[16:19]
v_exp_f32 v208, v72
v_mfma_f32_16x16x32_bf16 v[16:19], a[232:235], a[112:115], v[16:19]
s_waitcnt lgkmcnt(6)
v_exp_f32 v209, v73
v_mfma_f32_16x16x32_bf16 v[16:19], a[240:243], a[128:131], v[16:19]
v_exp_f32 v210, v74
v_mfma_f32_16x16x32_bf16 v[16:19], a[244:247], a[136:139], v[16:19]
buffer_load_dwordx4 v32, s[16:19], s53 offen offset:1024 sc1 lds
ds_read_b128 a[232:235], v33 offset:33792
ds_read_b128 a[236:239], v33 offset:35840
v_exp_f32 v211, v75
v_pk_fma_f32 v[240:241], v[240:241], s[56:57], s[56:57]
v_pk_fma_f32 v[242:243], v[242:243], s[56:57], s[56:57]
v_pk_fma_f32 v[208:209], v[208:209], s[56:57], s[56:57]
v_pk_fma_f32 v[210:211], v[210:211], s[56:57], s[56:57]
v_mfma_f32_16x16x32_bf16 v[20:23], a[244:247], a[140:143], v[20:23]
v_rcp_f32 v240, v240
v_mfma_f32_16x16x32_bf16 v[20:23], a[240:243], a[132:135], v[20:23]
s_waitcnt lgkmcnt(6)
v_rcp_f32 v241, v241
v_rcp_f32 v242, v242
v_rcp_f32 v243, v243
v_rcp_f32 v208, v208
v_mfma_f32_16x16x32_bf16 v[28:31], a[248:251], a[132:135], v[24:27]
v_rcp_f32 v209, v209
v_mfma_f32_16x16x32_bf16 v[28:31], a[252:255], a[140:143], v[28:31]
s_waitcnt lgkmcnt(4)
ds_read_b128 a[240:243], v33 offset:29696
ds_read_b128 a[244:247], v33 offset:31744
v_rcp_f32 v210, v210
v_rcp_f32 v211, v211
v_pk_mul_f32 v[64:65], v[64:65], v[240:241]
v_pk_mul_f32 v[66:67], v[66:67], v[242:243]
v_pk_mul_f32 v[72:73], v[72:73], v[208:209]
v_pk_mul_f32 v[74:75], v[74:75], v[210:211]
v_cvt_pk_bf16_f32 v240, v64, v65
v_cvt_pk_bf16_f32 v241, v66, v67
v_cvt_pk_bf16_f32 v242, v72, v73
v_cvt_pk_bf16_f32 v243, v74, v75
v_pk_mul_f32 v[4:5], v[4:5], v[36:37] op_sel_hi:[1,0]
v_pk_mul_f32 v[6:7], v[6:7], v[36:37] op_sel_hi:[1,0]
v_pk_mul_f32 v[8:9], v[8:9], v[36:37] op_sel_hi:[1,0]
v_pk_mul_f32 v[10:11], v[10:11], v[36:37] op_sel_hi:[1,0]
v_mfma_f32_16x16x32_bf16 v[24:27], a[252:255], a[136:139], v[24:27]
v_exp_f32 v48, v68
v_mfma_f32_16x16x32_bf16 v[24:27], a[248:251], a[128:131], v[24:27]
s_waitcnt lgkmcnt(4)
v_exp_f32 v49, v69
v_mfma_f32_16x16x32_bf16 v[24:27], a[224:227], a[112:115], v[24:27]
v_exp_f32 v50, v70
v_mfma_f32_16x16x32_bf16 v[24:27], a[228:231], a[120:123], v[24:27]
buffer_load_dwordx4 v32, s[16:19], s53 offen offset:2048 sc1 lds
ds_read_b128 a[248:251], v33 offset:25600
ds_read_b128 a[252:255], v33 offset:27648
v_exp_f32 v51, v71
v_mfma_f32_16x16x32_bf16 v[28:31], a[228:231], a[124:127], v[28:31]
v_exp_f32 v56, v76
v_mfma_f32_16x16x32_bf16 v[28:31], a[224:227], a[116:119], v[28:31]
s_waitcnt lgkmcnt(4)
v_exp_f32 v57, v77
v_mfma_f32_16x16x32_bf16 v[28:31], a[232:235], a[100:103], v[28:31]
v_exp_f32 v58, v78
v_mfma_f32_16x16x32_bf16 v[28:31], a[236:239], a[108:111], v[28:31]
ds_read_b128 a[224:227], v33 offset:21504
ds_read_b128 a[228:231], v33 offset:23552
buffer_store_dwordx4 v[240:243], v37, s[24:27], s49 offen offset:1216 sc1
v_exp_f32 v59, v79
v_pk_fma_f32 v[48:49], v[48:49], s[56:57], s[56:57]
v_pk_fma_f32 v[50:51], v[50:51], s[56:57], s[56:57]
v_pk_fma_f32 v[56:57], v[56:57], s[56:57], s[56:57]
v_pk_fma_f32 v[58:59], v[58:59], s[56:57], s[56:57]
v_rcp_f32 v48, v48
v_rcp_f32 v49, v49
v_mfma_f32_16x16x32_bf16 v[24:27], a[236:239], a[104:107], v[24:27]
v_rcp_f32 v50, v50
v_mfma_f32_16x16x32_bf16 v[24:27], a[232:235], a[96:99], v[24:27]
s_waitcnt lgkmcnt(4)
v_rcp_f32 v51, v51
v_mfma_f32_16x16x32_bf16 v[24:27], a[240:243], a[80:83], v[24:27]
v_rcp_f32 v56, v56
v_mfma_f32_16x16x32_bf16 v[24:27], a[244:247], a[88:91], v[24:27]
buffer_load_dwordx4 v32, s[16:19], s53 offen offset:3072 sc1 lds
ds_read_b128 a[232:235], v33 offset:17408
ds_read_b128 a[236:239], v33 offset:19456
v_rcp_f32 v57, v57
v_rcp_f32 v58, v58
v_rcp_f32 v59, v59
v_pk_mul_f32 v[68:69], v[68:69], v[48:49]
v_pk_mul_f32 v[70:71], v[70:71], v[50:51]
v_pk_mul_f32 v[76:77], v[76:77], v[56:57]
v_pk_mul_f32 v[78:79], v[78:79], v[58:59]
v_mfma_f32_16x16x32_bf16 v[28:31], a[244:247], a[92:95], v[28:31]
v_cvt_pk_bf16_f32 v48, v68, v69
v_cvt_pk_bf16_f32 v49, v70, v71
v_mfma_f32_16x16x32_bf16 v[28:31], a[240:243], a[84:87], v[28:31]
s_waitcnt lgkmcnt(4)
v_cvt_pk_bf16_f32 v50, v76, v77
v_cvt_pk_bf16_f32 v51, v78, v79
v_mfma_f32_16x16x32_bf16 v[28:31], a[248:251], a[68:71], v[28:31]
v_accvgpr_read_b32 v196, a164
v_accvgpr_read_b32 v197, a165
v_mfma_f32_16x16x32_bf16 v[28:31], a[252:255], a[76:79], v[28:31]
ds_read_b128 a[240:243], v33 offset:13312
ds_read_b128 a[244:247], v33 offset:15360
buffer_store_dwordx4 v[48:51], v37, s[24:27], s50 offen offset:1216 sc1
v_accvgpr_read_b32 v198, a166
v_accvgpr_read_b32 v199, a167
v_accvgpr_read_b32 v248, a172
v_accvgpr_read_b32 v249, a173
v_accvgpr_read_b32 v250, a174
v_accvgpr_read_b32 v251, a175
v_pk_add_f32 v[52:53], v[196:197], v[132:133]
v_pk_add_f32 v[132:133], v[196:197], v[132:133] neg_lo:[0,1] neg_hi:[0,1]
v_pk_add_f32 v[54:55], v[198:199], v[134:135]
v_pk_add_f32 v[134:135], v[198:199], v[134:135] neg_lo:[0,1] neg_hi:[0,1]
v_pk_add_f32 v[60:61], v[248:249], v[140:141]
v_pk_add_f32 v[140:141], v[248:249], v[140:141] neg_lo:[0,1] neg_hi:[0,1]
v_pk_add_f32 v[62:63], v[250:251], v[142:143]
v_pk_add_f32 v[142:143], v[250:251], v[142:143] neg_lo:[0,1] neg_hi:[0,1]
v_mfma_f32_16x16x32_bf16 v[24:27], a[252:255], a[72:75], v[24:27]
s_add_u32 s54, s47, 819200
v_exp_f32 v224, v52
v_mfma_f32_16x16x32_bf16 v[24:27], a[248:251], a[64:67], v[24:27]
s_waitcnt lgkmcnt(4)
v_exp_f32 v225, v53
v_mfma_f32_16x16x32_bf16 v[24:27], a[224:227], a[48:51], v[24:27]
s_add_u32 m0, s43, 45056
v_exp_f32 v226, v54
v_mfma_f32_16x16x32_bf16 v[24:27], a[228:231], a[56:59], v[24:27]
buffer_load_dwordx4 v32, s[16:19], s54 offen sc1 lds
ds_read_b128 a[248:251], v33 offset:9216
ds_read_b128 a[252:255], v33 offset:11264
v_exp_f32 v227, v55
v_exp_f32 v216, v60
v_mfma_f32_16x16x32_bf16 v[28:31], a[228:231], a[60:63], v[28:31]
v_exp_f32 v217, v61
v_mfma_f32_16x16x32_bf16 v[28:31], a[224:227], a[52:55], v[28:31]
s_waitcnt lgkmcnt(4)
v_exp_f32 v218, v62
v_mfma_f32_16x16x32_bf16 v[28:31], a[232:235], a[36:39], v[28:31]
v_exp_f32 v219, v63
v_mfma_f32_16x16x32_bf16 v[28:31], a[236:239], a[44:47], v[28:31]
s_waitcnt vmcnt(13)
s_barrier
ds_read_b128 a[224:227], v32
ds_read_b128 a[228:231], v32 offset:2048
v_pk_fma_f32 v[224:225], v[224:225], s[56:57], s[56:57]
v_pk_fma_f32 v[226:227], v[226:227], s[56:57], s[56:57]
v_pk_fma_f32 v[216:217], v[216:217], s[56:57], s[56:57]
v_pk_fma_f32 v[218:219], v[218:219], s[56:57], s[56:57]
v_mfma_f32_16x16x32_bf16 v[24:27], a[236:239], a[40:43], v[24:27]
s_add_u32 s52, s47, 847872
v_rcp_f32 v224, v224
v_mfma_f32_16x16x32_bf16 v[24:27], a[232:235], a[32:35], v[24:27]
s_waitcnt lgkmcnt(4)
v_rcp_f32 v225, v225
v_mfma_f32_16x16x32_bf16 v[24:27], a[240:243], a[16:19], v[24:27]
s_add_u32 m0, s43, 73728
v_rcp_f32 v226, v226
v_mfma_f32_16x16x32_bf16 v[24:27], a[244:247], a[24:27], v[24:27]
buffer_load_dwordx4 v32, s[16:19], s52 offen sc1 lds
ds_read_b128 a[232:235], v32 offset:4096
ds_read_b128 a[236:239], v32 offset:6144
v_mfma_f32_16x16x32_bf16 v[28:31], a[244:247], a[28:31], v[28:31]
v_rcp_f32 v227, v227
v_mfma_f32_16x16x32_bf16 v[28:31], a[240:243], a[20:23], v[28:31]
s_waitcnt lgkmcnt(4)
v_rcp_f32 v216, v216
v_mfma_f32_16x16x32_bf16 v[28:31], a[248:251], a[4:7], v[28:31]
v_rcp_f32 v217, v217
v_mfma_f32_16x16x32_bf16 v[28:31], a[252:255], a[12:15], v[28:31]
ds_read_b128 a[240:243], v32 offset:8192
ds_read_b128 a[244:247], v32 offset:10240
v_rcp_f32 v218, v218
v_rcp_f32 v219, v219
v_pk_mul_f32 v[52:53], v[52:53], v[224:225]
v_pk_mul_f32 v[54:55], v[54:55], v[226:227]
v_pk_mul_f32 v[60:61], v[60:61], v[216:217]
v_pk_mul_f32 v[62:63], v[62:63], v[218:219]
v_mfma_f32_16x16x32_bf16 v[24:27], a[252:255], a[8:11], v[24:27]
v_cvt_pk_bf16_f32 v224, v52, v53
v_cvt_pk_bf16_f32 v225, v54, v55
v_mfma_f32_16x16x32_bf16 v[24:27], a[248:251], a[0:3], v[24:27]
s_waitcnt lgkmcnt(4)
v_cvt_pk_bf16_f32 v226, v60, v61
v_cvt_pk_bf16_f32 v227, v62, v63
v_mfma_f32_16x16x32_bf16 v[0:3], a[224:227], a[0:3], v[4:7]
v_accvgpr_read_b32 v244, a176
v_accvgpr_read_b32 v245, a177
v_mfma_f32_16x16x32_bf16 v[0:3], a[228:231], a[8:11], v[0:3]
s_waitcnt vmcnt(63)
buffer_load_dwordx4 v32, s[16:19], s52 offen offset:1024 sc1 lds
ds_read_b128 a[248:251], v32 offset:12288
ds_read_b128 a[252:255], v32 offset:14336
v_accvgpr_read_b32 v246, a178
v_accvgpr_read_b32 v247, a179
v_accvgpr_read_b32 v200, a184
v_mfma_f32_16x16x32_bf16 v[4:7], a[228:231], a[12:15], v[4:7]
buffer_store_dwordx4 v[224:227], v37, s[24:27], s50 offen offset:320 sc1
v_accvgpr_read_b32 v201, a185
v_accvgpr_read_b32 v202, a186
v_accvgpr_read_b32 v203, a187
v_pk_add_f32 v[252:253], v[244:245], v[144:145]
v_pk_add_f32 v[144:145], v[244:245], v[144:145] neg_lo:[0,1] neg_hi:[0,1]
v_pk_add_f32 v[254:255], v[246:247], v[146:147]
v_pk_add_f32 v[146:147], v[246:247], v[146:147] neg_lo:[0,1] neg_hi:[0,1]
v_pk_add_f32 v[232:233], v[200:201], v[152:153]
v_pk_add_f32 v[152:153], v[200:201], v[152:153] neg_lo:[0,1] neg_hi:[0,1]
v_pk_add_f32 v[234:235], v[202:203], v[154:155]
v_pk_add_f32 v[154:155], v[202:203], v[154:155] neg_lo:[0,1] neg_hi:[0,1]
v_mfma_f32_16x16x32_bf16 v[4:7], a[224:227], a[4:7], v[4:7]
s_waitcnt lgkmcnt(4)
v_exp_f32 v192, v252
v_mfma_f32_16x16x32_bf16 v[4:7], a[232:235], a[20:23], v[4:7]
v_exp_f32 v193, v253
v_mfma_f32_16x16x32_bf16 v[4:7], a[236:239], a[28:31], v[4:7]
ds_read_b128 a[224:227], v32 offset:16384
ds_read_b128 a[228:231], v32 offset:18432
v_exp_f32 v194, v254
v_exp_f32 v195, v255
v_mfma_f32_16x16x32_bf16 v[0:3], a[236:239], a[24:27], v[0:3]
v_exp_f32 v228, v232
v_mfma_f32_16x16x32_bf16 v[0:3], a[232:235], a[16:19], v[0:3]
s_waitcnt lgkmcnt(4)
v_exp_f32 v229, v233
v_mfma_f32_16x16x32_bf16 v[0:3], a[240:243], a[32:35], v[0:3]
v_exp_f32 v230, v234
v_mfma_f32_16x16x32_bf16 v[0:3], a[244:247], a[40:43], v[0:3]
buffer_load_dwordx4 v32, s[16:19], s52 offen offset:2048 sc1 lds
ds_read_b128 a[232:235], v32 offset:20480
ds_read_b128 a[236:239], v32 offset:22528
v_exp_f32 v231, v235
v_pk_fma_f32 v[192:193], v[192:193], s[56:57], s[56:57]
v_pk_fma_f32 v[194:195], v[194:195], s[56:57], s[56:57]
v_pk_fma_f32 v[228:229], v[228:229], s[56:57], s[56:57]
v_pk_fma_f32 v[230:231], v[230:231], s[56:57], s[56:57]
v_mfma_f32_16x16x32_bf16 v[4:7], a[244:247], a[44:47], v[4:7]
v_rcp_f32 v192, v192
v_mfma_f32_16x16x32_bf16 v[4:7], a[240:243], a[36:39], v[4:7]
s_waitcnt lgkmcnt(4)
v_rcp_f32 v193, v193
v_mfma_f32_16x16x32_bf16 v[4:7], a[248:251], a[52:55], v[4:7]
v_rcp_f32 v194, v194
v_mfma_f32_16x16x32_bf16 v[4:7], a[252:255], a[60:63], v[4:7]
ds_read_b128 a[240:243], v32 offset:24576
ds_read_b128 a[244:247], v32 offset:26624
v_rcp_f32 v195, v195
v_mfma_f32_16x16x32_bf16 v[0:3], a[252:255], a[56:59], v[0:3]
v_rcp_f32 v228, v228
v_mfma_f32_16x16x32_bf16 v[0:3], a[248:251], a[48:51], v[0:3]
s_waitcnt lgkmcnt(4)
v_rcp_f32 v229, v229
v_mfma_f32_16x16x32_bf16 v[0:3], a[224:227], a[64:67], v[0:3]
v_rcp_f32 v230, v230
v_mfma_f32_16x16x32_bf16 v[0:3], a[228:231], a[72:75], v[0:3]
buffer_load_dwordx4 v32, s[16:19], s52 offen offset:3072 sc1 lds
ds_read_b128 a[248:251], v32 offset:28672
ds_read_b128 a[252:255], v32 offset:30720
v_rcp_f32 v231, v231
v_pk_mul_f32 v[252:253], v[252:253], v[192:193]
v_pk_mul_f32 v[254:255], v[254:255], v[194:195]
v_pk_mul_f32 v[232:233], v[232:233], v[228:229]
v_pk_mul_f32 v[234:235], v[234:235], v[230:231]
v_mfma_f32_16x16x32_bf16 v[4:7], a[228:231], a[76:79], v[4:7]
v_cvt_pk_bf16_f32 v192, v252, v253
v_cvt_pk_bf16_f32 v193, v254, v255
v_mfma_f32_16x16x32_bf16 v[4:7], a[224:227], a[68:71], v[4:7]
s_waitcnt lgkmcnt(4)
v_cvt_pk_bf16_f32 v194, v232, v233
v_cvt_pk_bf16_f32 v195, v234, v235
v_mfma_f32_16x16x32_bf16 v[4:7], a[232:235], a[84:87], v[4:7]
v_sub_f32_dpp v16, v16, v16 row_shl:1 row_mask:0xf bank_mask:0xf bound_ctrl:1
v_sub_f32_dpp v17, v17, v17 row_shl:1 row_mask:0xf bank_mask:0xf bound_ctrl:1
v_mfma_f32_16x16x32_bf16 v[4:7], a[236:239], a[92:95], v[4:7]
s_waitcnt vmcnt(63)
ds_read_b128 a[224:227], v32 offset:32768
ds_read_b128 a[228:231], v32 offset:34816
buffer_store_dwordx4 v[192:195], v37, s[24:27], s49 offen offset:384 sc1
v_sub_f32_dpp v18, v18, v18 row_shl:1 row_mask:0xf bank_mask:0xf bound_ctrl:1
v_sub_f32_dpp v19, v19, v19 row_shl:1 row_mask:0xf bank_mask:0xf bound_ctrl:1
v_sub_f32_dpp v24, v24, v24 row_shl:1 row_mask:0xf bank_mask:0xf bound_ctrl:1
v_sub_f32_dpp v25, v25, v25 row_shl:1 row_mask:0xf bank_mask:0xf bound_ctrl:1
v_sub_f32_dpp v26, v26, v26 row_shl:1 row_mask:0xf bank_mask:0xf bound_ctrl:1
v_sub_f32_dpp v27, v27, v27 row_shl:1 row_mask:0xf bank_mask:0xf bound_ctrl:1
v_pk_add_f32 v[80:81], v[80:81], v[16:17]
v_pk_add_f32 v[82:83], v[82:83], v[18:19]
v_pk_add_f32 v[88:89], v[88:89], v[24:25]
v_pk_add_f32 v[90:91], v[90:91], v[26:27]
v_mfma_f32_16x16x32_bf16 v[0:3], a[236:239], a[88:91], v[0:3]
s_add_u32 s53, s47, 851968
v_sub_f32_dpp v20, v20, v20 row_shl:1 row_mask:0xf bank_mask:0xf bound_ctrl:1
v_sub_f32_dpp v21, v21, v21 row_shl:1 row_mask:0xf bank_mask:0xf bound_ctrl:1
v_mfma_f32_16x16x32_bf16 v[0:3], a[232:235], a[80:83], v[0:3]
s_waitcnt lgkmcnt(4)
v_sub_f32_dpp v22, v22, v22 row_shl:1 row_mask:0xf bank_mask:0xf bound_ctrl:1
v_sub_f32_dpp v23, v23, v23 row_shl:1 row_mask:0xf bank_mask:0xf bound_ctrl:1
v_mfma_f32_16x16x32_bf16 v[0:3], a[240:243], a[96:99], v[0:3]
s_add_u32 m0, s43, 77824
v_sub_f32_dpp v28, v28, v28 row_shl:1 row_mask:0xf bank_mask:0xf bound_ctrl:1
v_sub_f32_dpp v29, v29, v29 row_shl:1 row_mask:0xf bank_mask:0xf bound_ctrl:1
v_mfma_f32_16x16x32_bf16 v[0:3], a[244:247], a[104:107], v[0:3]
s_waitcnt vmcnt(63)
buffer_load_dwordx4 v32, s[16:19], s53 offen sc1 lds
ds_read_b128 a[232:235], v32 offset:33792
ds_read_b128 a[236:239], v32 offset:35840
v_sub_f32_dpp v30, v30, v30 row_shl:1 row_mask:0xf bank_mask:0xf bound_ctrl:1
v_sub_f32_dpp v31, v31, v31 row_shl:1 row_mask:0xf bank_mask:0xf bound_ctrl:1
v_pk_add_f32 v[84:85], v[84:85], v[20:21]
v_pk_add_f32 v[86:87], v[86:87], v[22:23]
v_pk_add_f32 v[92:93], v[92:93], v[28:29]
v_pk_add_f32 v[94:95], v[94:95], v[30:31]
v_mfma_f32_16x16x32_bf16 v[4:7], a[244:247], a[108:111], v[4:7]
ds_read_b128 v[20:23], v38 offset:2560
ds_read_b128 v[24:27], v38 offset:2576
v_mfma_f32_16x16x32_bf16 v[4:7], a[240:243], a[100:103], v[4:7]
s_waitcnt lgkmcnt(6)
v_exp_f32 v236, v80
v_mfma_f32_16x16x32_bf16 v[4:7], a[248:251], a[116:119], v[4:7]
v_exp_f32 v237, v81
v_mfma_f32_16x16x32_bf16 v[4:7], a[252:255], a[124:127], v[4:7]
ds_read_b128 a[240:243], v32 offset:29696
ds_read_b128 a[244:247], v32 offset:31744
v_exp_f32 v238, v82
v_exp_f32 v239, v83
v_mfma_f32_16x16x32_bf16 v[0:3], a[252:255], a[120:123], v[0:3]
v_exp_f32 v204, v88
v_mfma_f32_16x16x32_bf16 v[0:3], a[248:251], a[112:115], v[0:3]
s_waitcnt lgkmcnt(6)
v_exp_f32 v205, v89
v_mfma_f32_16x16x32_bf16 v[0:3], a[224:227], a[128:131], v[0:3]
v_exp_f32 v206, v90
v_mfma_f32_16x16x32_bf16 v[0:3], a[228:231], a[136:139], v[0:3]
buffer_load_dwordx4 v32, s[16:19], s53 offen offset:1024 sc1 lds
ds_read_b128 a[248:251], v32 offset:25600
ds_read_b128 a[252:255], v32 offset:27648
v_exp_f32 v207, v91
v_pk_fma_f32 v[236:237], v[236:237], s[56:57], s[56:57]
v_pk_fma_f32 v[238:239], v[238:239], s[56:57], s[56:57]
v_pk_fma_f32 v[204:205], v[204:205], s[56:57], s[56:57]
v_pk_fma_f32 v[206:207], v[206:207], s[56:57], s[56:57]
v_mfma_f32_16x16x32_bf16 v[4:7], a[228:231], a[140:143], v[4:7]
v_rcp_f32 v236, v236
v_mfma_f32_16x16x32_bf16 v[4:7], a[224:227], a[132:135], v[4:7]
s_waitcnt lgkmcnt(6)
v_rcp_f32 v237, v237
v_rcp_f32 v238, v238
v_rcp_f32 v239, v239
v_rcp_f32 v204, v204
v_mfma_f32_16x16x32_bf16 v[12:15], a[232:235], a[132:135], v[8:11]
v_rcp_f32 v205, v205
v_mfma_f32_16x16x32_bf16 v[12:15], a[236:239], a[140:143], v[12:15]
s_waitcnt lgkmcnt(4)
ds_read_b128 a[224:227], v32 offset:21504
ds_read_b128 a[228:231], v32 offset:23552
v_rcp_f32 v206, v206
v_rcp_f32 v207, v207
v_pk_mul_f32 v[80:81], v[80:81], v[236:237]
v_pk_mul_f32 v[82:83], v[82:83], v[238:239]
v_pk_mul_f32 v[88:89], v[88:89], v[204:205]
v_pk_mul_f32 v[90:91], v[90:91], v[206:207]
v_cvt_pk_bf16_f32 v236, v80, v81
v_cvt_pk_bf16_f32 v237, v82, v83
v_cvt_pk_bf16_f32 v238, v88, v89
v_cvt_pk_bf16_f32 v239, v90, v91
v_pk_mul_f32 v[20:21], v[20:21], v[36:37] op_sel_hi:[1,0]
v_pk_mul_f32 v[22:23], v[22:23], v[36:37] op_sel_hi:[1,0]
v_pk_mul_f32 v[24:25], v[24:25], v[36:37] op_sel_hi:[1,0]
v_pk_mul_f32 v[26:27], v[26:27], v[36:37] op_sel_hi:[1,0]
v_mfma_f32_16x16x32_bf16 v[8:11], a[236:239], a[136:139], v[8:11]
v_exp_f32 v44, v84
v_mfma_f32_16x16x32_bf16 v[8:11], a[232:235], a[128:131], v[8:11]
s_waitcnt lgkmcnt(4)
v_exp_f32 v45, v85
v_mfma_f32_16x16x32_bf16 v[8:11], a[240:243], a[112:115], v[8:11]
v_exp_f32 v46, v86
v_mfma_f32_16x16x32_bf16 v[8:11], a[244:247], a[120:123], v[8:11]
buffer_load_dwordx4 v32, s[16:19], s53 offen offset:2048 sc1 lds
ds_read_b128 a[232:235], v32 offset:17408
ds_read_b128 a[236:239], v32 offset:19456
v_exp_f32 v47, v87
v_mfma_f32_16x16x32_bf16 v[12:15], a[244:247], a[124:127], v[12:15]
v_exp_f32 v212, v92
v_mfma_f32_16x16x32_bf16 v[12:15], a[240:243], a[116:119], v[12:15]
s_waitcnt lgkmcnt(4)
v_exp_f32 v213, v93
v_mfma_f32_16x16x32_bf16 v[12:15], a[248:251], a[100:103], v[12:15]
v_exp_f32 v214, v94
v_mfma_f32_16x16x32_bf16 v[12:15], a[252:255], a[108:111], v[12:15]
ds_read_b128 a[240:243], v32 offset:13312
ds_read_b128 a[244:247], v32 offset:15360
buffer_store_dwordx4 v[236:239], v37, s[24:27], s49 offen offset:1280 sc1
v_exp_f32 v215, v95
v_pk_fma_f32 v[44:45], v[44:45], s[56:57], s[56:57]
v_pk_fma_f32 v[46:47], v[46:47], s[56:57], s[56:57]
v_pk_fma_f32 v[212:213], v[212:213], s[56:57], s[56:57]
v_pk_fma_f32 v[214:215], v[214:215], s[56:57], s[56:57]
v_rcp_f32 v44, v44
v_rcp_f32 v45, v45
v_mfma_f32_16x16x32_bf16 v[8:11], a[252:255], a[104:107], v[8:11]
v_rcp_f32 v46, v46
v_mfma_f32_16x16x32_bf16 v[8:11], a[248:251], a[96:99], v[8:11]
s_waitcnt lgkmcnt(4)
v_rcp_f32 v47, v47
v_mfma_f32_16x16x32_bf16 v[8:11], a[224:227], a[80:83], v[8:11]
v_rcp_f32 v212, v212
v_mfma_f32_16x16x32_bf16 v[8:11], a[228:231], a[88:91], v[8:11]
buffer_load_dwordx4 v32, s[16:19], s53 offen offset:3072 sc1 lds
L_pg14:
s_cbranch_vccnz L_vr3
ds_read_b128 a[248:251], v32 offset:9216
ds_read_b128 a[252:255], v32 offset:11264
v_rcp_f32 v213, v213
v_rcp_f32 v214, v214
v_rcp_f32 v215, v215
v_pk_mul_f32 v[84:85], v[84:85], v[44:45]
v_pk_mul_f32 v[86:87], v[86:87], v[46:47]
v_pk_mul_f32 v[92:93], v[92:93], v[212:213]
v_pk_mul_f32 v[94:95], v[94:95], v[214:215]
v_mfma_f32_16x16x32_bf16 v[12:15], a[228:231], a[92:95], v[12:15]
s_load_dword s77, s[78:79], 61440
v_cvt_pk_bf16_f32 v44, v84, v85
v_cvt_pk_bf16_f32 v45, v86, v87
v_mfma_f32_16x16x32_bf16 v[12:15], a[224:227], a[84:87], v[12:15]
s_waitcnt lgkmcnt(4)
v_cvt_pk_bf16_f32 v46, v92, v93
v_cvt_pk_bf16_f32 v47, v94, v95
v_mfma_f32_16x16x32_bf16 v[12:15], a[232:235], a[68:71], v[12:15]
v_accvgpr_read_b32 v40, a180
v_accvgpr_read_b32 v41, a181
v_mfma_f32_16x16x32_bf16 v[12:15], a[236:239], a[76:79], v[12:15]
s_waitcnt vmcnt(63)
ds_read_b128 a[224:227], v32 offset:5120
ds_read_b128 a[228:231], v32 offset:7168
buffer_store_dwordx4 v[44:47], v37, s[24:27], s50 offen offset:1280 sc1
v_accvgpr_read_b32 v42, a182
v_accvgpr_read_b32 v43, a183
v_accvgpr_read_b32 v220, a188
v_accvgpr_read_b32 v221, a189
v_accvgpr_read_b32 v222, a190
v_accvgpr_read_b32 v223, a191
v_pk_add_f32 v[64:65], v[40:41], v[148:149]
v_pk_add_f32 v[148:149], v[40:41], v[148:149] neg_lo:[0,1] neg_hi:[0,1]
v_pk_add_f32 v[66:67], v[42:43], v[150:151]
v_pk_add_f32 v[150:151], v[42:43], v[150:151] neg_lo:[0,1] neg_hi:[0,1]
v_pk_add_f32 v[72:73], v[220:221], v[156:157]
v_pk_add_f32 v[156:157], v[220:221], v[156:157] neg_lo:[0,1] neg_hi:[0,1]
v_pk_add_f32 v[74:75], v[222:223], v[158:159]
v_pk_add_f32 v[158:159], v[222:223], v[158:159] neg_lo:[0,1] neg_hi:[0,1]
v_mfma_f32_16x16x32_bf16 v[8:11], a[236:239], a[72:75], v[8:11]
s_add_u32 s54, s47, 856064
v_exp_f32 v208, v64
v_mfma_f32_16x16x32_bf16 v[8:11], a[232:235], a[64:67], v[8:11]
s_waitcnt lgkmcnt(4)
v_exp_f32 v209, v65
v_mfma_f32_16x16x32_bf16 v[8:11], a[240:243], a[48:51], v[8:11]
s_add_u32 m0, s43, 81920
v_exp_f32 v210, v66
v_mfma_f32_16x16x32_bf16 v[8:11], a[244:247], a[56:59], v[8:11]
buffer_load_dwordx4 v32, s[16:19], s54 offen sc1 lds
ds_read_b128 a[232:235], v32 offset:1024
ds_read_b128 a[236:239], v32 offset:3072
v_exp_f32 v211, v67
v_exp_f32 v240, v72
v_mfma_f32_16x16x32_bf16 v[12:15], a[244:247], a[60:63], v[12:15]
v_exp_f32 v241, v73
v_mfma_f32_16x16x32_bf16 v[12:15], a[240:243], a[52:55], v[12:15]
s_waitcnt lgkmcnt(4)
v_exp_f32 v242, v74
v_mfma_f32_16x16x32_bf16 v[12:15], a[248:251], a[36:39], v[12:15]
v_exp_f32 v243, v75
v_mfma_f32_16x16x32_bf16 v[12:15], a[252:255], a[44:47], v[12:15]
s_waitcnt vmcnt(13)
s_barrier
ds_read_b128 a[240:243], v32 offset:36864
ds_read_b128 a[244:247], v32 offset:38912
v_pk_fma_f32 v[208:209], v[208:209], s[56:57], s[56:57]
v_pk_fma_f32 v[210:211], v[210:211], s[56:57], s[56:57]
v_pk_fma_f32 v[240:241], v[240:241], s[56:57], s[56:57]
v_pk_fma_f32 v[242:243], v[242:243], s[56:57], s[56:57]
v_mfma_f32_16x16x32_bf16 v[8:11], a[252:255], a[40:43], v[8:11]
s_add_u32 s52, s47, 884736
v_rcp_f32 v208, v208
v_mfma_f32_16x16x32_bf16 v[8:11], a[248:251], a[32:35], v[8:11]
s_waitcnt lgkmcnt(4)
v_rcp_f32 v209, v209
v_mfma_f32_16x16x32_bf16 v[8:11], a[224:227], a[16:19], v[8:11]
s_add_u32 m0, s43, 0
v_rcp_f32 v210, v210
v_mfma_f32_16x16x32_bf16 v[8:11], a[228:231], a[24:27], v[8:11]
buffer_load_dwordx4 v32, s[16:19], s52 offen sc1 lds
ds_read_b128 a[248:251], v32 offset:40960
ds_read_b128 a[252:255], v32 offset:43008
v_mfma_f32_16x16x32_bf16 v[12:15], a[228:231], a[28:31], v[12:15]
v_rcp_f32 v211, v211
v_mfma_f32_16x16x32_bf16 v[12:15], a[224:227], a[20:23], v[12:15]
s_waitcnt lgkmcnt(4)
v_rcp_f32 v240, v240
v_mfma_f32_16x16x32_bf16 v[12:15], a[232:235], a[4:7], v[12:15]
v_rcp_f32 v241, v241
v_mfma_f32_16x16x32_bf16 v[12:15], a[236:239], a[12:15], v[12:15]
ds_read_b128 a[224:227], v32 offset:45056
ds_read_b128 a[228:231], v32 offset:47104
v_rcp_f32 v242, v242
v_rcp_f32 v243, v243
v_pk_mul_f32 v[64:65], v[64:65], v[208:209]
v_pk_mul_f32 v[66:67], v[66:67], v[210:211]
v_pk_mul_f32 v[72:73], v[72:73], v[240:241]
v_pk_mul_f32 v[74:75], v[74:75], v[242:243]
v_mfma_f32_16x16x32_bf16 v[8:11], a[236:239], a[8:11], v[8:11]
v_cvt_pk_bf16_f32 v208, v64, v65
v_cvt_pk_bf16_f32 v209, v66, v67
v_mfma_f32_16x16x32_bf16 v[8:11], a[232:235], a[0:3], v[8:11]
s_waitcnt lgkmcnt(4)
v_cvt_pk_bf16_f32 v210, v72, v73
v_cvt_pk_bf16_f32 v211, v74, v75
v_mfma_f32_16x16x32_bf16 v[16:19], a[240:243], a[0:3], v[20:23]
v_accvgpr_read_b32 v68, a192
v_accvgpr_read_b32 v69, a193
v_mfma_f32_16x16x32_bf16 v[16:19], a[244:247], a[8:11], v[16:19]
buffer_load_dwordx4 v32, s[16:19], s52 offen offset:1024 sc1 lds
ds_read_b128 a[232:235], v32 offset:49152
ds_read_b128 a[236:239], v32 offset:51200
v_accvgpr_read_b32 v70, a194
v_accvgpr_read_b32 v71, a195
v_accvgpr_read_b32 v76, a200
v_mfma_f32_16x16x32_bf16 v[20:23], a[244:247], a[12:15], v[20:23]
buffer_store_dwordx4 v[208:211], v37, s[24:27], s50 offen offset:384 sc1
v_accvgpr_read_b32 v77, a201
v_accvgpr_read_b32 v78, a202
v_accvgpr_read_b32 v79, a203
v_pk_add_f32 v[56:57], v[68:69], v[160:161]
v_pk_add_f32 v[160:161], v[68:69], v[160:161] neg_lo:[0,1] neg_hi:[0,1]
v_pk_add_f32 v[58:59], v[70:71], v[162:163]
v_pk_add_f32 v[162:163], v[70:71], v[162:163] neg_lo:[0,1] neg_hi:[0,1]
v_pk_add_f32 v[196:197], v[76:77], v[168:169]
v_pk_add_f32 v[168:169], v[76:77], v[168:169] neg_lo:[0,1] neg_hi:[0,1]
v_pk_add_f32 v[198:199], v[78:79], v[170:171]
v_pk_add_f32 v[170:171], v[78:79], v[170:171] neg_lo:[0,1] neg_hi:[0,1]
v_mfma_f32_16x16x32_bf16 v[20:23], a[240:243], a[4:7], v[20:23]
s_waitcnt lgkmcnt(4)
v_exp_f32 v248, v56
v_mfma_f32_16x16x32_bf16 v[20:23], a[248:251], a[20:23], v[20:23]
v_exp_f32 v249, v57
v_mfma_f32_16x16x32_bf16 v[20:23], a[252:255], a[28:31], v[20:23]
ds_read_b128 a[240:243], v32 offset:53248
ds_read_b128 a[244:247], v32 offset:55296
v_exp_f32 v250, v58
v_exp_f32 v251, v59
v_mfma_f32_16x16x32_bf16 v[16:19], a[252:255], a[24:27], v[16:19]
v_exp_f32 v48, v196
v_mfma_f32_16x16x32_bf16 v[16:19], a[248:251], a[16:19], v[16:19]
s_waitcnt lgkmcnt(4)
v_exp_f32 v49, v197
v_mfma_f32_16x16x32_bf16 v[16:19], a[224:227], a[32:35], v[16:19]
v_exp_f32 v50, v198
v_mfma_f32_16x16x32_bf16 v[16:19], a[228:231], a[40:43], v[16:19]
buffer_load_dwordx4 v32, s[16:19], s52 offen offset:2048 sc1 lds
ds_read_b128 a[248:251], v32 offset:57344
ds_read_b128 a[252:255], v32 offset:59392
v_exp_f32 v51, v199
v_pk_fma_f32 v[248:249], v[248:249], s[56:57], s[56:57]
v_pk_fma_f32 v[250:251], v[250:251], s[56:57], s[56:57]
v_pk_fma_f32 v[48:49], v[48:49], s[56:57], s[56:57]
v_pk_fma_f32 v[50:51], v[50:51], s[56:57], s[56:57]
v_mfma_f32_16x16x32_bf16 v[20:23], a[228:231], a[44:47], v[20:23]
v_rcp_f32 v248, v248
v_mfma_f32_16x16x32_bf16 v[20:23], a[224:227], a[36:39], v[20:23]
s_waitcnt lgkmcnt(4)
v_rcp_f32 v249, v249
v_mfma_f32_16x16x32_bf16 v[20:23], a[232:235], a[52:55], v[20:23]
v_rcp_f32 v250, v250
v_mfma_f32_16x16x32_bf16 v[20:23], a[236:239], a[60:63], v[20:23]
ds_read_b128 a[224:227], v32 offset:61440
ds_read_b128 a[228:231], v32 offset:63488
v_rcp_f32 v251, v251
v_mfma_f32_16x16x32_bf16 v[16:19], a[236:239], a[56:59], v[16:19]
v_rcp_f32 v48, v48
v_mfma_f32_16x16x32_bf16 v[16:19], a[232:235], a[48:51], v[16:19]
s_waitcnt lgkmcnt(4)
v_rcp_f32 v49, v49
v_mfma_f32_16x16x32_bf16 v[16:19], a[240:243], a[64:67], v[16:19]
v_rcp_f32 v50, v50
v_mfma_f32_16x16x32_bf16 v[16:19], a[244:247], a[72:75], v[16:19]
buffer_load_dwordx4 v32, s[16:19], s52 offen offset:3072 sc1 lds
ds_read_b128 a[232:235], v33
ds_read_b128 a[236:239], v33 offset:2048
v_rcp_f32 v51, v51
v_pk_mul_f32 v[56:57], v[56:57], v[248:249]
v_pk_mul_f32 v[58:59], v[58:59], v[250:251]
v_pk_mul_f32 v[196:197], v[196:197], v[48:49]
v_pk_mul_f32 v[198:199], v[198:199], v[50:51]
v_mfma_f32_16x16x32_bf16 v[20:23], a[244:247], a[76:79], v[20:23]
v_cvt_pk_bf16_f32 v248, v56, v57
v_cvt_pk_bf16_f32 v249, v58, v59
v_mfma_f32_16x16x32_bf16 v[20:23], a[240:243], a[68:71], v[20:23]
s_waitcnt lgkmcnt(4)
v_cvt_pk_bf16_f32 v250, v196, v197
v_cvt_pk_bf16_f32 v251, v198, v199
v_mfma_f32_16x16x32_bf16 v[20:23], a[248:251], a[84:87], v[20:23]
v_sub_f32_dpp v0, v0, v0 row_shl:1 row_mask:0xf bank_mask:0xf bound_ctrl:1
v_sub_f32_dpp v1, v1, v1 row_shl:1 row_mask:0xf bank_mask:0xf bound_ctrl:1
v_mfma_f32_16x16x32_bf16 v[20:23], a[252:255], a[92:95], v[20:23]
s_waitcnt vmcnt(63)
ds_read_b128 a[240:243], v33 offset:4096
ds_read_b128 a[244:247], v33 offset:6144
buffer_store_dwordx4 v[248:251], v37, s[24:27], s49 offen offset:448 sc1
v_sub_f32_dpp v2, v2, v2 row_shl:1 row_mask:0xf bank_mask:0xf bound_ctrl:1
v_sub_f32_dpp v3, v3, v3 row_shl:1 row_mask:0xf bank_mask:0xf bound_ctrl:1
v_sub_f32_dpp v8, v8, v8 row_shl:1 row_mask:0xf bank_mask:0xf bound_ctrl:1
v_sub_f32_dpp v9, v9, v9 row_shl:1 row_mask:0xf bank_mask:0xf bound_ctrl:1
v_sub_f32_dpp v10, v10, v10 row_shl:1 row_mask:0xf bank_mask:0xf bound_ctrl:1
v_sub_f32_dpp v11, v11, v11 row_shl:1 row_mask:0xf bank_mask:0xf bound_ctrl:1
v_pk_add_f32 v[96:97], v[96:97], v[0:1]
v_pk_add_f32 v[98:99], v[98:99], v[2:3]
v_pk_add_f32 v[104:105], v[104:105], v[8:9]
v_pk_add_f32 v[106:107], v[106:107], v[10:11]
v_mfma_f32_16x16x32_bf16 v[16:19], a[252:255], a[88:91], v[16:19]
s_add_u32 s53, s47, 888832
v_sub_f32_dpp v4, v4, v4 row_shl:1 row_mask:0xf bank_mask:0xf bound_ctrl:1
v_sub_f32_dpp v5, v5, v5 row_shl:1 row_mask:0xf bank_mask:0xf bound_ctrl:1
v_mfma_f32_16x16x32_bf16 v[16:19], a[248:251], a[80:83], v[16:19]
s_waitcnt lgkmcnt(4)
v_sub_f32_dpp v6, v6, v6 row_shl:1 row_mask:0xf bank_mask:0xf bound_ctrl:1
v_sub_f32_dpp v7, v7, v7 row_shl:1 row_mask:0xf bank_mask:0xf bound_ctrl:1
v_mfma_f32_16x16x32_bf16 v[16:19], a[224:227], a[96:99], v[16:19]
s_add_u32 m0, s43, 4096
v_sub_f32_dpp v12, v12, v12 row_shl:1 row_mask:0xf bank_mask:0xf bound_ctrl:1
v_sub_f32_dpp v13, v13, v13 row_shl:1 row_mask:0xf bank_mask:0xf bound_ctrl:1
v_mfma_f32_16x16x32_bf16 v[16:19], a[228:231], a[104:107], v[16:19]
s_waitcnt vmcnt(63)
buffer_load_dwordx4 v32, s[16:19], s53 offen sc1 lds
ds_read_b128 a[248:251], v33 offset:5120
ds_read_b128 a[252:255], v33 offset:7168
v_sub_f32_dpp v14, v14, v14 row_shl:1 row_mask:0xf bank_mask:0xf bound_ctrl:1
v_sub_f32_dpp v15, v15, v15 row_shl:1 row_mask:0xf bank_mask:0xf bound_ctrl:1
v_pk_add_f32 v[100:101], v[100:101], v[4:5]
v_pk_add_f32 v[102:103], v[102:103], v[6:7]
v_pk_add_f32 v[108:109], v[108:109], v[12:13]
v_pk_add_f32 v[110:111], v[110:111], v[14:15]
v_mfma_f32_16x16x32_bf16 v[20:23], a[228:231], a[108:111], v[20:23]
ds_read_b128 v[4:7], v38 offset:2688
ds_read_b128 v[8:11], v38 offset:2704
v_mfma_f32_16x16x32_bf16 v[20:23], a[224:227], a[100:103], v[20:23]
s_waitcnt lgkmcnt(6)
v_exp_f32 v52, v96
v_mfma_f32_16x16x32_bf16 v[20:23], a[232:235], a[116:119], v[20:23]
v_exp_f32 v53, v97
v_mfma_f32_16x16x32_bf16 v[20:23], a[236:239], a[124:127], v[20:23]
ds_read_b128 a[224:227], v33 offset:1024
ds_read_b128 a[228:231], v33 offset:3072
v_exp_f32 v54, v98
v_exp_f32 v55, v99
v_mfma_f32_16x16x32_bf16 v[16:19], a[236:239], a[120:123], v[16:19]
v_exp_f32 v60, v104
v_mfma_f32_16x16x32_bf16 v[16:19], a[232:235], a[112:115], v[16:19]
s_waitcnt lgkmcnt(6)
v_exp_f32 v61, v105
v_mfma_f32_16x16x32_bf16 v[16:19], a[240:243], a[128:131], v[16:19]
v_exp_f32 v62, v106
v_mfma_f32_16x16x32_bf16 v[16:19], a[244:247], a[136:139], v[16:19]
buffer_load_dwordx4 v32, s[16:19], s53 offen offset:1024 sc1 lds
ds_read_b128 a[232:235], v32 offset:62464
ds_read_b128 a[236:239], v32 offset:64512
v_exp_f32 v63, v107
v_pk_fma_f32 v[52:53], v[52:53], s[56:57], s[56:57]
v_pk_fma_f32 v[54:55], v[54:55], s[56:57], s[56:57]
v_pk_fma_f32 v[60:61], v[60:61], s[56:57], s[56:57]
v_pk_fma_f32 v[62:63], v[62:63], s[56:57], s[56:57]
v_mfma_f32_16x16x32_bf16 v[20:23], a[244:247], a[140:143], v[20:23]
v_rcp_f32 v52, v52
v_mfma_f32_16x16x32_bf16 v[20:23], a[240:243], a[132:135], v[20:23]
s_waitcnt lgkmcnt(6)
v_rcp_f32 v53, v53
v_rcp_f32 v54, v54
v_rcp_f32 v55, v55
v_rcp_f32 v60, v60
v_mfma_f32_16x16x32_bf16 v[28:31], a[248:251], a[132:135], v[24:27]
v_rcp_f32 v61, v61
v_mfma_f32_16x16x32_bf16 v[28:31], a[252:255], a[140:143], v[28:31]
s_waitcnt lgkmcnt(4)
ds_read_b128 a[240:243], v32 offset:58368
ds_read_b128 a[244:247], v32 offset:60416
v_rcp_f32 v62, v62
v_rcp_f32 v63, v63
v_pk_mul_f32 v[96:97], v[96:97], v[52:53]
v_pk_mul_f32 v[98:99], v[98:99], v[54:55]
v_pk_mul_f32 v[104:105], v[104:105], v[60:61]
v_pk_mul_f32 v[106:107], v[106:107], v[62:63]
v_cvt_pk_bf16_f32 v52, v96, v97
v_cvt_pk_bf16_f32 v53, v98, v99
v_cvt_pk_bf16_f32 v54, v104, v105
v_cvt_pk_bf16_f32 v55, v106, v107
v_pk_mul_f32 v[4:5], v[4:5], v[36:37] op_sel_hi:[1,0]
v_pk_mul_f32 v[6:7], v[6:7], v[36:37] op_sel_hi:[1,0]
v_pk_mul_f32 v[8:9], v[8:9], v[36:37] op_sel_hi:[1,0]
v_pk_mul_f32 v[10:11], v[10:11], v[36:37] op_sel_hi:[1,0]
v_mfma_f32_16x16x32_bf16 v[24:27], a[252:255], a[136:139], v[24:27]
v_exp_f32 v216, v100
v_mfma_f32_16x16x32_bf16 v[24:27], a[248:251], a[128:131], v[24:27]
s_waitcnt lgkmcnt(4)
v_exp_f32 v217, v101
v_mfma_f32_16x16x32_bf16 v[24:27], a[224:227], a[112:115], v[24:27]
v_exp_f32 v218, v102
v_mfma_f32_16x16x32_bf16 v[24:27], a[228:231], a[120:123], v[24:27]
buffer_load_dwordx4 v32, s[16:19], s53 offen offset:2048 sc1 lds
ds_read_b128 a[248:251], v32 offset:54272
ds_read_b128 a[252:255], v32 offset:56320
v_exp_f32 v219, v103
v_mfma_f32_16x16x32_bf16 v[28:31], a[228:231], a[124:127], v[28:31]
v_exp_f32 v244, v108
v_mfma_f32_16x16x32_bf16 v[28:31], a[224:227], a[116:119], v[28:31]
s_waitcnt lgkmcnt(4)
v_exp_f32 v245, v109
v_mfma_f32_16x16x32_bf16 v[28:31], a[232:235], a[100:103], v[28:31]
v_exp_f32 v246, v110
v_mfma_f32_16x16x32_bf16 v[28:31], a[236:239], a[108:111], v[28:31]
ds_read_b128 a[224:227], v32 offset:50176
ds_read_b128 a[228:231], v32 offset:52224
buffer_store_dwordx4 v[52:55], v37, s[24:27], s49 offen offset:1344 sc1
v_exp_f32 v247, v111
v_pk_fma_f32 v[216:217], v[216:217], s[56:57], s[56:57]
v_pk_fma_f32 v[218:219], v[218:219], s[56:57], s[56:57]
v_pk_fma_f32 v[244:245], v[244:245], s[56:57], s[56:57]
v_pk_fma_f32 v[246:247], v[246:247], s[56:57], s[56:57]
v_rcp_f32 v216, v216
v_rcp_f32 v217, v217
v_mfma_f32_16x16x32_bf16 v[24:27], a[236:239], a[104:107], v[24:27]
v_rcp_f32 v218, v218
v_mfma_f32_16x16x32_bf16 v[24:27], a[232:235], a[96:99], v[24:27]
s_waitcnt lgkmcnt(4)
v_rcp_f32 v219, v219
v_mfma_f32_16x16x32_bf16 v[24:27], a[240:243], a[80:83], v[24:27]
v_rcp_f32 v244, v244
v_mfma_f32_16x16x32_bf16 v[24:27], a[244:247], a[88:91], v[24:27]
buffer_load_dwordx4 v32, s[16:19], s53 offen offset:3072 sc1 lds
ds_read_b128 a[232:235], v32 offset:46080
ds_read_b128 a[236:239], v32 offset:48128
v_rcp_f32 v245, v245
v_rcp_f32 v246, v246
v_rcp_f32 v247, v247
v_pk_mul_f32 v[100:101], v[100:101], v[216:217]
v_pk_mul_f32 v[102:103], v[102:103], v[218:219]
v_pk_mul_f32 v[108:109], v[108:109], v[244:245]
v_pk_mul_f32 v[110:111], v[110:111], v[246:247]
v_mfma_f32_16x16x32_bf16 v[28:31], a[244:247], a[92:95], v[28:31]
v_cvt_pk_bf16_f32 v216, v100, v101
v_cvt_pk_bf16_f32 v217, v102, v103
v_mfma_f32_16x16x32_bf16 v[28:31], a[240:243], a[84:87], v[28:31]
s_waitcnt lgkmcnt(4)
v_cvt_pk_bf16_f32 v218, v108, v109
v_cvt_pk_bf16_f32 v219, v110, v111
v_mfma_f32_16x16x32_bf16 v[28:31], a[248:251], a[68:71], v[28:31]
v_accvgpr_read_b32 v200, a196
v_accvgpr_read_b32 v201, a197
v_mfma_f32_16x16x32_bf16 v[28:31], a[252:255], a[76:79], v[28:31]
ds_read_b128 a[240:243], v32 offset:41984
ds_read_b128 a[244:247], v32 offset:44032
buffer_store_dwordx4 v[216:219], v37, s[24:27], s50 offen offset:1344 sc1
v_accvgpr_read_b32 v202, a198
v_accvgpr_read_b32 v203, a199
v_accvgpr_read_b32 v224, a204
v_accvgpr_read_b32 v225, a205
v_accvgpr_read_b32 v226, a206
v_accvgpr_read_b32 v227, a207
v_pk_add_f32 v[252:253], v[200:201], v[164:165]
v_pk_add_f32 v[164:165], v[200:201], v[164:165] neg_lo:[0,1] neg_hi:[0,1]
v_pk_add_f32 v[254:255], v[202:203], v[166:167]
v_pk_add_f32 v[166:167], v[202:203], v[166:167] neg_lo:[0,1] neg_hi:[0,1]
v_pk_add_f32 v[232:233], v[224:225], v[172:173]
v_pk_add_f32 v[172:173], v[224:225], v[172:173] neg_lo:[0,1] neg_hi:[0,1]
v_pk_add_f32 v[234:235], v[226:227], v[174:175]
v_pk_add_f32 v[174:175], v[226:227], v[174:175] neg_lo:[0,1] neg_hi:[0,1]
v_mfma_f32_16x16x32_bf16 v[24:27], a[252:255], a[72:75], v[24:27]
s_add_u32 s54, s47, 892928
v_exp_f32 v228, v252
v_mfma_f32_16x16x32_bf16 v[24:27], a[248:251], a[64:67], v[24:27]
s_waitcnt lgkmcnt(4)
v_exp_f32 v229, v253
v_mfma_f32_16x16x32_bf16 v[24:27], a[224:227], a[48:51], v[24:27]
s_add_u32 m0, s43, 8192
v_exp_f32 v230, v254
v_mfma_f32_16x16x32_bf16 v[24:27], a[228:231], a[56:59], v[24:27]
buffer_load_dwordx4 v32, s[16:19], s54 offen sc1 lds
ds_read_b128 a[248:251], v32 offset:37888
ds_read_b128 a[252:255], v32 offset:39936
v_exp_f32 v231, v255
v_exp_f32 v192, v232
v_mfma_f32_16x16x32_bf16 v[28:31], a[228:231], a[60:63], v[28:31]
v_exp_f32 v193, v233
v_mfma_f32_16x16x32_bf16 v[28:31], a[224:227], a[52:55], v[28:31]
s_waitcnt lgkmcnt(4)
v_exp_f32 v194, v234
v_mfma_f32_16x16x32_bf16 v[28:31], a[232:235], a[36:39], v[28:31]
v_exp_f32 v195, v235
v_mfma_f32_16x16x32_bf16 v[28:31], a[236:239], a[44:47], v[28:31]
s_waitcnt vmcnt(13)
s_barrier
ds_read_b128 a[224:227], v33 offset:8192
ds_read_b128 a[228:231], v33 offset:10240
v_pk_fma_f32 v[228:229], v[228:229], s[56:57], s[56:57]
v_pk_fma_f32 v[230:231], v[230:231], s[56:57], s[56:57]
v_pk_fma_f32 v[192:193], v[192:193], s[56:57], s[56:57]
v_pk_fma_f32 v[194:195], v[194:195], s[56:57], s[56:57]
v_mfma_f32_16x16x32_bf16 v[24:27], a[236:239], a[40:43], v[24:27]
s_add_u32 s52, s47, 921600
v_rcp_f32 v228, v228
v_mfma_f32_16x16x32_bf16 v[24:27], a[232:235], a[32:35], v[24:27]
s_waitcnt lgkmcnt(4)
v_rcp_f32 v229, v229
v_mfma_f32_16x16x32_bf16 v[24:27], a[240:243], a[16:19], v[24:27]
s_add_u32 m0, s43, 36864
v_rcp_f32 v230, v230
v_mfma_f32_16x16x32_bf16 v[24:27], a[244:247], a[24:27], v[24:27]
buffer_load_dwordx4 v32, s[16:19], s52 offen sc1 lds
ds_read_b128 a[232:235], v33 offset:12288
ds_read_b128 a[236:239], v33 offset:14336
v_mfma_f32_16x16x32_bf16 v[28:31], a[244:247], a[28:31], v[28:31]
v_rcp_f32 v231, v231
v_mfma_f32_16x16x32_bf16 v[28:31], a[240:243], a[20:23], v[28:31]
s_waitcnt lgkmcnt(4)
v_rcp_f32 v192, v192
v_mfma_f32_16x16x32_bf16 v[28:31], a[248:251], a[4:7], v[28:31]
v_rcp_f32 v193, v193
v_mfma_f32_16x16x32_bf16 v[28:31], a[252:255], a[12:15], v[28:31]
ds_read_b128 a[240:243], v33 offset:16384
ds_read_b128 a[244:247], v33 offset:18432
v_rcp_f32 v194, v194
v_rcp_f32 v195, v195
v_pk_mul_f32 v[252:253], v[252:253], v[228:229]
v_pk_mul_f32 v[254:255], v[254:255], v[230:231]
v_pk_mul_f32 v[232:233], v[232:233], v[192:193]
v_pk_mul_f32 v[234:235], v[234:235], v[194:195]
v_mfma_f32_16x16x32_bf16 v[24:27], a[252:255], a[8:11], v[24:27]
v_cvt_pk_bf16_f32 v228, v252, v253
v_cvt_pk_bf16_f32 v229, v254, v255
v_mfma_f32_16x16x32_bf16 v[24:27], a[248:251], a[0:3], v[24:27]
s_waitcnt lgkmcnt(4)
v_cvt_pk_bf16_f32 v230, v232, v233
v_cvt_pk_bf16_f32 v231, v234, v235
v_mfma_f32_16x16x32_bf16 v[0:3], a[224:227], a[0:3], v[4:7]
v_accvgpr_read_b32 v80, a208
v_accvgpr_read_b32 v81, a209
v_mfma_f32_16x16x32_bf16 v[0:3], a[228:231], a[8:11], v[0:3]
buffer_load_dwordx4 v32, s[16:19], s52 offen offset:1024 sc1 lds
ds_read_b128 a[248:251], v33 offset:20480
ds_read_b128 a[252:255], v33 offset:22528
v_accvgpr_read_b32 v82, a210
v_mfma_f32_16x16x32_bf16 v[4:7], a[228:231], a[12:15], v[4:7]
v_accvgpr_read_b32 v83, a211
v_accvgpr_read_b32 v88, a216
v_mfma_f32_16x16x32_bf16 v[4:7], a[224:227], a[4:7], v[4:7]
s_waitcnt lgkmcnt(4)
buffer_store_dwordx4 v[228:231], v37, s[24:27], s50 offen offset:448 sc1
v_accvgpr_read_b32 v89, a217
v_accvgpr_read_b32 v90, a218
v_accvgpr_read_b32 v91, a219
v_pk_add_f32 v[204:205], v[80:81], v[176:177]
v_pk_add_f32 v[176:177], v[80:81], v[176:177] neg_lo:[0,1] neg_hi:[0,1]
v_pk_add_f32 v[206:207], v[82:83], v[178:179]
v_pk_add_f32 v[178:179], v[82:83], v[178:179] neg_lo:[0,1] neg_hi:[0,1]
v_pk_add_f32 v[236:237], v[88:89], v[184:185]
v_pk_add_f32 v[184:185], v[88:89], v[184:185] neg_lo:[0,1] neg_hi:[0,1]
v_pk_add_f32 v[238:239], v[90:91], v[186:187]
v_mfma_f32_16x16x32_bf16 v[4:7], a[232:235], a[20:23], v[4:7]
v_sub_f32 v186, v90, v186
v_sub_f32 v187, v91, v187
v_mfma_f32_16x16x32_bf16 v[4:7], a[236:239], a[28:31], v[4:7]
ds_read_b128 a[224:227], v33 offset:24576
ds_read_b128 a[228:231], v33 offset:26624
v_mfma_f32_16x16x32_bf16 v[0:3], a[236:239], a[24:27], v[0:3]
v_exp_f32 v84, v204
v_mfma_f32_16x16x32_bf16 v[0:3], a[232:235], a[16:19], v[0:3]
s_waitcnt lgkmcnt(4)
v_exp_f32 v85, v205
v_mfma_f32_16x16x32_bf16 v[0:3], a[240:243], a[32:35], v[0:3]
v_exp_f32 v86, v206
v_mfma_f32_16x16x32_bf16 v[0:3], a[244:247], a[40:43], v[0:3]
buffer_load_dwordx4 v32, s[16:19], s52 offen offset:2048 sc1 lds
ds_read_b128 a[232:235], v33 offset:28672
ds_read_b128 a[236:239], v33 offset:30720
v_mfma_f32_16x16x32_bf16 v[4:7], a[244:247], a[44:47], v[4:7]
v_exp_f32 v87, v207
v_mfma_f32_16x16x32_bf16 v[4:7], a[240:243], a[36:39], v[4:7]
s_waitcnt lgkmcnt(4)
v_exp_f32 v92, v236
v_mfma_f32_16x16x32_bf16 v[4:7], a[248:251], a[52:55], v[4:7]
v_exp_f32 v93, v237
v_mfma_f32_16x16x32_bf16 v[4:7], a[252:255], a[60:63], v[4:7]
ds_read_b128 a[240:243], v33 offset:32768
ds_read_b128 a[244:247], v33 offset:34816
v_exp_f32 v94, v238
v_exp_f32 v95, v239
v_pk_fma_f32 v[84:85], v[84:85], s[56:57], s[56:57]
v_pk_fma_f32 v[86:87], v[86:87], s[56:57], s[56:57]
v_pk_fma_f32 v[92:93], v[92:93], s[56:57], s[56:57]
v_mfma_f32_16x16x32_bf16 v[0:3], a[252:255], a[56:59], v[0:3]
v_fma_f32 v94, v94, s56, s56
v_fma_f32 v95, v95, s56, s56
v_mfma_f32_16x16x32_bf16 v[0:3], a[248:251], a[48:51], v[0:3]
s_waitcnt lgkmcnt(4)
v_rcp_f32 v84, v84
v_mfma_f32_16x16x32_bf16 v[0:3], a[224:227], a[64:67], v[0:3]
v_rcp_f32 v85, v85
v_mfma_f32_16x16x32_bf16 v[0:3], a[228:231], a[72:75], v[0:3]
buffer_load_dwordx4 v32, s[16:19], s52 offen offset:3072 sc1 lds
ds_read_b128 a[248:251], v33 offset:36864
ds_read_b128 a[252:255], v33 offset:38912
v_mfma_f32_16x16x32_bf16 v[4:7], a[228:231], a[76:79], v[4:7]
v_rcp_f32 v86, v86
v_mfma_f32_16x16x32_bf16 v[4:7], a[224:227], a[68:71], v[4:7]
s_waitcnt lgkmcnt(4)
v_rcp_f32 v87, v87
v_mfma_f32_16x16x32_bf16 v[4:7], a[232:235], a[84:87], v[4:7]
v_rcp_f32 v92, v92
v_mfma_f32_16x16x32_bf16 v[4:7], a[236:239], a[92:95], v[4:7]
ds_read_b128 a[224:227], v33 offset:40960
ds_read_b128 a[228:231], v33 offset:43008
v_mfma_f32_16x16x32_bf16 v[0:3], a[236:239], a[88:91], v[0:3]
s_add_u32 s53, s47, 925696
v_rcp_f32 v93, v93
v_mfma_f32_16x16x32_bf16 v[0:3], a[232:235], a[80:83], v[0:3]
s_waitcnt lgkmcnt(4)
v_rcp_f32 v94, v94
v_mfma_f32_16x16x32_bf16 v[0:3], a[240:243], a[96:99], v[0:3]
s_add_u32 m0, s43, 40960
v_rcp_f32 v95, v95
v_mfma_f32_16x16x32_bf16 v[0:3], a[244:247], a[104:107], v[0:3]
buffer_load_dwordx4 v32, s[16:19], s53 offen sc1 lds
ds_read_b128 a[232:235], v33 offset:41984
ds_read_b128 a[236:239], v33 offset:44032
v_mul_f32 v204, v204, v84
v_mul_f32 v205, v205, v85
v_pk_mul_f32 v[206:207], v[206:207], v[86:87]
v_pk_mul_f32 v[236:237], v[236:237], v[92:93]
v_mfma_f32_16x16x32_bf16 v[4:7], a[244:247], a[108:111], v[4:7]
v_mul_f32 v238, v238, v94
v_mul_f32_e64 v239, v239, v95
v_mfma_f32_16x16x32_bf16 v[4:7], a[240:243], a[100:103], v[4:7]
s_waitcnt lgkmcnt(4)
v_cvt_pk_bf16_f32 v84, v204, v205
v_cvt_pk_bf16_f32 v85, v206, v207
v_mfma_f32_16x16x32_bf16 v[4:7], a[248:251], a[116:119], v[4:7]
v_cvt_pk_bf16_f32 v86, v236, v237
v_cvt_pk_bf16_f32 v87, v238, v239
v_mfma_f32_16x16x32_bf16 v[4:7], a[252:255], a[124:127], v[4:7]
ds_read_b128 a[240:243], v33 offset:37888
ds_read_b128 a[244:247], v33 offset:39936
v_mfma_f32_16x16x32_bf16 v[0:3], a[252:255], a[120:123], v[0:3]
v_sub_f32_dpp v16, v16, v16 row_shl:1 row_mask:0xf bank_mask:0xf bound_ctrl:1
v_sub_f32_dpp v17, v17, v17 row_shl:1 row_mask:0xf bank_mask:0xf bound_ctrl:1
v_mfma_f32_16x16x32_bf16 v[0:3], a[248:251], a[112:115], v[0:3]
s_waitcnt lgkmcnt(4)
v_sub_f32_dpp v18, v18, v18 row_shl:1 row_mask:0xf bank_mask:0xf bound_ctrl:1
v_sub_f32_dpp v19, v19, v19 row_shl:1 row_mask:0xf bank_mask:0xf bound_ctrl:1
v_mfma_f32_16x16x32_bf16 v[0:3], a[224:227], a[128:131], v[0:3]
v_sub_f32_dpp v24, v24, v24 row_shl:1 row_mask:0xf bank_mask:0xf bound_ctrl:1
v_sub_f32_dpp v25, v25, v25 row_shl:1 row_mask:0xf bank_mask:0xf bound_ctrl:1
v_mfma_f32_16x16x32_bf16 v[0:3], a[228:231], a[136:139], v[0:3]
buffer_load_dwordx4 v32, s[16:19], s53 offen offset:1024 sc1 lds
ds_read_b128 a[248:251], v33 offset:33792
ds_read_b128 a[252:255], v33 offset:35840
v_sub_f32_dpp v26, v26, v26 row_shl:1 row_mask:0xf bank_mask:0xf bound_ctrl:1
v_sub_f32_dpp v27, v27, v27 row_shl:1 row_mask:0xf bank_mask:0xf bound_ctrl:1
v_pk_add_f32 v[112:113], v[112:113], v[16:17]
v_pk_add_f32 v[114:115], v[114:115], v[18:19]
v_pk_add_f32 v[120:121], v[120:121], v[24:25]
v_pk_add_f32 v[122:123], v[122:123], v[26:27]
v_mfma_f32_16x16x32_bf16 v[4:7], a[228:231], a[140:143], v[4:7]
s_waitcnt vmcnt(63)
v_sub_f32_dpp v20, v20, v20 row_shl:1 row_mask:0xf bank_mask:0xf bound_ctrl:1
v_sub_f32_dpp v21, v21, v21 row_shl:1 row_mask:0xf bank_mask:0xf bound_ctrl:1
v_mfma_f32_16x16x32_bf16 v[4:7], a[224:227], a[132:135], v[4:7]
s_waitcnt lgkmcnt(4)
buffer_store_dwordx4 v[84:87], v37, s[24:27], s58 offen offset:512 sc1
v_sub_f32_dpp v22, v22, v22 row_shl:1 row_mask:0xf bank_mask:0xf bound_ctrl:1
v_sub_f32_dpp v23, v23, v23 row_shl:1 row_mask:0xf bank_mask:0xf bound_ctrl:1
v_sub_f32_dpp v28, v28, v28 row_shl:1 row_mask:0xf bank_mask:0xf bound_ctrl:1
v_sub_f32_dpp v29, v29, v29 row_shl:1 row_mask:0xf bank_mask:0xf bound_ctrl:1
v_sub_f32_dpp v30, v30, v30 row_shl:1 row_mask:0xf bank_mask:0xf bound_ctrl:1
v_sub_f32_dpp v31, v31, v31 row_shl:1 row_mask:0xf bank_mask:0xf bound_ctrl:1
v_pk_add_f32 v[116:117], v[116:117], v[20:21]
v_pk_add_f32 v[118:119], v[118:119], v[22:23]
v_pk_add_f32 v[124:125], v[124:125], v[28:29]
v_pk_add_f32 v[126:127], v[126:127], v[30:31]
v_mfma_f32_16x16x32_bf16 v[12:15], a[232:235], a[132:135], v[8:11]
ds_read_b128 v[20:23], v38 offset:2816
ds_read_b128 v[24:27], v38 offset:2832
v_mfma_f32_16x16x32_bf16 v[12:15], a[236:239], a[140:143], v[12:15]
ds_read_b128 a[224:227], v33 offset:29696
ds_read_b128 a[228:231], v33 offset:31744
v_mfma_f32_16x16x32_bf16 v[8:11], a[236:239], a[136:139], v[8:11]
v_exp_f32 v212, v112
v_mfma_f32_16x16x32_bf16 v[8:11], a[232:235], a[128:131], v[8:11]
s_waitcnt lgkmcnt(6)
v_exp_f32 v213, v113
v_mfma_f32_16x16x32_bf16 v[8:11], a[240:243], a[112:115], v[8:11]
L_pg15:
s_cbranch_vccnz L_vr3
v_exp_f32 v214, v114
v_mfma_f32_16x16x32_bf16 v[8:11], a[244:247], a[120:123], v[8:11]
buffer_load_dwordx4 v32, s[16:19], s53 offen offset:2048 sc1 lds
ds_read_b128 a[232:235], v33 offset:25600
ds_read_b128 a[236:239], v33 offset:27648
v_mfma_f32_16x16x32_bf16 v[12:15], a[244:247], a[124:127], v[12:15]
v_exp_f32 v215, v115
v_mfma_f32_16x16x32_bf16 v[12:15], a[240:243], a[116:119], v[12:15]
s_waitcnt lgkmcnt(6)
v_exp_f32 v40, v120
v_mfma_f32_16x16x32_bf16 v[12:15], a[248:251], a[100:103], v[12:15]
v_exp_f32 v41, v121
v_mfma_f32_16x16x32_bf16 v[12:15], a[252:255], a[108:111], v[12:15]
ds_read_b128 a[240:243], v33 offset:21504
ds_read_b128 a[244:247], v33 offset:23552
v_exp_f32 v42, v122
v_exp_f32 v43, v123
v_pk_fma_f32 v[212:213], v[212:213], s[56:57], s[56:57]
v_pk_fma_f32 v[214:215], v[214:215], s[56:57], s[56:57]
v_pk_fma_f32 v[40:41], v[40:41], s[56:57], s[56:57]
v_pk_fma_f32 v[42:43], v[42:43], s[56:57], s[56:57]
v_mfma_f32_16x16x32_bf16 v[8:11], a[252:255], a[104:107], v[8:11]
v_rcp_f32 v212, v212
v_mfma_f32_16x16x32_bf16 v[8:11], a[248:251], a[96:99], v[8:11]
s_waitcnt lgkmcnt(4)
v_rcp_f32 v213, v213
v_mfma_f32_16x16x32_bf16 v[8:11], a[224:227], a[80:83], v[8:11]
v_rcp_f32 v214, v214
v_mfma_f32_16x16x32_bf16 v[8:11], a[228:231], a[88:91], v[8:11]
buffer_load_dwordx4 v32, s[16:19], s53 offen offset:3072 sc1 lds
ds_read_b128 a[248:251], v33 offset:17408
ds_read_b128 a[252:255], v33 offset:19456
v_mfma_f32_16x16x32_bf16 v[12:15], a[228:231], a[92:95], v[12:15]
v_rcp_f32 v215, v215
v_mfma_f32_16x16x32_bf16 v[12:15], a[224:227], a[84:87], v[12:15]
s_waitcnt lgkmcnt(4)
v_rcp_f32 v40, v40
v_mfma_f32_16x16x32_bf16 v[12:15], a[232:235], a[68:71], v[12:15]
v_rcp_f32 v41, v41
v_mfma_f32_16x16x32_bf16 v[12:15], a[236:239], a[76:79], v[12:15]
ds_read_b128 a[224:227], v33 offset:13312
ds_read_b128 a[228:231], v33 offset:15360
v_rcp_f32 v42, v42
v_rcp_f32_e64 v43, v43
v_pk_mul_f32 v[112:113], v[112:113], v[212:213]
v_pk_mul_f32 v[114:115], v[114:115], v[214:215]
v_pk_mul_f32 v[120:121], v[120:121], v[40:41]
v_pk_mul_f32 v[122:123], v[122:123], v[42:43]
v_cvt_pk_bf16_f32 v212, v112, v113
v_cvt_pk_bf16_f32 v213, v114, v115
v_cvt_pk_bf16_f32 v214, v120, v121
v_cvt_pk_bf16_f32 v215, v122, v123
v_pk_mul_f32 v[20:21], v[20:21], v[36:37] op_sel_hi:[1,0]
v_pk_mul_f32 v[22:23], v[22:23], v[36:37] op_sel_hi:[1,0]
v_pk_mul_f32 v[24:25], v[24:25], v[36:37] op_sel_hi:[1,0]
v_pk_mul_f32 v[26:27], v[26:27], v[36:37] op_sel_hi:[1,0]
v_mfma_f32_16x16x32_bf16 v[8:11], a[236:239], a[72:75], v[8:11]
s_add_u32 s54, s47, 929792
v_exp_f32 v220, v116
v_mfma_f32_16x16x32_bf16 v[8:11], a[232:235], a[64:67], v[8:11]
s_waitcnt lgkmcnt(4)
v_exp_f32 v221, v117
v_mfma_f32_16x16x32_bf16 v[8:11], a[240:243], a[48:51], v[8:11]
s_add_u32 m0, s43, 45056
v_exp_f32 v222, v118
v_mfma_f32_16x16x32_bf16 v[8:11], a[244:247], a[56:59], v[8:11]
s_add_u32 s4, s0, L_slow-standalone__batchnorm__sampling_kernel+-64772
s_min_u32 s78, s78, s4
s_load_dword s77, s[78:79], 65536
buffer_load_dwordx4 v32, s[16:19], s54 offen sc1 lds
ds_read_b128 a[232:235], v33 offset:9216
ds_read_b128 a[236:239], v33 offset:11264
v_mfma_f32_16x16x32_bf16 v[12:15], a[244:247], a[60:63], v[12:15]
v_exp_f32 v223, v119
v_mfma_f32_16x16x32_bf16 v[12:15], a[240:243], a[52:55], v[12:15]
s_waitcnt lgkmcnt(4)
v_exp_f32 v44, v124
v_mfma_f32_16x16x32_bf16 v[12:15], a[248:251], a[36:39], v[12:15]
buffer_store_dwordx4 v[212:215], v37, s[24:27], s49 offen offset:1408 sc1
v_exp_f32 v45, v125
v_exp_f32 v46, v126
v_exp_f32 v47, v127
v_pk_fma_f32 v[220:221], v[220:221], s[56:57], s[56:57]
v_pk_fma_f32 v[222:223], v[222:223], s[56:57], s[56:57]
v_pk_fma_f32 v[44:45], v[44:45], s[56:57], s[56:57]
v_pk_fma_f32 v[46:47], v[46:47], s[56:57], s[56:57]
v_mfma_f32_16x16x32_bf16 v[12:15], a[252:255], a[44:47], v[12:15]
s_waitcnt vmcnt(12)
s_barrier
ds_read_b128 a[240:243], v32
ds_read_b128 a[244:247], v32 offset:2048
v_mfma_f32_16x16x32_bf16 v[8:11], a[252:255], a[40:43], v[8:11]
s_add_u32 s52, s47, 958464
v_rcp_f32 v220, v220
v_mfma_f32_16x16x32_bf16 v[8:11], a[248:251], a[32:35], v[8:11]
s_waitcnt lgkmcnt(4)
v_rcp_f32 v221, v221
v_mfma_f32_16x16x32_bf16 v[8:11], a[224:227], a[16:19], v[8:11]
s_add_u32 m0, s43, 73728
v_rcp_f32 v222, v222
v_mfma_f32_16x16x32_bf16 v[8:11], a[228:231], a[24:27], v[8:11]
buffer_load_dwordx4 v32, s[16:19], s52 offen sc1 lds
ds_read_b128 a[248:251], v32 offset:4096
ds_read_b128 a[252:255], v32 offset:6144
v_mfma_f32_16x16x32_bf16 v[12:15], a[228:231], a[28:31], v[12:15]
v_rcp_f32 v223, v223
v_mfma_f32_16x16x32_bf16 v[12:15], a[224:227], a[20:23], v[12:15]
s_waitcnt lgkmcnt(4)
v_rcp_f32 v44, v44
v_mfma_f32_16x16x32_bf16 v[12:15], a[232:235], a[4:7], v[12:15]
v_rcp_f32 v45, v45
v_mfma_f32_16x16x32_bf16 v[12:15], a[236:239], a[12:15], v[12:15]
ds_read_b128 a[224:227], v32 offset:8192
ds_read_b128 a[228:231], v32 offset:10240
v_rcp_f32 v46, v46
v_rcp_f32 v47, v47
v_pk_mul_f32 v[116:117], v[116:117], v[220:221]
v_pk_mul_f32 v[118:119], v[118:119], v[222:223]
v_pk_mul_f32 v[124:125], v[124:125], v[44:45]
v_pk_mul_f32 v[126:127], v[126:127], v[46:47]
v_mfma_f32_16x16x32_bf16 v[8:11], a[236:239], a[8:11], v[8:11]
v_cvt_pk_bf16_f32 v220, v116, v117
v_cvt_pk_bf16_f32 v221, v118, v119
v_mfma_f32_16x16x32_bf16 v[8:11], a[232:235], a[0:3], v[8:11]
s_waitcnt lgkmcnt(4)
v_cvt_pk_bf16_f32 v222, v124, v125
v_cvt_pk_bf16_f32 v223, v126, v127
v_mfma_f32_16x16x32_bf16 v[16:19], a[240:243], a[0:3], v[20:23]
v_accvgpr_read_b32 v64, a212
v_accvgpr_read_b32 v65, a213
v_mfma_f32_16x16x32_bf16 v[16:19], a[244:247], a[8:11], v[16:19]
buffer_load_dwordx4 v32, s[16:19], s52 offen offset:1024 sc1 lds
ds_read_b128 a[232:235], v32 offset:12288
ds_read_b128 a[236:239], v32 offset:14336
v_accvgpr_read_b32 v66, a214
v_mfma_f32_16x16x32_bf16 v[20:23], a[244:247], a[12:15], v[20:23]
s_waitcnt vmcnt(63)
v_accvgpr_read_b32 v67, a215
v_accvgpr_read_b32 v72, a220
v_mfma_f32_16x16x32_bf16 v[20:23], a[240:243], a[4:7], v[20:23]
s_waitcnt lgkmcnt(4)
buffer_store_dwordx4 v[220:223], v37, s[24:27], s50 offen offset:1408 sc1
v_accvgpr_read_b32 v73, a221
v_accvgpr_read_b32 v74, a222
v_accvgpr_read_b32 v75, a223
v_pk_add_f32 v[240:241], v[64:65], v[180:181]
v_pk_add_f32 v[180:181], v[64:65], v[180:181] neg_lo:[0,1] neg_hi:[0,1]
v_pk_add_f32 v[242:243], v[66:67], v[182:183]
v_pk_add_f32 v[182:183], v[66:67], v[182:183] neg_lo:[0,1] neg_hi:[0,1]
v_pk_add_f32 v[68:69], v[72:73], v[188:189]
v_pk_add_f32 v[188:189], v[72:73], v[188:189] neg_lo:[0,1] neg_hi:[0,1]
v_pk_add_f32 v[70:71], v[74:75], v[190:191]
v_mfma_f32_16x16x32_bf16 v[20:23], a[248:251], a[20:23], v[20:23]
v_sub_f32 v190, v74, v190
v_sub_f32 v191, v75, v191
v_mfma_f32_16x16x32_bf16 v[20:23], a[252:255], a[28:31], v[20:23]
ds_read_b128 a[240:243], v32 offset:16384
ds_read_b128 a[244:247], v32 offset:18432
v_mfma_f32_16x16x32_bf16 v[16:19], a[252:255], a[24:27], v[16:19]
v_exp_f32 v76, v240
v_mfma_f32_16x16x32_bf16 v[16:19], a[248:251], a[16:19], v[16:19]
s_waitcnt lgkmcnt(4)
v_exp_f32 v77, v241
v_mfma_f32_16x16x32_bf16 v[16:19], a[224:227], a[32:35], v[16:19]
v_exp_f32 v78, v242
v_mfma_f32_16x16x32_bf16 v[16:19], a[228:231], a[40:43], v[16:19]
buffer_load_dwordx4 v32, s[16:19], s52 offen offset:2048 sc1 lds
ds_read_b128 a[248:251], v32 offset:20480
ds_read_b128 a[252:255], v32 offset:22528
v_mfma_f32_16x16x32_bf16 v[20:23], a[228:231], a[44:47], v[20:23]
v_exp_f32 v79, v243
v_mfma_f32_16x16x32_bf16 v[20:23], a[224:227], a[36:39], v[20:23]
s_waitcnt lgkmcnt(4)
v_exp_f32 v208, v68
v_mfma_f32_16x16x32_bf16 v[20:23], a[232:235], a[52:55], v[20:23]
v_exp_f32 v209, v69
v_mfma_f32_16x16x32_bf16 v[20:23], a[236:239], a[60:63], v[20:23]
ds_read_b128 a[224:227], v32 offset:24576
ds_read_b128 a[228:231], v32 offset:26624
v_exp_f32 v210, v70
v_exp_f32 v211, v71
v_pk_fma_f32 v[76:77], v[76:77], s[56:57], s[56:57]
v_pk_fma_f32 v[78:79], v[78:79], s[56:57], s[56:57]
v_pk_fma_f32 v[208:209], v[208:209], s[56:57], s[56:57]
v_mfma_f32_16x16x32_bf16 v[16:19], a[236:239], a[56:59], v[16:19]
v_fma_f32 v210, v210, s56, s56
v_fma_f32 v211, v211, s56, s56
v_mfma_f32_16x16x32_bf16 v[16:19], a[232:235], a[48:51], v[16:19]
s_waitcnt lgkmcnt(4)
v_rcp_f32 v76, v76
v_mfma_f32_16x16x32_bf16 v[16:19], a[240:243], a[64:67], v[16:19]
v_rcp_f32 v77, v77
v_mfma_f32_16x16x32_bf16 v[16:19], a[244:247], a[72:75], v[16:19]
buffer_load_dwordx4 v32, s[16:19], s52 offen offset:3072 sc1 lds
ds_read_b128 a[232:235], v32 offset:28672
ds_read_b128 a[236:239], v32 offset:30720
v_mfma_f32_16x16x32_bf16 v[20:23], a[244:247], a[76:79], v[20:23]
v_rcp_f32 v78, v78
v_mfma_f32_16x16x32_bf16 v[20:23], a[240:243], a[68:71], v[20:23]
s_waitcnt lgkmcnt(4)
v_rcp_f32 v79, v79
v_mfma_f32_16x16x32_bf16 v[20:23], a[248:251], a[84:87], v[20:23]
v_rcp_f32 v208, v208
v_mfma_f32_16x16x32_bf16 v[20:23], a[252:255], a[92:95], v[20:23]
ds_read_b128 a[240:243], v32 offset:32768
ds_read_b128 a[244:247], v32 offset:34816
v_mfma_f32_16x16x32_bf16 v[16:19], a[252:255], a[88:91], v[16:19]
s_add_u32 s53, s47, 962560
v_rcp_f32 v209, v209
v_mfma_f32_16x16x32_bf16 v[16:19], a[248:251], a[80:83], v[16:19]
s_waitcnt lgkmcnt(4)
v_rcp_f32 v210, v210
v_mfma_f32_16x16x32_bf16 v[16:19], a[224:227], a[96:99], v[16:19]
s_add_u32 m0, s43, 77824
v_rcp_f32 v211, v211
v_mfma_f32_16x16x32_bf16 v[16:19], a[228:231], a[104:107], v[16:19]
buffer_load_dwordx4 v32, s[16:19], s53 offen sc1 lds
ds_read_b128 a[248:251], v32 offset:33792
ds_read_b128 a[252:255], v32 offset:35840
v_mul_f32 v240, v240, v76
v_mul_f32 v241, v241, v77
v_pk_mul_f32 v[242:243], v[242:243], v[78:79]
v_pk_mul_f32 v[68:69], v[68:69], v[208:209]
v_mfma_f32_16x16x32_bf16 v[20:23], a[228:231], a[108:111], v[20:23]
v_mul_f32 v70, v70, v210
v_mul_f32_e64 v71, v71, v211
v_mfma_f32_16x16x32_bf16 v[20:23], a[224:227], a[100:103], v[20:23]
s_waitcnt lgkmcnt(4)
v_cvt_pk_bf16_f32 v76, v240, v241
v_cvt_pk_bf16_f32 v77, v242, v243
v_mfma_f32_16x16x32_bf16 v[20:23], a[232:235], a[116:119], v[20:23]
v_cvt_pk_bf16_f32 v78, v68, v69
v_cvt_pk_bf16_f32 v79, v70, v71
v_mfma_f32_16x16x32_bf16 v[20:23], a[236:239], a[124:127], v[20:23]
ds_read_b128 a[224:227], v32 offset:29696
ds_read_b128 a[228:231], v32 offset:31744
v_mfma_f32_16x16x32_bf16 v[16:19], a[236:239], a[120:123], v[16:19]
v_sub_f32_dpp v0, v0, v0 row_shl:1 row_mask:0xf bank_mask:0xf bound_ctrl:1
v_sub_f32_dpp v1, v1, v1 row_shl:1 row_mask:0xf bank_mask:0xf bound_ctrl:1
v_mfma_f32_16x16x32_bf16 v[16:19], a[232:235], a[112:115], v[16:19]
s_waitcnt lgkmcnt(4)
v_sub_f32_dpp v2, v2, v2 row_shl:1 row_mask:0xf bank_mask:0xf bound_ctrl:1
v_sub_f32_dpp v3, v3, v3 row_shl:1 row_mask:0xf bank_mask:0xf bound_ctrl:1
v_mfma_f32_16x16x32_bf16 v[16:19], a[240:243], a[128:131], v[16:19]
v_sub_f32_dpp v8, v8, v8 row_shl:1 row_mask:0xf bank_mask:0xf bound_ctrl:1
v_sub_f32_dpp v9, v9, v9 row_shl:1 row_mask:0xf bank_mask:0xf bound_ctrl:1
v_mfma_f32_16x16x32_bf16 v[16:19], a[244:247], a[136:139], v[16:19]
buffer_load_dwordx4 v32, s[16:19], s53 offen offset:1024 sc1 lds
ds_read_b128 a[232:235], v32 offset:25600
ds_read_b128 a[236:239], v32 offset:27648
v_sub_f32_dpp v10, v10, v10 row_shl:1 row_mask:0xf bank_mask:0xf bound_ctrl:1
v_sub_f32_dpp v11, v11, v11 row_shl:1 row_mask:0xf bank_mask:0xf bound_ctrl:1
v_pk_add_f32 v[128:129], v[128:129], v[0:1]
v_pk_add_f32 v[130:131], v[130:131], v[2:3]
v_pk_add_f32 v[136:137], v[136:137], v[8:9]
v_pk_add_f32 v[138:139], v[138:139], v[10:11]
v_mfma_f32_16x16x32_bf16 v[20:23], a[244:247], a[140:143], v[20:23]
s_waitcnt vmcnt(63)
v_sub_f32_dpp v4, v4, v4 row_shl:1 row_mask:0xf bank_mask:0xf bound_ctrl:1
v_sub_f32_dpp v5, v5, v5 row_shl:1 row_mask:0xf bank_mask:0xf bound_ctrl:1
v_mfma_f32_16x16x32_bf16 v[20:23], a[240:243], a[132:135], v[20:23]
s_waitcnt lgkmcnt(4)
buffer_store_dwordx4 v[76:79], v37, s[24:27], s59 offen offset:512 sc1
v_sub_f32_dpp v6, v6, v6 row_shl:1 row_mask:0xf bank_mask:0xf bound_ctrl:1
v_sub_f32_dpp v7, v7, v7 row_shl:1 row_mask:0xf bank_mask:0xf bound_ctrl:1
v_sub_f32_dpp v12, v12, v12 row_shl:1 row_mask:0xf bank_mask:0xf bound_ctrl:1
v_sub_f32_dpp v13, v13, v13 row_shl:1 row_mask:0xf bank_mask:0xf bound_ctrl:1
v_sub_f32_dpp v14, v14, v14 row_shl:1 row_mask:0xf bank_mask:0xf bound_ctrl:1
v_sub_f32_dpp v15, v15, v15 row_shl:1 row_mask:0xf bank_mask:0xf bound_ctrl:1
v_pk_add_f32 v[132:133], v[132:133], v[4:5]
v_pk_add_f32 v[134:135], v[134:135], v[6:7]
v_pk_add_f32 v[140:141], v[140:141], v[12:13]
v_pk_add_f32 v[142:143], v[142:143], v[14:15]
v_mfma_f32_16x16x32_bf16 v[28:31], a[248:251], a[132:135], v[24:27]
ds_read_b128 v[4:7], v38 offset:2944
ds_read_b128 v[8:11], v38 offset:2960
v_mfma_f32_16x16x32_bf16 v[28:31], a[252:255], a[140:143], v[28:31]
ds_read_b128 a[240:243], v32 offset:21504
ds_read_b128 a[244:247], v32 offset:23552
v_mfma_f32_16x16x32_bf16 v[24:27], a[252:255], a[136:139], v[24:27]
v_exp_f32 v56, v128
v_mfma_f32_16x16x32_bf16 v[24:27], a[248:251], a[128:131], v[24:27]
s_waitcnt lgkmcnt(6)
v_exp_f32 v57, v129
v_mfma_f32_16x16x32_bf16 v[24:27], a[224:227], a[112:115], v[24:27]
v_exp_f32 v58, v130
v_mfma_f32_16x16x32_bf16 v[24:27], a[228:231], a[120:123], v[24:27]
buffer_load_dwordx4 v32, s[16:19], s53 offen offset:2048 sc1 lds
ds_read_b128 a[248:251], v32 offset:17408
ds_read_b128 a[252:255], v32 offset:19456
v_mfma_f32_16x16x32_bf16 v[28:31], a[228:231], a[124:127], v[28:31]
v_exp_f32 v59, v131
v_mfma_f32_16x16x32_bf16 v[28:31], a[224:227], a[116:119], v[28:31]
s_waitcnt lgkmcnt(6)
v_exp_f32 v196, v136
v_mfma_f32_16x16x32_bf16 v[28:31], a[232:235], a[100:103], v[28:31]
v_exp_f32 v197, v137
v_mfma_f32_16x16x32_bf16 v[28:31], a[236:239], a[108:111], v[28:31]
ds_read_b128 a[224:227], v32 offset:13312
ds_read_b128 a[228:231], v32 offset:15360
v_exp_f32 v198, v138
v_exp_f32 v199, v139
v_pk_fma_f32 v[56:57], v[56:57], s[56:57], s[56:57]
v_pk_fma_f32 v[58:59], v[58:59], s[56:57], s[56:57]
v_pk_fma_f32 v[196:197], v[196:197], s[56:57], s[56:57]
v_pk_fma_f32 v[198:199], v[198:199], s[56:57], s[56:57]
v_mfma_f32_16x16x32_bf16 v[24:27], a[236:239], a[104:107], v[24:27]
v_rcp_f32 v56, v56
v_mfma_f32_16x16x32_bf16 v[24:27], a[232:235], a[96:99], v[24:27]
s_waitcnt lgkmcnt(4)
v_rcp_f32 v57, v57
v_mfma_f32_16x16x32_bf16 v[24:27], a[240:243], a[80:83], v[24:27]
v_rcp_f32 v58, v58
v_mfma_f32_16x16x32_bf16 v[24:27], a[244:247], a[88:91], v[24:27]
buffer_load_dwordx4 v32, s[16:19], s53 offen offset:3072 sc1 lds
ds_read_b128 a[232:235], v32 offset:9216
ds_read_b128 a[236:239], v32 offset:11264
v_mfma_f32_16x16x32_bf16 v[28:31], a[244:247], a[92:95], v[28:31]
v_rcp_f32 v59, v59
v_mfma_f32_16x16x32_bf16 v[28:31], a[240:243], a[84:87], v[28:31]
s_waitcnt lgkmcnt(4)
v_rcp_f32 v196, v196
v_mfma_f32_16x16x32_bf16 v[28:31], a[248:251], a[68:71], v[28:31]
v_rcp_f32 v197, v197
v_mfma_f32_16x16x32_bf16 v[28:31], a[252:255], a[76:79], v[28:31]
ds_read_b128 a[240:243], v32 offset:5120
ds_read_b128 a[244:247], v32 offset:7168
v_rcp_f32 v198, v198
v_rcp_f32 v199, v199
v_pk_mul_f32 v[128:129], v[128:129], v[56:57]
v_pk_mul_f32 v[130:131], v[130:131], v[58:59]
v_pk_mul_f32 v[136:137], v[136:137], v[196:197]
v_pk_mul_f32 v[138:139], v[138:139], v[198:199]
v_cvt_pk_bf16_f32 v56, v128, v129
v_cvt_pk_bf16_f32 v57, v130, v131
v_cvt_pk_bf16_f32 v58, v136, v137
v_cvt_pk_bf16_f32 v59, v138, v139
v_pk_mul_f32 v[4:5], v[4:5], v[36:37] op_sel_hi:[1,0]
v_pk_mul_f32 v[6:7], v[6:7], v[36:37] op_sel_hi:[1,0]
v_pk_mul_f32 v[8:9], v[8:9], v[36:37] op_sel_hi:[1,0]
v_pk_mul_f32 v[10:11], v[10:11], v[36:37] op_sel_hi:[1,0]
v_mfma_f32_16x16x32_bf16 v[24:27], a[252:255], a[72:75], v[24:27]
s_add_u32 s54, s47, 966656
v_exp_f32 v48, v132
v_mfma_f32_16x16x32_bf16 v[24:27], a[248:251], a[64:67], v[24:27]
s_waitcnt lgkmcnt(4)
v_exp_f32 v49, v133
v_mfma_f32_16x16x32_bf16 v[24:27], a[224:227], a[48:51], v[24:27]
s_add_u32 m0, s43, 81920
v_exp_f32 v50, v134
v_mfma_f32_16x16x32_bf16 v[24:27], a[228:231], a[56:59], v[24:27]
buffer_load_dwordx4 v32, s[16:19], s54 offen sc1 lds
ds_read_b128 a[248:251], v32 offset:1024
ds_read_b128 a[252:255], v32 offset:3072
v_mfma_f32_16x16x32_bf16 v[28:31], a[228:231], a[60:63], v[28:31]
v_exp_f32 v51, v135
v_mfma_f32_16x16x32_bf16 v[28:31], a[224:227], a[52:55], v[28:31]
s_waitcnt lgkmcnt(4)
v_exp_f32 v248, v140
v_mfma_f32_16x16x32_bf16 v[28:31], a[232:235], a[36:39], v[28:31]
buffer_store_dwordx4 v[56:59], v37, s[24:27], s49 offen offset:1472 sc1
v_exp_f32 v249, v141
v_exp_f32 v250, v142
v_exp_f32 v251, v143
v_pk_fma_f32 v[48:49], v[48:49], s[56:57], s[56:57]
v_pk_fma_f32 v[50:51], v[50:51], s[56:57], s[56:57]
v_pk_fma_f32 v[248:249], v[248:249], s[56:57], s[56:57]
v_pk_fma_f32 v[250:251], v[250:251], s[56:57], s[56:57]
v_mfma_f32_16x16x32_bf16 v[28:31], a[236:239], a[44:47], v[28:31]
s_waitcnt vmcnt(13)
s_barrier
ds_read_b128 a[224:227], v32 offset:36864
ds_read_b128 a[228:231], v32 offset:38912
v_mfma_f32_16x16x32_bf16 v[24:27], a[236:239], a[40:43], v[24:27]
v_rcp_f32 v48, v48
v_mfma_f32_16x16x32_bf16 v[24:27], a[232:235], a[32:35], v[24:27]
s_waitcnt lgkmcnt(4)
v_rcp_f32 v49, v49
v_mfma_f32_16x16x32_bf16 v[24:27], a[240:243], a[16:19], v[24:27]
v_rcp_f32 v50, v50
v_mfma_f32_16x16x32_bf16 v[24:27], a[244:247], a[24:27], v[24:27]
ds_read_b128 a[232:235], v32 offset:40960
ds_read_b128 a[236:239], v32 offset:43008
v_mfma_f32_16x16x32_bf16 v[28:31], a[244:247], a[28:31], v[28:31]
v_rcp_f32 v51, v51
v_mfma_f32_16x16x32_bf16 v[28:31], a[240:243], a[20:23], v[28:31]
s_waitcnt lgkmcnt(4)
v_rcp_f32 v248, v248
v_mfma_f32_16x16x32_bf16 v[28:31], a[248:251], a[4:7], v[28:31]
v_rcp_f32 v249, v249
v_mfma_f32_16x16x32_bf16 v[28:31], a[252:255], a[12:15], v[28:31]
ds_read_b128 a[240:243], v32 offset:45056
ds_read_b128 a[244:247], v32 offset:47104
v_rcp_f32 v250, v250
v_rcp_f32 v251, v251
v_pk_mul_f32 v[132:133], v[132:133], v[48:49]
v_pk_mul_f32 v[134:135], v[134:135], v[50:51]
v_pk_mul_f32 v[140:141], v[140:141], v[248:249]
v_pk_mul_f32 v[142:143], v[142:143], v[250:251]
v_mfma_f32_16x16x32_bf16 v[24:27], a[252:255], a[8:11], v[24:27]
v_cvt_pk_bf16_f32 v48, v132, v133
v_cvt_pk_bf16_f32 v49, v134, v135
v_mfma_f32_16x16x32_bf16 v[24:27], a[248:251], a[0:3], v[24:27]
s_waitcnt lgkmcnt(4)
v_cvt_pk_bf16_f32 v50, v140, v141
v_cvt_pk_bf16_f32 v51, v142, v143
v_mfma_f32_16x16x32_bf16 v[0:3], a[224:227], a[0:3], v[4:7]
v_sub_f32_dpp v16, v16, v16 row_shl:1 row_mask:0xf bank_mask:0xf bound_ctrl:1
v_sub_f32_dpp v17, v17, v17 row_shl:1 row_mask:0xf bank_mask:0xf bound_ctrl:1
v_mfma_f32_16x16x32_bf16 v[0:3], a[228:231], a[8:11], v[0:3]
ds_read_b128 a[248:251], v32 offset:49152
ds_read_b128 a[252:255], v32 offset:51200
v_mfma_f32_16x16x32_bf16 v[4:7], a[228:231], a[12:15], v[4:7]
v_sub_f32_dpp v18, v18, v18 row_shl:1 row_mask:0xf bank_mask:0xf bound_ctrl:1
v_sub_f32_dpp v19, v19, v19 row_shl:1 row_mask:0xf bank_mask:0xf bound_ctrl:1
v_mfma_f32_16x16x32_bf16 v[4:7], a[224:227], a[4:7], v[4:7]
s_waitcnt lgkmcnt(4)
v_sub_f32_dpp v20, v20, v20 row_shl:1 row_mask:0xf bank_mask:0xf bound_ctrl:1
v_sub_f32_dpp v21, v21, v21 row_shl:1 row_mask:0xf bank_mask:0xf bound_ctrl:1
v_mfma_f32_16x16x32_bf16 v[4:7], a[232:235], a[20:23], v[4:7]
v_sub_f32_dpp v22, v22, v22 row_shl:1 row_mask:0xf bank_mask:0xf bound_ctrl:1
v_sub_f32_dpp v23, v23, v23 row_shl:1 row_mask:0xf bank_mask:0xf bound_ctrl:1
v_mfma_f32_16x16x32_bf16 v[4:7], a[236:239], a[28:31], v[4:7]
ds_read_b128 a[224:227], v32 offset:53248
ds_read_b128 a[228:231], v32 offset:55296
v_mfma_f32_16x16x32_bf16 v[0:3], a[236:239], a[24:27], v[0:3]
v_sub_f32_dpp v28, v28, v28 row_shl:1 row_mask:0xf bank_mask:0xf bound_ctrl:1
v_sub_f32_dpp v29, v29, v29 row_shl:1 row_mask:0xf bank_mask:0xf bound_ctrl:1
v_mfma_f32_16x16x32_bf16 v[0:3], a[232:235], a[16:19], v[0:3]
s_waitcnt lgkmcnt(4)
v_sub_f32_dpp v30, v30, v30 row_shl:1 row_mask:0xf bank_mask:0xf bound_ctrl:1
v_sub_f32_dpp v31, v31, v31 row_shl:1 row_mask:0xf bank_mask:0xf bound_ctrl:1
v_mfma_f32_16x16x32_bf16 v[0:3], a[240:243], a[32:35], v[0:3]
v_sub_f32_dpp v24, v24, v24 row_shl:1 row_mask:0xf bank_mask:0xf bound_ctrl:1
v_sub_f32_dpp v25, v25, v25 row_shl:1 row_mask:0xf bank_mask:0xf bound_ctrl:1
v_mfma_f32_16x16x32_bf16 v[0:3], a[244:247], a[40:43], v[0:3]
s_waitcnt vmcnt(63)
ds_read_b128 a[232:235], v32 offset:57344
ds_read_b128 a[236:239], v32 offset:59392
buffer_store_dwordx4 v[48:51], v37, s[24:27], s50 offen offset:1472 sc1
v_sub_f32_dpp v26, v26, v26 row_shl:1 row_mask:0xf bank_mask:0xf bound_ctrl:1
v_sub_f32_dpp v27, v27, v27 row_shl:1 row_mask:0xf bank_mask:0xf bound_ctrl:1
v_pk_add_f32 v[144:145], v[144:145], v[16:17]
v_pk_add_f32 v[146:147], v[146:147], v[18:19]
v_pk_add_f32 v[152:153], v[152:153], v[24:25]
v_pk_add_f32 v[154:155], v[154:155], v[26:27]
v_pk_add_f32 v[148:149], v[148:149], v[20:21]
v_pk_add_f32 v[150:151], v[150:151], v[22:23]
v_pk_add_f32 v[156:157], v[156:157], v[28:29]
v_pk_add_f32 v[158:159], v[158:159], v[30:31]
v_mfma_f32_16x16x32_bf16 v[4:7], a[244:247], a[44:47], v[4:7]
ds_read_b128 v[20:23], v38 offset:3072
ds_read_b128 v[24:27], v38 offset:3088
v_mfma_f32_16x16x32_bf16 v[4:7], a[240:243], a[36:39], v[4:7]
s_waitcnt lgkmcnt(6)
v_exp_f32 v96, v144
v_mfma_f32_16x16x32_bf16 v[4:7], a[248:251], a[52:55], v[4:7]
v_exp_f32 v97, v145
v_mfma_f32_16x16x32_bf16 v[4:7], a[252:255], a[60:63], v[4:7]
ds_read_b128 a[240:243], v32 offset:61440
ds_read_b128 a[244:247], v32 offset:63488
v_mfma_f32_16x16x32_bf16 v[0:3], a[252:255], a[56:59], v[0:3]
v_exp_f32 v98, v146
v_mfma_f32_16x16x32_bf16 v[0:3], a[248:251], a[48:51], v[0:3]
s_waitcnt lgkmcnt(6)
v_exp_f32 v99, v147
v_mfma_f32_16x16x32_bf16 v[0:3], a[224:227], a[64:67], v[0:3]
v_exp_f32 v104, v152
v_mfma_f32_16x16x32_bf16 v[0:3], a[228:231], a[72:75], v[0:3]
ds_read_b128 a[248:251], v33
ds_read_b128 a[252:255], v33 offset:2048
v_mfma_f32_16x16x32_bf16 v[4:7], a[228:231], a[76:79], v[4:7]
v_exp_f32 v105, v153
v_mfma_f32_16x16x32_bf16 v[4:7], a[224:227], a[68:71], v[4:7]
s_waitcnt lgkmcnt(6)
v_exp_f32 v106, v154
v_mfma_f32_16x16x32_bf16 v[4:7], a[232:235], a[84:87], v[4:7]
v_exp_f32 v107, v155
v_mfma_f32_16x16x32_bf16 v[4:7], a[236:239], a[92:95], v[4:7]
ds_read_b128 a[224:227], v33 offset:4096
ds_read_b128 a[228:231], v33 offset:6144
v_mfma_f32_16x16x32_bf16 v[0:3], a[236:239], a[88:91], v[0:3]
v_fma_f32 v96, v96, s56, s56
v_fma_f32 v97, v97, s56, s56
v_mfma_f32_16x16x32_bf16 v[0:3], a[232:235], a[80:83], v[0:3]
s_waitcnt lgkmcnt(4)
v_fma_f32 v98, v98, s56, s56
v_fma_f32 v99, v99, s56, s56
v_mfma_f32_16x16x32_bf16 v[0:3], a[240:243], a[96:99], v[0:3]
v_fma_f32 v104, v104, s56, s56
v_fma_f32 v105, v105, s56, s56
v_mfma_f32_16x16x32_bf16 v[0:3], a[244:247], a[104:107], v[0:3]
ds_read_b128 a[232:235], v33 offset:5120
ds_read_b128 a[236:239], v33 offset:7168
v_mfma_f32_16x16x32_bf16 v[4:7], a[244:247], a[108:111], v[4:7]
v_fma_f32 v106, v106, s56, s56
v_fma_f32 v107, v107, s56, s56
v_mfma_f32_16x16x32_bf16 v[4:7], a[240:243], a[100:103], v[4:7]
s_waitcnt lgkmcnt(4)
v_rcp_f32 v96, v96
v_mfma_f32_16x16x32_bf16 v[4:7], a[248:251], a[116:119], v[4:7]
v_rcp_f32 v97, v97
v_mfma_f32_16x16x32_bf16 v[4:7], a[252:255], a[124:127], v[4:7]
ds_read_b128 a[240:243], v33 offset:1024
ds_read_b128 a[244:247], v33 offset:3072
v_mfma_f32_16x16x32_bf16 v[0:3], a[252:255], a[120:123], v[0:3]
v_rcp_f32 v98, v98
v_mfma_f32_16x16x32_bf16 v[0:3], a[248:251], a[112:115], v[0:3]
s_waitcnt lgkmcnt(4)
v_rcp_f32 v99, v99
v_mfma_f32_16x16x32_bf16 v[0:3], a[224:227], a[128:131], v[0:3]
v_rcp_f32 v104, v104
v_mfma_f32_16x16x32_bf16 v[0:3], a[228:231], a[136:139], v[0:3]
ds_read_b128 a[248:251], v32 offset:62464
ds_read_b128 a[252:255], v32 offset:64512
v_mfma_f32_16x16x32_bf16 v[4:7], a[228:231], a[140:143], v[4:7]
v_rcp_f32 v105, v105
v_mfma_f32_16x16x32_bf16 v[4:7], a[224:227], a[132:135], v[4:7]
s_waitcnt lgkmcnt(4)
v_rcp_f32 v106, v106
v_mfma_f32_16x16x32_bf16 v[12:15], a[232:235], a[132:135], v[8:11]
v_rcp_f32 v107, v107
v_mfma_f32_16x16x32_bf16 v[12:15], a[236:239], a[140:143], v[12:15]
ds_read_b128 a[224:227], v32 offset:58368
ds_read_b128 a[228:231], v32 offset:60416
v_mfma_f32_16x16x32_bf16 v[8:11], a[236:239], a[136:139], v[8:11]
v_mul_f32 v144, v144, v96
v_mul_f32 v145, v145, v97
v_mfma_f32_16x16x32_bf16 v[8:11], a[232:235], a[128:131], v[8:11]
s_waitcnt lgkmcnt(4)
v_mul_f32 v146, v146, v98
v_mul_f32 v147, v147, v99
v_mfma_f32_16x16x32_bf16 v[8:11], a[240:243], a[112:115], v[8:11]
v_mul_f32 v152, v152, v104
v_mul_f32 v153, v153, v105
v_mfma_f32_16x16x32_bf16 v[8:11], a[244:247], a[120:123], v[8:11]
ds_read_b128 a[232:235], v32 offset:54272
ds_read_b128 a[236:239], v32 offset:56320
v_mfma_f32_16x16x32_bf16 v[12:15], a[244:247], a[124:127], v[12:15]
v_mul_f32 v154, v154, v106
v_mul_f32 v155, v155, v107
v_mfma_f32_16x16x32_bf16 v[12:15], a[240:243], a[116:119], v[12:15]
s_waitcnt lgkmcnt(4)
v_cvt_pk_bf16_f32 v96, v144, v145
v_cvt_pk_bf16_f32 v97, v146, v147
v_mfma_f32_16x16x32_bf16 v[12:15], a[248:251], a[100:103], v[12:15]
v_cvt_pk_bf16_f32 v98, v152, v153
v_cvt_pk_bf16_f32 v99, v154, v155
v_mfma_f32_16x16x32_bf16 v[12:15], a[252:255], a[108:111], v[12:15]
ds_read_b128 a[240:243], v32 offset:50176
ds_read_b128 a[244:247], v32 offset:52224
v_mfma_f32_16x16x32_bf16 v[8:11], a[252:255], a[104:107], v[8:11]
v_mul_f32 v20, v36, v20
v_mul_f32 v21, v36, v21
v_mfma_f32_16x16x32_bf16 v[8:11], a[248:251], a[96:99], v[8:11]
s_waitcnt lgkmcnt(4)
v_mul_f32 v22, v36, v22
v_mul_f32 v23, v36, v23
v_mfma_f32_16x16x32_bf16 v[8:11], a[224:227], a[80:83], v[8:11]
v_mul_f32 v24, v36, v24
v_mul_f32 v25, v36, v25
v_mfma_f32_16x16x32_bf16 v[8:11], a[228:231], a[88:91], v[8:11]
ds_read_b128 a[248:251], v32 offset:46080
ds_read_b128 a[252:255], v32 offset:48128
v_mfma_f32_16x16x32_bf16 v[12:15], a[228:231], a[92:95], v[12:15]
v_mul_f32 v26, v36, v26
v_mul_f32 v27, v36, v27
v_mfma_f32_16x16x32_bf16 v[12:15], a[224:227], a[84:87], v[12:15]
s_waitcnt lgkmcnt(4)
v_exp_f32 v60, v148
v_mfma_f32_16x16x32_bf16 v[12:15], a[232:235], a[68:71], v[12:15]
v_exp_f32 v61, v149
v_mfma_f32_16x16x32_bf16 v[12:15], a[236:239], a[76:79], v[12:15]
ds_read_b128 a[224:227], v32 offset:41984
ds_read_b128 a[228:231], v32 offset:44032
v_mfma_f32_16x16x32_bf16 v[8:11], a[236:239], a[72:75], v[8:11]
v_exp_f32 v62, v150
v_mfma_f32_16x16x32_bf16 v[8:11], a[232:235], a[64:67], v[8:11]
s_waitcnt lgkmcnt(4)
v_exp_f32 v63, v151
v_mfma_f32_16x16x32_bf16 v[8:11], a[240:243], a[48:51], v[8:11]
v_exp_f32 v52, v156
v_mfma_f32_16x16x32_bf16 v[8:11], a[244:247], a[56:59], v[8:11]
ds_read_b128 a[232:235], v32 offset:37888
ds_read_b128 a[236:239], v32 offset:39936
v_mfma_f32_16x16x32_bf16 v[12:15], a[244:247], a[60:63], v[12:15]
v_exp_f32 v53, v157
v_mfma_f32_16x16x32_bf16 v[12:15], a[240:243], a[52:55], v[12:15]
s_waitcnt lgkmcnt(4)
v_exp_f32 v54, v158
v_mfma_f32_16x16x32_bf16 v[12:15], a[248:251], a[36:39], v[12:15]
v_exp_f32_e64 v55, v159
v_mfma_f32_16x16x32_bf16 v[12:15], a[252:255], a[44:47], v[12:15]
s_waitcnt vmcnt(2)
s_barrier
ds_read_b128 a[240:243], v33 offset:8192
ds_read_b128 a[244:247], v33 offset:10240
L_pg16:
s_cbranch_vccnz L_vr3
v_pk_fma_f32 v[60:61], v[60:61], s[56:57], s[56:57]
v_pk_fma_f32 v[62:63], v[62:63], s[56:57], s[56:57]
v_pk_fma_f32 v[52:53], v[52:53], s[56:57], s[56:57]
v_pk_fma_f32 v[54:55], v[54:55], s[56:57], s[56:57]
v_mfma_f32_16x16x32_bf16 v[8:11], a[252:255], a[40:43], v[8:11]
v_rcp_f32 v60, v60
v_mfma_f32_16x16x32_bf16 v[8:11], a[248:251], a[32:35], v[8:11]
s_waitcnt lgkmcnt(4)
v_rcp_f32 v61, v61
v_mfma_f32_16x16x32_bf16 v[8:11], a[224:227], a[16:19], v[8:11]
v_rcp_f32 v62, v62
v_mfma_f32_16x16x32_bf16 v[8:11], a[228:231], a[24:27], v[8:11]
ds_read_b128 a[248:251], v33 offset:12288
ds_read_b128 a[252:255], v33 offset:14336
v_mfma_f32_16x16x32_bf16 v[12:15], a[228:231], a[28:31], v[12:15]
v_rcp_f32 v63, v63
v_mfma_f32_16x16x32_bf16 v[12:15], a[224:227], a[20:23], v[12:15]
s_waitcnt lgkmcnt(4)
v_rcp_f32 v52, v52
v_mfma_f32_16x16x32_bf16 v[12:15], a[232:235], a[4:7], v[12:15]
buffer_store_dwordx4 v[96:99], v37, s[24:27], s49 offen offset:1536 sc1
v_rcp_f32 v53, v53
v_rcp_f32 v54, v54
v_rcp_f32_e64 v55, v55
v_pk_mul_f32 v[148:149], v[148:149], v[60:61]
v_pk_mul_f32 v[150:151], v[150:151], v[62:63]
v_pk_mul_f32 v[156:157], v[156:157], v[52:53]
v_pk_mul_f32 v[158:159], v[158:159], v[54:55]
v_mfma_f32_16x16x32_bf16 v[12:15], a[236:239], a[12:15], v[12:15]
ds_read_b128 a[224:227], v33 offset:16384
ds_read_b128 a[228:231], v33 offset:18432
v_mfma_f32_16x16x32_bf16 v[8:11], a[236:239], a[8:11], v[8:11]
v_cvt_pk_bf16_f32 v60, v148, v149
v_cvt_pk_bf16_f32 v61, v150, v151
v_mfma_f32_16x16x32_bf16 v[8:11], a[232:235], a[0:3], v[8:11]
s_waitcnt lgkmcnt(4)
v_cvt_pk_bf16_f32 v62, v156, v157
v_cvt_pk_bf16_f32 v63, v158, v159
v_mfma_f32_16x16x32_bf16 v[16:19], a[240:243], a[0:3], v[20:23]
v_sub_f32_dpp v0, v0, v0 row_shl:1 row_mask:0xf bank_mask:0xf bound_ctrl:1
v_sub_f32_dpp v1, v1, v1 row_shl:1 row_mask:0xf bank_mask:0xf bound_ctrl:1
v_mfma_f32_16x16x32_bf16 v[16:19], a[244:247], a[8:11], v[16:19]
ds_read_b128 a[232:235], v33 offset:20480
ds_read_b128 a[236:239], v33 offset:22528
v_mfma_f32_16x16x32_bf16 v[20:23], a[244:247], a[12:15], v[20:23]
v_sub_f32_dpp v2, v2, v2 row_shl:1 row_mask:0xf bank_mask:0xf bound_ctrl:1
v_sub_f32_dpp v3, v3, v3 row_shl:1 row_mask:0xf bank_mask:0xf bound_ctrl:1
v_mfma_f32_16x16x32_bf16 v[20:23], a[240:243], a[4:7], v[20:23]
s_waitcnt lgkmcnt(4)
v_sub_f32_dpp v4, v4, v4 row_shl:1 row_mask:0xf bank_mask:0xf bound_ctrl:1
v_sub_f32_dpp v5, v5, v5 row_shl:1 row_mask:0xf bank_mask:0xf bound_ctrl:1
v_mfma_f32_16x16x32_bf16 v[20:23], a[248:251], a[20:23], v[20:23]
v_sub_f32_dpp v6, v6, v6 row_shl:1 row_mask:0xf bank_mask:0xf bound_ctrl:1
v_sub_f32_dpp v7, v7, v7 row_shl:1 row_mask:0xf bank_mask:0xf bound_ctrl:1
v_mfma_f32_16x16x32_bf16 v[20:23], a[252:255], a[28:31], v[20:23]
ds_read_b128 a[240:243], v33 offset:24576
ds_read_b128 a[244:247], v33 offset:26624
v_mfma_f32_16x16x32_bf16 v[16:19], a[252:255], a[24:27], v[16:19]
v_sub_f32_dpp v12, v12, v12 row_shl:1 row_mask:0xf bank_mask:0xf bound_ctrl:1
v_sub_f32_dpp v13, v13, v13 row_shl:1 row_mask:0xf bank_mask:0xf bound_ctrl:1
v_mfma_f32_16x16x32_bf16 v[16:19], a[248:251], a[16:19], v[16:19]
s_waitcnt lgkmcnt(4)
v_sub_f32_dpp v14, v14, v14 row_shl:1 row_mask:0xf bank_mask:0xf bound_ctrl:1
v_sub_f32_dpp v15, v15, v15 row_shl:1 row_mask:0xf bank_mask:0xf bound_ctrl:1
v_mfma_f32_16x16x32_bf16 v[16:19], a[224:227], a[32:35], v[16:19]
v_sub_f32_dpp v8, v8, v8 row_shl:1 row_mask:0xf bank_mask:0xf bound_ctrl:1
v_sub_f32_dpp v9, v9, v9 row_shl:1 row_mask:0xf bank_mask:0xf bound_ctrl:1
v_mfma_f32_16x16x32_bf16 v[16:19], a[228:231], a[40:43], v[16:19]
s_waitcnt vmcnt(63)
ds_read_b128 a[248:251], v33 offset:28672
ds_read_b128 a[252:255], v33 offset:30720
buffer_store_dwordx4 v[60:63], v37, s[24:27], s50 offen offset:1536 sc1
v_sub_f32_dpp v10, v10, v10 row_shl:1 row_mask:0xf bank_mask:0xf bound_ctrl:1
v_sub_f32_dpp v11, v11, v11 row_shl:1 row_mask:0xf bank_mask:0xf bound_ctrl:1
v_pk_add_f32 v[160:161], v[160:161], v[0:1]
v_pk_add_f32 v[162:163], v[162:163], v[2:3]
v_pk_add_f32 v[168:169], v[168:169], v[8:9]
v_pk_add_f32 v[170:171], v[170:171], v[10:11]
v_pk_add_f32 v[164:165], v[164:165], v[4:5]
v_pk_add_f32 v[166:167], v[166:167], v[6:7]
v_pk_add_f32 v[172:173], v[172:173], v[12:13]
v_pk_add_f32 v[174:175], v[174:175], v[14:15]
v_mfma_f32_16x16x32_bf16 v[20:23], a[228:231], a[44:47], v[20:23]
v_exp_f32 v100, v160
v_mfma_f32_16x16x32_bf16 v[20:23], a[224:227], a[36:39], v[20:23]
s_waitcnt lgkmcnt(4)
v_exp_f32 v101, v161
v_mfma_f32_16x16x32_bf16 v[20:23], a[232:235], a[52:55], v[20:23]
v_exp_f32 v102, v162
v_mfma_f32_16x16x32_bf16 v[20:23], a[236:239], a[60:63], v[20:23]
ds_read_b128 a[224:227], v33 offset:32768
ds_read_b128 a[228:231], v33 offset:34816
v_mfma_f32_16x16x32_bf16 v[16:19], a[236:239], a[56:59], v[16:19]
v_exp_f32 v103, v163
v_mfma_f32_16x16x32_bf16 v[16:19], a[232:235], a[48:51], v[16:19]
s_waitcnt lgkmcnt(4)
v_exp_f32 v108, v168
v_mfma_f32_16x16x32_bf16 v[16:19], a[240:243], a[64:67], v[16:19]
v_exp_f32 v109, v169
v_mfma_f32_16x16x32_bf16 v[16:19], a[244:247], a[72:75], v[16:19]
ds_read_b128 a[232:235], v33 offset:36864
ds_read_b128 a[236:239], v33 offset:38912
v_mfma_f32_16x16x32_bf16 v[20:23], a[244:247], a[76:79], v[20:23]
v_exp_f32 v110, v170
v_mfma_f32_16x16x32_bf16 v[20:23], a[240:243], a[68:71], v[20:23]
s_waitcnt lgkmcnt(4)
v_exp_f32 v111, v171
v_mfma_f32_16x16x32_bf16 v[20:23], a[248:251], a[84:87], v[20:23]
v_fma_f32 v100, v100, s56, s56
v_fma_f32 v101, v101, s56, s56
v_mfma_f32_16x16x32_bf16 v[20:23], a[252:255], a[92:95], v[20:23]
ds_read_b128 a[240:243], v33 offset:40960
ds_read_b128 a[244:247], v33 offset:43008
v_mfma_f32_16x16x32_bf16 v[16:19], a[252:255], a[88:91], v[16:19]
v_fma_f32 v102, v102, s56, s56
v_fma_f32 v103, v103, s56, s56
v_mfma_f32_16x16x32_bf16 v[16:19], a[248:251], a[80:83], v[16:19]
s_waitcnt lgkmcnt(4)
v_fma_f32 v108, v108, s56, s56
v_fma_f32 v109, v109, s56, s56
v_mfma_f32_16x16x32_bf16 v[16:19], a[224:227], a[96:99], v[16:19]
v_fma_f32 v110, v110, s56, s56
v_fma_f32 v111, v111, s56, s56
v_mfma_f32_16x16x32_bf16 v[16:19], a[228:231], a[104:107], v[16:19]
ds_read_b128 a[248:251], v33 offset:41984
ds_read_b128 a[252:255], v33 offset:44032
v_mfma_f32_16x16x32_bf16 v[20:23], a[228:231], a[108:111], v[20:23]
v_rcp_f32 v100, v100
v_mfma_f32_16x16x32_bf16 v[20:23], a[224:227], a[100:103], v[20:23]
s_waitcnt lgkmcnt(4)
v_rcp_f32 v101, v101
v_mfma_f32_16x16x32_bf16 v[20:23], a[232:235], a[116:119], v[20:23]
v_rcp_f32 v102, v102
v_mfma_f32_16x16x32_bf16 v[20:23], a[236:239], a[124:127], v[20:23]
ds_read_b128 a[224:227], v33 offset:37888
ds_read_b128 a[228:231], v33 offset:39936
v_mfma_f32_16x16x32_bf16 v[16:19], a[236:239], a[120:123], v[16:19]
v_rcp_f32 v103, v103
v_mfma_f32_16x16x32_bf16 v[16:19], a[232:235], a[112:115], v[16:19]
s_waitcnt lgkmcnt(4)
v_rcp_f32 v108, v108
v_mfma_f32_16x16x32_bf16 v[16:19], a[240:243], a[128:131], v[16:19]
v_rcp_f32 v109, v109
v_mfma_f32_16x16x32_bf16 v[16:19], a[244:247], a[136:139], v[16:19]
ds_read_b128 a[232:235], v33 offset:33792
ds_read_b128 a[236:239], v33 offset:35840
v_rcp_f32 v110, v110
v_rcp_f32 v111, v111
v_pk_mul_f32 v[160:161], v[160:161], v[100:101]
v_pk_mul_f32 v[162:163], v[162:163], v[102:103]
v_pk_mul_f32 v[168:169], v[168:169], v[108:109]
v_pk_mul_f32 v[170:171], v[170:171], v[110:111]
v_mfma_f32_16x16x32_bf16 v[20:23], a[244:247], a[140:143], v[20:23]
v_cvt_pk_bf16_f32 v100, v160, v161
v_cvt_pk_bf16_f32 v101, v162, v163
v_mfma_f32_16x16x32_bf16 v[20:23], a[240:243], a[132:135], v[20:23]
s_waitcnt lgkmcnt(4)
v_cvt_pk_bf16_f32 v102, v168, v169
v_cvt_pk_bf16_f32 v103, v170, v171
v_mfma_f32_16x16x32_bf16 v[28:31], a[248:251], a[132:135], v[24:27]
v_exp_f32 v244, v164
v_mfma_f32_16x16x32_bf16 v[28:31], a[252:255], a[140:143], v[28:31]
ds_read_b128 a[240:243], v33 offset:29696
ds_read_b128 a[244:247], v33 offset:31744
v_mfma_f32_16x16x32_bf16 v[24:27], a[252:255], a[136:139], v[24:27]
v_exp_f32 v245, v165
v_mfma_f32_16x16x32_bf16 v[24:27], a[248:251], a[128:131], v[24:27]
s_waitcnt lgkmcnt(4)
v_exp_f32 v246, v166
v_mfma_f32_16x16x32_bf16 v[24:27], a[224:227], a[112:115], v[24:27]
v_exp_f32 v247, v167
v_mfma_f32_16x16x32_bf16 v[24:27], a[228:231], a[120:123], v[24:27]
ds_read_b128 a[248:251], v33 offset:25600
ds_read_b128 a[252:255], v33 offset:27648
v_mfma_f32_16x16x32_bf16 v[28:31], a[228:231], a[124:127], v[28:31]
v_exp_f32 v200, v172
v_mfma_f32_16x16x32_bf16 v[28:31], a[224:227], a[116:119], v[28:31]
s_waitcnt lgkmcnt(4)
buffer_store_dwordx4 v[100:103], v37, s[24:27], s49 offen offset:1600 sc1
v_exp_f32 v201, v173
v_exp_f32 v202, v174
v_exp_f32_e64 v203, v175
v_pk_fma_f32 v[244:245], v[244:245], s[56:57], s[56:57]
v_pk_fma_f32 v[246:247], v[246:247], s[56:57], s[56:57]
v_pk_fma_f32 v[200:201], v[200:201], s[56:57], s[56:57]
v_pk_fma_f32 v[202:203], v[202:203], s[56:57], s[56:57]
v_mfma_f32_16x16x32_bf16 v[28:31], a[232:235], a[100:103], v[28:31]
v_rcp_f32 v244, v244
v_mfma_f32_16x16x32_bf16 v[28:31], a[236:239], a[108:111], v[28:31]
ds_read_b128 a[224:227], v33 offset:21504
ds_read_b128 a[228:231], v33 offset:23552
v_mfma_f32_16x16x32_bf16 v[24:27], a[236:239], a[104:107], v[24:27]
v_rcp_f32 v245, v245
v_mfma_f32_16x16x32_bf16 v[24:27], a[232:235], a[96:99], v[24:27]
s_waitcnt lgkmcnt(4)
v_rcp_f32 v246, v246
v_mfma_f32_16x16x32_bf16 v[24:27], a[240:243], a[80:83], v[24:27]
v_rcp_f32 v247, v247
v_mfma_f32_16x16x32_bf16 v[24:27], a[244:247], a[88:91], v[24:27]
ds_read_b128 a[232:235], v33 offset:17408
ds_read_b128 a[236:239], v33 offset:19456
v_mfma_f32_16x16x32_bf16 v[28:31], a[244:247], a[92:95], v[28:31]
v_rcp_f32 v200, v200
v_mfma_f32_16x16x32_bf16 v[28:31], a[240:243], a[84:87], v[28:31]
s_waitcnt lgkmcnt(4)
v_rcp_f32 v201, v201
v_mfma_f32_16x16x32_bf16 v[28:31], a[248:251], a[68:71], v[28:31]
v_rcp_f32 v202, v202
v_mfma_f32_16x16x32_bf16 v[28:31], a[252:255], a[76:79], v[28:31]
ds_read_b128 a[240:243], v33 offset:13312
ds_read_b128 a[244:247], v33 offset:15360
v_mfma_f32_16x16x32_bf16 v[24:27], a[252:255], a[72:75], v[24:27]
v_rcp_f32 v203, v203
v_mfma_f32_16x16x32_bf16 v[24:27], a[248:251], a[64:67], v[24:27]
s_waitcnt lgkmcnt(4)
v_mul_f32 v164, v164, v244
v_mul_f32 v165, v165, v245
v_mfma_f32_16x16x32_bf16 v[24:27], a[224:227], a[48:51], v[24:27]
v_mul_f32 v166, v166, v246
v_mul_f32 v167, v167, v247
v_mfma_f32_16x16x32_bf16 v[24:27], a[228:231], a[56:59], v[24:27]
ds_read_b128 a[248:251], v33 offset:9216
ds_read_b128 a[252:255], v33 offset:11264
v_mfma_f32_16x16x32_bf16 v[28:31], a[228:231], a[60:63], v[28:31]
v_mul_f32 v172, v172, v200
v_mul_f32 v173, v173, v201
v_mfma_f32_16x16x32_bf16 v[28:31], a[224:227], a[52:55], v[28:31]
s_waitcnt lgkmcnt(4)
v_mul_f32 v174, v174, v202
v_mul_f32 v175, v175, v203
v_mfma_f32_16x16x32_bf16 v[28:31], a[232:235], a[36:39], v[28:31]
v_cvt_pk_bf16_f32 v244, v164, v165
v_cvt_pk_bf16_f32 v245, v166, v167
v_mfma_f32_16x16x32_bf16 v[28:31], a[236:239], a[44:47], v[28:31]
v_cvt_pk_bf16_f32 v246, v172, v173
v_cvt_pk_bf16_f32 v247, v174, v175
v_sub_f32_dpp v20, v20, v20 row_shl:1 row_mask:0xf bank_mask:0xf bound_ctrl:1
v_sub_f32_dpp v21, v21, v21 row_shl:1 row_mask:0xf bank_mask:0xf bound_ctrl:1
v_sub_f32_dpp v22, v22, v22 row_shl:1 row_mask:0xf bank_mask:0xf bound_ctrl:1
v_sub_f32_dpp v23, v23, v23 row_shl:1 row_mask:0xf bank_mask:0xf bound_ctrl:1
v_pk_add_f32 v[180:181], v[180:181], v[20:21]
v_mfma_f32_16x16x32_bf16 v[24:27], a[236:239], a[40:43], v[24:27]
v_add_f32 v182, v182, v22
v_add_f32 v183, v183, v23
v_mfma_f32_16x16x32_bf16 v[24:27], a[232:235], a[32:35], v[24:27]
s_waitcnt lgkmcnt(2)
v_exp_f32 v224, v180
v_mfma_f32_16x16x32_bf16 v[24:27], a[240:243], a[16:19], v[24:27]
v_exp_f32 v225, v181
v_mfma_f32_16x16x32_bf16 v[24:27], a[244:247], a[24:27], v[24:27]
buffer_store_dwordx4 v[244:247], v37, s[24:27], s50 offen offset:1600 sc1
v_exp_f32 v226, v182
v_exp_f32 v227, v183
v_pk_fma_f32 v[224:225], v[224:225], s[56:57], s[56:57]
v_pk_fma_f32 v[226:227], v[226:227], s[56:57], s[56:57]
v_rcp_f32 v224, v224
v_rcp_f32 v225, v225
v_mfma_f32_16x16x32_bf16 v[28:31], a[244:247], a[28:31], v[28:31]
v_rcp_f32 v226, v226
v_mfma_f32_16x16x32_bf16 v[28:31], a[240:243], a[20:23], v[28:31]
s_waitcnt lgkmcnt(0)
v_rcp_f32 v227, v227
v_mfma_f32_16x16x32_bf16 v[28:31], a[248:251], a[4:7], v[28:31]
v_mul_f32 v180, v180, v224
v_mul_f32 v181, v181, v225
v_mfma_f32_16x16x32_bf16 v[28:31], a[252:255], a[12:15], v[28:31]
v_mul_f32 v182, v182, v226
v_mul_f32 v183, v183, v227
v_mfma_f32_16x16x32_bf16 v[24:27], a[252:255], a[8:11], v[24:27]
v_cvt_pk_bf16_f32 v224, v180, v181
v_cvt_pk_bf16_f32 v225, v182, v183
v_mfma_f32_16x16x32_bf16 v[24:27], a[248:251], a[0:3], v[24:27]
s_nop 1
v_sub_f32_dpp v28, v28, v28 row_shl:1 row_mask:0xf bank_mask:0xf bound_ctrl:1
v_sub_f32_dpp v29, v29, v29 row_shl:1 row_mask:0xf bank_mask:0xf bound_ctrl:1
v_sub_f32_dpp v30, v30, v30 row_shl:1 row_mask:0xf bank_mask:0xf bound_ctrl:1
v_sub_f32_dpp v31, v31, v31 row_shl:1 row_mask:0xf bank_mask:0xf bound_ctrl:1
v_pk_add_f32 v[188:189], v[188:189], v[28:29]
v_pk_add_f32 v[190:191], v[190:191], v[30:31]
v_exp_f32 v216, v188
v_exp_f32 v217, v189
v_exp_f32 v218, v190
v_exp_f32 v219, v191
v_pk_fma_f32 v[216:217], v[216:217], s[56:57], s[56:57]
v_pk_fma_f32 v[218:219], v[218:219], s[56:57], s[56:57]
v_rcp_f32 v216, v216
v_rcp_f32 v217, v217
v_rcp_f32 v218, v218
v_rcp_f32_e64 v219, v219
v_pk_mul_f32 v[188:189], v[188:189], v[216:217]
v_pk_mul_f32 v[190:191], v[190:191], v[218:219]
v_cvt_pk_bf16_f32 v226, v188, v189
v_cvt_pk_bf16_f32 v227, v190, v191
buffer_store_dwordx4 v[224:227], v37, s[24:27], s59 offen offset:1664 sc1
v_sub_f32_dpp v16, v16, v16 row_shl:1 row_mask:0xf bank_mask:0xf bound_ctrl:1
v_sub_f32_dpp v17, v17, v17 row_shl:1 row_mask:0xf bank_mask:0xf bound_ctrl:1
v_sub_f32_dpp v18, v18, v18 row_shl:1 row_mask:0xf bank_mask:0xf bound_ctrl:1
v_sub_f32_dpp v19, v19, v19 row_shl:1 row_mask:0xf bank_mask:0xf bound_ctrl:1
v_sub_f32_dpp v24, v24, v24 row_shl:1 row_mask:0xf bank_mask:0xf bound_ctrl:1
v_sub_f32_dpp v25, v25, v25 row_shl:1 row_mask:0xf bank_mask:0xf bound_ctrl:1
v_sub_f32_dpp v26, v26, v26 row_shl:1 row_mask:0xf bank_mask:0xf bound_ctrl:1
v_sub_f32_dpp v27, v27, v27 row_shl:1 row_mask:0xf bank_mask:0xf bound_ctrl:1
v_pk_add_f32 v[176:177], v[176:177], v[16:17]
v_pk_add_f32 v[178:179], v[178:179], v[18:19]
v_pk_add_f32 v[184:185], v[184:185], v[24:25]
v_pk_add_f32 v[186:187], v[186:187], v[26:27]
v_exp_f32 v252, v176
v_exp_f32 v253, v177
v_exp_f32 v254, v178
v_exp_f32 v255, v179
v_exp_f32 v232, v184
v_exp_f32 v233, v185
v_exp_f32 v234, v186
v_exp_f32 v235, v187
v_pk_fma_f32 v[252:253], v[252:253], s[56:57], s[56:57]
v_pk_fma_f32 v[254:255], v[254:255], s[56:57], s[56:57]
v_pk_fma_f32 v[232:233], v[232:233], s[56:57], s[56:57]
v_pk_fma_f32 v[234:235], v[234:235], s[56:57], s[56:57]
v_rcp_f32 v252, v252
v_rcp_f32 v253, v253
v_rcp_f32 v254, v254
v_rcp_f32 v255, v255
v_rcp_f32 v232, v232
v_rcp_f32 v233, v233
v_rcp_f32 v234, v234
v_rcp_f32 v235, v235
v_pk_mul_f32 v[176:177], v[176:177], v[252:253]
v_pk_mul_f32 v[178:179], v[178:179], v[254:255]
v_pk_mul_f32 v[184:185], v[184:185], v[232:233]
v_pk_mul_f32 v[186:187], v[186:187], v[234:235]
v_cvt_pk_bf16_f32 v252, v176, v177
v_cvt_pk_bf16_f32 v253, v178, v179
v_cvt_pk_bf16_f32 v254, v184, v185
v_cvt_pk_bf16_f32 v255, v186, v187
buffer_store_dwordx4 v[252:255], v37, s[24:27], s58 offen offset:1664 sc1
s_endpgm
L_slow:
s_mov_b32 s7, 4000
L_spin:
v_mov_b32 v252, 0
buffer_load_dword v252, v252, s[28:31], 0 offen sc1
s_waitcnt vmcnt(0) lgkmcnt(0)
v_readfirstlane_b32 s3, v252
s_sub_u32 s7, s7, 1
s_cmp_ge_u32 s3, 90
s_cbranch_scc1 L_back
s_cmp_lg_u32 s7, 0
s_cbranch_scc1 L_spin
s_mov_b32 s58, 0
v_lshrrev_b32 v242, 9, v32
v_bfe_u32 v238, v32, 8, 1
v_and_b32 v243, 255, v32
v_lshl_add_u32 v243, v238, 10, v243
v_bfe_u32 v239, v32, 6, 2
v_lshl_add_u32 v239, v242, 2, v239
v_lshl_add_u32 v239, v239, 1, v238
v_bfe_u32 v238, v32, 4, 2
v_lshl_add_u32 v239, v239, 2, v238
v_lshlrev_b32 v239, 1, v239
v_mov_b32 v238, 0
v_mul_u32_u24 v238, 9216, v238
v_add_u32 v238, v238, v239
L_fn:
s_mov_b32 s59, 0
L_fk:
s_cmp_lt_u32 s58, 16
s_cselect_b32 s4, s41, 0
s_lshr_b32 s3, s58, 2
s_and_b32 s62, s58, 3
s_mul_i32 s5, s4, 5
s_add_u32 s5, s5, s3
s_lshl_b32 s5, s5, 7
s_lshl2_add_u32 s60, s59, s62
s_mul_i32 s60, s60, 9216
s_add_u32 s60, s60, s5
s_mul_i32 s4, s4, 995328
s_lshl_b32 s62, s62, 8
s_add_u32 s4, s4, s62
s_mul_i32 s61, s59, 9
s_add_u32 s61, s61, s3
s_lshl_b32 s61, s61, 12
s_add_u32 s61, s61, s4
s_mul_i32 s62, s3, 36
s_add_u32 s62, s62, s59
s_lshl_b32 s62, s62, 11
s_add_u32 s62, s62, s4
s_add_u32 s62, s62, 663552
s_cmp_lt_u32 s58, 16
s_mov_b32 s3, 995328
s_cselect_b32 s4, 36864, s3
s_cselect_b32 s3, 2048, s3
v_mad_u32_u24 v240, v242, s3, v243
v_mad_u32_u24 v241, v242, s4, v243
v_add_u32 v255, s5, v239
global_load_ushort v253, v255, s[70:71]
global_load_ushort v254, v255, s[72:73]
buffer_load_ushort v200, v238, s[12:15], s60 offen
s_add_u32 s60, s60, 1152
buffer_load_ushort v201, v238, s[12:15], s60 offen
s_add_u32 s60, s60, 1152
buffer_load_ushort v202, v238, s[12:15], s60 offen
s_add_u32 s60, s60, 1152
buffer_load_ushort v203, v238, s[12:15], s60 offen
s_add_u32 s60, s60, 1152
buffer_load_ushort v204, v238, s[12:15], s60 offen
s_add_u32 s60, s60, 1152
buffer_load_ushort v205, v238, s[12:15], s60 offen
s_add_u32 s60, s60, 1152
buffer_load_ushort v206, v238, s[12:15], s60 offen
s_add_u32 s60, s60, 1152
buffer_load_ushort v207, v238, s[12:15], s60 offen
s_add_u32 s60, s60, 655488
buffer_load_ushort v208, v238, s[12:15], s60 offen
s_add_u32 s60, s60, 1152
buffer_load_ushort v209, v238, s[12:15], s60 offen
s_add_u32 s60, s60, 1152
buffer_load_ushort v210, v238, s[12:15], s60 offen
s_add_u32 s60, s60, 1152
buffer_load_ushort v211, v238, s[12:15], s60 offen
s_add_u32 s60, s60, 1152
buffer_load_ushort v212, v238, s[12:15], s60 offen
s_add_u32 s60, s60, 1152
buffer_load_ushort v213, v238, s[12:15], s60 offen
s_add_u32 s60, s60, 1152
buffer_load_ushort v214, v238, s[12:15], s60 offen
s_add_u32 s60, s60, 1152
buffer_load_ushort v215, v238, s[12:15], s60 offen
s_add_u32 s60, s60, 655488
buffer_load_ushort v216, v238, s[12:15], s60 offen
s_add_u32 s60, s60, 1152
buffer_load_ushort v217, v238, s[12:15], s60 offen
s_add_u32 s60, s60, 1152
buffer_load_ushort v218, v238, s[12:15], s60 offen
s_add_u32 s60, s60, 1152
buffer_load_ushort v219, v238, s[12:15], s60 offen
s_add_u32 s60, s60, 1152
buffer_load_ushort v220, v238, s[12:15], s60 offen
s_add_u32 s60, s60, 1152
buffer_load_ushort v221, v238, s[12:15], s60 offen
s_add_u32 s60, s60, 1152
buffer_load_ushort v222, v238, s[12:15], s60 offen
s_add_u32 s60, s60, 1152
buffer_load_ushort v223, v238, s[12:15], s60 offen
s_add_u32 s60, s60, 655488
s_add_u32 s60, s61, 18432
s_waitcnt vmcnt(0) lgkmcnt(0)
v_lshlrev_b32 v200, 16, v200
v_lshlrev_b32 v201, 16, v201
v_lshlrev_b32 v202, 16, v202
v_lshlrev_b32 v203, 16, v203
v_lshlrev_b32 v204, 16, v204
v_lshlrev_b32 v205, 16, v205
v_lshlrev_b32 v206, 16, v206
v_lshlrev_b32 v207, 16, v207
v_lshlrev_b32 v208, 16, v208
v_lshlrev_b32 v209, 16, v209
v_lshlrev_b32 v210, 16, v210
v_lshlrev_b32 v211, 16, v211
v_lshlrev_b32 v212, 16, v212
v_lshlrev_b32 v213, 16, v213
v_lshlrev_b32 v214, 16, v214
v_lshlrev_b32 v215, 16, v215
v_lshlrev_b32 v216, 16, v216
v_lshlrev_b32 v217, 16, v217
v_lshlrev_b32 v218, 16, v218
v_lshlrev_b32 v219, 16, v219
v_lshlrev_b32 v220, 16, v220
v_lshlrev_b32 v221, 16, v221
v_lshlrev_b32 v222, 16, v222
v_lshlrev_b32 v223, 16, v223
v_lshlrev_b32 v253, 16, v253
v_lshlrev_b32 v254, 16, v254
v_add_f32 v253, 0x3727c5ac, v253
v_cvt_pk_bf16_f32 v253, v253, v253
v_and_b32 v253, s55, v253
v_sqrt_f32 v253, v253
s_nop 0
v_cvt_pk_bf16_f32 v253, v253, v253
v_and_b32 v253, s55, v253
v_rcp_f32 v253, v253
s_nop 0
v_cvt_pk_bf16_f32 v253, v253, v253
v_and_b32 v253, s55, v253
v_mul_f32 v253, v254, v253
v_cvt_pk_bf16_f32 v253, v253, v253
v_and_b32 v253, s55, v253
v_mul_f32 v253, 0xbf38aa3b, v253
v_add_f32 v200, v200, v216
v_add_f32 v201, v201, v217
v_mul_f32 v200, v200, v253
v_mul_f32 v201, v201, v253
v_mul_f32 v216, v216, v253
v_mul_f32 v217, v217, v253
v_fma_f32 v236, v208, v253, v200
v_fma_f32 v237, v209, v253, v201
v_fma_f32 v200, -v208, v253, v200
v_fma_f32 v201, -v209, v253, v201
v_add_f32 v216, v216, v216
v_add_f32 v217, v217, v217
v_cvt_pk_bf16_f32 v224, v236, v237
v_cvt_pk_bf16_f32 v228, v200, v201
v_cvt_pk_bf16_f32 v232, v216, v217
v_add_f32 v202, v202, v218
v_add_f32 v203, v203, v219
v_mul_f32 v202, v202, v253
v_mul_f32 v203, v203, v253
v_mul_f32 v218, v218, v253
v_mul_f32 v219, v219, v253
v_fma_f32 v236, v210, v253, v202
v_fma_f32 v237, v211, v253, v203
v_fma_f32 v202, -v210, v253, v202
v_fma_f32 v203, -v211, v253, v203
v_add_f32 v218, v218, v218
v_add_f32 v219, v219, v219
v_cvt_pk_bf16_f32 v225, v236, v237
v_cvt_pk_bf16_f32 v229, v202, v203
v_cvt_pk_bf16_f32 v233, v218, v219
v_add_f32 v204, v204, v220
v_add_f32 v205, v205, v221
v_mul_f32 v204, v204, v253
v_mul_f32 v205, v205, v253
v_mul_f32 v220, v220, v253
v_mul_f32 v221, v221, v253
v_fma_f32 v236, v212, v253, v204
v_fma_f32 v237, v213, v253, v205
v_fma_f32 v204, -v212, v253, v204
v_fma_f32 v205, -v213, v253, v205
v_add_f32 v220, v220, v220
v_add_f32 v221, v221, v221
v_cvt_pk_bf16_f32 v226, v236, v237
v_cvt_pk_bf16_f32 v230, v204, v205
v_cvt_pk_bf16_f32 v234, v220, v221
v_add_f32 v206, v206, v222
v_add_f32 v207, v207, v223
v_mul_f32 v206, v206, v253
v_mul_f32 v207, v207, v253
v_mul_f32 v222, v222, v253
v_mul_f32 v223, v223, v253
v_fma_f32 v236, v214, v253, v206
v_fma_f32 v237, v215, v253, v207
v_fma_f32 v206, -v214, v253, v206
v_fma_f32 v207, -v215, v253, v207
v_add_f32 v222, v222, v222
v_add_f32 v223, v223, v223
v_cvt_pk_bf16_f32 v227, v236, v237
v_cvt_pk_bf16_f32 v231, v206, v207
v_cvt_pk_bf16_f32 v235, v222, v223
buffer_store_dwordx4 v[224:227], v240, s[16:19], s61 offen sc1
buffer_store_dwordx4 v[228:231], v240, s[16:19], s60 offen sc1
buffer_store_dwordx4 v[232:235], v241, s[16:19], s62 offen sc1
s_waitcnt vmcnt(0) lgkmcnt(0)
s_add_u32 s59, s59, 1
s_cmp_lt_u32 s59, 18
s_cbranch_scc1 L_fk
s_add_u32 s58, s58, 1
s_cmp_lt_u32 s58, 20
s_cbranch_scc1 L_fn
s_branch L_back
L_codeend:
s_endpgm
.section .rodata,"a"
.p2align 6
.amdhsa_kernel standalone__batchnorm__sampling_kernel
  .amdhsa_next_free_vgpr 512
  .amdhsa_next_free_sgpr 102
  .amdhsa_accum_offset 256
  .amdhsa_group_segment_fixed_size 0
  .amdhsa_kernarg_size 72
  .amdhsa_user_sgpr_count 2
  .amdhsa_user_sgpr_kernarg_segment_ptr 1
  .amdhsa_system_sgpr_workgroup_id_x 1
.end_amdhsa_kernel
```
